```python
import torch

def _softmax(x, axis=-1):
    return torch.softmax(x, dim=axis)

def _gelu(x):
    return torch.nn.functional.gelu(x, approximate='tanh')

def _silu(x):
    return torch.nn.functional.silu(x)

def _sigmoid(x):
    return torch.sigmoid(x)

def _layernorm(x, axis=-1, eps=1e-05):
    m = x.mean(dim=axis, keepdim=True)
    v = x.var(dim=axis, keepdim=True, unbiased=False)
    return (x - m) / torch.sqrt(v + eps)

def _scatter_add(tgt, idx, src, axis=0):
    return tgt.clone().index_add_(axis, idx, src)

def _segment_sum(src, seg, n):
    out = torch.zeros((n,) + src.shape[1:], dtype=src.dtype)
    return out.index_add_(0, seg, src)

def _pad(x, pw):
    flat = tuple((v for pair in reversed(pw) for v in pair))
    return torch.nn.functional.pad(x, flat)
kernel_name = 'adaLN_cond__softmax_full_mha__mixer_gmlp__prompt'

def setup_inputs():

    _w = lambda a: (lambda t: t.to(torch.bfloat16) if t.is_floating_point() else t)(torch.as_tensor(a))

    def _A_setup():
        B, S, D = (1, 2048, 640)
        return {'x': _w((lambda *s: torch.randn(*s, dtype=torch.bfloat16) * 0.05)(B, S, D)), 'wqkv': _w((lambda *s: torch.randn(*s, dtype=torch.bfloat16) * 0.05)(D, 3 * D)), 'wo': _w((lambda *s: torch.randn(*s, dtype=torch.bfloat16) * 0.05)(D, D))}
    _A_in = _A_setup()

    def _B_setup():
        B, S, D, F = (1, 2048, 640, 1728)
        Fh = F // 2
        return {'x': _w((lambda *s: torch.randn(*s, dtype=torch.bfloat16) * 0.05)(B, S, D)), 'w_in': _w((lambda *s: torch.randn(*s, dtype=torch.bfloat16) * 0.4)(D, 2 * Fh)), 'w_sp': _w(0.01 * (lambda *s: torch.randn(*s, dtype=torch.bfloat16) * 0.4)(S, S)), 'b_sp': _w(1.0 + 0.01 * (lambda *s: torch.randn(*s, dtype=torch.bfloat16) * 0.05)(S)), 'w_out': _w((lambda *s: torch.randn(*s, dtype=torch.bfloat16) * 0.05)(Fh, D))}
    _B_in = _B_setup()
    return {'A_x': _A_in['x'], 'A_wqkv': _A_in['wqkv'], 'A_wo': _A_in['wo'], 'B_x': _B_in['x'], 'B_w_in': _B_in['w_in'], 'B_w_sp': _B_in['w_sp'], 'B_b_sp': _B_in['b_sp'], 'B_w_out': _B_in['w_out'], 'c': _w((lambda *s: torch.randn(*s, dtype=torch.bfloat16) * 0.1)(1, 640) * 8.0), 'w_mod': _w((lambda *s: torch.randn(*s, dtype=torch.bfloat16) * 0.1)(640, 6 * 640) * 640 ** (-0.5) * 8.0)}

def reference(A_x, A_wqkv, A_wo, B_x, B_w_in, B_w_sp, B_b_sp, B_w_out, c, w_mod):

    def _A_ref(x, wqkv, wo):
        B, S, D = x.shape
        H = 32
        Dh = D // H
        qkv = (lambda x, *d: x.permute(*d))((x @ wqkv).reshape(B, S, 3, H, Dh), 2, 0, 3, 1, 4)
        q, k, v = (qkv[0], qkv[1], qkv[2])
        scale = Dh ** (-0.5)
        scores = torch.einsum('bhqd,bhkd->bhqk', q, k) * scale
        p = _softmax(scores, axis=-1)
        o = torch.einsum('bhqk,bhkd->bhqd', p, v)
        return (lambda x, *d: x.permute(*d))(o, 0, 2, 1, 3).reshape(B, S, D) @ wo

    def _B_ref(x, w_in, w_sp, b_sp, w_out):
        B, S, D = x.shape
        F = w_in.shape[-1]
        Fh = F // 2
        z = _gelu(torch.einsum('bsd,df->bsf', x, w_in))
        z1 = z[..., :Fh].clone()
        z2 = _layernorm(z[..., Fh:], axis=-1)
        g = torch.einsum('ts,bsf->btf', w_sp, z2) + b_sp[None, :, None]
        return torch.einsum('bsf,fd->bsd', z1 * g, w_out)
    x = A_x
    mod = (_silu(c) @ w_mod).reshape(c.shape[0], 6, 1, -1)
    sa, ca, ga, sb, cb, gb = (mod[:, 0].clone(), mod[:, 1].clone(), mod[:, 2].clone(), mod[:, 3].clone(), mod[:, 4].clone(), mod[:, 5].clone())
    h = _layernorm(x, axis=-1) * (1 + ca) + sa
    x = x + ga * _A_ref(h, A_wqkv, A_wo)
    h = _layernorm(x, axis=-1) * (1 + cb) + sb
    x = x + gb * _B_ref(h, B_w_in, B_w_sp, B_b_sp, B_w_out)
    return x
```

```asm
; @launch kernel=kf_kernel grid=(256,1,1) block=(512,1,1) lds=163840
.amdgcn_target "amdgcn-amd-amdhsa--gfx950"
.text
.globl kf_kernel
.p2align 8
.type kf_kernel,@function
kf_kernel:
    s_load_dwordx16 s[16:31], s[0:1], 0
    s_load_dwordx8 s[32:39], s[0:1], 64
    s_load_dwordx2 s[40:41], s[0:1], 96
    s_cmp_ge_u32 s2, 256
    s_cbranch_scc1 kf_kernel_a_exit
    s_cmp_lt_u32 s2, 16
    s_cbranch_scc0 kf_kernel_npf
    s_lshr_b32 s98, s2, 3
    s_lshl_b32 s98, s98, zlit_b-zlit_a+(16)
    v_lshl_add_u32 v254, v0, 7, s98
    s_getpc_b64 s[96:97]
    v_min_u32 v254, kf_kernel_codeend-kf_kernel-128, v254
    v_mov_b32 v255, s97
    v_add_co_u32 v254, vcc, s96, v254
    s_nop 1
    v_addc_co_u32_e64 v255, vcc, 0, v255, vcc
    global_load_dword v254, v[254:255], off
kf_kernel_npf:
    v_lshrrev_b32 v12, 6, v0
    v_and_b32 v2, 63, v0
    v_readfirstlane_b32 s48, v12
    v_lshlrev_b32 v3, 4, v2
    s_cmp_lt_u32 s2, 16
    s_cbranch_scc1 kf_kernel_a_prod
    s_sub_u32 s57, s2, zlit_b-zlit_a+(16)
    s_mov_b32 s10, 268435456
    s_mov_b32 s11, 0x00020000
    v_mov_b32 v8, 28672
    v_mul_u32_u24 v13, 20480, v12
    v_mov_b32 v14, 0
    v_mov_b32 v15, 0
    ds_write_b64 v13, v[14:15] offset:19968
    s_cmp_eq_u32 s48, zlit_b-zlit_a+(7)
    s_cselect_b32 s74, s57, 100
    s_cmp_lt_u32 s74, 100
    s_cbranch_scc0 kf_kernel_a_np1
    v_lshrrev_b32 v13, 4, v2
    v_bfe_u32 v14, v2, 3, 1
    v_lshl_add_u32 v13, v13, 5, v14
    v_mul_u32_u24 v13, 7680, v13
    v_and_b32_e64 v14, 7, v2
    v_lshl_add_u32 v13, v14, 4, v13
    v_lshlrev_b32_e64 v14, 2, v2
    s_mul_i32 s56, s74, 205
    s_lshr_b32 s56, s56, 12
    s_mul_i32 s51, s56, zlit_b-zlit_a+(20)
    s_sub_u32 s51, s74, s51
    s_mul_i32 s58, s56, 983040
    s_lshl_b32 s52, s51, 7
    s_add_u32 s58, s58, s52
    s_lshl_b32 s59, s56, zlit_b-zlit_a+(8)
    s_mul_i32 s72, s56, 5120
    s_lshl_b32 s51, s51, 8
    s_add_u32 s72, s72, s51
    s_add_u32 s72, s72, 0
    s_waitcnt lgkmcnt(0)
    s_mov_b32 s8, s40
    s_mov_b32 s9, s41
    s_mov_b32 s12, s34
    s_mov_b32 s13, s35
    s_mov_b32 s14, 4915200
    s_mov_b32 s15, 0x00020000
    s_mov_b32 s44, s32
    s_mov_b32 s45, s33
    s_mov_b32 s46, 1280
    s_mov_b32 s47, 0x00020000
    buffer_load_dword v195, v14, s[44:47], s59 offen
    buffer_load_dwordx4 v[96:99], v13, s[12:15], s58 offen nt
    s_add_u32 s58, s58, 15360
    buffer_load_dwordx4 v[100:103], v13, s[12:15], s58 offen nt
    s_add_u32 s58, s58, 15360
    buffer_load_dwordx4 v[104:107], v13, s[12:15], s58 offen nt
    s_add_u32 s58, s58, 15360
    buffer_load_dwordx4 v[108:111], v13, s[12:15], s58 offen nt
    s_add_u32 s58, s58, 15360
    buffer_load_dwordx4 v[112:115], v13, s[12:15], s58 offen nt
    s_add_u32 s58, s58, 15360
    buffer_load_dwordx4 v[116:119], v13, s[12:15], s58 offen nt
    s_add_u32 s58, s58, 15360
    buffer_load_dwordx4 v[120:123], v13, s[12:15], s58 offen nt
    s_add_u32 s58, s58, 15360
    buffer_load_dwordx4 v[124:127], v13, s[12:15], s58 offen nt
    s_add_u32 s58, s58, 15360
    buffer_load_dwordx4 v[128:131], v13, s[12:15], s58 offen nt
    s_add_u32 s58, s58, 15360
    buffer_load_dwordx4 v[132:135], v13, s[12:15], s58 offen nt
    s_add_u32 s58, s58, 15360
    buffer_load_dwordx4 v[136:139], v13, s[12:15], s58 offen nt
    s_add_u32 s58, s58, 15360
    buffer_load_dwordx4 v[140:143], v13, s[12:15], s58 offen nt
    s_add_u32 s58, s58, 15360
    buffer_load_dwordx4 v[144:147], v13, s[12:15], s58 offen nt
    s_add_u32 s58, s58, 15360
    buffer_load_dwordx4 v[148:151], v13, s[12:15], s58 offen nt
    s_add_u32 s58, s58, 15360
    buffer_load_dwordx4 v[152:155], v13, s[12:15], s58 offen nt
    s_add_u32 s58, s58, 15360
    buffer_load_dwordx4 v[156:159], v13, s[12:15], s58 offen nt
    buffer_load_dword v8, v8, s[8:11], 0 offen sc1
    s_barrier
kf_kernel_a_np1:
    s_and_b32 s51, s2, 1
    s_mul_i32 s51, s51, 30
    s_lshr_b32 s52, s57, 3
    s_add_u32 s51, s51, s52
    s_lshr_b32 s50, s51, 2
    s_and_b32 s51, s51, 3
    s_and_b32 s49, s2, 6
    s_lshl_b32 s49, s49, 1
    s_add_u32 s49, s49, s51
    s_mul_i32 s83, s50, 3
    s_mul_i32 s51, s49, zlit_b-zlit_a+(0)
    s_add_u32 s83, s83, s51
    s_mul_i32 s51, s83, 205
    s_lshr_b32 s51, s51, 10
    s_and_b32 s53, s48, 1
    s_lshr_b32 s54, s48, 1
    s_lshl_b32 s52, s51, 1
    s_xor_b32 s52, s52, s54
    s_and_b32 s52, s52, 3
    s_lshl_b32 s48, s53, 2
    s_add_u32 s48, s48, s54
    s_mul_i32 s51, s51, 5
    s_sub_u32 s83, s83, s51
    s_lshl_b32 s49, s49, 2
    s_add_u32 s49, s49, s52
    s_mul_i32 s70, s48, 20480
    s_mul_i32 s73, s49, 40960
    s_mul_i32 s51, s53, 640
    s_add_u32 s73, s73, s51
    s_add_u32 s42, s73, 640
    s_lshl_b32 s51, s83, 7
    s_add_u32 s73, s73, s51
    v_lshrrev_b32 v12, 3, v2
    v_lshrrev_b32 v241, 4, v2
    v_xor_b32 v241, v241, v2
    v_and_b32_e64 v241, 7, v241
    v_mul_u32_u24 v12, 1280, v12
    v_lshl_add_u32 v240, v241, 4, v12
    v_xor_b32_e64 v241, 64, v240
    v_add_u32 v242, 18432, v240
    v_add_u32 v243, 27648, v241
    v_add_u32 v241, 9216, v241
    s_waitcnt lgkmcnt(0)
    s_mov_b32 s8, s40
    s_mov_b32 s9, s41
    s_mov_b32 s4, s16
    s_mov_b32 s5, s17
    s_mov_b32 s6, 2621440
    s_mov_b32 s7, 0x00020000
    s_cmp_lt_u32 s54, 2
    s_cbranch_scc0 kf_kernel_a_late
    s_setprio 2
    s_barrier
    s_add_u32 m0, s70, zlit_b-zlit_a+(0)
    s_nop 0
    buffer_load_dwordx4 v240, s[4:7], s73 offen offset:0 lds
    buffer_load_dwordx4 v241, s[4:7], s73 offen offset:1024 lds
    buffer_load_dwordx4 v242, s[4:7], s73 offen offset:2048 lds
    buffer_load_dwordx4 v243, s[4:7], s73 offen offset:3072 lds
    s_add_u32 s73, s73, 128
    s_cmp_ge_u32 s73, s42
    s_cselect_b32 s51, 640, 0
    s_sub_u32 s73, s73, s51
    s_add_u32 m0, s70, 4096
    s_nop 0
    buffer_load_dwordx4 v240, s[4:7], s73 offen offset:0 lds
    buffer_load_dwordx4 v241, s[4:7], s73 offen offset:1024 lds
    buffer_load_dwordx4 v242, s[4:7], s73 offen offset:2048 lds
    buffer_load_dwordx4 v243, s[4:7], s73 offen offset:3072 lds
    s_add_u32 s73, s73, 128
    s_cmp_ge_u32 s73, s42
    s_cselect_b32 s51, 640, 0
    s_sub_u32 s73, s73, s51
    s_mov_b32 s12, s18
    s_mov_b32 s13, s19
    s_mov_b32 s14, 2457600
    s_mov_b32 s15, 0x00020000
    s_cmp_ge_u32 s50, 10
    s_cselect_b32 s55, 1, 0
    s_cmp_ge_u32 s50, 5
    s_cselect_b32 s51, 5, 0
    s_sub_u32 s56, s50, s51
    s_mov_b32 s60, 0x76543210
    s_mov_b32 s61, 0xfedcba98
    s_cmp_eq_u32 s56, zlit_b-zlit_a+(0)
    s_cselect_b32 s60, 2556773136, s60
    s_cselect_b32 s61, 4235390394, s61
    s_cmp_eq_u32 s56, zlit_b-zlit_a+(1)
    s_cselect_b32 s60, 2844218418, s60
    s_cselect_b32 s61, 3054567132, s61
    s_cmp_eq_u32 s56, zlit_b-zlit_a+(2)
    s_cselect_b32 s60, 2557887265, s60
    s_cselect_b32 s61, 4199607755, s61
    s_cmp_eq_u32 s56, zlit_b-zlit_a+(3)
    s_cselect_b32 s60, 2271556112, s60
    s_cselect_b32 s61, 4271168698, s61
    s_cmp_eq_u32 s56, zlit_b-zlit_a+(4)
    s_cselect_b32 s60, 2843104289, s60
    s_cselect_b32 s61, 3627089611, s61
    v_lshrrev_b32 v12, 4, v2
    v_and_b32 v13, 3, v2
    v_lshl_add_u32 v12, v12, 2, v13
    s_lshl_b32 s51, s53, 3
    v_xor_b32 v12, s51, v12
    v_lshlrev_b32_e64 v12, 2, v12
    v_lshrrev_b64 v[14:15], v12, s[60:61]
    v_and_b32_e64 v14, 15, v14
    v_bfe_u32 v13, v2, 2, 2
    v_mul_u32_u24 v13, 3840, v13
    v_lshl_add_u32 v12, v14, 4, v13
    v_add_u32 v13, 29696, v12
    s_mul_i32 s71, s53, 1228800
    s_and_b32 s51, s54, zlit_b-zlit_a+(1)
    s_mul_i32 s51, s51, 15360
    s_add_u32 s71, s71, s51
    s_lshl_b32 s51, s50, zlit_b-zlit_a+(8)
    s_add_u32 s71, s71, s51
    s_add_u32 s43, s71, 1228800
    s_mul_i32 s51, s83, 245760
    s_add_u32 s71, s71, s51
    buffer_load_dword v8, v8, s[8:11], 0 offen sc1
    s_add_u32 m0, s70, 8192
    s_nop 0
    buffer_load_dwordx4 v240, s[4:7], s73 offen offset:0 lds
    buffer_load_dwordx4 v241, s[4:7], s73 offen offset:1024 lds
    buffer_load_dwordx4 v242, s[4:7], s73 offen offset:2048 lds
    buffer_load_dwordx4 v243, s[4:7], s73 offen offset:3072 lds
    s_add_u32 s73, s73, 128
    s_cmp_ge_u32 s73, s42
    s_cselect_b32 s51, 640, 0
    s_sub_u32 s73, s73, s51
    s_add_u32 m0, s70, 12288
    s_nop 0
    buffer_load_dwordx4 v240, s[4:7], s73 offen offset:0 lds
    buffer_load_dwordx4 v241, s[4:7], s73 offen offset:1024 lds
    buffer_load_dwordx4 v242, s[4:7], s73 offen offset:2048 lds
    buffer_load_dwordx4 v243, s[4:7], s73 offen offset:3072 lds
    s_add_u32 s73, s73, 128
    s_cmp_ge_u32 s73, s42
    s_cselect_b32 s51, 640, 0
    s_sub_u32 s73, s73, s51
    s_add_u32 m0, s70, 16384
    s_nop 0
    buffer_load_dwordx4 v240, s[4:7], s73 offen offset:0 lds
    buffer_load_dwordx4 v241, s[4:7], s73 offen offset:1024 lds
    buffer_load_dwordx4 v242, s[4:7], s73 offen offset:2048 lds
    buffer_load_dwordx4 v243, s[4:7], s73 offen offset:3072 lds
    v_and_b32 v237, 31, v2
    v_lshrrev_b32 v238, 5, v2
    v_bfe_u32 v14, v2, 1, 3
    v_xor_b32 v14, v14, v238
    v_lshlrev_b32 v14, 4, v14
    v_lshl_add_u32 v14, v237, 7, v14
    v_add_u32 v236, s70, v14
    v_xor_b32 v237, 32, v236
    v_xor_b32_e64 v238, 64, v236
    v_xor_b32 v239, 96, v236
    v_mov_b32 v232, 0x3f803f80
    s_add_u32 s51, s70, 19712
    v_lshl_add_u32 v244, v2, 2, s51
    v_mov_b32 v245, s51
    v_and_b32 v246, 31, v2
    s_xor_b32 s51, s48, zlit_b-zlit_a+(4)
    s_mul_i32 s51, s51, 20480
    v_add_u32_e64 v0, s51, v3
    s_add_u32 s51, s51, 19712
    v_lshl_add_u32 v246, v246, 2, s51
    v_mov_b32 v247, s51
    v_lshrrev_b32 v14, 5, v2
    s_mul_i32 s51, s53, 81920
    v_lshlrev_b32_e64 v4, 10, v14
    v_bfe_u32 v15, v2, 2, 2
    v_lshl_add_u32 v4, v15, 6, v4
    v_bfe_u32 v15, v2, 4, 1
    v_lshl_add_u32 v4, v15, 5, v4
    v_and_b32_e64 v15, 3, v2
    v_lshl_add_u32 v4, v15, 3, v4
    v_add_u32_e64 v4, s51, v4
    v_add_u32 v5, 40960, v4
    s_add_u32 s51, s51, 18432
    v_lshl_add_u32 v6, v14, 5, s51
    v_add_u32 v7, s70, v3
    s_lshl_b32 s51, s83, 8
    v_add_u32_e64 v248, s51, v3
    v_add_u32 v249, 640, v248
    v_subrev_u32 v14, 1280, v248
    v_subrev_u32 v15, 1280, v249
    v_min_u32 v248, v248, v14
    v_min_u32 v249, v249, v15
    s_mul_i32 s84, s53, 1280
    s_cmp_eq_u32 s54, zlit_b-zlit_a+(0)
    s_cselect_b32 s51, 2560, 0
    s_add_u32 s84, s84, s51
    s_add_u32 s85, s84, 5120
    s_add_u32 s86, s84, 10240
    s_add_u32 s87, s84, 15360
    s_add_u32 s88, s84, 20480
    s_mov_b32 s80, 0x05040100
    s_mov_b32 s81, 0x07060302
    s_mov_b32 s82, -1
    s_mov_b32 s44, s20
    s_mov_b32 s45, s21
    s_mov_b32 s46, 819200
    s_mov_b32 s47, 0x00020000
    s_cmp_eq_u32 s54, 3
    s_cbranch_scc1 kf_kernel_a_sj3e
    s_mul_i32 s58, s57, 3
    s_add_u32 s58, s58, s54
    s_cmp_lt_u32 s58, 640
    s_cbranch_scc1 kf_kernel_a_sj1e
    s_mov_b32 s80, 0x0d0d0d0d
    s_mov_b32 s81, 0x0d0d0d0d
    s_lshl_b32 s79, s58, 12
    s_add_u32 s79, s79, 33665024
    s_cmp_lt_u32 s58, 705
    s_cselect_b32 s79, s79, 0x40000000
    v_lshrrev_b32 v11, 3, v2
    v_lshlrev_b32 v11, 9, v11
    v_and_b32 v10, 7, v2
    v_lshl_add_u32 v11, v10, 5, v11
    s_mov_b32 s75, 0x40000000
    s_mov_b32 s76, 0
    s_mov_b32 s77, 0
    s_mov_b32 s78, zlit_b-zlit_a+(0)
    s_branch kf_kernel_a_sjde
kf_kernel_a_sj1e:
    s_mov_b32 s44, s24
    s_mov_b32 s45, s25
    s_mov_b32 s46, 2211840
    s_mov_b32 s47, 0x00020000
    s_mul_i32 s62, s58, 1639
    s_lshr_b32 s62, s62, 16
    s_mul_i32 s51, s62, 40
    s_sub_u32 s63, s58, s51
    s_and_b32 s64, s63, 1
    s_lshr_b32 s63, s63, 1
    s_mul_i32 s65, s63, 52
    s_lshr_b32 s65, s65, 8
    s_mul_i32 s51, s65, 5
    s_sub_u32 s66, s63, s51
    s_lshr_b32 s51, s66, 1
    s_mul_i32 s51, s51, 80
    s_and_b32 s52, s66, 1
    s_mul_i32 s52, s52, 48
    s_add_u32 s51, s51, s52
    s_cmp_lt_u32 s66, 4
    s_cselect_b32 s51, s51, zlit_b-zlit_a+(32)
    s_cselect_b32 s77, 16, 80
    s_mul_i32 s77, s77, 3456
    s_mul_i32 s65, s65, 160
    s_add_u32 s51, s51, s65
    s_lshl_b32 s52, s64, zlit_b-zlit_a+(3)
    s_add_u32 s51, s51, s52
    s_mul_i32 s51, s51, 3456
    s_and_b32 s52, s62, zlit_b-zlit_a+(1)
    s_mul_i32 s52, s52, 1728
    s_add_u32 s75, s51, s52
    s_lshr_b32 s52, s62, 1
    s_mul_i32 s52, s52, 224
    v_lshl_add_u32 v10, v2, 2, s52
    v_mov_b32_e64 v11, 0x40000000
    v_cmp_gt_u32 vcc, 1728, v10
    s_nop 1
    v_cndmask_b32 v10, v11, v10, vcc
    s_mov_b32 s76, 13824
    s_mov_b32 s78, 3456
    s_mov_b32 s82, 0x00ffffff
    v_lshrrev_b32_e64 v11, 4, v2
    v_mul_u32_u24 v11, 40960, v11
    v_bfe_u32 v14, v2, 3, 1
    v_lshl_add_u32 v11, v14, 10, v11
    v_and_b32_e64 v14, 7, v2
    v_lshl_add_u32 v11, v14, 5, v11
    s_lshl_b32 s52, s63, 10
    v_subrev_u32 v14, s52, v11
    v_cmp_gt_u32 vcc, 48, v2
    s_nop 1
    v_cndmask_b32_e64 v11, v14, v11, vcc
    s_mul_i32 s51, s62, 143360
    s_lshl_b32 s52, s63, 11
    s_add_u32 s51, s51, s52
    s_lshl_b32 s52, s64, 9
    s_add_u32 s51, s51, s52
    s_add_u32 s79, s51, 315392
    s_branch kf_kernel_a_sjde
kf_kernel_a_sj3e:
    s_lshr_b32 s51, s57, 2
    s_mul_i32 s62, s51, 171
    s_lshr_b32 s62, s62, 9
    s_mul_i32 s52, s62, 3
    s_sub_u32 s64, s51, s52
    s_and_b32 s51, s57, 1
    s_lshl_b32 s63, s62, 1
    s_add_u32 s63, s63, s51
    s_mul_i32 s75, s63, zlit_b-zlit_a+(20)
    s_mul_i32 s51, s63, 80
    s_sub_u32 s51, s51, 2544
    s_cmp_lt_u32 s63, 32
    s_cselect_b32 s75, s75, s51
    s_cselect_b32 s76, 4, zlit_b-zlit_a+(20)
    s_mul_i32 s75, s75, 1280
    s_mul_i32 s76, s76, 1280
    s_lshl_b32 s77, s76, zlit_b-zlit_a+(1)
    s_mov_b32 s78, 1280
    s_lshl_b32 s51, s64, 8
    s_and_b32 s52, s57, 2
    s_lshl_b32 s52, s52, 6
    s_add_u32 s65, s51, s52
    v_lshl_add_u32 v14, v2, 1, s65
    v_lshlrev_b32 v10, 1, v14
    v_lshrrev_b32 v11, 4, v14
    v_mul_u32_u24 v14, 205, v11
    v_lshrrev_b32 v14, 10, v14
    v_lshlrev_b32 v11, 10, v11
    v_mul_u32_u24 v14, 97280, v14
    v_add_u32 v11, v11, v14
    v_and_b32 v14, 7, v2
    v_lshl_add_u32 v11, v14, 5, v11
    s_mul_i32 s51, s62, 5120
    s_and_b32 s52, s63, 1
    s_lshl_b32 s52, s52, zlit_b-zlit_a+(9)
    s_add_u32 s51, s51, s52
    s_add_u32 s79, s51, 2674688
    s_cmp_lt_u32 s65, 640
    s_cselect_b32 s79, s79, 0x40000000
    s_cselect_b32 s75, s75, 0x40000000
kf_kernel_a_sjde:
    s_mul_i32 s76, s76, s53
    s_add_u32 s75, s75, s76
    s_lshl_b32 s76, s53, 8
    s_add_u32 s79, s79, s76
    s_mul_i32 s51, s50, 52
    s_lshr_b32 s51, s51, 8
    s_mul_i32 s52, s51, 5
    s_sub_u32 s52, s50, s52
    s_lshl_b32 s101, s51, 7
    s_and_b32 s51, s52, 1
    s_lshl_b32 s51, s51, 6
    s_add_u32 s101, s101, s51
    s_mul_i32 s52, s52, 6560
    s_lshr_b32 s52, s52, 10
    s_lshl_b32 s52, s52, 12
    s_add_u32 s101, s101, s52
    s_and_b32 s51, s49, zlit_b-zlit_a+(60)
    s_add_u32 s101, s101, s51
    s_add_u32 s101, s101, 36143104
    s_lshl_b32 s61, s54, zlit_b-zlit_a+(1)
    s_add_u32 s61, s61, s53
    s_waitcnt vmcnt(17)
    ds_read_b128 v[16:19], v236 offset:0
    ds_read_b128 v[20:23], v237 offset:0
    ds_read_b128 v[24:27], v238 offset:0
    ds_read_b128 v[28:31], v239 offset:0
    s_waitcnt lgkmcnt(3)
    v_dot2_f32_bf16 v224, v16, v232, 0
    v_dot2_f32_bf16 v225, v16, v16, 0
    v_dot2_f32_bf16 v226, v17, v232, 0
    v_dot2_f32_bf16 v227, v17, v17, 0
    v_dot2_f32_bf16 v224, v18, v232, v224
    v_dot2_f32_bf16 v225, v18, v18, v225
    v_dot2_f32_bf16 v226, v19, v232, v226
    v_dot2_f32_bf16 v227, v19, v19, v227
    s_waitcnt lgkmcnt(2)
    v_dot2_f32_bf16 v224, v20, v232, v224
    v_dot2_f32_bf16 v225, v20, v20, v225
    v_dot2_f32_bf16 v226, v21, v232, v226
    v_dot2_f32_bf16 v227, v21, v21, v227
    v_dot2_f32_bf16 v224, v22, v232, v224
    v_dot2_f32_bf16 v225, v22, v22, v225
    v_dot2_f32_bf16 v226, v23, v232, v226
    v_dot2_f32_bf16 v227, v23, v23, v227
    s_waitcnt lgkmcnt(1)
    v_dot2_f32_bf16 v224, v24, v232, v224
    v_dot2_f32_bf16 v225, v24, v24, v225
    v_dot2_f32_bf16 v226, v25, v232, v226
    v_dot2_f32_bf16 v227, v25, v25, v227
    v_dot2_f32_bf16 v224, v26, v232, v224
    v_dot2_f32_bf16 v225, v26, v26, v225
    v_dot2_f32_bf16 v226, v27, v232, v226
    v_dot2_f32_bf16 v227, v27, v27, v227
    s_waitcnt lgkmcnt(0)
    s_setprio 0
    v_dot2_f32_bf16 v224, v28, v232, v224
    v_dot2_f32_bf16 v225, v28, v28, v225
    v_dot2_f32_bf16 v226, v29, v232, v226
    v_dot2_f32_bf16 v227, v29, v29, v227
    v_dot2_f32_bf16 v224, v30, v232, v224
    v_dot2_f32_bf16 v225, v30, v30, v225
    v_dot2_f32_bf16 v226, v31, v232, v226
    v_dot2_f32_bf16 v227, v31, v31, v227
    s_waitcnt vmcnt(13)
    ds_read_b128 v[32:35], v236 offset:4096
    ds_read_b128 v[36:39], v237 offset:4096
    ds_read_b128 v[40:43], v238 offset:4096
    ds_read_b128 v[44:47], v239 offset:4096
    s_waitcnt lgkmcnt(3)
    v_dot2_f32_bf16 v224, v32, v232, v224
    v_dot2_f32_bf16 v225, v32, v32, v225
    v_dot2_f32_bf16 v226, v33, v232, v226
    v_dot2_f32_bf16 v227, v33, v33, v227
    v_dot2_f32_bf16 v224, v34, v232, v224
    v_dot2_f32_bf16 v225, v34, v34, v225
    v_dot2_f32_bf16 v226, v35, v232, v226
    v_dot2_f32_bf16 v227, v35, v35, v227
    s_waitcnt lgkmcnt(2)
    v_dot2_f32_bf16 v224, v36, v232, v224
    v_dot2_f32_bf16 v225, v36, v36, v225
    v_dot2_f32_bf16 v226, v37, v232, v226
    v_dot2_f32_bf16 v227, v37, v37, v227
    v_dot2_f32_bf16 v224, v38, v232, v224
    v_dot2_f32_bf16 v225, v38, v38, v225
    v_dot2_f32_bf16 v226, v39, v232, v226
    v_dot2_f32_bf16 v227, v39, v39, v227
    s_waitcnt lgkmcnt(1)
    v_dot2_f32_bf16 v224, v40, v232, v224
    v_dot2_f32_bf16 v225, v40, v40, v225
    v_dot2_f32_bf16 v226, v41, v232, v226
    v_dot2_f32_bf16 v227, v41, v41, v227
    v_dot2_f32_bf16 v224, v42, v232, v224
    v_dot2_f32_bf16 v225, v42, v42, v225
    v_dot2_f32_bf16 v226, v43, v232, v226
    v_dot2_f32_bf16 v227, v43, v43, v227
    s_waitcnt lgkmcnt(0)
    v_dot2_f32_bf16 v224, v44, v232, v224
    v_dot2_f32_bf16 v225, v44, v44, v225
    v_dot2_f32_bf16 v226, v45, v232, v226
    v_dot2_f32_bf16 v227, v45, v45, v227
    v_dot2_f32_bf16 v224, v46, v232, v224
    v_dot2_f32_bf16 v225, v46, v46, v225
    v_dot2_f32_bf16 v226, v47, v232, v226
    v_dot2_f32_bf16 v227, v47, v47, v227
    s_waitcnt vmcnt(8)
    ds_read_b128 v[48:51], v236 offset:8192
    ds_read_b128 v[52:55], v237 offset:8192
    ds_read_b128 v[56:59], v238 offset:8192
    ds_read_b128 v[60:63], v239 offset:8192
    s_waitcnt lgkmcnt(3)
    v_dot2_f32_bf16 v224, v48, v232, v224
    v_dot2_f32_bf16 v225, v48, v48, v225
    v_dot2_f32_bf16 v226, v49, v232, v226
    v_dot2_f32_bf16 v227, v49, v49, v227
    v_dot2_f32_bf16 v224, v50, v232, v224
    v_dot2_f32_bf16 v225, v50, v50, v225
    v_dot2_f32_bf16 v226, v51, v232, v226
    v_dot2_f32_bf16 v227, v51, v51, v227
    s_waitcnt lgkmcnt(2)
    v_dot2_f32_bf16 v224, v52, v232, v224
    v_dot2_f32_bf16 v225, v52, v52, v225
    v_dot2_f32_bf16 v226, v53, v232, v226
    v_dot2_f32_bf16 v227, v53, v53, v227
    v_dot2_f32_bf16 v224, v54, v232, v224
    v_dot2_f32_bf16 v225, v54, v54, v225
    v_dot2_f32_bf16 v226, v55, v232, v226
    v_dot2_f32_bf16 v227, v55, v55, v227
    s_waitcnt lgkmcnt(1)
    v_dot2_f32_bf16 v224, v56, v232, v224
    v_dot2_f32_bf16 v225, v56, v56, v225
    v_dot2_f32_bf16 v226, v57, v232, v226
    v_dot2_f32_bf16 v227, v57, v57, v227
    v_dot2_f32_bf16 v224, v58, v232, v224
    v_dot2_f32_bf16 v225, v58, v58, v225
    v_dot2_f32_bf16 v226, v59, v232, v226
    v_dot2_f32_bf16 v227, v59, v59, v227
    s_waitcnt lgkmcnt(0)
    v_dot2_f32_bf16 v224, v60, v232, v224
    v_dot2_f32_bf16 v225, v60, v60, v225
    v_dot2_f32_bf16 v226, v61, v232, v226
    v_dot2_f32_bf16 v227, v61, v61, v227
    v_dot2_f32_bf16 v224, v62, v232, v224
    v_dot2_f32_bf16 v225, v62, v62, v225
    v_dot2_f32_bf16 v226, v63, v232, v226
    v_dot2_f32_bf16 v227, v63, v63, v227
    s_waitcnt vmcnt(4)
    ds_read_b128 v[64:67], v236 offset:12288
    ds_read_b128 v[68:71], v237 offset:12288
    ds_read_b128 v[72:75], v238 offset:12288
    ds_read_b128 v[76:79], v239 offset:12288
    s_waitcnt lgkmcnt(3)
    v_dot2_f32_bf16 v224, v64, v232, v224
    v_dot2_f32_bf16 v225, v64, v64, v225
    v_dot2_f32_bf16 v226, v65, v232, v226
    v_dot2_f32_bf16 v227, v65, v65, v227
    v_dot2_f32_bf16 v224, v66, v232, v224
    v_dot2_f32_bf16 v225, v66, v66, v225
    v_dot2_f32_bf16 v226, v67, v232, v226
    v_dot2_f32_bf16 v227, v67, v67, v227
    s_waitcnt lgkmcnt(2)
    v_dot2_f32_bf16 v224, v68, v232, v224
    v_dot2_f32_bf16 v225, v68, v68, v225
    v_dot2_f32_bf16 v226, v69, v232, v226
    v_dot2_f32_bf16 v227, v69, v69, v227
    v_dot2_f32_bf16 v224, v70, v232, v224
    v_dot2_f32_bf16 v225, v70, v70, v225
    v_dot2_f32_bf16 v226, v71, v232, v226
    v_dot2_f32_bf16 v227, v71, v71, v227
    s_waitcnt lgkmcnt(1)
    v_dot2_f32_bf16 v224, v72, v232, v224
    v_dot2_f32_bf16 v225, v72, v72, v225
    v_dot2_f32_bf16 v226, v73, v232, v226
    v_dot2_f32_bf16 v227, v73, v73, v227
    v_dot2_f32_bf16 v224, v74, v232, v224
    v_dot2_f32_bf16 v225, v74, v74, v225
    v_dot2_f32_bf16 v226, v75, v232, v226
    v_dot2_f32_bf16 v227, v75, v75, v227
    s_waitcnt lgkmcnt(0)
    v_dot2_f32_bf16 v224, v76, v232, v224
    v_dot2_f32_bf16 v225, v76, v76, v225
    v_dot2_f32_bf16 v226, v77, v232, v226
    v_dot2_f32_bf16 v227, v77, v77, v227
    v_dot2_f32_bf16 v224, v78, v232, v224
    v_dot2_f32_bf16 v225, v78, v78, v225
    v_dot2_f32_bf16 v226, v79, v232, v226
    v_dot2_f32_bf16 v227, v79, v79, v227
    s_waitcnt vmcnt(0)
    ds_read_b128 v[80:83], v236 offset:16384
    ds_read_b128 v[84:87], v237 offset:16384
    ds_read_b128 v[88:91], v238 offset:16384
    ds_read_b128 v[92:95], v239 offset:16384
    s_waitcnt lgkmcnt(3)
    v_dot2_f32_bf16 v224, v80, v232, v224
    v_dot2_f32_bf16 v225, v80, v80, v225
    v_dot2_f32_bf16 v226, v81, v232, v226
    v_dot2_f32_bf16 v227, v81, v81, v227
    v_dot2_f32_bf16 v224, v82, v232, v224
    v_dot2_f32_bf16 v225, v82, v82, v225
    v_dot2_f32_bf16 v226, v83, v232, v226
    v_dot2_f32_bf16 v227, v83, v83, v227
    s_waitcnt lgkmcnt(2)
    v_dot2_f32_bf16 v224, v84, v232, v224
    v_dot2_f32_bf16 v225, v84, v84, v225
    v_dot2_f32_bf16 v226, v85, v232, v226
    v_dot2_f32_bf16 v227, v85, v85, v227
    v_dot2_f32_bf16 v224, v86, v232, v224
    v_dot2_f32_bf16 v225, v86, v86, v225
    v_dot2_f32_bf16 v226, v87, v232, v226
    v_dot2_f32_bf16 v227, v87, v87, v227
    s_waitcnt lgkmcnt(1)
    v_dot2_f32_bf16 v224, v88, v232, v224
    v_dot2_f32_bf16 v225, v88, v88, v225
    v_dot2_f32_bf16 v226, v89, v232, v226
    v_dot2_f32_bf16 v227, v89, v89, v227
    v_dot2_f32_bf16 v224, v90, v232, v224
    v_dot2_f32_bf16 v225, v90, v90, v225
    v_dot2_f32_bf16 v226, v91, v232, v226
    v_dot2_f32_bf16 v227, v91, v91, v227
    s_waitcnt lgkmcnt(0)
    v_dot2_f32_bf16 v224, v92, v232, v224
    v_dot2_f32_bf16 v225, v92, v92, v225
    v_dot2_f32_bf16 v226, v93, v232, v226
    v_dot2_f32_bf16 v227, v93, v93, v227
    v_dot2_f32_bf16 v224, v94, v232, v224
    v_dot2_f32_bf16 v225, v94, v94, v225
    v_dot2_f32_bf16 v226, v95, v232, v226
    v_dot2_f32_bf16 v227, v95, v95, v227
    s_nop 1
    v_add_f32 v224, v224, v226
    v_add_f32 v225, v225, v227
    v_add_u32 v8, 0x01010101, v8
    s_nop 0
    v_permlane32_swap_b32 v224, v225
    v_add_f32_e64 v224, v224, v225
    ds_write_b32 v244, v224
    v_not_b32_e64 v9, v8
    ds_write_b64 v245, v[8:9] offset:256
    v_mov_b32 v225, v224
    s_nop 1
    v_permlane32_swap_b32_e64 v224, v225
    s_mov_b32 exec_hi, 0xff
    buffer_load_dwordx4 v[96:99], v248, s[8:11], s84 offen sc1
    s_mov_b32 exec_hi, zlit_b-zlit_a+(-1)
    s_mov_b32 exec_hi, 0xff
    buffer_load_dwordx4 v[100:103], v249, s[8:11], s84 offen sc1
    s_mov_b32 exec_hi, zlit_b-zlit_a+(-1)
    s_mov_b32 exec_hi, 0xff
    buffer_load_dwordx4 v[104:107], v248, s[8:11], s85 offen sc1
    s_mov_b32 exec_hi, zlit_b-zlit_a+(-1)
    s_mov_b32 exec_hi, 0xff
    buffer_load_dwordx4 v[108:111], v249, s[8:11], s85 offen sc1
    s_mov_b32 exec_hi, zlit_b-zlit_a+(-1)
kf_kernel_a_spine:
    ds_read_b64 v[14:15], v247 offset:256
    ds_read2_b32 v[226:227], v246 offset1:32
    s_waitcnt lgkmcnt(0)
    v_cmp_eq_u64 vcc, v[14:15], v[8:9]
    s_cbranch_vccnz kf_kernel_a_spune
    s_sleep 1
    s_branch kf_kernel_a_spine
kf_kernel_a_spune:
    v_readfirstlane_b32 s100, v8
    v_add_f32 v224, v224, v226
    v_add_f32 v225, v225, v227
    v_mul_f32 v224, 0x3acccccd, v224
    v_mul_f32 v225, 0x3acccccd, v225
    v_fma_f32 v225, -v224, v224, v225
    v_max_f32_e64 v225, 0, v225
    v_cvt_pk_bf16_f32 v225, v225, v224
    v_and_b32 v9, 0xffff0000, v225
    v_lshlrev_b32_e64 v225, 16, v225
    v_add_f32 v225, 0x3727c5ac, v225
    v_cvt_pk_bf16_f32 v225, v225, v225
    v_lshlrev_b32 v225, 16, v225
    v_sqrt_f32_e64 v225, v225
    s_nop 0
    v_cvt_pk_bf16_f32 v225, v225, v225
    v_lshlrev_b32 v225, 16, v225
    v_rcp_f32_e64 v15, v225
    s_nop 0
    v_mul_f32 v14, -v9, v15
    s_mov_b32 exec_hi, 0xff
    buffer_load_dwordx4 v[112:115], v248, s[8:11], s86 offen sc1
    s_mov_b32 exec_hi, -1
    v_lshlrev_b32 v224, 16, v16
    v_and_b32 v225, 0xffff0000, v16
    v_lshlrev_b32_e64 v226, 16, v17
    v_and_b32 v227, 0xffff0000, v17
    v_lshlrev_b32_e64 v228, 16, v18
    v_and_b32 v229, 0xffff0000, v18
    v_lshlrev_b32_e64 v230, 16, v19
    v_and_b32 v231, 0xffff0000, v19
    v_pk_fma_f32 v[224:225], v[14:15], v[224:225], v[14:15] op_sel:[1,0,0] op_sel_hi:[1,1,0]
    v_pk_fma_f32 v[226:227], v[14:15], v[226:227], v[14:15] op_sel:[1,0,0] op_sel_hi:[1,1,0]
    v_pk_fma_f32 v[228:229], v[14:15], v[228:229], v[14:15] op_sel:[1,0,0] op_sel_hi:[1,1,0]
    v_pk_fma_f32 v[230:231], v[14:15], v[230:231], v[14:15] op_sel:[1,0,0] op_sel_hi:[1,1,0]
    v_cvt_pk_f16_f32 v16, v224, v225
    v_cvt_pk_f16_f32 v17, v226, v227
    v_cvt_pk_f16_f32 v18, v228, v229
    v_cvt_pk_f16_f32 v19, v230, v231
    s_mov_b32 exec_hi, 0xff
    buffer_load_dwordx4 v[116:119], v249, s[8:11], s86 offen sc1
    s_mov_b32 exec_hi, -1
    v_lshlrev_b32 v232, 16, v20
    v_and_b32 v233, 0xffff0000, v20
    v_lshlrev_b32_e64 v234, 16, v21
    v_and_b32 v235, 0xffff0000, v21
    v_lshlrev_b32_e64 v236, 16, v22
    v_and_b32 v237, 0xffff0000, v22
    v_lshlrev_b32_e64 v238, 16, v23
    v_and_b32 v239, 0xffff0000, v23
    v_pk_fma_f32 v[232:233], v[14:15], v[232:233], v[14:15] op_sel:[1,0,0] op_sel_hi:[1,1,0]
    v_pk_fma_f32 v[234:235], v[14:15], v[234:235], v[14:15] op_sel:[1,0,0] op_sel_hi:[1,1,0]
    v_pk_fma_f32 v[236:237], v[14:15], v[236:237], v[14:15] op_sel:[1,0,0] op_sel_hi:[1,1,0]
    v_pk_fma_f32 v[238:239], v[14:15], v[238:239], v[14:15] op_sel:[1,0,0] op_sel_hi:[1,1,0]
    v_cvt_pk_f16_f32 v20, v232, v233
    v_cvt_pk_f16_f32 v21, v234, v235
    v_cvt_pk_f16_f32 v22, v236, v237
    v_cvt_pk_f16_f32 v23, v238, v239
    s_mov_b32 exec_hi, 0xff
    buffer_load_dwordx4 v[120:123], v248, s[8:11], s87 offen sc1
    s_mov_b32 exec_hi, -1
    v_lshlrev_b32 v224, 16, v24
    v_and_b32 v225, 0xffff0000, v24
    v_lshlrev_b32_e64 v226, 16, v25
    v_and_b32 v227, 0xffff0000, v25
    v_lshlrev_b32_e64 v228, 16, v26
    v_and_b32 v229, 0xffff0000, v26
    v_lshlrev_b32_e64 v230, 16, v27
    v_and_b32 v231, 0xffff0000, v27
    v_pk_fma_f32 v[224:225], v[14:15], v[224:225], v[14:15] op_sel:[1,0,0] op_sel_hi:[1,1,0]
    v_pk_fma_f32 v[226:227], v[14:15], v[226:227], v[14:15] op_sel:[1,0,0] op_sel_hi:[1,1,0]
    v_pk_fma_f32 v[228:229], v[14:15], v[228:229], v[14:15] op_sel:[1,0,0] op_sel_hi:[1,1,0]
    v_pk_fma_f32 v[230:231], v[14:15], v[230:231], v[14:15] op_sel:[1,0,0] op_sel_hi:[1,1,0]
    v_cvt_pk_f16_f32 v24, v224, v225
    v_cvt_pk_f16_f32 v25, v226, v227
    v_cvt_pk_f16_f32 v26, v228, v229
    v_cvt_pk_f16_f32 v27, v230, v231
    s_mov_b32 exec_hi, 0xff
    buffer_load_dwordx4 v[124:127], v249, s[8:11], s87 offen sc1
    s_mov_b32 exec_hi, -1
    v_lshlrev_b32 v232, 16, v28
    v_and_b32 v233, 0xffff0000, v28
    v_lshlrev_b32_e64 v234, 16, v29
    v_and_b32 v235, 0xffff0000, v29
    v_lshlrev_b32_e64 v236, 16, v30
    v_and_b32 v237, 0xffff0000, v30
    v_lshlrev_b32_e64 v238, 16, v31
    v_and_b32 v239, 0xffff0000, v31
    v_pk_fma_f32 v[232:233], v[14:15], v[232:233], v[14:15] op_sel:[1,0,0] op_sel_hi:[1,1,0]
    v_pk_fma_f32 v[234:235], v[14:15], v[234:235], v[14:15] op_sel:[1,0,0] op_sel_hi:[1,1,0]
    v_pk_fma_f32 v[236:237], v[14:15], v[236:237], v[14:15] op_sel:[1,0,0] op_sel_hi:[1,1,0]
    v_pk_fma_f32 v[238:239], v[14:15], v[238:239], v[14:15] op_sel:[1,0,0] op_sel_hi:[1,1,0]
    v_cvt_pk_f16_f32 v28, v232, v233
    v_cvt_pk_f16_f32 v29, v234, v235
    v_cvt_pk_f16_f32 v30, v236, v237
    v_cvt_pk_f16_f32 v31, v238, v239
    s_mov_b32 exec_hi, 0xff
    buffer_load_dwordx4 v[128:131], v248, s[8:11], s88 offen sc1
    s_mov_b32 exec_hi, -1
    v_lshlrev_b32 v224, 16, v32
    v_and_b32 v225, 0xffff0000, v32
    v_lshlrev_b32_e64 v226, 16, v33
    v_and_b32 v227, 0xffff0000, v33
    v_lshlrev_b32_e64 v228, 16, v34
    v_and_b32 v229, 0xffff0000, v34
    v_lshlrev_b32_e64 v230, 16, v35
    v_and_b32 v231, 0xffff0000, v35
    v_pk_fma_f32 v[224:225], v[14:15], v[224:225], v[14:15] op_sel:[1,0,0] op_sel_hi:[1,1,0]
    v_pk_fma_f32 v[226:227], v[14:15], v[226:227], v[14:15] op_sel:[1,0,0] op_sel_hi:[1,1,0]
    v_pk_fma_f32 v[228:229], v[14:15], v[228:229], v[14:15] op_sel:[1,0,0] op_sel_hi:[1,1,0]
    v_pk_fma_f32 v[230:231], v[14:15], v[230:231], v[14:15] op_sel:[1,0,0] op_sel_hi:[1,1,0]
    v_cvt_pk_f16_f32 v32, v224, v225
    v_cvt_pk_f16_f32 v33, v226, v227
    v_cvt_pk_f16_f32 v34, v228, v229
    v_cvt_pk_f16_f32 v35, v230, v231
    s_mov_b32 exec_hi, 0xff
    buffer_load_dwordx4 v[132:135], v249, s[8:11], s88 offen sc1
    s_mov_b32 exec_hi, -1
    v_lshlrev_b32 v232, 16, v36
    v_and_b32 v233, 0xffff0000, v36
    v_lshlrev_b32_e64 v234, 16, v37
    v_and_b32 v235, 0xffff0000, v37
    v_lshlrev_b32_e64 v236, 16, v38
    v_and_b32 v237, 0xffff0000, v38
    v_lshlrev_b32_e64 v238, 16, v39
    v_and_b32 v239, 0xffff0000, v39
    v_pk_fma_f32 v[232:233], v[14:15], v[232:233], v[14:15] op_sel:[1,0,0] op_sel_hi:[1,1,0]
    v_pk_fma_f32 v[234:235], v[14:15], v[234:235], v[14:15] op_sel:[1,0,0] op_sel_hi:[1,1,0]
    v_pk_fma_f32 v[236:237], v[14:15], v[236:237], v[14:15] op_sel:[1,0,0] op_sel_hi:[1,1,0]
    v_pk_fma_f32 v[238:239], v[14:15], v[238:239], v[14:15] op_sel:[1,0,0] op_sel_hi:[1,1,0]
    v_cvt_pk_f16_f32 v36, v232, v233
    v_cvt_pk_f16_f32 v37, v234, v235
    v_cvt_pk_f16_f32 v38, v236, v237
    v_cvt_pk_f16_f32 v39, v238, v239
    s_add_u32 m0, s70, 0
    s_nop 0
    buffer_load_dwordx4 v12, s[12:15], s71 offen offset:0 lds
    v_lshlrev_b32_e64 v224, 16, v40
    v_and_b32 v225, 0xffff0000, v40
    v_lshlrev_b32_e64 v226, 16, v41
    v_and_b32 v227, 0xffff0000, v41
    v_lshlrev_b32_e64 v228, 16, v42
    v_and_b32 v229, 0xffff0000, v42
    v_lshlrev_b32_e64 v230, 16, v43
    v_and_b32 v231, 0xffff0000, v43
    v_pk_fma_f32 v[224:225], v[14:15], v[224:225], v[14:15] op_sel:[1,0,0] op_sel_hi:[1,1,0]
    v_pk_fma_f32 v[226:227], v[14:15], v[226:227], v[14:15] op_sel:[1,0,0] op_sel_hi:[1,1,0]
    v_pk_fma_f32 v[228:229], v[14:15], v[228:229], v[14:15] op_sel:[1,0,0] op_sel_hi:[1,1,0]
    v_pk_fma_f32 v[230:231], v[14:15], v[230:231], v[14:15] op_sel:[1,0,0] op_sel_hi:[1,1,0]
    v_cvt_pk_f16_f32 v40, v224, v225
    v_cvt_pk_f16_f32 v41, v226, v227
    v_cvt_pk_f16_f32 v42, v228, v229
    v_cvt_pk_f16_f32 v43, v230, v231
    buffer_load_dwordx4 v13, s[12:15], s71 offen offset:1024 lds
    s_add_u32 s71, s71, 61440
    s_cmp_ge_u32 s71, s43
    s_cselect_b32 s51, 1228800, 0
    s_sub_u32 s71, s71, s51
    v_lshlrev_b32_e64 v232, 16, v44
    v_and_b32 v233, 0xffff0000, v44
    v_lshlrev_b32_e64 v234, 16, v45
    v_and_b32 v235, 0xffff0000, v45
    v_lshlrev_b32_e64 v236, 16, v46
    v_and_b32 v237, 0xffff0000, v46
    v_lshlrev_b32_e64 v238, 16, v47
    v_and_b32 v239, 0xffff0000, v47
    v_pk_fma_f32 v[232:233], v[14:15], v[232:233], v[14:15] op_sel:[1,0,0] op_sel_hi:[1,1,0]
    v_pk_fma_f32 v[234:235], v[14:15], v[234:235], v[14:15] op_sel:[1,0,0] op_sel_hi:[1,1,0]
    v_pk_fma_f32 v[236:237], v[14:15], v[236:237], v[14:15] op_sel:[1,0,0] op_sel_hi:[1,1,0]
    v_pk_fma_f32 v[238:239], v[14:15], v[238:239], v[14:15] op_sel:[1,0,0] op_sel_hi:[1,1,0]
    v_cvt_pk_f16_f32 v44, v232, v233
    v_cvt_pk_f16_f32 v45, v234, v235
    v_cvt_pk_f16_f32 v46, v236, v237
    v_cvt_pk_f16_f32 v47, v238, v239
    s_add_u32 m0, s70, 2048
    s_nop 0
    buffer_load_dwordx4 v12, s[12:15], s71 offen offset:0 lds
    v_lshlrev_b32 v224, 16, v48
    v_and_b32 v225, 0xffff0000, v48
    v_lshlrev_b32_e64 v226, 16, v49
    v_and_b32 v227, 0xffff0000, v49
    v_lshlrev_b32_e64 v228, 16, v50
    v_and_b32 v229, 0xffff0000, v50
    v_lshlrev_b32_e64 v230, 16, v51
    v_and_b32 v231, 0xffff0000, v51
    v_pk_fma_f32 v[224:225], v[14:15], v[224:225], v[14:15] op_sel:[1,0,0] op_sel_hi:[1,1,0]
    v_pk_fma_f32 v[226:227], v[14:15], v[226:227], v[14:15] op_sel:[1,0,0] op_sel_hi:[1,1,0]
    v_pk_fma_f32 v[228:229], v[14:15], v[228:229], v[14:15] op_sel:[1,0,0] op_sel_hi:[1,1,0]
    v_pk_fma_f32 v[230:231], v[14:15], v[230:231], v[14:15] op_sel:[1,0,0] op_sel_hi:[1,1,0]
    v_cvt_pk_f16_f32 v48, v224, v225
    v_cvt_pk_f16_f32 v49, v226, v227
    v_cvt_pk_f16_f32 v50, v228, v229
    v_cvt_pk_f16_f32 v51, v230, v231
    buffer_load_dwordx4 v13, s[12:15], s71 offen offset:1024 lds
    s_add_u32 s71, s71, 61440
    s_cmp_ge_u32 s71, s43
    s_cselect_b32 s51, 1228800, 0
    s_sub_u32 s71, s71, s51
    v_lshlrev_b32_e64 v232, 16, v52
    v_and_b32 v233, 0xffff0000, v52
    v_lshlrev_b32_e64 v234, 16, v53
    v_and_b32 v235, 0xffff0000, v53
    v_lshlrev_b32_e64 v236, 16, v54
    v_and_b32 v237, 0xffff0000, v54
    v_lshlrev_b32_e64 v238, 16, v55
    v_and_b32 v239, 0xffff0000, v55
    v_pk_fma_f32 v[232:233], v[14:15], v[232:233], v[14:15] op_sel:[1,0,0] op_sel_hi:[1,1,0]
    v_pk_fma_f32 v[234:235], v[14:15], v[234:235], v[14:15] op_sel:[1,0,0] op_sel_hi:[1,1,0]
    v_pk_fma_f32 v[236:237], v[14:15], v[236:237], v[14:15] op_sel:[1,0,0] op_sel_hi:[1,1,0]
    v_pk_fma_f32 v[238:239], v[14:15], v[238:239], v[14:15] op_sel:[1,0,0] op_sel_hi:[1,1,0]
    v_cvt_pk_f16_f32 v52, v232, v233
    v_cvt_pk_f16_f32 v53, v234, v235
    v_cvt_pk_f16_f32 v54, v236, v237
    v_cvt_pk_f16_f32 v55, v238, v239
    s_add_u32 m0, s70, 4096
    s_nop 0
    buffer_load_dwordx4 v12, s[12:15], s71 offen offset:0 lds
    v_lshlrev_b32 v224, 16, v56
    v_and_b32 v225, 0xffff0000, v56
    v_lshlrev_b32_e64 v226, 16, v57
    v_and_b32 v227, 0xffff0000, v57
    v_lshlrev_b32_e64 v228, 16, v58
    v_and_b32 v229, 0xffff0000, v58
    v_lshlrev_b32_e64 v230, 16, v59
    v_and_b32 v231, 0xffff0000, v59
    v_pk_fma_f32 v[224:225], v[14:15], v[224:225], v[14:15] op_sel:[1,0,0] op_sel_hi:[1,1,0]
    v_pk_fma_f32 v[226:227], v[14:15], v[226:227], v[14:15] op_sel:[1,0,0] op_sel_hi:[1,1,0]
    v_pk_fma_f32 v[228:229], v[14:15], v[228:229], v[14:15] op_sel:[1,0,0] op_sel_hi:[1,1,0]
    v_pk_fma_f32 v[230:231], v[14:15], v[230:231], v[14:15] op_sel:[1,0,0] op_sel_hi:[1,1,0]
    v_cvt_pk_f16_f32 v56, v224, v225
    v_cvt_pk_f16_f32 v57, v226, v227
    v_cvt_pk_f16_f32 v58, v228, v229
    v_cvt_pk_f16_f32 v59, v230, v231
    buffer_load_dwordx4 v13, s[12:15], s71 offen offset:1024 lds
    s_add_u32 s71, s71, 61440
    s_cmp_ge_u32 s71, s43
    s_cselect_b32 s51, 1228800, 0
    s_sub_u32 s71, s71, s51
    v_lshlrev_b32_e64 v232, 16, v60
    v_and_b32 v233, 0xffff0000, v60
    v_lshlrev_b32_e64 v234, 16, v61
    v_and_b32 v235, 0xffff0000, v61
    v_lshlrev_b32_e64 v236, 16, v62
    v_and_b32 v237, 0xffff0000, v62
    v_lshlrev_b32_e64 v238, 16, v63
    v_and_b32 v239, 0xffff0000, v63
    v_pk_fma_f32 v[232:233], v[14:15], v[232:233], v[14:15] op_sel:[1,0,0] op_sel_hi:[1,1,0]
    v_pk_fma_f32 v[234:235], v[14:15], v[234:235], v[14:15] op_sel:[1,0,0] op_sel_hi:[1,1,0]
    v_pk_fma_f32 v[236:237], v[14:15], v[236:237], v[14:15] op_sel:[1,0,0] op_sel_hi:[1,1,0]
    v_pk_fma_f32 v[238:239], v[14:15], v[238:239], v[14:15] op_sel:[1,0,0] op_sel_hi:[1,1,0]
    v_cvt_pk_f16_f32 v60, v232, v233
    v_cvt_pk_f16_f32 v61, v234, v235
    v_cvt_pk_f16_f32 v62, v236, v237
    v_cvt_pk_f16_f32 v63, v238, v239
    s_add_u32 m0, s70, 6144
    s_nop 0
    buffer_load_dwordx4 v12, s[12:15], s71 offen offset:0 lds
    v_lshlrev_b32 v224, 16, v64
    v_and_b32 v225, 0xffff0000, v64
    v_lshlrev_b32_e64 v226, 16, v65
    v_and_b32 v227, 0xffff0000, v65
    v_lshlrev_b32_e64 v228, 16, v66
    v_and_b32 v229, 0xffff0000, v66
    v_lshlrev_b32_e64 v230, 16, v67
    v_and_b32 v231, 0xffff0000, v67
    v_pk_fma_f32 v[224:225], v[14:15], v[224:225], v[14:15] op_sel:[1,0,0] op_sel_hi:[1,1,0]
    v_pk_fma_f32 v[226:227], v[14:15], v[226:227], v[14:15] op_sel:[1,0,0] op_sel_hi:[1,1,0]
    v_pk_fma_f32 v[228:229], v[14:15], v[228:229], v[14:15] op_sel:[1,0,0] op_sel_hi:[1,1,0]
    v_pk_fma_f32 v[230:231], v[14:15], v[230:231], v[14:15] op_sel:[1,0,0] op_sel_hi:[1,1,0]
    v_cvt_pk_f16_f32 v64, v224, v225
    v_cvt_pk_f16_f32 v65, v226, v227
    v_cvt_pk_f16_f32 v66, v228, v229
    v_cvt_pk_f16_f32 v67, v230, v231
    buffer_load_dwordx4 v13, s[12:15], s71 offen offset:1024 lds
    s_add_u32 s71, s71, 61440
    s_cmp_ge_u32 s71, s43
    s_cselect_b32 s51, 1228800, 0
    s_sub_u32 s71, s71, s51
    v_lshlrev_b32_e64 v232, 16, v68
    v_and_b32 v233, 0xffff0000, v68
    v_lshlrev_b32_e64 v234, 16, v69
    v_and_b32 v235, 0xffff0000, v69
    v_lshlrev_b32_e64 v236, 16, v70
    v_and_b32 v237, 0xffff0000, v70
    v_lshlrev_b32_e64 v238, 16, v71
    v_and_b32 v239, 0xffff0000, v71
    v_pk_fma_f32 v[232:233], v[14:15], v[232:233], v[14:15] op_sel:[1,0,0] op_sel_hi:[1,1,0]
    v_pk_fma_f32 v[234:235], v[14:15], v[234:235], v[14:15] op_sel:[1,0,0] op_sel_hi:[1,1,0]
    v_pk_fma_f32 v[236:237], v[14:15], v[236:237], v[14:15] op_sel:[1,0,0] op_sel_hi:[1,1,0]
    v_pk_fma_f32 v[238:239], v[14:15], v[238:239], v[14:15] op_sel:[1,0,0] op_sel_hi:[1,1,0]
    v_cvt_pk_f16_f32 v68, v232, v233
    v_cvt_pk_f16_f32 v69, v234, v235
    v_cvt_pk_f16_f32 v70, v236, v237
    v_cvt_pk_f16_f32 v71, v238, v239
    v_lshlrev_b32_e64 v224, 16, v72
    v_and_b32 v225, 0xffff0000, v72
    v_lshlrev_b32_e64 v226, 16, v73
    v_and_b32 v227, 0xffff0000, v73
    v_lshlrev_b32_e64 v228, 16, v74
    v_and_b32 v229, 0xffff0000, v74
    v_lshlrev_b32_e64 v230, 16, v75
    v_and_b32 v231, 0xffff0000, v75
    v_pk_fma_f32 v[224:225], v[14:15], v[224:225], v[14:15] op_sel:[1,0,0] op_sel_hi:[1,1,0]
    v_pk_fma_f32 v[226:227], v[14:15], v[226:227], v[14:15] op_sel:[1,0,0] op_sel_hi:[1,1,0]
    v_pk_fma_f32 v[228:229], v[14:15], v[228:229], v[14:15] op_sel:[1,0,0] op_sel_hi:[1,1,0]
    v_pk_fma_f32 v[230:231], v[14:15], v[230:231], v[14:15] op_sel:[1,0,0] op_sel_hi:[1,1,0]
    v_cvt_pk_f16_f32 v72, v224, v225
    v_cvt_pk_f16_f32 v73, v226, v227
    v_cvt_pk_f16_f32 v74, v228, v229
    v_cvt_pk_f16_f32 v75, v230, v231
    v_lshlrev_b32_e64 v232, 16, v76
    v_and_b32 v233, 0xffff0000, v76
    v_lshlrev_b32_e64 v234, 16, v77
    v_and_b32 v235, 0xffff0000, v77
    v_lshlrev_b32_e64 v236, 16, v78
    v_and_b32 v237, 0xffff0000, v78
    v_lshlrev_b32_e64 v238, 16, v79
    v_and_b32 v239, 0xffff0000, v79
    v_pk_fma_f32 v[232:233], v[14:15], v[232:233], v[14:15] op_sel:[1,0,0] op_sel_hi:[1,1,0]
    v_pk_fma_f32 v[234:235], v[14:15], v[234:235], v[14:15] op_sel:[1,0,0] op_sel_hi:[1,1,0]
    v_pk_fma_f32 v[236:237], v[14:15], v[236:237], v[14:15] op_sel:[1,0,0] op_sel_hi:[1,1,0]
    v_pk_fma_f32 v[238:239], v[14:15], v[238:239], v[14:15] op_sel:[1,0,0] op_sel_hi:[1,1,0]
    v_cvt_pk_f16_f32 v76, v232, v233
    v_cvt_pk_f16_f32 v77, v234, v235
    v_cvt_pk_f16_f32 v78, v236, v237
    v_cvt_pk_f16_f32 v79, v238, v239
    v_lshlrev_b32_e64 v224, 16, v80
    v_and_b32 v225, 0xffff0000, v80
    v_lshlrev_b32_e64 v226, 16, v81
    v_and_b32 v227, 0xffff0000, v81
    v_lshlrev_b32_e64 v228, 16, v82
    v_and_b32 v229, 0xffff0000, v82
    v_lshlrev_b32_e64 v230, 16, v83
    v_and_b32 v231, 0xffff0000, v83
    v_pk_fma_f32 v[224:225], v[14:15], v[224:225], v[14:15] op_sel:[1,0,0] op_sel_hi:[1,1,0]
    v_pk_fma_f32 v[226:227], v[14:15], v[226:227], v[14:15] op_sel:[1,0,0] op_sel_hi:[1,1,0]
    v_pk_fma_f32 v[228:229], v[14:15], v[228:229], v[14:15] op_sel:[1,0,0] op_sel_hi:[1,1,0]
    v_pk_fma_f32 v[230:231], v[14:15], v[230:231], v[14:15] op_sel:[1,0,0] op_sel_hi:[1,1,0]
    v_cvt_pk_f16_f32 v80, v224, v225
    v_cvt_pk_f16_f32 v81, v226, v227
    v_cvt_pk_f16_f32 v82, v228, v229
    v_cvt_pk_f16_f32 v83, v230, v231
    v_lshlrev_b32_e64 v232, 16, v84
    v_and_b32 v233, 0xffff0000, v84
    v_lshlrev_b32_e64 v234, 16, v85
    v_and_b32 v235, 0xffff0000, v85
    v_lshlrev_b32_e64 v236, 16, v86
    v_and_b32 v237, 0xffff0000, v86
    v_lshlrev_b32_e64 v238, 16, v87
    v_and_b32 v239, 0xffff0000, v87
    v_pk_fma_f32 v[232:233], v[14:15], v[232:233], v[14:15] op_sel:[1,0,0] op_sel_hi:[1,1,0]
    v_pk_fma_f32 v[234:235], v[14:15], v[234:235], v[14:15] op_sel:[1,0,0] op_sel_hi:[1,1,0]
    v_pk_fma_f32 v[236:237], v[14:15], v[236:237], v[14:15] op_sel:[1,0,0] op_sel_hi:[1,1,0]
    v_pk_fma_f32 v[238:239], v[14:15], v[238:239], v[14:15] op_sel:[1,0,0] op_sel_hi:[1,1,0]
    v_cvt_pk_f16_f32 v84, v232, v233
    v_cvt_pk_f16_f32 v85, v234, v235
    v_cvt_pk_f16_f32 v86, v236, v237
    v_cvt_pk_f16_f32 v87, v238, v239
    v_lshlrev_b32_e64 v224, 16, v88
    v_and_b32 v225, 0xffff0000, v88
    v_lshlrev_b32_e64 v226, 16, v89
    v_and_b32 v227, 0xffff0000, v89
    v_lshlrev_b32_e64 v228, 16, v90
    v_and_b32 v229, 0xffff0000, v90
    v_lshlrev_b32_e64 v230, 16, v91
    v_and_b32 v231, 0xffff0000, v91
    v_pk_fma_f32 v[224:225], v[14:15], v[224:225], v[14:15] op_sel:[1,0,0] op_sel_hi:[1,1,0]
    v_pk_fma_f32 v[226:227], v[14:15], v[226:227], v[14:15] op_sel:[1,0,0] op_sel_hi:[1,1,0]
    v_pk_fma_f32 v[228:229], v[14:15], v[228:229], v[14:15] op_sel:[1,0,0] op_sel_hi:[1,1,0]
    v_pk_fma_f32 v[230:231], v[14:15], v[230:231], v[14:15] op_sel:[1,0,0] op_sel_hi:[1,1,0]
    v_cvt_pk_f16_f32 v88, v224, v225
    v_cvt_pk_f16_f32 v89, v226, v227
    v_cvt_pk_f16_f32 v90, v228, v229
    v_cvt_pk_f16_f32 v91, v230, v231
    v_lshlrev_b32_e64 v232, 16, v92
    v_and_b32 v233, 0xffff0000, v92
    v_lshlrev_b32_e64 v234, 16, v93
    v_and_b32 v235, 0xffff0000, v93
    v_lshlrev_b32_e64 v236, 16, v94
    v_and_b32 v237, 0xffff0000, v94
    v_lshlrev_b32_e64 v238, 16, v95
    v_and_b32 v239, 0xffff0000, v95
    v_pk_fma_f32 v[232:233], v[14:15], v[232:233], v[14:15] op_sel:[1,0,0] op_sel_hi:[1,1,0]
    v_pk_fma_f32 v[234:235], v[14:15], v[234:235], v[14:15] op_sel:[1,0,0] op_sel_hi:[1,1,0]
    v_pk_fma_f32 v[236:237], v[14:15], v[236:237], v[14:15] op_sel:[1,0,0] op_sel_hi:[1,1,0]
    v_pk_fma_f32 v[238:239], v[14:15], v[238:239], v[14:15] op_sel:[1,0,0] op_sel_hi:[1,1,0]
    v_cvt_pk_f16_f32 v92, v232, v233
    v_cvt_pk_f16_f32 v93, v234, v235
    v_cvt_pk_f16_f32 v94, v236, v237
    v_cvt_pk_f16_f32 v95, v238, v239
    s_add_u32 m0, s70, 8192
    s_nop 0
    buffer_load_dwordx4 v12, s[12:15], s71 offen lds
    buffer_load_dwordx4 v13, s[12:15], s71 offen offset:1024 lds
    s_add_u32 s71, s71, 61440
    s_cmp_ge_u32 s71, s43
    s_cselect_b32 s51, 1228800, 0
    s_sub_u32 s71, s71, s51
    s_add_u32 m0, s70, 10240
    s_nop 0
    buffer_load_dwordx4 v12, s[12:15], s71 offen lds
    buffer_load_dwordx4 v13, s[12:15], s71 offen offset:1024 lds
    s_add_u32 s71, s71, 61440
    s_cmp_ge_u32 s71, s43
    s_cselect_b32 s51, 1228800, 0
    s_sub_u32 s71, s71, s51
    s_add_u32 m0, s70, 12288
    s_nop 0
    buffer_load_dwordx4 v12, s[12:15], s71 offen lds
    buffer_load_dwordx4 v13, s[12:15], s71 offen offset:1024 lds
    s_add_u32 s71, s71, 61440
    s_cmp_ge_u32 s71, s43
    s_cselect_b32 s51, 1228800, 0
    s_sub_u32 s71, s71, s51
    s_add_u32 m0, s70, 14336
    s_nop 0
    buffer_load_dwordx4 v12, s[12:15], s71 offen lds
    buffer_load_dwordx4 v13, s[12:15], s71 offen offset:1024 lds
    s_add_u32 s71, s71, 61440
    s_cmp_ge_u32 s71, s43
    s_cselect_b32 s51, 1228800, 0
    s_sub_u32 s71, s71, s51
    s_add_u32 m0, s70, 16384
    s_nop 0
    buffer_load_dwordx4 v12, s[12:15], s71 offen lds
    buffer_load_dwordx4 v13, s[12:15], s71 offen offset:1024 lds
    s_add_u32 s71, s71, 614400
    s_cmp_ge_u32 s71, s43
    s_cselect_b32 s51, 1228800, 0
    s_sub_u32 s71, s71, s51
    v_lshrrev_b32 v225, 8, v8
    v_lshrrev_b32 v226, 16, v8
    v_lshrrev_b32 v227, 24, v8
    s_cmp_lt_u32 s50, zlit_b-zlit_a+(5)
    s_cselect_b32 s58, 0x3ea52b5c, 1.0
    s_cmp_eq_u32 s54, 0
    s_cselect_b32 s52, 1.0, 0
    s_mov_b32 s59, zlit_b-zlit_a+(0)
    s_mov_b32 exec_hi, 0xff
    s_waitcnt vmcnt(18)
kf_kernel_a_chk:
    v_xor_b32 v228, v96, v8
    v_xor_b32 v229, v97, v225
    v_xor_b32 v230, v98, v226
    v_xor_b32_e64 v231, v99, v227
    v_bitop3_b32 v228, v228, v100, v8 bitop3:0xf6
    v_bitop3_b32 v229, v229, v101, v225 bitop3:0xf6
    v_bitop3_b32 v230, v230, v102, v226 bitop3:0xf6
    v_bitop3_b32 v231, v231, v103, v227 bitop3:0xf6
    v_bitop3_b32 v228, v228, v104, v8 bitop3:0xf6
    v_bitop3_b32 v229, v229, v105, v225 bitop3:0xf6
    v_bitop3_b32 v230, v230, v106, v226 bitop3:0xf6
    v_bitop3_b32 v231, v231, v107, v227 bitop3:0xf6
    v_bitop3_b32 v228, v228, v108, v8 bitop3:0xf6
    v_bitop3_b32 v229, v229, v109, v225 bitop3:0xf6
    v_bitop3_b32 v230, v230, v110, v226 bitop3:0xf6
    v_bitop3_b32 v231, v231, v111, v227 bitop3:0xf6
    v_bitop3_b32 v228, v228, v112, v8 bitop3:0xf6
    v_bitop3_b32 v229, v229, v113, v225 bitop3:0xf6
    v_bitop3_b32 v230, v230, v114, v226 bitop3:0xf6
    v_bitop3_b32 v231, v231, v115, v227 bitop3:0xf6
    v_bitop3_b32 v228, v228, v116, v8 bitop3:0xf6
    v_bitop3_b32 v229, v229, v117, v225 bitop3:0xf6
    v_bitop3_b32 v230, v230, v118, v226 bitop3:0xf6
    v_bitop3_b32 v231, v231, v119, v227 bitop3:0xf6
    v_bitop3_b32 v228, v228, v120, v8 bitop3:0xf6
    v_bitop3_b32 v229, v229, v121, v225 bitop3:0xf6
    v_bitop3_b32 v230, v230, v122, v226 bitop3:0xf6
    v_bitop3_b32 v231, v231, v123, v227 bitop3:0xf6
    v_bitop3_b32 v228, v228, v124, v8 bitop3:0xf6
    v_bitop3_b32 v229, v229, v125, v225 bitop3:0xf6
    v_bitop3_b32 v230, v230, v126, v226 bitop3:0xf6
    v_bitop3_b32 v231, v231, v127, v227 bitop3:0xf6
    v_bitop3_b32 v228, v228, v128, v8 bitop3:0xf6
    v_bitop3_b32 v229, v229, v129, v225 bitop3:0xf6
    v_bitop3_b32 v230, v230, v130, v226 bitop3:0xf6
    v_bitop3_b32 v231, v231, v131, v227 bitop3:0xf6
    v_bitop3_b32 v228, v228, v132, v8 bitop3:0xf6
    v_bitop3_b32 v229, v229, v133, v225 bitop3:0xf6
    v_bitop3_b32 v230, v230, v134, v226 bitop3:0xf6
    v_bitop3_b32 v231, v231, v135, v227 bitop3:0xf6
    v_or3_b32 v228, v228, v229, v230
    v_or_b32_e64 v228, v228, v231
    v_and_b32 v228, 0xff, v228
    v_cmp_ne_u32_e64 vcc, 0, v228
    s_cbranch_vccz kf_kernel_a_got
    s_sleep 2
    buffer_load_dwordx4 v[96:99], v248, s[8:11], s84 offen sc1
    buffer_load_dwordx4 v[100:103], v249, s[8:11], s84 offen sc1
    buffer_load_dwordx4 v[104:107], v248, s[8:11], s85 offen sc1
    buffer_load_dwordx4 v[108:111], v249, s[8:11], s85 offen sc1
    buffer_load_dwordx4 v[112:115], v248, s[8:11], s86 offen sc1
    buffer_load_dwordx4 v[116:119], v249, s[8:11], s86 offen sc1
    buffer_load_dwordx4 v[120:123], v248, s[8:11], s87 offen sc1
    buffer_load_dwordx4 v[124:127], v249, s[8:11], s87 offen sc1
    buffer_load_dwordx4 v[128:131], v248, s[8:11], s88 offen sc1
    buffer_load_dwordx4 v[132:135], v249, s[8:11], s88 offen sc1
    s_add_u32 s59, s59, zlit_b-zlit_a+(1)
    s_cmp_lt_u32 s59, 0x40000
    s_waitcnt vmcnt(0)
    s_cbranch_scc1 kf_kernel_a_chk
kf_kernel_a_got:
    v_pk_add_f32 v[96:97], v[96:97], v[104:105]
    v_pk_add_f32 v[112:113], v[112:113], v[120:121]
    v_pk_add_f32 v[98:99], v[98:99], v[106:107]
    v_pk_add_f32 v[114:115], v[114:115], v[122:123]
    v_pk_add_f32 v[100:101], v[100:101], v[108:109]
    v_pk_add_f32 v[116:117], v[116:117], v[124:125]
    v_pk_add_f32 v[102:103], v[102:103], v[110:111]
    v_pk_add_f32 v[118:119], v[118:119], v[126:127]
    v_pk_add_f32 v[96:97], v[96:97], v[128:129]
    v_pk_add_f32 v[98:99], v[98:99], v[130:131]
    v_pk_add_f32 v[100:101], v[100:101], v[132:133]
    v_pk_add_f32 v[102:103], v[102:103], v[134:135]
    v_pk_add_f32 v[96:97], v[96:97], v[112:113]
    v_pk_add_f32 v[98:99], v[98:99], v[114:115]
    v_pk_add_f32 v[100:101], v[100:101], v[116:117]
    v_pk_add_f32 v[102:103], v[102:103], v[118:119]
    v_cvt_pk_bf16_f32 v97, v96, v97
    v_cvt_pk_bf16_f32 v101, v100, v101
    v_cvt_pk_bf16_f32 v99, v98, v99
    v_cvt_pk_bf16_f32 v103, v102, v103
    v_lshlrev_b32 v96, 16, v97
    v_lshlrev_b32 v100, 16, v101
    v_and_b32 v97, 0xffff0000, v97
    v_and_b32 v101, 0xffff0000, v101
    v_lshlrev_b32 v98, 16, v99
    v_lshlrev_b32 v102, 16, v103
    v_and_b32 v99, 0xffff0000, v99
    v_and_b32 v103, 0xffff0000, v103
    v_add_f32 v96, s52, v96
    v_add_f32 v100, s52, v100
    v_add_f32 v97, s52, v97
    v_add_f32 v101, s52, v101
    v_add_f32 v98, s52, v98
    v_add_f32 v102, s52, v102
    v_add_f32 v99, s52, v99
    v_add_f32 v103, s52, v103
    v_cvt_pk_bf16_f32 v97, v96, v97
    v_cvt_pk_bf16_f32 v101, v100, v101
    v_cvt_pk_bf16_f32 v99, v98, v99
    v_cvt_pk_bf16_f32 v103, v102, v103
    v_lshlrev_b32 v96, 16, v97
    v_lshlrev_b32 v100, 16, v101
    v_and_b32 v97, 0xffff0000, v97
    v_and_b32 v101, 0xffff0000, v101
    v_lshlrev_b32 v98, 16, v99
    v_lshlrev_b32 v102, 16, v103
    v_and_b32 v99, 0xffff0000, v99
    v_and_b32 v103, 0xffff0000, v103
    v_mul_f32 v96, s58, v96
    v_mul_f32 v100, s58, v100
    v_mul_f32 v97, s58, v97
    v_mul_f32 v101, s58, v101
    v_mul_f32 v98, s58, v98
    v_mul_f32 v102, s58, v102
    v_mul_f32 v99, s58, v99
    v_mul_f32 v103, s58, v103
    ds_write_b128 v7, v[96:99] offset:18432
    ds_write_b128 v7, v[100:103] offset:19072
    s_mov_b32 exec_hi, -1
    s_waitcnt vmcnt(10)
    s_setprio 0
    s_cmp_eq_u32 s55, zlit_b-zlit_a+(0)
    s_waitcnt lgkmcnt(0)
    s_barrier
    s_cbranch_scc0 kf_kernel_a_vpe
    ds_read_b128 v[192:195], v6 offset:0
    ds_read_b128 v[200:203], v6 offset:20480
    ds_read_b128 v[196:199], v6 offset:16
    ds_read_b128 v[204:207], v6 offset:20496
    ds_read_b128 v[208:211], v6 offset:64
    ds_read_b128 v[216:219], v6 offset:20544
    ds_read_b128 v[212:215], v6 offset:80
    ds_read_b128 v[220:223], v6 offset:20560
    ds_read_b64_tr_b16 v[160:161], v4 offset:512
    ds_read_b64_tr_b16 v[162:163], v4 offset:20992
    ds_read_b64_tr_b16 v[164:165], v4 offset:768
    ds_read_b64_tr_b16 v[166:167], v4 offset:21248
    s_waitcnt lgkmcnt(8)
    v_fma_mix_f32 v224, v16, v192, v200 op_sel:[0,0,0] op_sel_hi:[1,0,0]
    v_fma_mix_f32 v225, v16, v193, v201 op_sel:[1,0,0] op_sel_hi:[1,0,0]
    v_fma_mix_f32 v226, v17, v194, v202 op_sel:[0,0,0] op_sel_hi:[1,0,0]
    v_fma_mix_f32 v227, v17, v195, v203 op_sel:[1,0,0] op_sel_hi:[1,0,0]
    v_fma_mix_f32 v228, v18, v196, v204 op_sel:[0,0,0] op_sel_hi:[1,0,0]
    v_fma_mix_f32 v229, v18, v197, v205 op_sel:[1,0,0] op_sel_hi:[1,0,0]
    v_fma_mix_f32 v230, v19, v198, v206 op_sel:[0,0,0] op_sel_hi:[1,0,0]
    v_fma_mix_f32 v231, v19, v199, v207 op_sel:[1,0,0] op_sel_hi:[1,0,0]
    v_cvt_pk_bf16_f32 v16, v224, v225
    v_cvt_pk_bf16_f32 v17, v226, v227
    v_cvt_pk_bf16_f32 v18, v228, v229
    v_cvt_pk_bf16_f32 v19, v230, v231
    s_waitcnt lgkmcnt(2)
    s_nop 0
    v_mfma_f32_32x32x16_bf16 v[128:143], v[160:163], v[16:19], 0
    ds_read_b64_tr_b16 v[168:169], v4 offset:2560
    ds_read_b64_tr_b16 v[170:171], v4 offset:23040
    ds_read_b128 v[192:195], v6 offset:128
    ds_read_b128 v[200:203], v6 offset:20608
    v_fma_mix_f32 v232, v20, v208, v216 op_sel:[0,0,0] op_sel_hi:[1,0,0]
    v_fma_mix_f32 v233, v20, v209, v217 op_sel:[1,0,0] op_sel_hi:[1,0,0]
    v_fma_mix_f32 v234, v21, v210, v218 op_sel:[0,0,0] op_sel_hi:[1,0,0]
    v_fma_mix_f32 v235, v21, v211, v219 op_sel:[1,0,0] op_sel_hi:[1,0,0]
    v_fma_mix_f32 v236, v22, v212, v220 op_sel:[0,0,0] op_sel_hi:[1,0,0]
    v_fma_mix_f32 v237, v22, v213, v221 op_sel:[1,0,0] op_sel_hi:[1,0,0]
    s_waitcnt lgkmcnt(4)
    v_mfma_f32_32x32x16_bf16 v[144:159], v[164:167], v[16:19], 0
    ds_read_b64_tr_b16 v[172:173], v4 offset:2816
    ds_read_b64_tr_b16 v[174:175], v4 offset:23296
    ds_read_b128 v[196:199], v6 offset:144
    ds_read_b128 v[204:207], v6 offset:20624
    v_fma_mix_f32 v238, v23, v214, v222 op_sel:[0,0,0] op_sel_hi:[1,0,0]
    v_fma_mix_f32 v239, v23, v215, v223 op_sel:[1,0,0] op_sel_hi:[1,0,0]
    v_cvt_pk_bf16_f32 v20, v232, v233
    v_cvt_pk_bf16_f32 v21, v234, v235
    v_cvt_pk_bf16_f32 v22, v236, v237
    v_cvt_pk_bf16_f32 v23, v238, v239
    s_waitcnt lgkmcnt(6)
    s_nop 0
    v_mfma_f32_32x32x16_bf16 v[128:143], v[168:171], v[20:23], v[128:143]
    ds_read_b64_tr_b16 v[176:177], v4 offset:4608
    ds_read_b64_tr_b16 v[178:179], v4 offset:25088
    ds_read_b128 v[208:211], v6 offset:192
    ds_read_b128 v[216:219], v6 offset:20672
    s_waitcnt lgkmcnt(4)
    v_fma_mix_f32 v224, v24, v192, v200 op_sel:[0,0,0] op_sel_hi:[1,0,0]
    v_fma_mix_f32 v225, v24, v193, v201 op_sel:[1,0,0] op_sel_hi:[1,0,0]
    v_fma_mix_f32 v226, v25, v194, v202 op_sel:[0,0,0] op_sel_hi:[1,0,0]
    v_fma_mix_f32 v227, v25, v195, v203 op_sel:[1,0,0] op_sel_hi:[1,0,0]
    v_fma_mix_f32 v228, v26, v196, v204 op_sel:[0,0,0] op_sel_hi:[1,0,0]
    v_fma_mix_f32 v229, v26, v197, v205 op_sel:[1,0,0] op_sel_hi:[1,0,0]
    v_mfma_f32_32x32x16_bf16 v[144:159], v[172:175], v[20:23], v[144:159]
    ds_read_b64_tr_b16 v[180:181], v4 offset:4864
    ds_read_b64_tr_b16 v[182:183], v4 offset:25344
    ds_read_b128 v[212:215], v6 offset:208
    ds_read_b128 v[220:223], v6 offset:20688
    v_fma_mix_f32 v230, v27, v198, v206 op_sel:[0,0,0] op_sel_hi:[1,0,0]
    v_fma_mix_f32 v231, v27, v199, v207 op_sel:[1,0,0] op_sel_hi:[1,0,0]
    v_cvt_pk_bf16_f32 v24, v224, v225
    v_cvt_pk_bf16_f32 v25, v226, v227
    v_cvt_pk_bf16_f32 v26, v228, v229
    v_cvt_pk_bf16_f32 v27, v230, v231
    s_waitcnt lgkmcnt(6)
    s_nop 0
    v_mfma_f32_32x32x16_bf16 v[128:143], v[176:179], v[24:27], v[128:143]
    ds_read_b64_tr_b16 v[184:185], v4 offset:6656
    ds_read_b64_tr_b16 v[186:187], v4 offset:27136
    ds_read_b64_tr_b16 v[188:189], v4 offset:6912
    ds_read_b64_tr_b16 v[190:191], v4 offset:27392
    ds_read_b128 v[192:195], v6 offset:256
    ds_read_b128 v[200:203], v6 offset:20736
    s_waitcnt lgkmcnt(6)
    v_fma_mix_f32 v232, v28, v208, v216 op_sel:[0,0,0] op_sel_hi:[1,0,0]
    v_fma_mix_f32 v233, v28, v209, v217 op_sel:[1,0,0] op_sel_hi:[1,0,0]
    v_fma_mix_f32 v234, v29, v210, v218 op_sel:[0,0,0] op_sel_hi:[1,0,0]
    v_fma_mix_f32 v235, v29, v211, v219 op_sel:[1,0,0] op_sel_hi:[1,0,0]
    v_fma_mix_f32 v236, v30, v212, v220 op_sel:[0,0,0] op_sel_hi:[1,0,0]
    v_fma_mix_f32 v237, v30, v213, v221 op_sel:[1,0,0] op_sel_hi:[1,0,0]
    v_mfma_f32_32x32x16_bf16 v[144:159], v[180:183], v[24:27], v[144:159]
    ds_read_b64_tr_b16 v[160:161], v4 offset:0
    ds_read_b64_tr_b16 v[162:163], v4 offset:20480
    ds_read_b64_tr_b16 v[164:165], v4 offset:256
    ds_read_b64_tr_b16 v[166:167], v4 offset:20736
    ds_read_b128 v[196:199], v6 offset:272
    ds_read_b128 v[204:207], v6 offset:20752
    v_fma_mix_f32 v238, v31, v214, v222 op_sel:[0,0,0] op_sel_hi:[1,0,0]
    v_fma_mix_f32 v239, v31, v215, v223 op_sel:[1,0,0] op_sel_hi:[1,0,0]
    v_cvt_pk_bf16_f32 v28, v232, v233
    v_cvt_pk_bf16_f32 v29, v234, v235
    v_cvt_pk_bf16_f32 v30, v236, v237
    v_cvt_pk_bf16_f32 v31, v238, v239
    s_waitcnt vmcnt(0)
    s_barrier
    s_waitcnt lgkmcnt(10)
    v_mfma_f32_32x32x16_bf16 v[128:143], v[184:187], v[28:31], v[128:143]
    ds_read_b64_tr_b16 v[168:169], v4 offset:8704
    ds_read_b64_tr_b16 v[170:171], v4 offset:29184
    ds_read_b128 v[208:211], v6 offset:320
    ds_read_b128 v[216:219], v6 offset:20800
    s_waitcnt lgkmcnt(4)
    v_fma_mix_f32 v224, v32, v192, v200 op_sel:[0,0,0] op_sel_hi:[1,0,0]
    v_fma_mix_f32 v225, v32, v193, v201 op_sel:[1,0,0] op_sel_hi:[1,0,0]
    v_fma_mix_f32 v226, v33, v194, v202 op_sel:[0,0,0] op_sel_hi:[1,0,0]
    v_mfma_f32_32x32x16_bf16 v[144:159], v[188:191], v[28:31], v[144:159]
    ds_read_b64_tr_b16 v[172:173], v4 offset:8960
    ds_read_b64_tr_b16 v[174:175], v4 offset:29440
    ds_read_b128 v[212:215], v6 offset:336
    ds_read_b128 v[220:223], v6 offset:20816
    v_fma_mix_f32 v227, v33, v195, v203 op_sel:[1,0,0] op_sel_hi:[1,0,0]
    v_fma_mix_f32 v228, v34, v196, v204 op_sel:[0,0,0] op_sel_hi:[1,0,0]
    v_fma_mix_f32 v229, v34, v197, v205 op_sel:[1,0,0] op_sel_hi:[1,0,0]
    v_mfma_f32_32x32x16_bf16 v[96:111], v[160:163], v[16:19], 0
    ds_read_b64_tr_b16 v[176:177], v4 offset:2048
    ds_read_b64_tr_b16 v[178:179], v4 offset:22528
    v_fma_mix_f32 v230, v35, v198, v206 op_sel:[0,0,0] op_sel_hi:[1,0,0]
    v_fma_mix_f32 v231, v35, v199, v207 op_sel:[1,0,0] op_sel_hi:[1,0,0]
    v_cvt_pk_bf16_f32 v32, v224, v225
    v_mfma_f32_32x32x16_bf16 v[112:127], v[164:167], v[16:19], 0
    ds_read_b64_tr_b16 v[180:181], v4 offset:2304
    ds_read_b64_tr_b16 v[182:183], v4 offset:22784
    v_cvt_pk_bf16_f32 v33, v226, v227
    v_cvt_pk_bf16_f32 v34, v228, v229
    v_cvt_pk_bf16_f32 v35, v230, v231
    s_mov_b32 exec_hi, s82
    buffer_load_dword v240, v10, s[44:47], s75 offen nt
    s_add_u32 s75, s75, s78
    buffer_load_dword v241, v10, s[44:47], s75 offen nt
    s_add_u32 s75, s75, s78
    s_mov_b32 exec_hi, zlit_b-zlit_a+(-1)
    s_waitcnt lgkmcnt(10)
    v_mfma_f32_32x32x16_bf16 v[128:143], v[168:171], v[32:35], v[128:143]
    ds_read_b64_tr_b16 v[184:185], v4 offset:10752
    ds_read_b64_tr_b16 v[186:187], v4 offset:31232
    ds_read_b128 v[192:195], v6 offset:384
    ds_read_b128 v[200:203], v6 offset:20864
    s_waitcnt lgkmcnt(8)
    v_fma_mix_f32 v232, v36, v208, v216 op_sel:[0,0,0] op_sel_hi:[1,0,0]
    v_fma_mix_f32 v233, v36, v209, v217 op_sel:[1,0,0] op_sel_hi:[1,0,0]
    v_fma_mix_f32 v234, v37, v210, v218 op_sel:[0,0,0] op_sel_hi:[1,0,0]
    v_mfma_f32_32x32x16_bf16 v[144:159], v[172:175], v[32:35], v[144:159]
    ds_read_b64_tr_b16 v[188:189], v4 offset:11008
    ds_read_b64_tr_b16 v[190:191], v4 offset:31488
    ds_read_b128 v[196:199], v6 offset:400
    ds_read_b128 v[204:207], v6 offset:20880
    v_fma_mix_f32 v235, v37, v211, v219 op_sel:[1,0,0] op_sel_hi:[1,0,0]
    v_fma_mix_f32 v236, v38, v212, v220 op_sel:[0,0,0] op_sel_hi:[1,0,0]
    v_fma_mix_f32 v237, v38, v213, v221 op_sel:[1,0,0] op_sel_hi:[1,0,0]
    s_waitcnt lgkmcnt(10)
    v_mfma_f32_32x32x16_bf16 v[96:111], v[176:179], v[20:23], v[96:111]
    ds_read_b64_tr_b16 v[160:161], v4 offset:4096
    ds_read_b64_tr_b16 v[162:163], v4 offset:24576
    v_fma_mix_f32 v238, v39, v214, v222 op_sel:[0,0,0] op_sel_hi:[1,0,0]
    v_fma_mix_f32 v239, v39, v215, v223 op_sel:[1,0,0] op_sel_hi:[1,0,0]
    v_cvt_pk_bf16_f32 v36, v232, v233
    s_waitcnt lgkmcnt(10)
    v_mfma_f32_32x32x16_bf16 v[112:127], v[180:183], v[20:23], v[112:127]
    ds_read_b64_tr_b16 v[164:165], v4 offset:4352
    ds_read_b64_tr_b16 v[166:167], v4 offset:24832
    v_cvt_pk_bf16_f32 v37, v234, v235
    v_cvt_pk_bf16_f32 v38, v236, v237
    v_cvt_pk_bf16_f32 v39, v238, v239
    s_mov_b32 exec_hi, s82
    buffer_load_dword v242, v10, s[44:47], s75 offen nt
    s_add_u32 s75, s75, s78
    buffer_load_dword v243, v10, s[44:47], s75 offen nt
    s_mul_i32 s51, s78, 3
    s_sub_u32 s51, s77, s51
    s_add_u32 s75, s75, s51
    s_mov_b32 exec_hi, -1
    s_waitcnt lgkmcnt(10)
    v_mfma_f32_32x32x16_bf16 v[128:143], v[184:187], v[36:39], v[128:143]
    ds_read_b64_tr_b16 v[168:169], v4 offset:12800
    ds_read_b64_tr_b16 v[170:171], v4 offset:33280
    ds_read_b128 v[208:211], v6 offset:448
    ds_read_b128 v[216:219], v6 offset:20928
    s_waitcnt lgkmcnt(8)
    v_fma_mix_f32 v224, v40, v192, v200 op_sel:[0,0,0] op_sel_hi:[1,0,0]
    v_fma_mix_f32 v225, v40, v193, v201 op_sel:[1,0,0] op_sel_hi:[1,0,0]
    v_fma_mix_f32 v226, v41, v194, v202 op_sel:[0,0,0] op_sel_hi:[1,0,0]
    v_mfma_f32_32x32x16_bf16 v[144:159], v[188:191], v[36:39], v[144:159]
    ds_read_b64_tr_b16 v[172:173], v4 offset:13056
    ds_read_b64_tr_b16 v[174:175], v4 offset:33536
    ds_read_b128 v[212:215], v6 offset:464
    ds_read_b128 v[220:223], v6 offset:20944
    v_fma_mix_f32 v227, v41, v195, v203 op_sel:[1,0,0] op_sel_hi:[1,0,0]
    v_fma_mix_f32 v228, v42, v196, v204 op_sel:[0,0,0] op_sel_hi:[1,0,0]
    v_fma_mix_f32 v229, v42, v197, v205 op_sel:[1,0,0] op_sel_hi:[1,0,0]
    s_waitcnt lgkmcnt(10)
    v_mfma_f32_32x32x16_bf16 v[96:111], v[160:163], v[24:27], v[96:111]
    ds_read_b64_tr_b16 v[176:177], v4 offset:6144
    ds_read_b64_tr_b16 v[178:179], v4 offset:26624
    v_fma_mix_f32 v230, v43, v198, v206 op_sel:[0,0,0] op_sel_hi:[1,0,0]
    v_fma_mix_f32 v231, v43, v199, v207 op_sel:[1,0,0] op_sel_hi:[1,0,0]
    v_cvt_pk_bf16_f32 v40, v224, v225
    s_waitcnt lgkmcnt(10)
    v_mfma_f32_32x32x16_bf16 v[112:127], v[164:167], v[24:27], v[112:127]
    ds_read_b64_tr_b16 v[180:181], v4 offset:6400
    ds_read_b64_tr_b16 v[182:183], v4 offset:26880
    v_cvt_pk_bf16_f32 v41, v226, v227
    v_cvt_pk_bf16_f32 v42, v228, v229
    v_cvt_pk_bf16_f32 v43, v230, v231
    s_mov_b32 exec_hi, s82
    buffer_load_dword v244, v10, s[44:47], s75 offen nt
    s_add_u32 s75, s75, s78
    buffer_load_dword v245, v10, s[44:47], s75 offen nt
    s_add_u32 s75, s75, s78
    s_mov_b32 exec_hi, -1
    s_waitcnt lgkmcnt(10)
    v_mfma_f32_32x32x16_bf16 v[128:143], v[168:171], v[40:43], v[128:143]
    ds_read_b64_tr_b16 v[184:185], v4 offset:14848
    ds_read_b64_tr_b16 v[186:187], v4 offset:35328
    ds_read_b128 v[192:195], v6 offset:512
    ds_read_b128 v[200:203], v6 offset:20992
    s_waitcnt lgkmcnt(8)
    v_fma_mix_f32 v232, v44, v208, v216 op_sel:[0,0,0] op_sel_hi:[1,0,0]
    v_fma_mix_f32 v233, v44, v209, v217 op_sel:[1,0,0] op_sel_hi:[1,0,0]
    v_fma_mix_f32 v234, v45, v210, v218 op_sel:[0,0,0] op_sel_hi:[1,0,0]
    v_mfma_f32_32x32x16_bf16 v[144:159], v[172:175], v[40:43], v[144:159]
    ds_read_b64_tr_b16 v[188:189], v4 offset:15104
    ds_read_b64_tr_b16 v[190:191], v4 offset:35584
    ds_read_b128 v[196:199], v6 offset:528
    ds_read_b128 v[204:207], v6 offset:21008
    v_fma_mix_f32 v235, v45, v211, v219 op_sel:[1,0,0] op_sel_hi:[1,0,0]
    v_fma_mix_f32 v236, v46, v212, v220 op_sel:[0,0,0] op_sel_hi:[1,0,0]
    v_fma_mix_f32 v237, v46, v213, v221 op_sel:[1,0,0] op_sel_hi:[1,0,0]
    s_waitcnt lgkmcnt(10)
    v_mfma_f32_32x32x16_bf16 v[96:111], v[176:179], v[28:31], v[96:111]
    ds_read_b64_tr_b16 v[160:161], v4 offset:8192
    ds_read_b64_tr_b16 v[162:163], v4 offset:28672
    v_fma_mix_f32 v238, v47, v214, v222 op_sel:[0,0,0] op_sel_hi:[1,0,0]
    v_fma_mix_f32 v239, v47, v215, v223 op_sel:[1,0,0] op_sel_hi:[1,0,0]
    v_cvt_pk_bf16_f32 v44, v232, v233
    s_waitcnt lgkmcnt(10)
    v_mfma_f32_32x32x16_bf16 v[112:127], v[180:183], v[28:31], v[112:127]
    ds_read_b64_tr_b16 v[164:165], v4 offset:8448
    ds_read_b64_tr_b16 v[166:167], v4 offset:28928
    v_cvt_pk_bf16_f32 v45, v234, v235
    v_cvt_pk_bf16_f32 v46, v236, v237
    v_cvt_pk_bf16_f32 v47, v238, v239
    s_mov_b32 exec_hi, s82
    buffer_load_dword v246, v10, s[44:47], s75 offen nt
    s_add_u32 s75, s75, s78
    buffer_load_dword v247, v10, s[44:47], s75 offen nt
    s_mov_b32 exec_hi, zlit_b-zlit_a+(-1)
    s_waitcnt lgkmcnt(10)
    v_mfma_f32_32x32x16_bf16 v[128:143], v[184:187], v[44:47], v[128:143]
    ds_read_b64_tr_b16 v[168:169], v4 offset:16896
    ds_read_b64_tr_b16 v[170:171], v4 offset:37376
    ds_read_b128 v[208:211], v6 offset:576
    ds_read_b128 v[216:219], v6 offset:21056
    s_waitcnt lgkmcnt(8)
    v_fma_mix_f32 v224, v48, v192, v200 op_sel:[0,0,0] op_sel_hi:[1,0,0]
    v_fma_mix_f32 v225, v48, v193, v201 op_sel:[1,0,0] op_sel_hi:[1,0,0]
    v_fma_mix_f32 v226, v49, v194, v202 op_sel:[0,0,0] op_sel_hi:[1,0,0]
    v_mfma_f32_32x32x16_bf16 v[144:159], v[188:191], v[44:47], v[144:159]
    ds_read_b64_tr_b16 v[172:173], v4 offset:17152
    ds_read_b64_tr_b16 v[174:175], v4 offset:37632
    ds_read_b128 v[212:215], v6 offset:592
    ds_read_b128 v[220:223], v6 offset:21072
    v_fma_mix_f32 v227, v49, v195, v203 op_sel:[1,0,0] op_sel_hi:[1,0,0]
    v_fma_mix_f32 v228, v50, v196, v204 op_sel:[0,0,0] op_sel_hi:[1,0,0]
    v_fma_mix_f32 v229, v50, v197, v205 op_sel:[1,0,0] op_sel_hi:[1,0,0]
    s_waitcnt lgkmcnt(10)
    v_mfma_f32_32x32x16_bf16 v[96:111], v[160:163], v[32:35], v[96:111]
    ds_read_b64_tr_b16 v[176:177], v4 offset:10240
    ds_read_b64_tr_b16 v[178:179], v4 offset:30720
    v_fma_mix_f32 v230, v51, v198, v206 op_sel:[0,0,0] op_sel_hi:[1,0,0]
    v_fma_mix_f32 v231, v51, v199, v207 op_sel:[1,0,0] op_sel_hi:[1,0,0]
    v_cvt_pk_bf16_f32 v48, v224, v225
    s_waitcnt lgkmcnt(10)
    v_mfma_f32_32x32x16_bf16 v[112:127], v[164:167], v[32:35], v[112:127]
    ds_read_b64_tr_b16 v[180:181], v4 offset:10496
    ds_read_b64_tr_b16 v[182:183], v4 offset:30976
    v_cvt_pk_bf16_f32 v49, v226, v227
    v_cvt_pk_bf16_f32 v50, v228, v229
    v_cvt_pk_bf16_f32 v51, v230, v231
    s_barrier
    s_add_u32 m0, s70, 0
    s_nop 0
    buffer_load_dwordx4 v12, s[12:15], s71 offen lds
    buffer_load_dwordx4 v13, s[12:15], s71 offen offset:1024 lds
    s_add_u32 s71, s71, 61440
    s_cmp_ge_u32 s71, s43
    s_cselect_b32 s51, 1228800, 0
    s_sub_u32 s71, s71, s51
    s_add_u32 m0, s70, 2048
    s_nop 0
    buffer_load_dwordx4 v12, s[12:15], s71 offen lds
    buffer_load_dwordx4 v13, s[12:15], s71 offen offset:1024 lds
    s_waitcnt lgkmcnt(10)
    v_mfma_f32_32x32x16_bf16 v[128:143], v[168:171], v[48:51], v[128:143]
    ds_read_b64_tr_b16 v[184:185], v5 offset:512
    ds_read_b64_tr_b16 v[186:187], v5 offset:20992
    ds_read_b128 v[192:195], v6 offset:640
    ds_read_b128 v[200:203], v6 offset:21120
    s_waitcnt lgkmcnt(8)
    v_fma_mix_f32 v232, v52, v208, v216 op_sel:[0,0,0] op_sel_hi:[1,0,0]
    v_fma_mix_f32 v233, v52, v209, v217 op_sel:[1,0,0] op_sel_hi:[1,0,0]
    v_fma_mix_f32 v234, v53, v210, v218 op_sel:[0,0,0] op_sel_hi:[1,0,0]
    v_mfma_f32_32x32x16_bf16 v[144:159], v[172:175], v[48:51], v[144:159]
    ds_read_b64_tr_b16 v[188:189], v5 offset:768
    ds_read_b64_tr_b16 v[190:191], v5 offset:21248
    ds_read_b128 v[196:199], v6 offset:656
    ds_read_b128 v[204:207], v6 offset:21136
    v_fma_mix_f32 v235, v53, v211, v219 op_sel:[1,0,0] op_sel_hi:[1,0,0]
    v_fma_mix_f32 v236, v54, v212, v220 op_sel:[0,0,0] op_sel_hi:[1,0,0]
    v_fma_mix_f32 v237, v54, v213, v221 op_sel:[1,0,0] op_sel_hi:[1,0,0]
    s_waitcnt lgkmcnt(10)
    v_mfma_f32_32x32x16_bf16 v[96:111], v[176:179], v[36:39], v[96:111]
    ds_read_b64_tr_b16 v[160:161], v4 offset:12288
    ds_read_b64_tr_b16 v[162:163], v4 offset:32768
    v_fma_mix_f32 v238, v55, v214, v222 op_sel:[0,0,0] op_sel_hi:[1,0,0]
    v_fma_mix_f32 v239, v55, v215, v223 op_sel:[1,0,0] op_sel_hi:[1,0,0]
    v_cvt_pk_bf16_f32 v52, v232, v233
    s_waitcnt lgkmcnt(10)
    v_mfma_f32_32x32x16_bf16 v[112:127], v[180:183], v[36:39], v[112:127]
    ds_read_b64_tr_b16 v[164:165], v4 offset:12544
    ds_read_b64_tr_b16 v[166:167], v4 offset:33024
    v_cvt_pk_bf16_f32 v53, v234, v235
    v_cvt_pk_bf16_f32 v54, v236, v237
    v_cvt_pk_bf16_f32 v55, v238, v239
    s_waitcnt lgkmcnt(10)
    s_nop 0
    v_mfma_f32_32x32x16_bf16 v[128:143], v[184:187], v[52:55], v[128:143]
    ds_read_b64_tr_b16 v[168:169], v5 offset:2560
    ds_read_b64_tr_b16 v[170:171], v5 offset:23040
    ds_read_b128 v[208:211], v6 offset:704
    ds_read_b128 v[216:219], v6 offset:21184
    s_waitcnt lgkmcnt(8)
    v_fma_mix_f32 v224, v56, v192, v200 op_sel:[0,0,0] op_sel_hi:[1,0,0]
    v_fma_mix_f32 v225, v56, v193, v201 op_sel:[1,0,0] op_sel_hi:[1,0,0]
    v_fma_mix_f32 v226, v57, v194, v202 op_sel:[0,0,0] op_sel_hi:[1,0,0]
    v_mfma_f32_32x32x16_bf16 v[144:159], v[188:191], v[52:55], v[144:159]
    ds_read_b64_tr_b16 v[172:173], v5 offset:2816
    ds_read_b64_tr_b16 v[174:175], v5 offset:23296
    ds_read_b128 v[212:215], v6 offset:720
    ds_read_b128 v[220:223], v6 offset:21200
    v_fma_mix_f32 v227, v57, v195, v203 op_sel:[1,0,0] op_sel_hi:[1,0,0]
    v_fma_mix_f32 v228, v58, v196, v204 op_sel:[0,0,0] op_sel_hi:[1,0,0]
    v_fma_mix_f32 v229, v58, v197, v205 op_sel:[1,0,0] op_sel_hi:[1,0,0]
    s_waitcnt lgkmcnt(10)
    v_mfma_f32_32x32x16_bf16 v[96:111], v[160:163], v[40:43], v[96:111]
    ds_read_b64_tr_b16 v[176:177], v4 offset:14336
    ds_read_b64_tr_b16 v[178:179], v4 offset:34816
    v_fma_mix_f32 v230, v59, v198, v206 op_sel:[0,0,0] op_sel_hi:[1,0,0]
    v_fma_mix_f32 v231, v59, v199, v207 op_sel:[1,0,0] op_sel_hi:[1,0,0]
    v_cvt_pk_bf16_f32 v56, v224, v225
    s_waitcnt lgkmcnt(10)
    v_mfma_f32_32x32x16_bf16 v[112:127], v[164:167], v[40:43], v[112:127]
    ds_read_b64_tr_b16 v[180:181], v4 offset:14592
    ds_read_b64_tr_b16 v[182:183], v4 offset:35072
    v_cvt_pk_bf16_f32 v57, v226, v227
    v_cvt_pk_bf16_f32 v58, v228, v229
    v_cvt_pk_bf16_f32 v59, v230, v231
    s_waitcnt lgkmcnt(10)
    s_nop 0
    v_mfma_f32_32x32x16_bf16 v[128:143], v[168:171], v[56:59], v[128:143]
    ds_read_b64_tr_b16 v[184:185], v5 offset:4608
    ds_read_b64_tr_b16 v[186:187], v5 offset:25088
    ds_read_b128 v[192:195], v6 offset:768
    ds_read_b128 v[200:203], v6 offset:21248
    s_waitcnt lgkmcnt(8)
    v_fma_mix_f32 v232, v60, v208, v216 op_sel:[0,0,0] op_sel_hi:[1,0,0]
    v_fma_mix_f32 v233, v60, v209, v217 op_sel:[1,0,0] op_sel_hi:[1,0,0]
    v_fma_mix_f32 v234, v61, v210, v218 op_sel:[0,0,0] op_sel_hi:[1,0,0]
    v_mfma_f32_32x32x16_bf16 v[144:159], v[172:175], v[56:59], v[144:159]
    ds_read_b64_tr_b16 v[188:189], v5 offset:4864
    ds_read_b64_tr_b16 v[190:191], v5 offset:25344
    ds_read_b128 v[196:199], v6 offset:784
    ds_read_b128 v[204:207], v6 offset:21264
    v_fma_mix_f32 v235, v61, v211, v219 op_sel:[1,0,0] op_sel_hi:[1,0,0]
    v_fma_mix_f32 v236, v62, v212, v220 op_sel:[0,0,0] op_sel_hi:[1,0,0]
    v_fma_mix_f32 v237, v62, v213, v221 op_sel:[1,0,0] op_sel_hi:[1,0,0]
    s_waitcnt lgkmcnt(10)
    v_mfma_f32_32x32x16_bf16 v[96:111], v[176:179], v[44:47], v[96:111]
    ds_read_b64_tr_b16 v[160:161], v4 offset:16384
    ds_read_b64_tr_b16 v[162:163], v4 offset:36864
    v_fma_mix_f32 v238, v63, v214, v222 op_sel:[0,0,0] op_sel_hi:[1,0,0]
    v_fma_mix_f32 v239, v63, v215, v223 op_sel:[1,0,0] op_sel_hi:[1,0,0]
    v_cvt_pk_bf16_f32 v60, v232, v233
    s_waitcnt lgkmcnt(10)
    v_mfma_f32_32x32x16_bf16 v[112:127], v[180:183], v[44:47], v[112:127]
    ds_read_b64_tr_b16 v[164:165], v4 offset:16640
    ds_read_b64_tr_b16 v[166:167], v4 offset:37120
    v_cvt_pk_bf16_f32 v61, v234, v235
    v_cvt_pk_bf16_f32 v62, v236, v237
    v_cvt_pk_bf16_f32 v63, v238, v239
    s_waitcnt lgkmcnt(10)
    s_nop 0
    v_mfma_f32_32x32x16_bf16 v[128:143], v[184:187], v[60:63], v[128:143]
    ds_read_b64_tr_b16 v[168:169], v5 offset:6656
    ds_read_b64_tr_b16 v[170:171], v5 offset:27136
    ds_read_b128 v[208:211], v6 offset:832
    ds_read_b128 v[216:219], v6 offset:21312
    s_waitcnt lgkmcnt(8)
    v_fma_mix_f32 v224, v64, v192, v200 op_sel:[0,0,0] op_sel_hi:[1,0,0]
    v_fma_mix_f32 v225, v64, v193, v201 op_sel:[1,0,0] op_sel_hi:[1,0,0]
    v_fma_mix_f32 v226, v65, v194, v202 op_sel:[0,0,0] op_sel_hi:[1,0,0]
    v_mfma_f32_32x32x16_bf16 v[144:159], v[188:191], v[60:63], v[144:159]
    ds_read_b64_tr_b16 v[172:173], v5 offset:6912
    ds_read_b64_tr_b16 v[174:175], v5 offset:27392
    ds_read_b128 v[212:215], v6 offset:848
    ds_read_b128 v[220:223], v6 offset:21328
    v_fma_mix_f32 v227, v65, v195, v203 op_sel:[1,0,0] op_sel_hi:[1,0,0]
    v_fma_mix_f32 v228, v66, v196, v204 op_sel:[0,0,0] op_sel_hi:[1,0,0]
    v_fma_mix_f32 v229, v66, v197, v205 op_sel:[1,0,0] op_sel_hi:[1,0,0]
    s_waitcnt lgkmcnt(10)
    v_mfma_f32_32x32x16_bf16 v[96:111], v[160:163], v[48:51], v[96:111]
    ds_read_b64_tr_b16 v[176:177], v5 offset:0
    ds_read_b64_tr_b16 v[178:179], v5 offset:20480
    v_fma_mix_f32 v230, v67, v198, v206 op_sel:[0,0,0] op_sel_hi:[1,0,0]
    v_fma_mix_f32 v231, v67, v199, v207 op_sel:[1,0,0] op_sel_hi:[1,0,0]
    v_cvt_pk_bf16_f32 v64, v224, v225
    s_waitcnt lgkmcnt(10)
    v_mfma_f32_32x32x16_bf16 v[112:127], v[164:167], v[48:51], v[112:127]
    ds_read_b64_tr_b16 v[180:181], v5 offset:256
    ds_read_b64_tr_b16 v[182:183], v5 offset:20736
    v_cvt_pk_bf16_f32 v65, v226, v227
    v_cvt_pk_bf16_f32 v66, v228, v229
    v_cvt_pk_bf16_f32 v67, v230, v231
    s_barrier
    s_waitcnt lgkmcnt(10)
    v_mfma_f32_32x32x16_bf16 v[128:143], v[168:171], v[64:67], v[128:143]
    ds_read_b64_tr_b16 v[184:185], v5 offset:8704
    ds_read_b64_tr_b16 v[186:187], v5 offset:29184
    ds_read_b128 v[192:195], v6 offset:896
    ds_read_b128 v[200:203], v6 offset:21376
    s_waitcnt lgkmcnt(8)
    v_fma_mix_f32 v232, v68, v208, v216 op_sel:[0,0,0] op_sel_hi:[1,0,0]
    v_fma_mix_f32 v233, v68, v209, v217 op_sel:[1,0,0] op_sel_hi:[1,0,0]
    v_fma_mix_f32 v234, v69, v210, v218 op_sel:[0,0,0] op_sel_hi:[1,0,0]
    v_mfma_f32_32x32x16_bf16 v[144:159], v[172:175], v[64:67], v[144:159]
    ds_read_b64_tr_b16 v[188:189], v5 offset:8960
    ds_read_b64_tr_b16 v[190:191], v5 offset:29440
    ds_read_b128 v[196:199], v6 offset:912
    ds_read_b128 v[204:207], v6 offset:21392
    v_fma_mix_f32 v235, v69, v211, v219 op_sel:[1,0,0] op_sel_hi:[1,0,0]
    v_fma_mix_f32 v236, v70, v212, v220 op_sel:[0,0,0] op_sel_hi:[1,0,0]
    v_fma_mix_f32 v237, v70, v213, v221 op_sel:[1,0,0] op_sel_hi:[1,0,0]
    s_waitcnt lgkmcnt(10)
    v_mfma_f32_32x32x16_bf16 v[96:111], v[176:179], v[52:55], v[96:111]
    ds_read_b64_tr_b16 v[160:161], v5 offset:2048
    ds_read_b64_tr_b16 v[162:163], v5 offset:22528
    v_fma_mix_f32 v238, v71, v214, v222 op_sel:[0,0,0] op_sel_hi:[1,0,0]
    v_fma_mix_f32 v239, v71, v215, v223 op_sel:[1,0,0] op_sel_hi:[1,0,0]
    v_cvt_pk_bf16_f32 v68, v232, v233
    s_waitcnt lgkmcnt(10)
    v_mfma_f32_32x32x16_bf16 v[112:127], v[180:183], v[52:55], v[112:127]
    ds_read_b64_tr_b16 v[164:165], v5 offset:2304
    ds_read_b64_tr_b16 v[166:167], v5 offset:22784
    v_cvt_pk_bf16_f32 v69, v234, v235
    v_cvt_pk_bf16_f32 v70, v236, v237
    v_cvt_pk_bf16_f32 v71, v238, v239
    s_waitcnt vmcnt(4)
    v_perm_b32 v248, v241, v240, s80
    v_perm_b32 v252, v241, v240, s81
    v_perm_b32 v249, v243, v242, s80
    v_perm_b32 v253, v243, v242, s81
    v_perm_b32 v250, v245, v244, s80
    v_perm_b32 v254, v245, v244, s81
    v_perm_b32 v251, v247, v246, s80
    v_perm_b32 v255, v247, v246, s81
    s_mov_b32 exec_hi, s82
    buffer_store_dwordx4 v[248:251], v11, s[8:11], s79 offen offset:0 sc1
    buffer_store_dwordx4 v[252:255], v11, s[8:11], s79 offen offset:16 sc1
    s_mov_b32 exec_hi, zlit_b-zlit_a+(-1)
    s_waitcnt lgkmcnt(10)
    v_mfma_f32_32x32x16_bf16 v[128:143], v[184:187], v[68:71], v[128:143]
    ds_read_b64_tr_b16 v[168:169], v5 offset:10752
    ds_read_b64_tr_b16 v[170:171], v5 offset:31232
    ds_read_b128 v[208:211], v6 offset:960
    ds_read_b128 v[216:219], v6 offset:21440
    s_waitcnt lgkmcnt(8)
    v_fma_mix_f32 v224, v72, v192, v200 op_sel:[0,0,0] op_sel_hi:[1,0,0]
    v_fma_mix_f32 v225, v72, v193, v201 op_sel:[1,0,0] op_sel_hi:[1,0,0]
    v_fma_mix_f32 v226, v73, v194, v202 op_sel:[0,0,0] op_sel_hi:[1,0,0]
    v_mfma_f32_32x32x16_bf16 v[144:159], v[188:191], v[68:71], v[144:159]
    ds_read_b64_tr_b16 v[172:173], v5 offset:11008
    ds_read_b64_tr_b16 v[174:175], v5 offset:31488
    ds_read_b128 v[212:215], v6 offset:976
    ds_read_b128 v[220:223], v6 offset:21456
    v_fma_mix_f32 v227, v73, v195, v203 op_sel:[1,0,0] op_sel_hi:[1,0,0]
    v_fma_mix_f32 v228, v74, v196, v204 op_sel:[0,0,0] op_sel_hi:[1,0,0]
    v_fma_mix_f32 v229, v74, v197, v205 op_sel:[1,0,0] op_sel_hi:[1,0,0]
    s_waitcnt lgkmcnt(10)
    v_mfma_f32_32x32x16_bf16 v[96:111], v[160:163], v[56:59], v[96:111]
    ds_read_b64_tr_b16 v[176:177], v5 offset:4096
    ds_read_b64_tr_b16 v[178:179], v5 offset:24576
    v_fma_mix_f32 v230, v75, v198, v206 op_sel:[0,0,0] op_sel_hi:[1,0,0]
    v_fma_mix_f32 v231, v75, v199, v207 op_sel:[1,0,0] op_sel_hi:[1,0,0]
    v_cvt_pk_bf16_f32 v72, v224, v225
    s_waitcnt lgkmcnt(10)
    v_mfma_f32_32x32x16_bf16 v[112:127], v[164:167], v[56:59], v[112:127]
    ds_read_b64_tr_b16 v[180:181], v5 offset:4352
    ds_read_b64_tr_b16 v[182:183], v5 offset:24832
    v_cvt_pk_bf16_f32 v73, v226, v227
    v_cvt_pk_bf16_f32 v74, v228, v229
    v_cvt_pk_bf16_f32 v75, v230, v231
    s_waitcnt lgkmcnt(10)
    s_nop 0
    v_mfma_f32_32x32x16_bf16 v[128:143], v[168:171], v[72:75], v[128:143]
    ds_read_b64_tr_b16 v[184:185], v5 offset:12800
    ds_read_b64_tr_b16 v[186:187], v5 offset:33280
    ds_read_b128 v[192:195], v6 offset:1024
    ds_read_b128 v[200:203], v6 offset:21504
    s_waitcnt lgkmcnt(8)
    v_fma_mix_f32 v232, v76, v208, v216 op_sel:[0,0,0] op_sel_hi:[1,0,0]
    v_fma_mix_f32 v233, v76, v209, v217 op_sel:[1,0,0] op_sel_hi:[1,0,0]
    v_fma_mix_f32 v234, v77, v210, v218 op_sel:[0,0,0] op_sel_hi:[1,0,0]
    v_mfma_f32_32x32x16_bf16 v[144:159], v[172:175], v[72:75], v[144:159]
    ds_read_b64_tr_b16 v[188:189], v5 offset:13056
    ds_read_b64_tr_b16 v[190:191], v5 offset:33536
    ds_read_b128 v[196:199], v6 offset:1040
    ds_read_b128 v[204:207], v6 offset:21520
    v_fma_mix_f32 v235, v77, v211, v219 op_sel:[1,0,0] op_sel_hi:[1,0,0]
    v_fma_mix_f32 v236, v78, v212, v220 op_sel:[0,0,0] op_sel_hi:[1,0,0]
    v_fma_mix_f32 v237, v78, v213, v221 op_sel:[1,0,0] op_sel_hi:[1,0,0]
    s_waitcnt lgkmcnt(10)
    v_mfma_f32_32x32x16_bf16 v[96:111], v[176:179], v[60:63], v[96:111]
    ds_read_b64_tr_b16 v[160:161], v5 offset:6144
    ds_read_b64_tr_b16 v[162:163], v5 offset:26624
    v_fma_mix_f32 v238, v79, v214, v222 op_sel:[0,0,0] op_sel_hi:[1,0,0]
    v_fma_mix_f32 v239, v79, v215, v223 op_sel:[1,0,0] op_sel_hi:[1,0,0]
    v_cvt_pk_bf16_f32 v76, v232, v233
    s_waitcnt lgkmcnt(10)
    v_mfma_f32_32x32x16_bf16 v[112:127], v[180:183], v[60:63], v[112:127]
    ds_read_b64_tr_b16 v[164:165], v5 offset:6400
    ds_read_b64_tr_b16 v[166:167], v5 offset:26880
    v_cvt_pk_bf16_f32 v77, v234, v235
    v_cvt_pk_bf16_f32 v78, v236, v237
    v_cvt_pk_bf16_f32 v79, v238, v239
    s_waitcnt lgkmcnt(10)
    s_nop 0
    v_mfma_f32_32x32x16_bf16 v[128:143], v[184:187], v[76:79], v[128:143]
    ds_read_b64_tr_b16 v[168:169], v5 offset:14848
    ds_read_b64_tr_b16 v[170:171], v5 offset:35328
    ds_read_b128 v[208:211], v6 offset:1088
    ds_read_b128 v[216:219], v6 offset:21568
    s_waitcnt lgkmcnt(8)
    v_fma_mix_f32 v224, v80, v192, v200 op_sel:[0,0,0] op_sel_hi:[1,0,0]
    v_fma_mix_f32 v225, v80, v193, v201 op_sel:[1,0,0] op_sel_hi:[1,0,0]
    v_fma_mix_f32 v226, v81, v194, v202 op_sel:[0,0,0] op_sel_hi:[1,0,0]
    v_mfma_f32_32x32x16_bf16 v[144:159], v[188:191], v[76:79], v[144:159]
    ds_read_b64_tr_b16 v[172:173], v5 offset:15104
    ds_read_b64_tr_b16 v[174:175], v5 offset:35584
    ds_read_b128 v[212:215], v6 offset:1104
    ds_read_b128 v[220:223], v6 offset:21584
    v_fma_mix_f32 v227, v81, v195, v203 op_sel:[1,0,0] op_sel_hi:[1,0,0]
    v_fma_mix_f32 v228, v82, v196, v204 op_sel:[0,0,0] op_sel_hi:[1,0,0]
    v_fma_mix_f32 v229, v82, v197, v205 op_sel:[1,0,0] op_sel_hi:[1,0,0]
    s_waitcnt lgkmcnt(10)
    v_mfma_f32_32x32x16_bf16 v[96:111], v[160:163], v[64:67], v[96:111]
    ds_read_b64_tr_b16 v[176:177], v5 offset:8192
    ds_read_b64_tr_b16 v[178:179], v5 offset:28672
    v_fma_mix_f32 v230, v83, v198, v206 op_sel:[0,0,0] op_sel_hi:[1,0,0]
    v_fma_mix_f32 v231, v83, v199, v207 op_sel:[1,0,0] op_sel_hi:[1,0,0]
    v_cvt_pk_bf16_f32 v80, v224, v225
    s_waitcnt lgkmcnt(10)
    v_mfma_f32_32x32x16_bf16 v[112:127], v[164:167], v[64:67], v[112:127]
    ds_read_b64_tr_b16 v[180:181], v5 offset:8448
    ds_read_b64_tr_b16 v[182:183], v5 offset:28928
    v_cvt_pk_bf16_f32 v81, v226, v227
    v_cvt_pk_bf16_f32 v82, v228, v229
    v_cvt_pk_bf16_f32 v83, v230, v231
    s_waitcnt lgkmcnt(10)
    s_nop 0
    v_mfma_f32_32x32x16_bf16 v[128:143], v[168:171], v[80:83], v[128:143]
    ds_read_b64_tr_b16 v[184:185], v5 offset:16896
    ds_read_b64_tr_b16 v[186:187], v5 offset:37376
    ds_read_b128 v[192:195], v6 offset:1152
    ds_read_b128 v[200:203], v6 offset:21632
    s_waitcnt lgkmcnt(8)
    v_fma_mix_f32 v232, v84, v208, v216 op_sel:[0,0,0] op_sel_hi:[1,0,0]
    v_fma_mix_f32 v233, v84, v209, v217 op_sel:[1,0,0] op_sel_hi:[1,0,0]
    v_fma_mix_f32 v234, v85, v210, v218 op_sel:[0,0,0] op_sel_hi:[1,0,0]
    v_mfma_f32_32x32x16_bf16 v[144:159], v[172:175], v[80:83], v[144:159]
    ds_read_b64_tr_b16 v[188:189], v5 offset:17152
    ds_read_b64_tr_b16 v[190:191], v5 offset:37632
    ds_read_b128 v[196:199], v6 offset:1168
    ds_read_b128 v[204:207], v6 offset:21648
    v_fma_mix_f32 v235, v85, v211, v219 op_sel:[1,0,0] op_sel_hi:[1,0,0]
    v_fma_mix_f32 v236, v86, v212, v220 op_sel:[0,0,0] op_sel_hi:[1,0,0]
    v_fma_mix_f32 v237, v86, v213, v221 op_sel:[1,0,0] op_sel_hi:[1,0,0]
    s_waitcnt lgkmcnt(10)
    v_mfma_f32_32x32x16_bf16 v[96:111], v[176:179], v[68:71], v[96:111]
    ds_read_b64_tr_b16 v[160:161], v5 offset:10240
    ds_read_b64_tr_b16 v[162:163], v5 offset:30720
    v_fma_mix_f32 v238, v87, v214, v222 op_sel:[0,0,0] op_sel_hi:[1,0,0]
    v_fma_mix_f32 v239, v87, v215, v223 op_sel:[1,0,0] op_sel_hi:[1,0,0]
    v_cvt_pk_bf16_f32 v84, v232, v233
    s_waitcnt lgkmcnt(10)
    v_mfma_f32_32x32x16_bf16 v[112:127], v[180:183], v[68:71], v[112:127]
    ds_read_b64_tr_b16 v[164:165], v5 offset:10496
    ds_read_b64_tr_b16 v[166:167], v5 offset:30976
    v_cvt_pk_bf16_f32 v85, v234, v235
    v_cvt_pk_bf16_f32 v86, v236, v237
    v_cvt_pk_bf16_f32 v87, v238, v239
    s_waitcnt vmcnt(2)
    s_barrier
    s_waitcnt lgkmcnt(10)
    v_mfma_f32_32x32x16_bf16 v[128:143], v[184:187], v[84:87], v[128:143]
    ds_read_b64_tr_b16 v[168:169], v4 offset:512
    ds_read_b64_tr_b16 v[170:171], v4 offset:20992
    ds_read_b128 v[208:211], v6 offset:1216
    ds_read_b128 v[216:219], v6 offset:21696
    s_waitcnt lgkmcnt(8)
    v_fma_mix_f32 v224, v88, v192, v200 op_sel:[0,0,0] op_sel_hi:[1,0,0]
    v_fma_mix_f32 v225, v88, v193, v201 op_sel:[1,0,0] op_sel_hi:[1,0,0]
    v_fma_mix_f32 v226, v89, v194, v202 op_sel:[0,0,0] op_sel_hi:[1,0,0]
    v_mfma_f32_32x32x16_bf16 v[144:159], v[188:191], v[84:87], v[144:159]
    ds_read_b64_tr_b16 v[172:173], v4 offset:768
    ds_read_b64_tr_b16 v[174:175], v4 offset:21248
    ds_read_b128 v[212:215], v6 offset:1232
    ds_read_b128 v[220:223], v6 offset:21712
    v_fma_mix_f32 v227, v89, v195, v203 op_sel:[1,0,0] op_sel_hi:[1,0,0]
    v_fma_mix_f32 v228, v90, v196, v204 op_sel:[0,0,0] op_sel_hi:[1,0,0]
    v_fma_mix_f32 v229, v90, v197, v205 op_sel:[1,0,0] op_sel_hi:[1,0,0]
    s_waitcnt lgkmcnt(10)
    v_mfma_f32_32x32x16_bf16 v[96:111], v[160:163], v[72:75], v[96:111]
    ds_read_b64_tr_b16 v[176:177], v5 offset:12288
    ds_read_b64_tr_b16 v[178:179], v5 offset:32768
    v_fma_mix_f32 v230, v91, v198, v206 op_sel:[0,0,0] op_sel_hi:[1,0,0]
    v_fma_mix_f32 v231, v91, v199, v207 op_sel:[1,0,0] op_sel_hi:[1,0,0]
    v_cvt_pk_bf16_f32 v88, v224, v225
    s_waitcnt lgkmcnt(10)
    v_mfma_f32_32x32x16_bf16 v[112:127], v[164:167], v[72:75], v[112:127]
    ds_read_b64_tr_b16 v[180:181], v5 offset:12544
    ds_read_b64_tr_b16 v[182:183], v5 offset:33024
    v_cvt_pk_bf16_f32 v89, v226, v227
    v_cvt_pk_bf16_f32 v90, v228, v229
    v_cvt_pk_bf16_f32 v91, v230, v231
    s_waitcnt lgkmcnt(10)
    s_nop 0
    v_mfma_f32_32x32x16_bf16 v[128:143], v[168:171], v[88:91], v[128:143]
    ds_read_b64_tr_b16 v[184:185], v4 offset:2560
    ds_read_b64_tr_b16 v[186:187], v4 offset:23040
    s_waitcnt lgkmcnt(6)
    v_fma_mix_f32 v232, v92, v208, v216 op_sel:[0,0,0] op_sel_hi:[1,0,0]
    v_fma_mix_f32 v233, v92, v209, v217 op_sel:[1,0,0] op_sel_hi:[1,0,0]
    v_fma_mix_f32 v234, v93, v210, v218 op_sel:[0,0,0] op_sel_hi:[1,0,0]
    v_mfma_f32_32x32x16_bf16 v[144:159], v[172:175], v[88:91], v[144:159]
    ds_read_b64_tr_b16 v[188:189], v4 offset:2816
    ds_read_b64_tr_b16 v[190:191], v4 offset:23296
    v_fma_mix_f32 v235, v93, v211, v219 op_sel:[1,0,0] op_sel_hi:[1,0,0]
    v_fma_mix_f32 v236, v94, v212, v220 op_sel:[0,0,0] op_sel_hi:[1,0,0]
    v_fma_mix_f32 v237, v94, v213, v221 op_sel:[1,0,0] op_sel_hi:[1,0,0]
    s_waitcnt lgkmcnt(6)
    v_mfma_f32_32x32x16_bf16 v[96:111], v[176:179], v[76:79], v[96:111]
    ds_read_b64_tr_b16 v[160:161], v5 offset:14336
    ds_read_b64_tr_b16 v[162:163], v5 offset:34816
    v_fma_mix_f32 v238, v95, v214, v222 op_sel:[0,0,0] op_sel_hi:[1,0,0]
    v_fma_mix_f32 v239, v95, v215, v223 op_sel:[1,0,0] op_sel_hi:[1,0,0]
    v_cvt_pk_bf16_f32 v92, v232, v233
    s_waitcnt lgkmcnt(6)
    v_mfma_f32_32x32x16_bf16 v[112:127], v[180:183], v[76:79], v[112:127]
    ds_read_b64_tr_b16 v[164:165], v5 offset:14592
    ds_read_b64_tr_b16 v[166:167], v5 offset:35072
    v_cvt_pk_bf16_f32 v93, v234, v235
    v_cvt_pk_bf16_f32 v94, v236, v237
    v_cvt_pk_bf16_f32 v95, v238, v239
    s_waitcnt lgkmcnt(6)
    s_nop 0
    v_mfma_f32_32x32x16_bf16 v[128:143], v[184:187], v[92:95], v[128:143]
    ds_read_b64_tr_b16 v[168:169], v5 offset:16384
    ds_read_b64_tr_b16 v[170:171], v5 offset:36864
    s_waitcnt lgkmcnt(6)
    v_mfma_f32_32x32x16_bf16 v[144:159], v[188:191], v[92:95], v[144:159]
    ds_read_b64_tr_b16 v[172:173], v5 offset:16640
    ds_read_b64_tr_b16 v[174:175], v5 offset:37120
    s_waitcnt lgkmcnt(6)
    v_mfma_f32_32x32x16_bf16 v[96:111], v[160:163], v[80:83], v[96:111]
    s_waitcnt lgkmcnt(4)
    v_mfma_f32_32x32x16_bf16 v[112:127], v[164:167], v[80:83], v[112:127]
    s_waitcnt lgkmcnt(2)
    v_mfma_f32_32x32x16_bf16 v[96:111], v[168:171], v[84:87], v[96:111]
    ds_read_b64_tr_b16 v[176:177], v4 offset:0
    ds_read_b64_tr_b16 v[178:179], v4 offset:20480
    s_waitcnt lgkmcnt(2)
    v_mfma_f32_32x32x16_bf16 v[112:127], v[172:175], v[84:87], v[112:127]
    ds_read_b64_tr_b16 v[180:181], v4 offset:256
    ds_read_b64_tr_b16 v[182:183], v4 offset:20736
    ds_write_b128 v7, v[128:131] offset:4096
    ds_write_b128 v7, v[132:135] offset:5120
    s_waitcnt lgkmcnt(4)
    v_mfma_f32_32x32x16_bf16 v[96:111], v[176:179], v[88:91], v[96:111]
    ds_read_b64_tr_b16 v[184:185], v4 offset:2048
    ds_read_b64_tr_b16 v[186:187], v4 offset:22528
    ds_write_b128 v7, v[136:139] offset:6144
    ds_write_b128 v7, v[140:143] offset:7168
    s_waitcnt lgkmcnt(6)
    v_mfma_f32_32x32x16_bf16 v[112:127], v[180:183], v[88:91], v[112:127]
    ds_read_b64_tr_b16 v[188:189], v4 offset:2304
    ds_read_b64_tr_b16 v[190:191], v4 offset:22784
    ds_write_b128 v7, v[144:147] offset:8192
    ds_write_b128 v7, v[148:151] offset:9216
    s_waitcnt lgkmcnt(6)
    v_mfma_f32_32x32x16_bf16 v[96:111], v[184:187], v[92:95], v[96:111]
    ds_write_b128 v7, v[152:155] offset:10240
    ds_write_b128 v7, v[156:159] offset:11264
    s_waitcnt lgkmcnt(4)
    v_mfma_f32_32x32x16_bf16 v[112:127], v[188:191], v[92:95], v[112:127]
    s_waitcnt lgkmcnt(0)
    s_barrier
    ds_read_b128 v[128:131], v0 offset:4096
    ds_read_b128 v[132:135], v0 offset:5120
    ds_read_b128 v[136:139], v0 offset:6144
    ds_read_b128 v[140:143], v0 offset:7168
    ds_read_b128 v[144:147], v0 offset:8192
    ds_read_b128 v[148:151], v0 offset:9216
    ds_read_b128 v[152:155], v0 offset:10240
    ds_read_b128 v[156:159], v0 offset:11264
    s_branch kf_kernel_a_epn
kf_kernel_a_vpe:
    ds_read_b128 v[192:195], v6 offset:0
    ds_read_b128 v[200:203], v6 offset:20480
    ds_read_b128 v[196:199], v6 offset:16
    ds_read_b128 v[204:207], v6 offset:20496
    ds_read_b128 v[208:211], v6 offset:64
    ds_read_b128 v[216:219], v6 offset:20544
    ds_read_b128 v[212:215], v6 offset:80
    ds_read_b128 v[220:223], v6 offset:20560
    ds_read_b64_tr_b16 v[160:161], v4 offset:512
    ds_read_b64_tr_b16 v[162:163], v4 offset:20992
    ds_read_b64_tr_b16 v[164:165], v4 offset:768
    ds_read_b64_tr_b16 v[166:167], v4 offset:21248
    s_waitcnt lgkmcnt(8)
    v_fma_mix_f32 v224, v16, v192, v200 op_sel:[0,0,0] op_sel_hi:[1,0,0]
    v_fma_mix_f32 v225, v16, v193, v201 op_sel:[1,0,0] op_sel_hi:[1,0,0]
    v_fma_mix_f32 v226, v17, v194, v202 op_sel:[0,0,0] op_sel_hi:[1,0,0]
    v_fma_mix_f32 v227, v17, v195, v203 op_sel:[1,0,0] op_sel_hi:[1,0,0]
    v_fma_mix_f32 v228, v18, v196, v204 op_sel:[0,0,0] op_sel_hi:[1,0,0]
    v_fma_mix_f32 v229, v18, v197, v205 op_sel:[1,0,0] op_sel_hi:[1,0,0]
    v_fma_mix_f32 v230, v19, v198, v206 op_sel:[0,0,0] op_sel_hi:[1,0,0]
    v_fma_mix_f32 v231, v19, v199, v207 op_sel:[1,0,0] op_sel_hi:[1,0,0]
    v_cvt_pk_bf16_f32 v16, v224, v225
    v_cvt_pk_bf16_f32 v17, v226, v227
    v_cvt_pk_bf16_f32 v18, v228, v229
    v_cvt_pk_bf16_f32 v19, v230, v231
    s_waitcnt lgkmcnt(2)
    s_nop 0
    v_mfma_f32_32x32x16_bf16 v[128:143], v[16:19], v[160:163], 0
    ds_read_b64_tr_b16 v[168:169], v4 offset:2560
    ds_read_b64_tr_b16 v[170:171], v4 offset:23040
    ds_read_b128 v[192:195], v6 offset:128
    ds_read_b128 v[200:203], v6 offset:20608
    v_fma_mix_f32 v232, v20, v208, v216 op_sel:[0,0,0] op_sel_hi:[1,0,0]
    v_fma_mix_f32 v233, v20, v209, v217 op_sel:[1,0,0] op_sel_hi:[1,0,0]
    v_fma_mix_f32 v234, v21, v210, v218 op_sel:[0,0,0] op_sel_hi:[1,0,0]
    v_fma_mix_f32 v235, v21, v211, v219 op_sel:[1,0,0] op_sel_hi:[1,0,0]
    v_fma_mix_f32 v236, v22, v212, v220 op_sel:[0,0,0] op_sel_hi:[1,0,0]
    v_fma_mix_f32 v237, v22, v213, v221 op_sel:[1,0,0] op_sel_hi:[1,0,0]
    s_waitcnt lgkmcnt(4)
    v_mfma_f32_32x32x16_bf16 v[144:159], v[16:19], v[164:167], 0
    ds_read_b64_tr_b16 v[172:173], v4 offset:2816
    ds_read_b64_tr_b16 v[174:175], v4 offset:23296
    ds_read_b128 v[196:199], v6 offset:144
    ds_read_b128 v[204:207], v6 offset:20624
    v_fma_mix_f32 v238, v23, v214, v222 op_sel:[0,0,0] op_sel_hi:[1,0,0]
    v_fma_mix_f32 v239, v23, v215, v223 op_sel:[1,0,0] op_sel_hi:[1,0,0]
    v_cvt_pk_bf16_f32 v20, v232, v233
    v_cvt_pk_bf16_f32 v21, v234, v235
    v_cvt_pk_bf16_f32 v22, v236, v237
    v_cvt_pk_bf16_f32 v23, v238, v239
    s_waitcnt lgkmcnt(6)
    s_nop 0
    v_mfma_f32_32x32x16_bf16 v[128:143], v[20:23], v[168:171], v[128:143]
    ds_read_b64_tr_b16 v[176:177], v4 offset:4608
    ds_read_b64_tr_b16 v[178:179], v4 offset:25088
    ds_read_b128 v[208:211], v6 offset:192
    ds_read_b128 v[216:219], v6 offset:20672
    s_waitcnt lgkmcnt(4)
    v_fma_mix_f32 v224, v24, v192, v200 op_sel:[0,0,0] op_sel_hi:[1,0,0]
    v_fma_mix_f32 v225, v24, v193, v201 op_sel:[1,0,0] op_sel_hi:[1,0,0]
    v_fma_mix_f32 v226, v25, v194, v202 op_sel:[0,0,0] op_sel_hi:[1,0,0]
    v_fma_mix_f32 v227, v25, v195, v203 op_sel:[1,0,0] op_sel_hi:[1,0,0]
    v_fma_mix_f32 v228, v26, v196, v204 op_sel:[0,0,0] op_sel_hi:[1,0,0]
    v_fma_mix_f32 v229, v26, v197, v205 op_sel:[1,0,0] op_sel_hi:[1,0,0]
    v_mfma_f32_32x32x16_bf16 v[144:159], v[20:23], v[172:175], v[144:159]
    ds_read_b64_tr_b16 v[180:181], v4 offset:4864
    ds_read_b64_tr_b16 v[182:183], v4 offset:25344
    ds_read_b128 v[212:215], v6 offset:208
    ds_read_b128 v[220:223], v6 offset:20688
    v_fma_mix_f32 v230, v27, v198, v206 op_sel:[0,0,0] op_sel_hi:[1,0,0]
    v_fma_mix_f32 v231, v27, v199, v207 op_sel:[1,0,0] op_sel_hi:[1,0,0]
    v_cvt_pk_bf16_f32 v24, v224, v225
    v_cvt_pk_bf16_f32 v25, v226, v227
    v_cvt_pk_bf16_f32 v26, v228, v229
    v_cvt_pk_bf16_f32 v27, v230, v231
    s_waitcnt lgkmcnt(6)
    s_nop 0
    v_mfma_f32_32x32x16_bf16 v[128:143], v[24:27], v[176:179], v[128:143]
    ds_read_b64_tr_b16 v[184:185], v4 offset:6656
    ds_read_b64_tr_b16 v[186:187], v4 offset:27136
    ds_read_b64_tr_b16 v[188:189], v4 offset:6912
    ds_read_b64_tr_b16 v[190:191], v4 offset:27392
    ds_read_b128 v[192:195], v6 offset:256
    ds_read_b128 v[200:203], v6 offset:20736
    s_waitcnt lgkmcnt(6)
    v_fma_mix_f32 v232, v28, v208, v216 op_sel:[0,0,0] op_sel_hi:[1,0,0]
    v_fma_mix_f32 v233, v28, v209, v217 op_sel:[1,0,0] op_sel_hi:[1,0,0]
    v_fma_mix_f32 v234, v29, v210, v218 op_sel:[0,0,0] op_sel_hi:[1,0,0]
    v_fma_mix_f32 v235, v29, v211, v219 op_sel:[1,0,0] op_sel_hi:[1,0,0]
    v_fma_mix_f32 v236, v30, v212, v220 op_sel:[0,0,0] op_sel_hi:[1,0,0]
    v_fma_mix_f32 v237, v30, v213, v221 op_sel:[1,0,0] op_sel_hi:[1,0,0]
    v_mfma_f32_32x32x16_bf16 v[144:159], v[24:27], v[180:183], v[144:159]
    ds_read_b64_tr_b16 v[160:161], v4 offset:0
    ds_read_b64_tr_b16 v[162:163], v4 offset:20480
    ds_read_b64_tr_b16 v[164:165], v4 offset:256
    ds_read_b64_tr_b16 v[166:167], v4 offset:20736
    ds_read_b128 v[196:199], v6 offset:272
    ds_read_b128 v[204:207], v6 offset:20752
    v_fma_mix_f32 v238, v31, v214, v222 op_sel:[0,0,0] op_sel_hi:[1,0,0]
    v_fma_mix_f32 v239, v31, v215, v223 op_sel:[1,0,0] op_sel_hi:[1,0,0]
    v_cvt_pk_bf16_f32 v28, v232, v233
    v_cvt_pk_bf16_f32 v29, v234, v235
    v_cvt_pk_bf16_f32 v30, v236, v237
    v_cvt_pk_bf16_f32 v31, v238, v239
    s_waitcnt vmcnt(0)
    s_barrier
    s_waitcnt lgkmcnt(10)
    v_mfma_f32_32x32x16_bf16 v[128:143], v[28:31], v[184:187], v[128:143]
    ds_read_b64_tr_b16 v[168:169], v4 offset:8704
    ds_read_b64_tr_b16 v[170:171], v4 offset:29184
    ds_read_b128 v[208:211], v6 offset:320
    ds_read_b128 v[216:219], v6 offset:20800
    s_waitcnt lgkmcnt(4)
    v_fma_mix_f32 v224, v32, v192, v200 op_sel:[0,0,0] op_sel_hi:[1,0,0]
    v_fma_mix_f32 v225, v32, v193, v201 op_sel:[1,0,0] op_sel_hi:[1,0,0]
    v_fma_mix_f32 v226, v33, v194, v202 op_sel:[0,0,0] op_sel_hi:[1,0,0]
    v_mfma_f32_32x32x16_bf16 v[144:159], v[28:31], v[188:191], v[144:159]
    ds_read_b64_tr_b16 v[172:173], v4 offset:8960
    ds_read_b64_tr_b16 v[174:175], v4 offset:29440
    ds_read_b128 v[212:215], v6 offset:336
    ds_read_b128 v[220:223], v6 offset:20816
    v_fma_mix_f32 v227, v33, v195, v203 op_sel:[1,0,0] op_sel_hi:[1,0,0]
    v_fma_mix_f32 v228, v34, v196, v204 op_sel:[0,0,0] op_sel_hi:[1,0,0]
    v_fma_mix_f32 v229, v34, v197, v205 op_sel:[1,0,0] op_sel_hi:[1,0,0]
    v_mfma_f32_32x32x16_bf16 v[96:111], v[16:19], v[160:163], 0
    ds_read_b64_tr_b16 v[176:177], v4 offset:2048
    ds_read_b64_tr_b16 v[178:179], v4 offset:22528
    v_fma_mix_f32 v230, v35, v198, v206 op_sel:[0,0,0] op_sel_hi:[1,0,0]
    v_fma_mix_f32 v231, v35, v199, v207 op_sel:[1,0,0] op_sel_hi:[1,0,0]
    v_cvt_pk_bf16_f32 v32, v224, v225
    v_mfma_f32_32x32x16_bf16 v[112:127], v[16:19], v[164:167], 0
    ds_read_b64_tr_b16 v[180:181], v4 offset:2304
    ds_read_b64_tr_b16 v[182:183], v4 offset:22784
    v_cvt_pk_bf16_f32 v33, v226, v227
    v_cvt_pk_bf16_f32 v34, v228, v229
    v_cvt_pk_bf16_f32 v35, v230, v231
    s_mov_b32 exec_hi, s82
    buffer_load_dword v240, v10, s[44:47], s75 offen nt
    s_add_u32 s75, s75, s78
    buffer_load_dword v241, v10, s[44:47], s75 offen nt
    s_add_u32 s75, s75, s78
    s_mov_b32 exec_hi, -1
    s_waitcnt lgkmcnt(10)
    v_mfma_f32_32x32x16_bf16 v[128:143], v[32:35], v[168:171], v[128:143]
    ds_read_b64_tr_b16 v[184:185], v4 offset:10752
    ds_read_b64_tr_b16 v[186:187], v4 offset:31232
    ds_read_b128 v[192:195], v6 offset:384
    ds_read_b128 v[200:203], v6 offset:20864
    s_waitcnt lgkmcnt(8)
    v_fma_mix_f32 v232, v36, v208, v216 op_sel:[0,0,0] op_sel_hi:[1,0,0]
    v_fma_mix_f32 v233, v36, v209, v217 op_sel:[1,0,0] op_sel_hi:[1,0,0]
    v_fma_mix_f32 v234, v37, v210, v218 op_sel:[0,0,0] op_sel_hi:[1,0,0]
    v_mfma_f32_32x32x16_bf16 v[144:159], v[32:35], v[172:175], v[144:159]
    ds_read_b64_tr_b16 v[188:189], v4 offset:11008
    ds_read_b64_tr_b16 v[190:191], v4 offset:31488
    ds_read_b128 v[196:199], v6 offset:400
    ds_read_b128 v[204:207], v6 offset:20880
    v_fma_mix_f32 v235, v37, v211, v219 op_sel:[1,0,0] op_sel_hi:[1,0,0]
    v_fma_mix_f32 v236, v38, v212, v220 op_sel:[0,0,0] op_sel_hi:[1,0,0]
    v_fma_mix_f32 v237, v38, v213, v221 op_sel:[1,0,0] op_sel_hi:[1,0,0]
    s_waitcnt lgkmcnt(10)
    v_mfma_f32_32x32x16_bf16 v[96:111], v[20:23], v[176:179], v[96:111]
    ds_read_b64_tr_b16 v[160:161], v4 offset:4096
    ds_read_b64_tr_b16 v[162:163], v4 offset:24576
    v_fma_mix_f32 v238, v39, v214, v222 op_sel:[0,0,0] op_sel_hi:[1,0,0]
    v_fma_mix_f32 v239, v39, v215, v223 op_sel:[1,0,0] op_sel_hi:[1,0,0]
    v_cvt_pk_bf16_f32 v36, v232, v233
    s_waitcnt lgkmcnt(10)
    v_mfma_f32_32x32x16_bf16 v[112:127], v[20:23], v[180:183], v[112:127]
    ds_read_b64_tr_b16 v[164:165], v4 offset:4352
    ds_read_b64_tr_b16 v[166:167], v4 offset:24832
    v_cvt_pk_bf16_f32 v37, v234, v235
    v_cvt_pk_bf16_f32 v38, v236, v237
    v_cvt_pk_bf16_f32 v39, v238, v239
    s_mov_b32 exec_hi, s82
    buffer_load_dword v242, v10, s[44:47], s75 offen nt
    s_add_u32 s75, s75, s78
    buffer_load_dword v243, v10, s[44:47], s75 offen nt
    s_mul_i32 s51, s78, 3
    s_sub_u32 s51, s77, s51
    s_add_u32 s75, s75, s51
    s_mov_b32 exec_hi, -1
    s_waitcnt lgkmcnt(10)
    v_mfma_f32_32x32x16_bf16 v[128:143], v[36:39], v[184:187], v[128:143]
    ds_read_b64_tr_b16 v[168:169], v4 offset:12800
    ds_read_b64_tr_b16 v[170:171], v4 offset:33280
    ds_read_b128 v[208:211], v6 offset:448
    ds_read_b128 v[216:219], v6 offset:20928
    s_waitcnt lgkmcnt(8)
    v_fma_mix_f32 v224, v40, v192, v200 op_sel:[0,0,0] op_sel_hi:[1,0,0]
    v_fma_mix_f32 v225, v40, v193, v201 op_sel:[1,0,0] op_sel_hi:[1,0,0]
    v_fma_mix_f32 v226, v41, v194, v202 op_sel:[0,0,0] op_sel_hi:[1,0,0]
    v_mfma_f32_32x32x16_bf16 v[144:159], v[36:39], v[188:191], v[144:159]
    ds_read_b64_tr_b16 v[172:173], v4 offset:13056
    ds_read_b64_tr_b16 v[174:175], v4 offset:33536
    ds_read_b128 v[212:215], v6 offset:464
    ds_read_b128 v[220:223], v6 offset:20944
    v_fma_mix_f32 v227, v41, v195, v203 op_sel:[1,0,0] op_sel_hi:[1,0,0]
    v_fma_mix_f32 v228, v42, v196, v204 op_sel:[0,0,0] op_sel_hi:[1,0,0]
    v_fma_mix_f32 v229, v42, v197, v205 op_sel:[1,0,0] op_sel_hi:[1,0,0]
    s_waitcnt lgkmcnt(10)
    v_mfma_f32_32x32x16_bf16 v[96:111], v[24:27], v[160:163], v[96:111]
    ds_read_b64_tr_b16 v[176:177], v4 offset:6144
    ds_read_b64_tr_b16 v[178:179], v4 offset:26624
    v_fma_mix_f32 v230, v43, v198, v206 op_sel:[0,0,0] op_sel_hi:[1,0,0]
    v_fma_mix_f32 v231, v43, v199, v207 op_sel:[1,0,0] op_sel_hi:[1,0,0]
    v_cvt_pk_bf16_f32 v40, v224, v225
    s_waitcnt lgkmcnt(10)
    v_mfma_f32_32x32x16_bf16 v[112:127], v[24:27], v[164:167], v[112:127]
    ds_read_b64_tr_b16 v[180:181], v4 offset:6400
    ds_read_b64_tr_b16 v[182:183], v4 offset:26880
    v_cvt_pk_bf16_f32 v41, v226, v227
    v_cvt_pk_bf16_f32 v42, v228, v229
    v_cvt_pk_bf16_f32 v43, v230, v231
    s_mov_b32 exec_hi, s82
    buffer_load_dword v244, v10, s[44:47], s75 offen nt
    s_add_u32 s75, s75, s78
    buffer_load_dword v245, v10, s[44:47], s75 offen nt
    s_add_u32 s75, s75, s78
    s_mov_b32 exec_hi, -1
    s_waitcnt lgkmcnt(10)
    v_mfma_f32_32x32x16_bf16 v[128:143], v[40:43], v[168:171], v[128:143]
    ds_read_b64_tr_b16 v[184:185], v4 offset:14848
    ds_read_b64_tr_b16 v[186:187], v4 offset:35328
    ds_read_b128 v[192:195], v6 offset:512
    ds_read_b128 v[200:203], v6 offset:20992
    s_waitcnt lgkmcnt(8)
    v_fma_mix_f32 v232, v44, v208, v216 op_sel:[0,0,0] op_sel_hi:[1,0,0]
    v_fma_mix_f32 v233, v44, v209, v217 op_sel:[1,0,0] op_sel_hi:[1,0,0]
    v_fma_mix_f32 v234, v45, v210, v218 op_sel:[0,0,0] op_sel_hi:[1,0,0]
    v_mfma_f32_32x32x16_bf16 v[144:159], v[40:43], v[172:175], v[144:159]
    ds_read_b64_tr_b16 v[188:189], v4 offset:15104
    ds_read_b64_tr_b16 v[190:191], v4 offset:35584
    ds_read_b128 v[196:199], v6 offset:528
    ds_read_b128 v[204:207], v6 offset:21008
    v_fma_mix_f32 v235, v45, v211, v219 op_sel:[1,0,0] op_sel_hi:[1,0,0]
    v_fma_mix_f32 v236, v46, v212, v220 op_sel:[0,0,0] op_sel_hi:[1,0,0]
    v_fma_mix_f32 v237, v46, v213, v221 op_sel:[1,0,0] op_sel_hi:[1,0,0]
    s_waitcnt lgkmcnt(10)
    v_mfma_f32_32x32x16_bf16 v[96:111], v[28:31], v[176:179], v[96:111]
    ds_read_b64_tr_b16 v[160:161], v4 offset:8192
    ds_read_b64_tr_b16 v[162:163], v4 offset:28672
    v_fma_mix_f32 v238, v47, v214, v222 op_sel:[0,0,0] op_sel_hi:[1,0,0]
    v_fma_mix_f32 v239, v47, v215, v223 op_sel:[1,0,0] op_sel_hi:[1,0,0]
    v_cvt_pk_bf16_f32 v44, v232, v233
    s_waitcnt lgkmcnt(10)
    v_mfma_f32_32x32x16_bf16 v[112:127], v[28:31], v[180:183], v[112:127]
    ds_read_b64_tr_b16 v[164:165], v4 offset:8448
    ds_read_b64_tr_b16 v[166:167], v4 offset:28928
    v_cvt_pk_bf16_f32 v45, v234, v235
    v_cvt_pk_bf16_f32 v46, v236, v237
    v_cvt_pk_bf16_f32 v47, v238, v239
    s_mov_b32 exec_hi, s82
    buffer_load_dword v246, v10, s[44:47], s75 offen nt
    s_add_u32 s75, s75, s78
    buffer_load_dword v247, v10, s[44:47], s75 offen nt
    s_mov_b32 exec_hi, zlit_b-zlit_a+(-1)
    s_waitcnt lgkmcnt(10)
    v_mfma_f32_32x32x16_bf16 v[128:143], v[44:47], v[184:187], v[128:143]
    ds_read_b64_tr_b16 v[168:169], v4 offset:16896
    ds_read_b64_tr_b16 v[170:171], v4 offset:37376
    ds_read_b128 v[208:211], v6 offset:576
    ds_read_b128 v[216:219], v6 offset:21056
    s_waitcnt lgkmcnt(8)
    v_fma_mix_f32 v224, v48, v192, v200 op_sel:[0,0,0] op_sel_hi:[1,0,0]
    v_fma_mix_f32 v225, v48, v193, v201 op_sel:[1,0,0] op_sel_hi:[1,0,0]
    v_fma_mix_f32 v226, v49, v194, v202 op_sel:[0,0,0] op_sel_hi:[1,0,0]
    v_mfma_f32_32x32x16_bf16 v[144:159], v[44:47], v[188:191], v[144:159]
    ds_read_b64_tr_b16 v[172:173], v4 offset:17152
    ds_read_b64_tr_b16 v[174:175], v4 offset:37632
    ds_read_b128 v[212:215], v6 offset:592
    ds_read_b128 v[220:223], v6 offset:21072
    v_fma_mix_f32 v227, v49, v195, v203 op_sel:[1,0,0] op_sel_hi:[1,0,0]
    v_fma_mix_f32 v228, v50, v196, v204 op_sel:[0,0,0] op_sel_hi:[1,0,0]
    v_fma_mix_f32 v229, v50, v197, v205 op_sel:[1,0,0] op_sel_hi:[1,0,0]
    s_waitcnt lgkmcnt(10)
    v_mfma_f32_32x32x16_bf16 v[96:111], v[32:35], v[160:163], v[96:111]
    ds_read_b64_tr_b16 v[176:177], v4 offset:10240
    ds_read_b64_tr_b16 v[178:179], v4 offset:30720
    v_fma_mix_f32 v230, v51, v198, v206 op_sel:[0,0,0] op_sel_hi:[1,0,0]
    v_fma_mix_f32 v231, v51, v199, v207 op_sel:[1,0,0] op_sel_hi:[1,0,0]
    v_cvt_pk_bf16_f32 v48, v224, v225
    s_waitcnt lgkmcnt(10)
    v_mfma_f32_32x32x16_bf16 v[112:127], v[32:35], v[164:167], v[112:127]
    ds_read_b64_tr_b16 v[180:181], v4 offset:10496
    ds_read_b64_tr_b16 v[182:183], v4 offset:30976
    v_cvt_pk_bf16_f32 v49, v226, v227
    v_cvt_pk_bf16_f32 v50, v228, v229
    v_cvt_pk_bf16_f32 v51, v230, v231
    s_barrier
    s_add_u32 m0, s70, 0
    s_nop 0
    buffer_load_dwordx4 v12, s[12:15], s71 offen lds
    buffer_load_dwordx4 v13, s[12:15], s71 offen offset:1024 lds
    s_add_u32 s71, s71, 61440
    s_cmp_ge_u32 s71, s43
    s_cselect_b32 s51, 1228800, 0
    s_sub_u32 s71, s71, s51
    s_add_u32 m0, s70, 2048
    s_nop 0
    buffer_load_dwordx4 v12, s[12:15], s71 offen lds
    buffer_load_dwordx4 v13, s[12:15], s71 offen offset:1024 lds
    s_waitcnt lgkmcnt(10)
    v_mfma_f32_32x32x16_bf16 v[128:143], v[48:51], v[168:171], v[128:143]
    ds_read_b64_tr_b16 v[184:185], v5 offset:512
    ds_read_b64_tr_b16 v[186:187], v5 offset:20992
    ds_read_b128 v[192:195], v6 offset:640
    ds_read_b128 v[200:203], v6 offset:21120
    s_waitcnt lgkmcnt(8)
    v_fma_mix_f32 v232, v52, v208, v216 op_sel:[0,0,0] op_sel_hi:[1,0,0]
    v_fma_mix_f32 v233, v52, v209, v217 op_sel:[1,0,0] op_sel_hi:[1,0,0]
    v_fma_mix_f32 v234, v53, v210, v218 op_sel:[0,0,0] op_sel_hi:[1,0,0]
    v_mfma_f32_32x32x16_bf16 v[144:159], v[48:51], v[172:175], v[144:159]
    ds_read_b64_tr_b16 v[188:189], v5 offset:768
    ds_read_b64_tr_b16 v[190:191], v5 offset:21248
    ds_read_b128 v[196:199], v6 offset:656
    ds_read_b128 v[204:207], v6 offset:21136
    v_fma_mix_f32 v235, v53, v211, v219 op_sel:[1,0,0] op_sel_hi:[1,0,0]
    v_fma_mix_f32 v236, v54, v212, v220 op_sel:[0,0,0] op_sel_hi:[1,0,0]
    v_fma_mix_f32 v237, v54, v213, v221 op_sel:[1,0,0] op_sel_hi:[1,0,0]
    s_waitcnt lgkmcnt(10)
    v_mfma_f32_32x32x16_bf16 v[96:111], v[36:39], v[176:179], v[96:111]
    ds_read_b64_tr_b16 v[160:161], v4 offset:12288
    ds_read_b64_tr_b16 v[162:163], v4 offset:32768
    v_fma_mix_f32 v238, v55, v214, v222 op_sel:[0,0,0] op_sel_hi:[1,0,0]
    v_fma_mix_f32 v239, v55, v215, v223 op_sel:[1,0,0] op_sel_hi:[1,0,0]
    v_cvt_pk_bf16_f32 v52, v232, v233
    s_waitcnt lgkmcnt(10)
    v_mfma_f32_32x32x16_bf16 v[112:127], v[36:39], v[180:183], v[112:127]
    ds_read_b64_tr_b16 v[164:165], v4 offset:12544
    ds_read_b64_tr_b16 v[166:167], v4 offset:33024
    v_cvt_pk_bf16_f32 v53, v234, v235
    v_cvt_pk_bf16_f32 v54, v236, v237
    v_cvt_pk_bf16_f32 v55, v238, v239
    s_waitcnt lgkmcnt(10)
    s_nop 0
    v_mfma_f32_32x32x16_bf16 v[128:143], v[52:55], v[184:187], v[128:143]
    ds_read_b64_tr_b16 v[168:169], v5 offset:2560
    ds_read_b64_tr_b16 v[170:171], v5 offset:23040
    ds_read_b128 v[208:211], v6 offset:704
    ds_read_b128 v[216:219], v6 offset:21184
    s_waitcnt lgkmcnt(8)
    v_fma_mix_f32 v224, v56, v192, v200 op_sel:[0,0,0] op_sel_hi:[1,0,0]
    v_fma_mix_f32 v225, v56, v193, v201 op_sel:[1,0,0] op_sel_hi:[1,0,0]
    v_fma_mix_f32 v226, v57, v194, v202 op_sel:[0,0,0] op_sel_hi:[1,0,0]
    v_mfma_f32_32x32x16_bf16 v[144:159], v[52:55], v[188:191], v[144:159]
    ds_read_b64_tr_b16 v[172:173], v5 offset:2816
    ds_read_b64_tr_b16 v[174:175], v5 offset:23296
    ds_read_b128 v[212:215], v6 offset:720
    ds_read_b128 v[220:223], v6 offset:21200
    v_fma_mix_f32 v227, v57, v195, v203 op_sel:[1,0,0] op_sel_hi:[1,0,0]
    v_fma_mix_f32 v228, v58, v196, v204 op_sel:[0,0,0] op_sel_hi:[1,0,0]
    v_fma_mix_f32 v229, v58, v197, v205 op_sel:[1,0,0] op_sel_hi:[1,0,0]
    s_waitcnt lgkmcnt(10)
    v_mfma_f32_32x32x16_bf16 v[96:111], v[40:43], v[160:163], v[96:111]
    ds_read_b64_tr_b16 v[176:177], v4 offset:14336
    ds_read_b64_tr_b16 v[178:179], v4 offset:34816
    v_fma_mix_f32 v230, v59, v198, v206 op_sel:[0,0,0] op_sel_hi:[1,0,0]
    v_fma_mix_f32 v231, v59, v199, v207 op_sel:[1,0,0] op_sel_hi:[1,0,0]
    v_cvt_pk_bf16_f32 v56, v224, v225
    s_waitcnt lgkmcnt(10)
    v_mfma_f32_32x32x16_bf16 v[112:127], v[40:43], v[164:167], v[112:127]
    ds_read_b64_tr_b16 v[180:181], v4 offset:14592
    ds_read_b64_tr_b16 v[182:183], v4 offset:35072
    v_cvt_pk_bf16_f32 v57, v226, v227
    v_cvt_pk_bf16_f32 v58, v228, v229
    v_cvt_pk_bf16_f32 v59, v230, v231
    s_waitcnt lgkmcnt(10)
    s_nop 0
    v_mfma_f32_32x32x16_bf16 v[128:143], v[56:59], v[168:171], v[128:143]
    ds_read_b64_tr_b16 v[184:185], v5 offset:4608
    ds_read_b64_tr_b16 v[186:187], v5 offset:25088
    ds_read_b128 v[192:195], v6 offset:768
    ds_read_b128 v[200:203], v6 offset:21248
    s_waitcnt lgkmcnt(8)
    v_fma_mix_f32 v232, v60, v208, v216 op_sel:[0,0,0] op_sel_hi:[1,0,0]
    v_fma_mix_f32 v233, v60, v209, v217 op_sel:[1,0,0] op_sel_hi:[1,0,0]
    v_fma_mix_f32 v234, v61, v210, v218 op_sel:[0,0,0] op_sel_hi:[1,0,0]
    v_mfma_f32_32x32x16_bf16 v[144:159], v[56:59], v[172:175], v[144:159]
    ds_read_b64_tr_b16 v[188:189], v5 offset:4864
    ds_read_b64_tr_b16 v[190:191], v5 offset:25344
    ds_read_b128 v[196:199], v6 offset:784
    ds_read_b128 v[204:207], v6 offset:21264
    v_fma_mix_f32 v235, v61, v211, v219 op_sel:[1,0,0] op_sel_hi:[1,0,0]
    v_fma_mix_f32 v236, v62, v212, v220 op_sel:[0,0,0] op_sel_hi:[1,0,0]
    v_fma_mix_f32 v237, v62, v213, v221 op_sel:[1,0,0] op_sel_hi:[1,0,0]
    s_waitcnt lgkmcnt(10)
    v_mfma_f32_32x32x16_bf16 v[96:111], v[44:47], v[176:179], v[96:111]
    ds_read_b64_tr_b16 v[160:161], v4 offset:16384
    ds_read_b64_tr_b16 v[162:163], v4 offset:36864
    v_fma_mix_f32 v238, v63, v214, v222 op_sel:[0,0,0] op_sel_hi:[1,0,0]
    v_fma_mix_f32 v239, v63, v215, v223 op_sel:[1,0,0] op_sel_hi:[1,0,0]
    v_cvt_pk_bf16_f32 v60, v232, v233
    s_waitcnt lgkmcnt(10)
    v_mfma_f32_32x32x16_bf16 v[112:127], v[44:47], v[180:183], v[112:127]
    ds_read_b64_tr_b16 v[164:165], v4 offset:16640
    ds_read_b64_tr_b16 v[166:167], v4 offset:37120
    v_cvt_pk_bf16_f32 v61, v234, v235
    v_cvt_pk_bf16_f32 v62, v236, v237
    v_cvt_pk_bf16_f32 v63, v238, v239
    s_waitcnt lgkmcnt(10)
    s_nop 0
    v_mfma_f32_32x32x16_bf16 v[128:143], v[60:63], v[184:187], v[128:143]
    ds_read_b64_tr_b16 v[168:169], v5 offset:6656
    ds_read_b64_tr_b16 v[170:171], v5 offset:27136
    ds_read_b128 v[208:211], v6 offset:832
    ds_read_b128 v[216:219], v6 offset:21312
    s_waitcnt lgkmcnt(8)
    v_fma_mix_f32 v224, v64, v192, v200 op_sel:[0,0,0] op_sel_hi:[1,0,0]
    v_fma_mix_f32 v225, v64, v193, v201 op_sel:[1,0,0] op_sel_hi:[1,0,0]
    v_fma_mix_f32 v226, v65, v194, v202 op_sel:[0,0,0] op_sel_hi:[1,0,0]
    v_mfma_f32_32x32x16_bf16 v[144:159], v[60:63], v[188:191], v[144:159]
    ds_read_b64_tr_b16 v[172:173], v5 offset:6912
    ds_read_b64_tr_b16 v[174:175], v5 offset:27392
    ds_read_b128 v[212:215], v6 offset:848
    ds_read_b128 v[220:223], v6 offset:21328
    v_fma_mix_f32 v227, v65, v195, v203 op_sel:[1,0,0] op_sel_hi:[1,0,0]
    v_fma_mix_f32 v228, v66, v196, v204 op_sel:[0,0,0] op_sel_hi:[1,0,0]
    v_fma_mix_f32 v229, v66, v197, v205 op_sel:[1,0,0] op_sel_hi:[1,0,0]
    s_waitcnt lgkmcnt(10)
    v_mfma_f32_32x32x16_bf16 v[96:111], v[48:51], v[160:163], v[96:111]
    ds_read_b64_tr_b16 v[176:177], v5 offset:0
    ds_read_b64_tr_b16 v[178:179], v5 offset:20480
    v_fma_mix_f32 v230, v67, v198, v206 op_sel:[0,0,0] op_sel_hi:[1,0,0]
    v_fma_mix_f32 v231, v67, v199, v207 op_sel:[1,0,0] op_sel_hi:[1,0,0]
    v_cvt_pk_bf16_f32 v64, v224, v225
    s_waitcnt lgkmcnt(10)
    v_mfma_f32_32x32x16_bf16 v[112:127], v[48:51], v[164:167], v[112:127]
    ds_read_b64_tr_b16 v[180:181], v5 offset:256
    ds_read_b64_tr_b16 v[182:183], v5 offset:20736
    v_cvt_pk_bf16_f32 v65, v226, v227
    v_cvt_pk_bf16_f32 v66, v228, v229
    v_cvt_pk_bf16_f32 v67, v230, v231
    s_barrier
    s_waitcnt lgkmcnt(10)
    v_mfma_f32_32x32x16_bf16 v[128:143], v[64:67], v[168:171], v[128:143]
    ds_read_b64_tr_b16 v[184:185], v5 offset:8704
    ds_read_b64_tr_b16 v[186:187], v5 offset:29184
    ds_read_b128 v[192:195], v6 offset:896
    ds_read_b128 v[200:203], v6 offset:21376
    s_waitcnt lgkmcnt(8)
    v_fma_mix_f32 v232, v68, v208, v216 op_sel:[0,0,0] op_sel_hi:[1,0,0]
    v_fma_mix_f32 v233, v68, v209, v217 op_sel:[1,0,0] op_sel_hi:[1,0,0]
    v_fma_mix_f32 v234, v69, v210, v218 op_sel:[0,0,0] op_sel_hi:[1,0,0]
    v_mfma_f32_32x32x16_bf16 v[144:159], v[64:67], v[172:175], v[144:159]
    ds_read_b64_tr_b16 v[188:189], v5 offset:8960
    ds_read_b64_tr_b16 v[190:191], v5 offset:29440
    ds_read_b128 v[196:199], v6 offset:912
    ds_read_b128 v[204:207], v6 offset:21392
    v_fma_mix_f32 v235, v69, v211, v219 op_sel:[1,0,0] op_sel_hi:[1,0,0]
    v_fma_mix_f32 v236, v70, v212, v220 op_sel:[0,0,0] op_sel_hi:[1,0,0]
    v_fma_mix_f32 v237, v70, v213, v221 op_sel:[1,0,0] op_sel_hi:[1,0,0]
    s_waitcnt lgkmcnt(10)
    v_mfma_f32_32x32x16_bf16 v[96:111], v[52:55], v[176:179], v[96:111]
    ds_read_b64_tr_b16 v[160:161], v5 offset:2048
    ds_read_b64_tr_b16 v[162:163], v5 offset:22528
    v_fma_mix_f32 v238, v71, v214, v222 op_sel:[0,0,0] op_sel_hi:[1,0,0]
    v_fma_mix_f32 v239, v71, v215, v223 op_sel:[1,0,0] op_sel_hi:[1,0,0]
    v_cvt_pk_bf16_f32 v68, v232, v233
    s_waitcnt lgkmcnt(10)
    v_mfma_f32_32x32x16_bf16 v[112:127], v[52:55], v[180:183], v[112:127]
    ds_read_b64_tr_b16 v[164:165], v5 offset:2304
    ds_read_b64_tr_b16 v[166:167], v5 offset:22784
    v_cvt_pk_bf16_f32 v69, v234, v235
    v_cvt_pk_bf16_f32 v70, v236, v237
    v_cvt_pk_bf16_f32 v71, v238, v239
    s_waitcnt vmcnt(4)
    v_perm_b32 v248, v241, v240, s80
    v_perm_b32 v252, v241, v240, s81
    v_perm_b32 v249, v243, v242, s80
    v_perm_b32 v253, v243, v242, s81
    v_perm_b32 v250, v245, v244, s80
    v_perm_b32 v254, v245, v244, s81
    v_perm_b32 v251, v247, v246, s80
    v_perm_b32 v255, v247, v246, s81
    s_mov_b32 exec_hi, s82
    buffer_store_dwordx4 v[248:251], v11, s[8:11], s79 offen offset:0 sc1
    buffer_store_dwordx4 v[252:255], v11, s[8:11], s79 offen offset:16 sc1
    s_mov_b32 exec_hi, zlit_b-zlit_a+(-1)
    s_waitcnt lgkmcnt(10)
    v_mfma_f32_32x32x16_bf16 v[128:143], v[68:71], v[184:187], v[128:143]
    ds_read_b64_tr_b16 v[168:169], v5 offset:10752
    ds_read_b64_tr_b16 v[170:171], v5 offset:31232
    ds_read_b128 v[208:211], v6 offset:960
    ds_read_b128 v[216:219], v6 offset:21440
    s_waitcnt lgkmcnt(8)
    v_fma_mix_f32 v224, v72, v192, v200 op_sel:[0,0,0] op_sel_hi:[1,0,0]
    v_fma_mix_f32 v225, v72, v193, v201 op_sel:[1,0,0] op_sel_hi:[1,0,0]
    v_fma_mix_f32 v226, v73, v194, v202 op_sel:[0,0,0] op_sel_hi:[1,0,0]
    v_mfma_f32_32x32x16_bf16 v[144:159], v[68:71], v[188:191], v[144:159]
    ds_read_b64_tr_b16 v[172:173], v5 offset:11008
    ds_read_b64_tr_b16 v[174:175], v5 offset:31488
    ds_read_b128 v[212:215], v6 offset:976
    ds_read_b128 v[220:223], v6 offset:21456
    v_fma_mix_f32 v227, v73, v195, v203 op_sel:[1,0,0] op_sel_hi:[1,0,0]
    v_fma_mix_f32 v228, v74, v196, v204 op_sel:[0,0,0] op_sel_hi:[1,0,0]
    v_fma_mix_f32 v229, v74, v197, v205 op_sel:[1,0,0] op_sel_hi:[1,0,0]
    s_waitcnt lgkmcnt(10)
    v_mfma_f32_32x32x16_bf16 v[96:111], v[56:59], v[160:163], v[96:111]
    ds_read_b64_tr_b16 v[176:177], v5 offset:4096
    ds_read_b64_tr_b16 v[178:179], v5 offset:24576
    v_fma_mix_f32 v230, v75, v198, v206 op_sel:[0,0,0] op_sel_hi:[1,0,0]
    v_fma_mix_f32 v231, v75, v199, v207 op_sel:[1,0,0] op_sel_hi:[1,0,0]
    v_cvt_pk_bf16_f32 v72, v224, v225
    s_waitcnt lgkmcnt(10)
    v_mfma_f32_32x32x16_bf16 v[112:127], v[56:59], v[164:167], v[112:127]
    ds_read_b64_tr_b16 v[180:181], v5 offset:4352
    ds_read_b64_tr_b16 v[182:183], v5 offset:24832
    v_cvt_pk_bf16_f32 v73, v226, v227
    v_cvt_pk_bf16_f32 v74, v228, v229
    v_cvt_pk_bf16_f32 v75, v230, v231
    s_waitcnt lgkmcnt(10)
    s_nop 0
    v_mfma_f32_32x32x16_bf16 v[128:143], v[72:75], v[168:171], v[128:143]
    ds_read_b64_tr_b16 v[184:185], v5 offset:12800
    ds_read_b64_tr_b16 v[186:187], v5 offset:33280
    ds_read_b128 v[192:195], v6 offset:1024
    ds_read_b128 v[200:203], v6 offset:21504
    s_waitcnt lgkmcnt(8)
    v_fma_mix_f32 v232, v76, v208, v216 op_sel:[0,0,0] op_sel_hi:[1,0,0]
    v_fma_mix_f32 v233, v76, v209, v217 op_sel:[1,0,0] op_sel_hi:[1,0,0]
    v_fma_mix_f32 v234, v77, v210, v218 op_sel:[0,0,0] op_sel_hi:[1,0,0]
    v_mfma_f32_32x32x16_bf16 v[144:159], v[72:75], v[172:175], v[144:159]
    ds_read_b64_tr_b16 v[188:189], v5 offset:13056
    ds_read_b64_tr_b16 v[190:191], v5 offset:33536
    ds_read_b128 v[196:199], v6 offset:1040
    ds_read_b128 v[204:207], v6 offset:21520
    v_fma_mix_f32 v235, v77, v211, v219 op_sel:[1,0,0] op_sel_hi:[1,0,0]
    v_fma_mix_f32 v236, v78, v212, v220 op_sel:[0,0,0] op_sel_hi:[1,0,0]
    v_fma_mix_f32 v237, v78, v213, v221 op_sel:[1,0,0] op_sel_hi:[1,0,0]
    s_waitcnt lgkmcnt(10)
    v_mfma_f32_32x32x16_bf16 v[96:111], v[60:63], v[176:179], v[96:111]
    ds_read_b64_tr_b16 v[160:161], v5 offset:6144
    ds_read_b64_tr_b16 v[162:163], v5 offset:26624
    v_fma_mix_f32 v238, v79, v214, v222 op_sel:[0,0,0] op_sel_hi:[1,0,0]
    v_fma_mix_f32 v239, v79, v215, v223 op_sel:[1,0,0] op_sel_hi:[1,0,0]
    v_cvt_pk_bf16_f32 v76, v232, v233
    s_waitcnt lgkmcnt(10)
    v_mfma_f32_32x32x16_bf16 v[112:127], v[60:63], v[180:183], v[112:127]
    ds_read_b64_tr_b16 v[164:165], v5 offset:6400
    ds_read_b64_tr_b16 v[166:167], v5 offset:26880
    v_cvt_pk_bf16_f32 v77, v234, v235
    v_cvt_pk_bf16_f32 v78, v236, v237
    v_cvt_pk_bf16_f32 v79, v238, v239
    s_waitcnt lgkmcnt(10)
    s_nop 0
    v_mfma_f32_32x32x16_bf16 v[128:143], v[76:79], v[184:187], v[128:143]
    ds_read_b64_tr_b16 v[168:169], v5 offset:14848
    ds_read_b64_tr_b16 v[170:171], v5 offset:35328
    ds_read_b128 v[208:211], v6 offset:1088
    ds_read_b128 v[216:219], v6 offset:21568
    s_waitcnt lgkmcnt(8)
    v_fma_mix_f32 v224, v80, v192, v200 op_sel:[0,0,0] op_sel_hi:[1,0,0]
    v_fma_mix_f32 v225, v80, v193, v201 op_sel:[1,0,0] op_sel_hi:[1,0,0]
    v_fma_mix_f32 v226, v81, v194, v202 op_sel:[0,0,0] op_sel_hi:[1,0,0]
    v_mfma_f32_32x32x16_bf16 v[144:159], v[76:79], v[188:191], v[144:159]
    ds_read_b64_tr_b16 v[172:173], v5 offset:15104
    ds_read_b64_tr_b16 v[174:175], v5 offset:35584
    ds_read_b128 v[212:215], v6 offset:1104
    ds_read_b128 v[220:223], v6 offset:21584
    v_fma_mix_f32 v227, v81, v195, v203 op_sel:[1,0,0] op_sel_hi:[1,0,0]
    v_fma_mix_f32 v228, v82, v196, v204 op_sel:[0,0,0] op_sel_hi:[1,0,0]
    v_fma_mix_f32 v229, v82, v197, v205 op_sel:[1,0,0] op_sel_hi:[1,0,0]
    s_waitcnt lgkmcnt(10)
    v_mfma_f32_32x32x16_bf16 v[96:111], v[64:67], v[160:163], v[96:111]
    ds_read_b64_tr_b16 v[176:177], v5 offset:8192
    ds_read_b64_tr_b16 v[178:179], v5 offset:28672
    v_fma_mix_f32 v230, v83, v198, v206 op_sel:[0,0,0] op_sel_hi:[1,0,0]
    v_fma_mix_f32 v231, v83, v199, v207 op_sel:[1,0,0] op_sel_hi:[1,0,0]
    v_cvt_pk_bf16_f32 v80, v224, v225
    s_waitcnt lgkmcnt(10)
    v_mfma_f32_32x32x16_bf16 v[112:127], v[64:67], v[164:167], v[112:127]
    ds_read_b64_tr_b16 v[180:181], v5 offset:8448
    ds_read_b64_tr_b16 v[182:183], v5 offset:28928
    v_cvt_pk_bf16_f32 v81, v226, v227
    v_cvt_pk_bf16_f32 v82, v228, v229
    v_cvt_pk_bf16_f32 v83, v230, v231
    s_waitcnt lgkmcnt(10)
    s_nop 0
    v_mfma_f32_32x32x16_bf16 v[128:143], v[80:83], v[168:171], v[128:143]
    ds_read_b64_tr_b16 v[184:185], v5 offset:16896
    ds_read_b64_tr_b16 v[186:187], v5 offset:37376
    ds_read_b128 v[192:195], v6 offset:1152
    ds_read_b128 v[200:203], v6 offset:21632
    s_waitcnt lgkmcnt(8)
    v_fma_mix_f32 v232, v84, v208, v216 op_sel:[0,0,0] op_sel_hi:[1,0,0]
    v_fma_mix_f32 v233, v84, v209, v217 op_sel:[1,0,0] op_sel_hi:[1,0,0]
    v_fma_mix_f32 v234, v85, v210, v218 op_sel:[0,0,0] op_sel_hi:[1,0,0]
    v_mfma_f32_32x32x16_bf16 v[144:159], v[80:83], v[172:175], v[144:159]
    ds_read_b64_tr_b16 v[188:189], v5 offset:17152
    ds_read_b64_tr_b16 v[190:191], v5 offset:37632
    ds_read_b128 v[196:199], v6 offset:1168
    ds_read_b128 v[204:207], v6 offset:21648
    v_fma_mix_f32 v235, v85, v211, v219 op_sel:[1,0,0] op_sel_hi:[1,0,0]
    v_fma_mix_f32 v236, v86, v212, v220 op_sel:[0,0,0] op_sel_hi:[1,0,0]
    v_fma_mix_f32 v237, v86, v213, v221 op_sel:[1,0,0] op_sel_hi:[1,0,0]
    s_waitcnt lgkmcnt(10)
    v_mfma_f32_32x32x16_bf16 v[96:111], v[68:71], v[176:179], v[96:111]
    ds_read_b64_tr_b16 v[160:161], v5 offset:10240
    ds_read_b64_tr_b16 v[162:163], v5 offset:30720
    v_fma_mix_f32 v238, v87, v214, v222 op_sel:[0,0,0] op_sel_hi:[1,0,0]
    v_fma_mix_f32 v239, v87, v215, v223 op_sel:[1,0,0] op_sel_hi:[1,0,0]
    v_cvt_pk_bf16_f32 v84, v232, v233
    s_waitcnt lgkmcnt(10)
    v_mfma_f32_32x32x16_bf16 v[112:127], v[68:71], v[180:183], v[112:127]
    ds_read_b64_tr_b16 v[164:165], v5 offset:10496
    ds_read_b64_tr_b16 v[166:167], v5 offset:30976
    v_cvt_pk_bf16_f32 v85, v234, v235
    v_cvt_pk_bf16_f32 v86, v236, v237
    v_cvt_pk_bf16_f32 v87, v238, v239
    s_waitcnt vmcnt(2)
    s_barrier
    s_waitcnt lgkmcnt(10)
    v_mfma_f32_32x32x16_bf16 v[128:143], v[84:87], v[184:187], v[128:143]
    ds_read_b64_tr_b16 v[168:169], v4 offset:512
    ds_read_b64_tr_b16 v[170:171], v4 offset:20992
    ds_read_b128 v[208:211], v6 offset:1216
    ds_read_b128 v[216:219], v6 offset:21696
    s_waitcnt lgkmcnt(8)
    v_fma_mix_f32 v224, v88, v192, v200 op_sel:[0,0,0] op_sel_hi:[1,0,0]
    v_fma_mix_f32 v225, v88, v193, v201 op_sel:[1,0,0] op_sel_hi:[1,0,0]
    v_fma_mix_f32 v226, v89, v194, v202 op_sel:[0,0,0] op_sel_hi:[1,0,0]
    v_mfma_f32_32x32x16_bf16 v[144:159], v[84:87], v[188:191], v[144:159]
    ds_read_b64_tr_b16 v[172:173], v4 offset:768
    ds_read_b64_tr_b16 v[174:175], v4 offset:21248
    ds_read_b128 v[212:215], v6 offset:1232
    ds_read_b128 v[220:223], v6 offset:21712
    v_fma_mix_f32 v227, v89, v195, v203 op_sel:[1,0,0] op_sel_hi:[1,0,0]
    v_fma_mix_f32 v228, v90, v196, v204 op_sel:[0,0,0] op_sel_hi:[1,0,0]
    v_fma_mix_f32 v229, v90, v197, v205 op_sel:[1,0,0] op_sel_hi:[1,0,0]
    s_waitcnt lgkmcnt(10)
    v_mfma_f32_32x32x16_bf16 v[96:111], v[72:75], v[160:163], v[96:111]
    ds_read_b64_tr_b16 v[176:177], v5 offset:12288
    ds_read_b64_tr_b16 v[178:179], v5 offset:32768
    v_fma_mix_f32 v230, v91, v198, v206 op_sel:[0,0,0] op_sel_hi:[1,0,0]
    v_fma_mix_f32 v231, v91, v199, v207 op_sel:[1,0,0] op_sel_hi:[1,0,0]
    v_cvt_pk_bf16_f32 v88, v224, v225
    s_waitcnt lgkmcnt(10)
    v_mfma_f32_32x32x16_bf16 v[112:127], v[72:75], v[164:167], v[112:127]
    ds_read_b64_tr_b16 v[180:181], v5 offset:12544
    ds_read_b64_tr_b16 v[182:183], v5 offset:33024
    v_cvt_pk_bf16_f32 v89, v226, v227
    v_cvt_pk_bf16_f32 v90, v228, v229
    v_cvt_pk_bf16_f32 v91, v230, v231
    s_waitcnt lgkmcnt(10)
    s_nop 0
    v_mfma_f32_32x32x16_bf16 v[128:143], v[88:91], v[168:171], v[128:143]
    ds_read_b64_tr_b16 v[184:185], v4 offset:2560
    ds_read_b64_tr_b16 v[186:187], v4 offset:23040
    s_waitcnt lgkmcnt(6)
    v_fma_mix_f32 v232, v92, v208, v216 op_sel:[0,0,0] op_sel_hi:[1,0,0]
    v_fma_mix_f32 v233, v92, v209, v217 op_sel:[1,0,0] op_sel_hi:[1,0,0]
    v_fma_mix_f32 v234, v93, v210, v218 op_sel:[0,0,0] op_sel_hi:[1,0,0]
    v_mfma_f32_32x32x16_bf16 v[144:159], v[88:91], v[172:175], v[144:159]
    ds_read_b64_tr_b16 v[188:189], v4 offset:2816
    ds_read_b64_tr_b16 v[190:191], v4 offset:23296
    v_fma_mix_f32 v235, v93, v211, v219 op_sel:[1,0,0] op_sel_hi:[1,0,0]
    v_fma_mix_f32 v236, v94, v212, v220 op_sel:[0,0,0] op_sel_hi:[1,0,0]
    v_fma_mix_f32 v237, v94, v213, v221 op_sel:[1,0,0] op_sel_hi:[1,0,0]
    s_waitcnt lgkmcnt(6)
    v_mfma_f32_32x32x16_bf16 v[96:111], v[76:79], v[176:179], v[96:111]
    ds_read_b64_tr_b16 v[160:161], v5 offset:14336
    ds_read_b64_tr_b16 v[162:163], v5 offset:34816
    v_fma_mix_f32 v238, v95, v214, v222 op_sel:[0,0,0] op_sel_hi:[1,0,0]
    v_fma_mix_f32 v239, v95, v215, v223 op_sel:[1,0,0] op_sel_hi:[1,0,0]
    v_cvt_pk_bf16_f32 v92, v232, v233
    s_waitcnt lgkmcnt(6)
    v_mfma_f32_32x32x16_bf16 v[112:127], v[76:79], v[180:183], v[112:127]
    ds_read_b64_tr_b16 v[164:165], v5 offset:14592
    ds_read_b64_tr_b16 v[166:167], v5 offset:35072
    v_cvt_pk_bf16_f32 v93, v234, v235
    v_cvt_pk_bf16_f32 v94, v236, v237
    v_cvt_pk_bf16_f32 v95, v238, v239
    s_waitcnt lgkmcnt(6)
    s_nop 0
    v_mfma_f32_32x32x16_bf16 v[128:143], v[92:95], v[184:187], v[128:143]
    ds_read_b64_tr_b16 v[168:169], v5 offset:16384
    ds_read_b64_tr_b16 v[170:171], v5 offset:36864
    s_waitcnt lgkmcnt(6)
    v_mfma_f32_32x32x16_bf16 v[144:159], v[92:95], v[188:191], v[144:159]
    ds_read_b64_tr_b16 v[172:173], v5 offset:16640
    ds_read_b64_tr_b16 v[174:175], v5 offset:37120
    s_waitcnt lgkmcnt(6)
    v_mfma_f32_32x32x16_bf16 v[96:111], v[80:83], v[160:163], v[96:111]
    s_waitcnt lgkmcnt(4)
    v_mfma_f32_32x32x16_bf16 v[112:127], v[80:83], v[164:167], v[112:127]
    s_waitcnt lgkmcnt(2)
    v_mfma_f32_32x32x16_bf16 v[96:111], v[84:87], v[168:171], v[96:111]
    ds_read_b64_tr_b16 v[176:177], v4 offset:0
    ds_read_b64_tr_b16 v[178:179], v4 offset:20480
    s_waitcnt lgkmcnt(2)
    v_mfma_f32_32x32x16_bf16 v[112:127], v[84:87], v[172:175], v[112:127]
    ds_read_b64_tr_b16 v[180:181], v4 offset:256
    ds_read_b64_tr_b16 v[182:183], v4 offset:20736
    ds_write_b128 v7, v[128:131] offset:4096
    ds_write_b128 v7, v[132:135] offset:5120
    s_waitcnt lgkmcnt(4)
    v_mfma_f32_32x32x16_bf16 v[96:111], v[88:91], v[176:179], v[96:111]
    ds_read_b64_tr_b16 v[184:185], v4 offset:2048
    ds_read_b64_tr_b16 v[186:187], v4 offset:22528
    ds_write_b128 v7, v[136:139] offset:6144
    ds_write_b128 v7, v[140:143] offset:7168
    s_waitcnt lgkmcnt(6)
    v_mfma_f32_32x32x16_bf16 v[112:127], v[88:91], v[180:183], v[112:127]
    ds_read_b64_tr_b16 v[188:189], v4 offset:2304
    ds_read_b64_tr_b16 v[190:191], v4 offset:22784
    ds_write_b128 v7, v[144:147] offset:8192
    ds_write_b128 v7, v[148:151] offset:9216
    s_waitcnt lgkmcnt(6)
    v_mfma_f32_32x32x16_bf16 v[96:111], v[92:95], v[184:187], v[96:111]
    ds_write_b128 v7, v[152:155] offset:10240
    ds_write_b128 v7, v[156:159] offset:11264
    s_waitcnt lgkmcnt(4)
    v_mfma_f32_32x32x16_bf16 v[112:127], v[92:95], v[188:191], v[112:127]
    s_waitcnt lgkmcnt(0)
    s_barrier
    ds_read_b128 v[128:131], v0 offset:4096
    ds_read_b128 v[132:135], v0 offset:5120
    ds_read_b128 v[136:139], v0 offset:6144
    ds_read_b128 v[140:143], v0 offset:7168
    ds_read_b128 v[144:147], v0 offset:8192
    ds_read_b128 v[148:151], v0 offset:9216
    ds_read_b128 v[152:155], v0 offset:10240
    ds_read_b128 v[156:159], v0 offset:11264
    s_branch kf_kernel_a_epv
kf_kernel_a_late:
    s_setprio 1
    s_cmp_lt_u32 s74, 100
    s_cbranch_scc1 kf_kernel_a_nb1
    s_barrier
kf_kernel_a_nb1:
    s_mov_b32 s12, s18
    s_mov_b32 s13, s19
    s_mov_b32 s14, 2457600
    s_mov_b32 s15, 0x00020000
    s_cmp_ge_u32 s50, 10
    s_cselect_b32 s55, 1, 0
    s_cmp_ge_u32 s50, 5
    s_cselect_b32 s51, 5, zlit_b-zlit_a+(0)
    s_sub_u32 s56, s50, s51
    s_mov_b32 s60, 0x76543210
    s_mov_b32 s61, 0xfedcba98
    s_cmp_eq_u32 s56, zlit_b-zlit_a+(0)
    s_cselect_b32 s60, 2556773136, s60
    s_cselect_b32 s61, 4235390394, s61
    s_cmp_eq_u32 s56, zlit_b-zlit_a+(1)
    s_cselect_b32 s60, 2844218418, s60
    s_cselect_b32 s61, 3054567132, s61
    s_cmp_eq_u32 s56, zlit_b-zlit_a+(2)
    s_cselect_b32 s60, 2557887265, s60
    s_cselect_b32 s61, 4199607755, s61
    s_cmp_eq_u32 s56, zlit_b-zlit_a+(3)
    s_cselect_b32 s60, 2271556112, s60
    s_cselect_b32 s61, 4271168698, s61
    s_cmp_eq_u32 s56, zlit_b-zlit_a+(4)
    s_cselect_b32 s60, 2843104289, s60
    s_cselect_b32 s61, 3627089611, s61
    v_lshrrev_b32 v12, 4, v2
    v_and_b32 v13, 3, v2
    v_lshl_add_u32 v12, v12, 2, v13
    s_lshl_b32 s51, s53, 3
    v_xor_b32 v12, s51, v12
    v_lshlrev_b32_e64 v12, 2, v12
    v_lshrrev_b64 v[14:15], v12, s[60:61]
    v_and_b32_e64 v14, 15, v14
    v_bfe_u32 v13, v2, 2, 2
    v_mul_u32_u24 v13, 3840, v13
    v_lshl_add_u32 v12, v14, 4, v13
    v_add_u32 v13, 29696, v12
    s_mul_i32 s71, s53, 1228800
    s_and_b32 s51, s54, zlit_b-zlit_a+(1)
    s_mul_i32 s51, s51, 15360
    s_add_u32 s71, s71, s51
    s_lshl_b32 s51, s50, zlit_b-zlit_a+(8)
    s_add_u32 s71, s71, s51
    s_add_u32 s43, s71, 1228800
    s_mul_i32 s51, s83, 245760
    s_add_u32 s71, s71, s51
    s_add_u32 s71, s71, 552960
    s_cmp_ge_u32 s71, s43
    s_cselect_b32 s51, 1228800, 0
    s_sub_u32 s71, s71, s51
    v_and_b32 v237, 31, v2
    v_lshrrev_b32_e64 v238, 5, v2
    v_bfe_u32 v14, v2, 1, 3
    v_xor_b32 v14, v14, v238
    v_lshlrev_b32 v14, 4, v14
    v_lshl_add_u32 v14, v237, 7, v14
    v_add_u32 v236, s70, v14
    v_xor_b32 v237, 32, v236
    v_xor_b32_e64 v238, 64, v236
    v_xor_b32 v239, 96, v236
    v_mov_b32 v232, 0x3f803f80
    s_add_u32 s51, s70, 19712
    v_lshl_add_u32 v244, v2, 2, s51
    v_mov_b32 v245, s51
    v_and_b32 v246, 31, v2
    s_xor_b32 s51, s48, zlit_b-zlit_a+(4)
    s_mul_i32 s51, s51, 20480
    v_add_u32_e64 v0, s51, v3
    s_add_u32 s51, s51, 19712
    v_lshl_add_u32 v246, v246, 2, s51
    v_mov_b32 v247, s51
    v_lshrrev_b32 v14, 5, v2
    s_mul_i32 s51, s53, 81920
    v_lshlrev_b32_e64 v4, 10, v14
    v_bfe_u32 v15, v2, 2, 2
    v_lshl_add_u32 v4, v15, 6, v4
    v_bfe_u32 v15, v2, 4, 1
    v_lshl_add_u32 v4, v15, 5, v4
    v_and_b32_e64 v15, 3, v2
    v_lshl_add_u32 v4, v15, 3, v4
    v_add_u32_e64 v4, s51, v4
    v_add_u32 v5, 40960, v4
    s_add_u32 s51, s51, 18432
    v_lshl_add_u32 v6, v14, 5, s51
    v_add_u32 v7, s70, v3
    s_lshl_b32 s51, s83, 8
    v_add_u32_e64 v248, s51, v3
    v_add_u32 v249, 640, v248
    v_subrev_u32 v14, 1280, v248
    v_subrev_u32 v15, 1280, v249
    v_min_u32 v248, v248, v14
    v_min_u32 v249, v249, v15
    s_mul_i32 s84, s53, 1280
    s_cmp_eq_u32 s54, zlit_b-zlit_a+(0)
    s_cselect_b32 s51, 2560, 0
    s_add_u32 s84, s84, s51
    s_add_u32 s85, s84, 5120
    s_add_u32 s86, s84, 10240
    s_add_u32 s87, s84, 15360
    s_add_u32 s88, s84, 20480
    s_mov_b32 s80, 0x05040100
    s_mov_b32 s81, 0x07060302
    s_mov_b32 s82, -1
    s_mov_b32 s44, s20
    s_mov_b32 s45, s21
    s_mov_b32 s46, 819200
    s_mov_b32 s47, 0x00020000
    s_cmp_eq_u32 s54, 3
    s_cbranch_scc1 kf_kernel_a_sj3l
    s_mul_i32 s58, s57, 3
    s_add_u32 s58, s58, s54
    s_cmp_lt_u32 s58, 640
    s_cbranch_scc1 kf_kernel_a_sj1l
    s_mov_b32 s80, 0x0d0d0d0d
    s_mov_b32 s81, 0x0d0d0d0d
    s_lshl_b32 s79, s58, 12
    s_add_u32 s79, s79, 33665024
    s_cmp_lt_u32 s58, 705
    s_cselect_b32 s79, s79, 0x40000000
    v_lshrrev_b32 v11, 3, v2
    v_lshlrev_b32 v11, 9, v11
    v_and_b32 v10, 7, v2
    v_lshl_add_u32 v11, v10, 5, v11
    s_mov_b32 s75, 0x40000000
    s_mov_b32 s76, 0
    s_mov_b32 s77, 0
    s_mov_b32 s78, zlit_b-zlit_a+(0)
    s_branch kf_kernel_a_sjdl
kf_kernel_a_sj1l:
    s_mov_b32 s44, s24
    s_mov_b32 s45, s25
    s_mov_b32 s46, 2211840
    s_mov_b32 s47, 0x00020000
    s_mul_i32 s62, s58, 1639
    s_lshr_b32 s62, s62, 16
    s_mul_i32 s51, s62, 40
    s_sub_u32 s63, s58, s51
    s_and_b32 s64, s63, 1
    s_lshr_b32 s63, s63, 1
    s_mul_i32 s65, s63, 52
    s_lshr_b32 s65, s65, 8
    s_mul_i32 s51, s65, 5
    s_sub_u32 s66, s63, s51
    s_lshr_b32 s51, s66, 1
    s_mul_i32 s51, s51, 80
    s_and_b32 s52, s66, 1
    s_mul_i32 s52, s52, 48
    s_add_u32 s51, s51, s52
    s_cmp_lt_u32 s66, 4
    s_cselect_b32 s51, s51, zlit_b-zlit_a+(32)
    s_cselect_b32 s77, 16, 80
    s_mul_i32 s77, s77, 3456
    s_mul_i32 s65, s65, 160
    s_add_u32 s51, s51, s65
    s_lshl_b32 s52, s64, zlit_b-zlit_a+(3)
    s_add_u32 s51, s51, s52
    s_mul_i32 s51, s51, 3456
    s_and_b32 s52, s62, zlit_b-zlit_a+(1)
    s_mul_i32 s52, s52, 1728
    s_add_u32 s75, s51, s52
    s_lshr_b32 s52, s62, 1
    s_mul_i32 s52, s52, 224
    v_lshl_add_u32 v10, v2, 2, s52
    v_mov_b32_e64 v11, 0x40000000
    v_cmp_gt_u32 vcc, 1728, v10
    s_nop 1
    v_cndmask_b32 v10, v11, v10, vcc
    s_mov_b32 s76, 13824
    s_mov_b32 s78, 3456
    s_mov_b32 s82, 0x00ffffff
    v_lshrrev_b32_e64 v11, 4, v2
    v_mul_u32_u24 v11, 40960, v11
    v_bfe_u32 v14, v2, 3, 1
    v_lshl_add_u32 v11, v14, 10, v11
    v_and_b32_e64 v14, 7, v2
    v_lshl_add_u32 v11, v14, 5, v11
    s_lshl_b32 s52, s63, 10
    v_subrev_u32 v14, s52, v11
    v_cmp_gt_u32 vcc, 48, v2
    s_nop 1
    v_cndmask_b32_e64 v11, v14, v11, vcc
    s_mul_i32 s51, s62, 143360
    s_lshl_b32 s52, s63, 11
    s_add_u32 s51, s51, s52
    s_lshl_b32 s52, s64, 9
    s_add_u32 s51, s51, s52
    s_add_u32 s79, s51, 315392
    s_branch kf_kernel_a_sjdl
kf_kernel_a_sj3l:
    s_lshr_b32 s51, s57, 2
    s_mul_i32 s62, s51, 171
    s_lshr_b32 s62, s62, 9
    s_mul_i32 s52, s62, 3
    s_sub_u32 s64, s51, s52
    s_and_b32 s51, s57, 1
    s_lshl_b32 s63, s62, 1
    s_add_u32 s63, s63, s51
    s_mul_i32 s75, s63, zlit_b-zlit_a+(20)
    s_mul_i32 s51, s63, 80
    s_sub_u32 s51, s51, 2544
    s_cmp_lt_u32 s63, 32
    s_cselect_b32 s75, s75, s51
    s_cselect_b32 s76, 4, zlit_b-zlit_a+(20)
    s_mul_i32 s75, s75, 1280
    s_mul_i32 s76, s76, 1280
    s_lshl_b32 s77, s76, zlit_b-zlit_a+(1)
    s_mov_b32 s78, 1280
    s_lshl_b32 s51, s64, 8
    s_and_b32 s52, s57, 2
    s_lshl_b32 s52, s52, 6
    s_add_u32 s65, s51, s52
    v_lshl_add_u32 v14, v2, 1, s65
    v_lshlrev_b32 v10, 1, v14
    v_lshrrev_b32 v11, 4, v14
    v_mul_u32_u24 v14, 205, v11
    v_lshrrev_b32 v14, 10, v14
    v_lshlrev_b32 v11, 10, v11
    v_mul_u32_u24 v14, 97280, v14
    v_add_u32 v11, v11, v14
    v_and_b32 v14, 7, v2
    v_lshl_add_u32 v11, v14, 5, v11
    s_mul_i32 s51, s62, 5120
    s_and_b32 s52, s63, 1
    s_lshl_b32 s52, s52, zlit_b-zlit_a+(9)
    s_add_u32 s51, s51, s52
    s_add_u32 s79, s51, 2674688
    s_cmp_lt_u32 s65, 640
    s_cselect_b32 s79, s79, 0x40000000
    s_cselect_b32 s75, s75, 0x40000000
kf_kernel_a_sjdl:
    s_mul_i32 s76, s76, s53
    s_add_u32 s75, s75, s76
    s_lshl_b32 s76, s53, 8
    s_add_u32 s79, s79, s76
    s_mul_i32 s51, s50, 52
    s_lshr_b32 s51, s51, 8
    s_mul_i32 s52, s51, 5
    s_sub_u32 s52, s50, s52
    s_lshl_b32 s101, s51, 7
    s_and_b32 s51, s52, 1
    s_lshl_b32 s51, s51, 6
    s_add_u32 s101, s101, s51
    s_mul_i32 s52, s52, 6560
    s_lshr_b32 s52, s52, 10
    s_lshl_b32 s52, s52, 12
    s_add_u32 s101, s101, s52
    s_and_b32 s51, s49, zlit_b-zlit_a+(60)
    s_add_u32 s101, s101, s51
    s_add_u32 s101, s101, 36143104
    s_lshl_b32 s61, s54, 1
    s_add_u32 s61, s61, s53
    s_cmp_lt_u32 s74, 100
    s_cbranch_scc0 kf_kernel_a_np2
    s_setprio 3
    v_bfe_u32 v192, v2, 3, 1
    v_mul_u32_u24 v192, 0x0202, v192
    v_add_u32 v192, 0x0c0c0100, v192
    v_and_b32 v193, 1, v2
    v_lshlrev_b32 v193, 4, v193
    v_alignbit_b32 v192, v192, v192, v193
    v_bfe_u32 v193, v2, 1, 2
    v_mov_b32 v194, 0x0c0c0c0c
    v_cmp_eq_u32 vcc, 0, v193
    s_nop 1
    v_cndmask_b32 v160, v194, v192, vcc
    v_cmp_eq_u32 vcc, 1, v193
    s_nop 1
    v_cndmask_b32 v161, v194, v192, vcc
    v_cmp_eq_u32 vcc, 2, v193
    s_nop 1
    v_cndmask_b32 v162, v194, v192, vcc
    v_cmp_eq_u32 vcc, 3, v193
    s_nop 1
    v_cndmask_b32 v163, v194, v192, vcc
    v_lshrrev_b32 v192, 4, v2
    v_lshlrev_b32 v224, 5, v2
    v_and_b32 v224, 0xff, v224
    v_lshl_add_u32 v224, v192, 4, v224
    s_mov_b32 s51, 0xff
    s_waitcnt vmcnt(17)
    v_lshlrev_b32 v192, 16, v195
    v_and_b32 v193, 0xffff0000, v195
    v_mul_f32 v194, 0xbfb8aa3b, v192
    v_mul_f32 v195, 0xbfb8aa3b, v193
    v_exp_f32 v194, v194
    v_exp_f32 v195, v195
    v_add_f32 v194, 1.0, v194
    v_add_f32 v195, 1.0, v195
    v_rcp_f32 v194, v194
    v_rcp_f32 v195, v195
    v_mul_f32 v192, v192, v194
    v_mul_f32 v193, v193, v195
    v_cvt_pk_bf16_f32 v195, v192, v193
    s_nop 1
    v_mov_b32_dpp v192, v195 row_newbcast:0 row_mask:0xf bank_mask:0xf
    v_perm_b32 v164, v192, v192, v160
    v_perm_b32 v165, v192, v192, v161
    v_perm_b32 v166, v192, v192, v162
    v_perm_b32 v167, v192, v192, v163
    v_mov_b32_dpp v193, v195 row_newbcast:1 row_mask:0xf bank_mask:0xf
    v_perm_b32 v168, v193, v193, v160
    v_perm_b32 v169, v193, v193, v161
    v_perm_b32 v170, v193, v193, v162
    v_perm_b32 v171, v193, v193, v163
    v_mov_b32_dpp v192, v195 row_newbcast:2 row_mask:0xf bank_mask:0xf
    v_perm_b32 v172, v192, v192, v160
    v_perm_b32 v173, v192, v192, v161
    v_perm_b32 v174, v192, v192, v162
    v_perm_b32 v175, v192, v192, v163
    s_waitcnt vmcnt(16)
    v_mfma_f32_16x16x32_bf16 v[184:187], v[164:167], v[96:99], 0
    v_mov_b32_dpp v193, v195 row_newbcast:3 row_mask:0xf bank_mask:0xf
    v_perm_b32 v176, v193, v193, v160
    v_perm_b32 v177, v193, v193, v161
    v_perm_b32 v178, v193, v193, v162
    v_perm_b32 v179, v193, v193, v163
    s_waitcnt vmcnt(15)
    v_mfma_f32_16x16x32_bf16 v[188:191], v[168:171], v[100:103], 0
    v_mov_b32_dpp v192, v195 row_newbcast:4 row_mask:0xf bank_mask:0xf
    v_perm_b32 v164, v192, v192, v160
    v_perm_b32 v165, v192, v192, v161
    v_perm_b32 v166, v192, v192, v162
    v_perm_b32 v167, v192, v192, v163
    s_waitcnt vmcnt(14)
    v_mfma_f32_16x16x32_bf16 v[184:187], v[172:175], v[104:107], v[184:187]
    v_mov_b32_dpp v193, v195 row_newbcast:5 row_mask:0xf bank_mask:0xf
    v_perm_b32 v168, v193, v193, v160
    v_perm_b32 v169, v193, v193, v161
    v_perm_b32 v170, v193, v193, v162
    v_perm_b32 v171, v193, v193, v163
    s_waitcnt vmcnt(13)
    v_mfma_f32_16x16x32_bf16 v[188:191], v[176:179], v[108:111], v[188:191]
    v_mov_b32_dpp v192, v195 row_newbcast:6 row_mask:0xf bank_mask:0xf
    v_perm_b32 v172, v192, v192, v160
    v_perm_b32 v173, v192, v192, v161
    v_perm_b32 v174, v192, v192, v162
    v_perm_b32 v175, v192, v192, v163
    s_waitcnt vmcnt(12)
    v_mfma_f32_16x16x32_bf16 v[184:187], v[164:167], v[112:115], v[184:187]
    v_mov_b32_dpp v193, v195 row_newbcast:7 row_mask:0xf bank_mask:0xf
    v_perm_b32 v176, v193, v193, v160
    v_perm_b32 v177, v193, v193, v161
    v_perm_b32 v178, v193, v193, v162
    v_perm_b32 v179, v193, v193, v163
    s_waitcnt vmcnt(11)
    v_mfma_f32_16x16x32_bf16 v[188:191], v[168:171], v[116:119], v[188:191]
    v_mov_b32_dpp v192, v195 row_newbcast:8 row_mask:0xf bank_mask:0xf
    v_perm_b32 v164, v192, v192, v160
    v_perm_b32 v165, v192, v192, v161
    v_perm_b32 v166, v192, v192, v162
    v_perm_b32 v167, v192, v192, v163
    s_waitcnt vmcnt(10)
    v_mfma_f32_16x16x32_bf16 v[184:187], v[172:175], v[120:123], v[184:187]
    v_mov_b32_dpp v193, v195 row_newbcast:9 row_mask:0xf bank_mask:0xf
    v_perm_b32 v168, v193, v193, v160
    v_perm_b32 v169, v193, v193, v161
    v_perm_b32 v170, v193, v193, v162
    v_perm_b32 v171, v193, v193, v163
    s_waitcnt vmcnt(9)
    v_mfma_f32_16x16x32_bf16 v[188:191], v[176:179], v[124:127], v[188:191]
    v_mov_b32_dpp v192, v195 row_newbcast:10 row_mask:0xf bank_mask:0xf
    v_perm_b32 v172, v192, v192, v160
    v_perm_b32 v173, v192, v192, v161
    v_perm_b32 v174, v192, v192, v162
    v_perm_b32 v175, v192, v192, v163
    s_waitcnt vmcnt(8)
    v_mfma_f32_16x16x32_bf16 v[184:187], v[164:167], v[128:131], v[184:187]
    v_mov_b32_dpp v193, v195 row_newbcast:11 row_mask:0xf bank_mask:0xf
    v_perm_b32 v176, v193, v193, v160
    v_perm_b32 v177, v193, v193, v161
    v_perm_b32 v178, v193, v193, v162
    v_perm_b32 v179, v193, v193, v163
    s_waitcnt vmcnt(7)
    v_mfma_f32_16x16x32_bf16 v[188:191], v[168:171], v[132:135], v[188:191]
    v_mov_b32_dpp v192, v195 row_newbcast:12 row_mask:0xf bank_mask:0xf
    v_perm_b32 v164, v192, v192, v160
    v_perm_b32 v165, v192, v192, v161
    v_perm_b32 v166, v192, v192, v162
    v_perm_b32 v167, v192, v192, v163
    s_waitcnt vmcnt(6)
    v_mfma_f32_16x16x32_bf16 v[184:187], v[172:175], v[136:139], v[184:187]
    v_mov_b32_dpp v193, v195 row_newbcast:13 row_mask:0xf bank_mask:0xf
    v_perm_b32 v168, v193, v193, v160
    v_perm_b32 v169, v193, v193, v161
    v_perm_b32 v170, v193, v193, v162
    v_perm_b32 v171, v193, v193, v163
    s_waitcnt vmcnt(5)
    v_mfma_f32_16x16x32_bf16 v[188:191], v[176:179], v[140:143], v[188:191]
    v_mov_b32_dpp v192, v195 row_newbcast:14 row_mask:0xf bank_mask:0xf
    v_perm_b32 v172, v192, v192, v160
    v_perm_b32 v173, v192, v192, v161
    v_perm_b32 v174, v192, v192, v162
    v_perm_b32 v175, v192, v192, v163
    s_waitcnt vmcnt(4)
    v_mfma_f32_16x16x32_bf16 v[184:187], v[164:167], v[144:147], v[184:187]
    v_mov_b32_dpp v193, v195 row_newbcast:15 row_mask:0xf bank_mask:0xf
    v_perm_b32 v176, v193, v193, v160
    v_perm_b32 v177, v193, v193, v161
    v_perm_b32 v178, v193, v193, v162
    v_perm_b32 v179, v193, v193, v163
    s_waitcnt vmcnt(3)
    v_mfma_f32_16x16x32_bf16 v[188:191], v[168:171], v[148:151], v[188:191]
    s_waitcnt vmcnt(2)
    v_mfma_f32_16x16x32_bf16 v[184:187], v[172:175], v[152:155], v[184:187]
    s_waitcnt vmcnt(1)
    v_mfma_f32_16x16x32_bf16 v[188:191], v[176:179], v[156:159], v[188:191]
    s_waitcnt vmcnt(0)
    v_add_u32 v192, 0x01010101, v8
    v_lshrrev_b32 v193, 8, v192
    v_lshrrev_b32 v194, 16, v192
    v_lshrrev_b32 v195, 24, v192
    s_nop 2
    v_add_f32 v184, v184, v188
    v_add_f32 v185, v185, v189
    v_add_f32 v186, v186, v190
    v_add_f32 v187, v187, v191
    v_mov_b32 v188, v184
    v_mov_b32 v189, v185
    v_mov_b32 v190, v186
    v_mov_b32 v191, v187
    v_permlane32_swap_b32 v184, v188
    v_permlane32_swap_b32 v185, v189
    v_permlane32_swap_b32 v186, v190
    v_permlane32_swap_b32 v187, v191
    v_add_f32_dpp v184, v188, v184 row_ror:8 row_mask:0xf bank_mask:0xf
    v_add_f32_dpp v185, v189, v185 row_ror:8 row_mask:0xf bank_mask:0xf
    v_add_f32_dpp v186, v190, v186 row_ror:8 row_mask:0xf bank_mask:0xf
    v_add_f32_dpp v187, v191, v187 row_ror:8 row_mask:0xf bank_mask:0xf
    v_bfi_b32 v184, s51, v192, v184
    v_bfi_b32 v185, s51, v193, v185
    v_bfi_b32 v186, s51, v194, v186
    v_bfi_b32 v187, s51, v195, v187
    s_mov_b64 exec, 0x00ff00ff
    buffer_store_dwordx4 v[184:187], v224, s[8:11], s72 offen sc1
    s_mov_b64 exec, -1
    s_setprio 1
    s_branch kf_kernel_a_np3
kf_kernel_a_np2:
    buffer_load_dword v8, v8, s[8:11], 0 offen sc1
kf_kernel_a_np3:
    s_add_u32 m0, s70, zlit_b-zlit_a+(0)
    s_nop 0
    buffer_load_dwordx4 v240, s[4:7], s73 offen offset:0 lds
    buffer_load_dwordx4 v241, s[4:7], s73 offen offset:1024 lds
    buffer_load_dwordx4 v242, s[4:7], s73 offen offset:2048 lds
    buffer_load_dwordx4 v243, s[4:7], s73 offen offset:3072 lds
    s_add_u32 s73, s73, 128
    s_cmp_ge_u32 s73, s42
    s_cselect_b32 s51, 640, 0
    s_sub_u32 s73, s73, s51
    s_add_u32 m0, s70, 4096
    s_nop 0
    buffer_load_dwordx4 v240, s[4:7], s73 offen offset:0 lds
    buffer_load_dwordx4 v241, s[4:7], s73 offen offset:1024 lds
    buffer_load_dwordx4 v242, s[4:7], s73 offen offset:2048 lds
    buffer_load_dwordx4 v243, s[4:7], s73 offen offset:3072 lds
    s_add_u32 s73, s73, 128
    s_cmp_ge_u32 s73, s42
    s_cselect_b32 s51, 640, 0
    s_sub_u32 s73, s73, s51
    s_add_u32 m0, s70, 8192
    s_nop 0
    buffer_load_dwordx4 v240, s[4:7], s73 offen offset:0 lds
    buffer_load_dwordx4 v241, s[4:7], s73 offen offset:1024 lds
    buffer_load_dwordx4 v242, s[4:7], s73 offen offset:2048 lds
    buffer_load_dwordx4 v243, s[4:7], s73 offen offset:3072 lds
    s_add_u32 s73, s73, 128
    s_cmp_ge_u32 s73, s42
    s_cselect_b32 s51, 640, 0
    s_sub_u32 s73, s73, s51
    s_add_u32 m0, s70, 12288
    s_nop 0
    buffer_load_dwordx4 v240, s[4:7], s73 offen offset:0 lds
    buffer_load_dwordx4 v241, s[4:7], s73 offen offset:1024 lds
    buffer_load_dwordx4 v242, s[4:7], s73 offen offset:2048 lds
    buffer_load_dwordx4 v243, s[4:7], s73 offen offset:3072 lds
    s_add_u32 s73, s73, 128
    s_cmp_ge_u32 s73, s42
    s_cselect_b32 s51, 640, 0
    s_sub_u32 s73, s73, s51
    s_add_u32 m0, s70, 16384
    s_nop 0
    buffer_load_dwordx4 v240, s[4:7], s73 offen offset:0 lds
    buffer_load_dwordx4 v241, s[4:7], s73 offen offset:1024 lds
    buffer_load_dwordx4 v242, s[4:7], s73 offen offset:2048 lds
    buffer_load_dwordx4 v243, s[4:7], s73 offen offset:3072 lds
    s_setprio 0
    s_waitcnt vmcnt(16)
    ds_read_b128 v[16:19], v236 offset:0
    ds_read_b128 v[20:23], v237 offset:0
    ds_read_b128 v[24:27], v238 offset:0
    ds_read_b128 v[28:31], v239 offset:0
    s_waitcnt lgkmcnt(3)
    v_dot2_f32_bf16 v224, v16, v232, 0
    v_dot2_f32_bf16 v225, v16, v16, 0
    v_dot2_f32_bf16 v226, v17, v232, 0
    v_dot2_f32_bf16 v227, v17, v17, 0
    v_dot2_f32_bf16 v224, v18, v232, v224
    v_dot2_f32_bf16 v225, v18, v18, v225
    v_dot2_f32_bf16 v226, v19, v232, v226
    v_dot2_f32_bf16 v227, v19, v19, v227
    s_waitcnt lgkmcnt(2)
    v_dot2_f32_bf16 v224, v20, v232, v224
    v_dot2_f32_bf16 v225, v20, v20, v225
    v_dot2_f32_bf16 v226, v21, v232, v226
    v_dot2_f32_bf16 v227, v21, v21, v227
    v_dot2_f32_bf16 v224, v22, v232, v224
    v_dot2_f32_bf16 v225, v22, v22, v225
    v_dot2_f32_bf16 v226, v23, v232, v226
    v_dot2_f32_bf16 v227, v23, v23, v227
    s_waitcnt lgkmcnt(1)
    v_dot2_f32_bf16 v224, v24, v232, v224
    v_dot2_f32_bf16 v225, v24, v24, v225
    v_dot2_f32_bf16 v226, v25, v232, v226
    v_dot2_f32_bf16 v227, v25, v25, v227
    v_dot2_f32_bf16 v224, v26, v232, v224
    v_dot2_f32_bf16 v225, v26, v26, v225
    v_dot2_f32_bf16 v226, v27, v232, v226
    v_dot2_f32_bf16 v227, v27, v27, v227
    s_waitcnt lgkmcnt(0)
    v_dot2_f32_bf16 v224, v28, v232, v224
    v_dot2_f32_bf16 v225, v28, v28, v225
    v_dot2_f32_bf16 v226, v29, v232, v226
    v_dot2_f32_bf16 v227, v29, v29, v227
    v_dot2_f32_bf16 v224, v30, v232, v224
    v_dot2_f32_bf16 v225, v30, v30, v225
    v_dot2_f32_bf16 v226, v31, v232, v226
    v_dot2_f32_bf16 v227, v31, v31, v227
    s_waitcnt vmcnt(12)
    ds_read_b128 v[32:35], v236 offset:4096
    ds_read_b128 v[36:39], v237 offset:4096
    ds_read_b128 v[40:43], v238 offset:4096
    ds_read_b128 v[44:47], v239 offset:4096
    s_waitcnt lgkmcnt(3)
    v_dot2_f32_bf16 v224, v32, v232, v224
    v_dot2_f32_bf16 v225, v32, v32, v225
    v_dot2_f32_bf16 v226, v33, v232, v226
    v_dot2_f32_bf16 v227, v33, v33, v227
    v_dot2_f32_bf16 v224, v34, v232, v224
    v_dot2_f32_bf16 v225, v34, v34, v225
    v_dot2_f32_bf16 v226, v35, v232, v226
    v_dot2_f32_bf16 v227, v35, v35, v227
    s_waitcnt lgkmcnt(2)
    v_dot2_f32_bf16 v224, v36, v232, v224
    v_dot2_f32_bf16 v225, v36, v36, v225
    v_dot2_f32_bf16 v226, v37, v232, v226
    v_dot2_f32_bf16 v227, v37, v37, v227
    v_dot2_f32_bf16 v224, v38, v232, v224
    v_dot2_f32_bf16 v225, v38, v38, v225
    v_dot2_f32_bf16 v226, v39, v232, v226
    v_dot2_f32_bf16 v227, v39, v39, v227
    s_waitcnt lgkmcnt(1)
    v_dot2_f32_bf16 v224, v40, v232, v224
    v_dot2_f32_bf16 v225, v40, v40, v225
    v_dot2_f32_bf16 v226, v41, v232, v226
    v_dot2_f32_bf16 v227, v41, v41, v227
    v_dot2_f32_bf16 v224, v42, v232, v224
    v_dot2_f32_bf16 v225, v42, v42, v225
    v_dot2_f32_bf16 v226, v43, v232, v226
    v_dot2_f32_bf16 v227, v43, v43, v227
    s_waitcnt lgkmcnt(0)
    v_dot2_f32_bf16 v224, v44, v232, v224
    v_dot2_f32_bf16 v225, v44, v44, v225
    v_dot2_f32_bf16 v226, v45, v232, v226
    v_dot2_f32_bf16 v227, v45, v45, v227
    v_dot2_f32_bf16 v224, v46, v232, v224
    v_dot2_f32_bf16 v225, v46, v46, v225
    v_dot2_f32_bf16 v226, v47, v232, v226
    v_dot2_f32_bf16 v227, v47, v47, v227
    s_waitcnt vmcnt(8)
    ds_read_b128 v[48:51], v236 offset:8192
    ds_read_b128 v[52:55], v237 offset:8192
    ds_read_b128 v[56:59], v238 offset:8192
    ds_read_b128 v[60:63], v239 offset:8192
    s_waitcnt lgkmcnt(3)
    v_dot2_f32_bf16 v224, v48, v232, v224
    v_dot2_f32_bf16 v225, v48, v48, v225
    v_dot2_f32_bf16 v226, v49, v232, v226
    v_dot2_f32_bf16 v227, v49, v49, v227
    v_dot2_f32_bf16 v224, v50, v232, v224
    v_dot2_f32_bf16 v225, v50, v50, v225
    v_dot2_f32_bf16 v226, v51, v232, v226
    v_dot2_f32_bf16 v227, v51, v51, v227
    s_waitcnt lgkmcnt(2)
    v_dot2_f32_bf16 v224, v52, v232, v224
    v_dot2_f32_bf16 v225, v52, v52, v225
    v_dot2_f32_bf16 v226, v53, v232, v226
    v_dot2_f32_bf16 v227, v53, v53, v227
    v_dot2_f32_bf16 v224, v54, v232, v224
    v_dot2_f32_bf16 v225, v54, v54, v225
    v_dot2_f32_bf16 v226, v55, v232, v226
    v_dot2_f32_bf16 v227, v55, v55, v227
    s_waitcnt lgkmcnt(1)
    v_dot2_f32_bf16 v224, v56, v232, v224
    v_dot2_f32_bf16 v225, v56, v56, v225
    v_dot2_f32_bf16 v226, v57, v232, v226
    v_dot2_f32_bf16 v227, v57, v57, v227
    v_dot2_f32_bf16 v224, v58, v232, v224
    v_dot2_f32_bf16 v225, v58, v58, v225
    v_dot2_f32_bf16 v226, v59, v232, v226
    v_dot2_f32_bf16 v227, v59, v59, v227
    s_waitcnt lgkmcnt(0)
    v_dot2_f32_bf16 v224, v60, v232, v224
    v_dot2_f32_bf16 v225, v60, v60, v225
    v_dot2_f32_bf16 v226, v61, v232, v226
    v_dot2_f32_bf16 v227, v61, v61, v227
    v_dot2_f32_bf16 v224, v62, v232, v224
    v_dot2_f32_bf16 v225, v62, v62, v225
    v_dot2_f32_bf16 v226, v63, v232, v226
    v_dot2_f32_bf16 v227, v63, v63, v227
    s_waitcnt vmcnt(4)
    ds_read_b128 v[64:67], v236 offset:12288
    ds_read_b128 v[68:71], v237 offset:12288
    ds_read_b128 v[72:75], v238 offset:12288
    ds_read_b128 v[76:79], v239 offset:12288
    s_waitcnt lgkmcnt(3)
    v_dot2_f32_bf16 v224, v64, v232, v224
    v_dot2_f32_bf16 v225, v64, v64, v225
    v_dot2_f32_bf16 v226, v65, v232, v226
    v_dot2_f32_bf16 v227, v65, v65, v227
    v_dot2_f32_bf16 v224, v66, v232, v224
    v_dot2_f32_bf16 v225, v66, v66, v225
    v_dot2_f32_bf16 v226, v67, v232, v226
    v_dot2_f32_bf16 v227, v67, v67, v227
    s_waitcnt lgkmcnt(2)
    v_dot2_f32_bf16 v224, v68, v232, v224
    v_dot2_f32_bf16 v225, v68, v68, v225
    v_dot2_f32_bf16 v226, v69, v232, v226
    v_dot2_f32_bf16 v227, v69, v69, v227
    v_dot2_f32_bf16 v224, v70, v232, v224
    v_dot2_f32_bf16 v225, v70, v70, v225
    v_dot2_f32_bf16 v226, v71, v232, v226
    v_dot2_f32_bf16 v227, v71, v71, v227
    s_waitcnt lgkmcnt(1)
    v_dot2_f32_bf16 v224, v72, v232, v224
    v_dot2_f32_bf16 v225, v72, v72, v225
    v_dot2_f32_bf16 v226, v73, v232, v226
    v_dot2_f32_bf16 v227, v73, v73, v227
    v_dot2_f32_bf16 v224, v74, v232, v224
    v_dot2_f32_bf16 v225, v74, v74, v225
    v_dot2_f32_bf16 v226, v75, v232, v226
    v_dot2_f32_bf16 v227, v75, v75, v227
    s_waitcnt lgkmcnt(0)
    v_dot2_f32_bf16 v224, v76, v232, v224
    v_dot2_f32_bf16 v225, v76, v76, v225
    v_dot2_f32_bf16 v226, v77, v232, v226
    v_dot2_f32_bf16 v227, v77, v77, v227
    v_dot2_f32_bf16 v224, v78, v232, v224
    v_dot2_f32_bf16 v225, v78, v78, v225
    v_dot2_f32_bf16 v226, v79, v232, v226
    v_dot2_f32_bf16 v227, v79, v79, v227
    s_waitcnt vmcnt(0)
    ds_read_b128 v[80:83], v236 offset:16384
    ds_read_b128 v[84:87], v237 offset:16384
    ds_read_b128 v[88:91], v238 offset:16384
    ds_read_b128 v[92:95], v239 offset:16384
    s_waitcnt lgkmcnt(3)
    v_dot2_f32_bf16 v224, v80, v232, v224
    v_dot2_f32_bf16 v225, v80, v80, v225
    v_dot2_f32_bf16 v226, v81, v232, v226
    v_dot2_f32_bf16 v227, v81, v81, v227
    v_dot2_f32_bf16 v224, v82, v232, v224
    v_dot2_f32_bf16 v225, v82, v82, v225
    v_dot2_f32_bf16 v226, v83, v232, v226
    v_dot2_f32_bf16 v227, v83, v83, v227
    s_waitcnt lgkmcnt(2)
    v_dot2_f32_bf16 v224, v84, v232, v224
    v_dot2_f32_bf16 v225, v84, v84, v225
    v_dot2_f32_bf16 v226, v85, v232, v226
    v_dot2_f32_bf16 v227, v85, v85, v227
    v_dot2_f32_bf16 v224, v86, v232, v224
    v_dot2_f32_bf16 v225, v86, v86, v225
    v_dot2_f32_bf16 v226, v87, v232, v226
    v_dot2_f32_bf16 v227, v87, v87, v227
    s_waitcnt lgkmcnt(1)
    v_dot2_f32_bf16 v224, v88, v232, v224
    v_dot2_f32_bf16 v225, v88, v88, v225
    v_dot2_f32_bf16 v226, v89, v232, v226
    v_dot2_f32_bf16 v227, v89, v89, v227
    v_dot2_f32_bf16 v224, v90, v232, v224
    v_dot2_f32_bf16 v225, v90, v90, v225
    v_dot2_f32_bf16 v226, v91, v232, v226
    v_dot2_f32_bf16 v227, v91, v91, v227
    s_waitcnt lgkmcnt(0)
    v_dot2_f32_bf16 v224, v92, v232, v224
    v_dot2_f32_bf16 v225, v92, v92, v225
    v_dot2_f32_bf16 v226, v93, v232, v226
    v_dot2_f32_bf16 v227, v93, v93, v227
    v_dot2_f32_bf16 v224, v94, v232, v224
    v_dot2_f32_bf16 v225, v94, v94, v225
    v_dot2_f32_bf16 v226, v95, v232, v226
    v_dot2_f32_bf16 v227, v95, v95, v227
    s_nop 1
    v_add_f32 v224, v224, v226
    v_add_f32_e64 v225, v225, v227
    v_add_u32 v8, 0x01010101, v8
    s_nop 0
    v_permlane32_swap_b32 v224, v225
    v_add_f32_e64 v224, v224, v225
    ds_write_b32 v244, v224
    v_not_b32_e64 v9, v8
    ds_write_b64 v245, v[8:9] offset:256
    v_mov_b32 v225, v224
    s_nop 1
    v_permlane32_swap_b32_e64 v224, v225
kf_kernel_a_spinl:
    ds_read_b64 v[14:15], v247 offset:256
    ds_read2_b32 v[226:227], v246 offset1:32
    s_waitcnt lgkmcnt(0)
    v_cmp_eq_u64 vcc, v[14:15], v[8:9]
    s_cbranch_vccnz kf_kernel_a_spunl
    s_sleep 1
    s_branch kf_kernel_a_spinl
kf_kernel_a_spunl:
    v_readfirstlane_b32 s100, v8
    v_add_f32 v224, v224, v226
    v_add_f32 v225, v225, v227
    v_mul_f32 v224, 0x3acccccd, v224
    v_mul_f32 v225, 0x3acccccd, v225
    v_fma_f32 v225, -v224, v224, v225
    v_max_f32_e64 v225, 0, v225
    v_cvt_pk_bf16_f32 v225, v225, v224
    v_and_b32 v9, 0xffff0000, v225
    v_lshlrev_b32_e64 v225, 16, v225
    v_add_f32 v225, 0x3727c5ac, v225
    v_cvt_pk_bf16_f32 v225, v225, v225
    v_lshlrev_b32 v225, 16, v225
    v_sqrt_f32_e64 v225, v225
    s_nop 0
    v_cvt_pk_bf16_f32 v225, v225, v225
    v_lshlrev_b32 v225, 16, v225
    v_rcp_f32_e64 v15, v225
    s_nop 0
    v_mul_f32 v14, -v9, v15
    v_lshlrev_b32_e64 v224, 16, v16
    v_and_b32 v225, 0xffff0000, v16
    v_lshlrev_b32_e64 v226, 16, v17
    v_and_b32 v227, 0xffff0000, v17
    v_lshlrev_b32_e64 v228, 16, v18
    v_and_b32 v229, 0xffff0000, v18
    v_lshlrev_b32_e64 v230, 16, v19
    v_and_b32 v231, 0xffff0000, v19
    v_pk_fma_f32 v[224:225], v[14:15], v[224:225], v[14:15] op_sel:[1,0,0] op_sel_hi:[1,1,0]
    v_pk_fma_f32 v[226:227], v[14:15], v[226:227], v[14:15] op_sel:[1,0,0] op_sel_hi:[1,1,0]
    v_pk_fma_f32 v[228:229], v[14:15], v[228:229], v[14:15] op_sel:[1,0,0] op_sel_hi:[1,1,0]
    v_pk_fma_f32 v[230:231], v[14:15], v[230:231], v[14:15] op_sel:[1,0,0] op_sel_hi:[1,1,0]
    v_cvt_pk_f16_f32 v16, v224, v225
    v_cvt_pk_f16_f32 v17, v226, v227
    v_cvt_pk_f16_f32 v18, v228, v229
    v_cvt_pk_f16_f32 v19, v230, v231
    v_lshlrev_b32_e64 v232, 16, v20
    v_and_b32 v233, 0xffff0000, v20
    v_lshlrev_b32_e64 v234, 16, v21
    v_and_b32 v235, 0xffff0000, v21
    v_lshlrev_b32_e64 v236, 16, v22
    v_and_b32 v237, 0xffff0000, v22
    v_lshlrev_b32_e64 v238, 16, v23
    v_and_b32 v239, 0xffff0000, v23
    v_pk_fma_f32 v[232:233], v[14:15], v[232:233], v[14:15] op_sel:[1,0,0] op_sel_hi:[1,1,0]
    v_pk_fma_f32 v[234:235], v[14:15], v[234:235], v[14:15] op_sel:[1,0,0] op_sel_hi:[1,1,0]
    v_pk_fma_f32 v[236:237], v[14:15], v[236:237], v[14:15] op_sel:[1,0,0] op_sel_hi:[1,1,0]
    v_pk_fma_f32 v[238:239], v[14:15], v[238:239], v[14:15] op_sel:[1,0,0] op_sel_hi:[1,1,0]
    v_cvt_pk_f16_f32 v20, v232, v233
    v_cvt_pk_f16_f32 v21, v234, v235
    v_cvt_pk_f16_f32 v22, v236, v237
    v_cvt_pk_f16_f32 v23, v238, v239
    v_lshlrev_b32_e64 v224, 16, v24
    v_and_b32 v225, 0xffff0000, v24
    v_lshlrev_b32_e64 v226, 16, v25
    v_and_b32 v227, 0xffff0000, v25
    v_lshlrev_b32_e64 v228, 16, v26
    v_and_b32 v229, 0xffff0000, v26
    v_lshlrev_b32_e64 v230, 16, v27
    v_and_b32 v231, 0xffff0000, v27
    v_pk_fma_f32 v[224:225], v[14:15], v[224:225], v[14:15] op_sel:[1,0,0] op_sel_hi:[1,1,0]
    v_pk_fma_f32 v[226:227], v[14:15], v[226:227], v[14:15] op_sel:[1,0,0] op_sel_hi:[1,1,0]
    v_pk_fma_f32 v[228:229], v[14:15], v[228:229], v[14:15] op_sel:[1,0,0] op_sel_hi:[1,1,0]
    v_pk_fma_f32 v[230:231], v[14:15], v[230:231], v[14:15] op_sel:[1,0,0] op_sel_hi:[1,1,0]
    v_cvt_pk_f16_f32 v24, v224, v225
    v_cvt_pk_f16_f32 v25, v226, v227
    v_cvt_pk_f16_f32 v26, v228, v229
    v_cvt_pk_f16_f32 v27, v230, v231
    v_lshlrev_b32_e64 v232, 16, v28
    v_and_b32 v233, 0xffff0000, v28
    v_lshlrev_b32_e64 v234, 16, v29
    v_and_b32 v235, 0xffff0000, v29
    v_lshlrev_b32_e64 v236, 16, v30
    v_and_b32 v237, 0xffff0000, v30
    v_lshlrev_b32_e64 v238, 16, v31
    v_and_b32 v239, 0xffff0000, v31
    v_pk_fma_f32 v[232:233], v[14:15], v[232:233], v[14:15] op_sel:[1,0,0] op_sel_hi:[1,1,0]
    v_pk_fma_f32 v[234:235], v[14:15], v[234:235], v[14:15] op_sel:[1,0,0] op_sel_hi:[1,1,0]
    v_pk_fma_f32 v[236:237], v[14:15], v[236:237], v[14:15] op_sel:[1,0,0] op_sel_hi:[1,1,0]
    v_pk_fma_f32 v[238:239], v[14:15], v[238:239], v[14:15] op_sel:[1,0,0] op_sel_hi:[1,1,0]
    v_cvt_pk_f16_f32 v28, v232, v233
    v_cvt_pk_f16_f32 v29, v234, v235
    v_cvt_pk_f16_f32 v30, v236, v237
    v_cvt_pk_f16_f32 v31, v238, v239
    v_lshlrev_b32_e64 v224, 16, v32
    v_and_b32 v225, 0xffff0000, v32
    v_lshlrev_b32_e64 v226, 16, v33
    v_and_b32 v227, 0xffff0000, v33
    v_lshlrev_b32_e64 v228, 16, v34
    v_and_b32 v229, 0xffff0000, v34
    v_lshlrev_b32_e64 v230, 16, v35
    v_and_b32 v231, 0xffff0000, v35
    v_pk_fma_f32 v[224:225], v[14:15], v[224:225], v[14:15] op_sel:[1,0,0] op_sel_hi:[1,1,0]
    v_pk_fma_f32 v[226:227], v[14:15], v[226:227], v[14:15] op_sel:[1,0,0] op_sel_hi:[1,1,0]
    v_pk_fma_f32 v[228:229], v[14:15], v[228:229], v[14:15] op_sel:[1,0,0] op_sel_hi:[1,1,0]
    v_pk_fma_f32 v[230:231], v[14:15], v[230:231], v[14:15] op_sel:[1,0,0] op_sel_hi:[1,1,0]
    v_cvt_pk_f16_f32 v32, v224, v225
    v_cvt_pk_f16_f32 v33, v226, v227
    v_cvt_pk_f16_f32 v34, v228, v229
    v_cvt_pk_f16_f32 v35, v230, v231
    v_lshlrev_b32_e64 v232, 16, v36
    v_and_b32 v233, 0xffff0000, v36
    v_lshlrev_b32_e64 v234, 16, v37
    v_and_b32 v235, 0xffff0000, v37
    v_lshlrev_b32_e64 v236, 16, v38
    v_and_b32 v237, 0xffff0000, v38
    v_lshlrev_b32_e64 v238, 16, v39
    v_and_b32 v239, 0xffff0000, v39
    v_pk_fma_f32 v[232:233], v[14:15], v[232:233], v[14:15] op_sel:[1,0,0] op_sel_hi:[1,1,0]
    v_pk_fma_f32 v[234:235], v[14:15], v[234:235], v[14:15] op_sel:[1,0,0] op_sel_hi:[1,1,0]
    v_pk_fma_f32 v[236:237], v[14:15], v[236:237], v[14:15] op_sel:[1,0,0] op_sel_hi:[1,1,0]
    v_pk_fma_f32 v[238:239], v[14:15], v[238:239], v[14:15] op_sel:[1,0,0] op_sel_hi:[1,1,0]
    v_cvt_pk_f16_f32 v36, v232, v233
    v_cvt_pk_f16_f32 v37, v234, v235
    v_cvt_pk_f16_f32 v38, v236, v237
    v_cvt_pk_f16_f32 v39, v238, v239
    v_lshlrev_b32_e64 v224, 16, v40
    v_and_b32 v225, 0xffff0000, v40
    v_lshlrev_b32_e64 v226, 16, v41
    v_and_b32 v227, 0xffff0000, v41
    v_lshlrev_b32_e64 v228, 16, v42
    v_and_b32 v229, 0xffff0000, v42
    v_lshlrev_b32_e64 v230, 16, v43
    v_and_b32 v231, 0xffff0000, v43
    v_pk_fma_f32 v[224:225], v[14:15], v[224:225], v[14:15] op_sel:[1,0,0] op_sel_hi:[1,1,0]
    v_pk_fma_f32 v[226:227], v[14:15], v[226:227], v[14:15] op_sel:[1,0,0] op_sel_hi:[1,1,0]
    v_pk_fma_f32 v[228:229], v[14:15], v[228:229], v[14:15] op_sel:[1,0,0] op_sel_hi:[1,1,0]
    v_pk_fma_f32 v[230:231], v[14:15], v[230:231], v[14:15] op_sel:[1,0,0] op_sel_hi:[1,1,0]
    v_cvt_pk_f16_f32 v40, v224, v225
    v_cvt_pk_f16_f32 v41, v226, v227
    v_cvt_pk_f16_f32 v42, v228, v229
    v_cvt_pk_f16_f32 v43, v230, v231
    v_lshlrev_b32_e64 v232, 16, v44
    v_and_b32 v233, 0xffff0000, v44
    v_lshlrev_b32_e64 v234, 16, v45
    v_and_b32 v235, 0xffff0000, v45
    v_lshlrev_b32_e64 v236, 16, v46
    v_and_b32 v237, 0xffff0000, v46
    v_lshlrev_b32_e64 v238, 16, v47
    v_and_b32 v239, 0xffff0000, v47
    v_pk_fma_f32 v[232:233], v[14:15], v[232:233], v[14:15] op_sel:[1,0,0] op_sel_hi:[1,1,0]
    v_pk_fma_f32 v[234:235], v[14:15], v[234:235], v[14:15] op_sel:[1,0,0] op_sel_hi:[1,1,0]
    v_pk_fma_f32 v[236:237], v[14:15], v[236:237], v[14:15] op_sel:[1,0,0] op_sel_hi:[1,1,0]
    v_pk_fma_f32 v[238:239], v[14:15], v[238:239], v[14:15] op_sel:[1,0,0] op_sel_hi:[1,1,0]
    v_cvt_pk_f16_f32 v44, v232, v233
    v_cvt_pk_f16_f32 v45, v234, v235
    v_cvt_pk_f16_f32 v46, v236, v237
    v_cvt_pk_f16_f32 v47, v238, v239
    v_lshlrev_b32_e64 v224, 16, v48
    v_and_b32 v225, 0xffff0000, v48
    v_lshlrev_b32_e64 v226, 16, v49
    v_and_b32 v227, 0xffff0000, v49
    v_lshlrev_b32_e64 v228, 16, v50
    v_and_b32 v229, 0xffff0000, v50
    v_lshlrev_b32_e64 v230, 16, v51
    v_and_b32 v231, 0xffff0000, v51
    v_pk_fma_f32 v[224:225], v[14:15], v[224:225], v[14:15] op_sel:[1,0,0] op_sel_hi:[1,1,0]
    v_pk_fma_f32 v[226:227], v[14:15], v[226:227], v[14:15] op_sel:[1,0,0] op_sel_hi:[1,1,0]
    v_pk_fma_f32 v[228:229], v[14:15], v[228:229], v[14:15] op_sel:[1,0,0] op_sel_hi:[1,1,0]
    v_pk_fma_f32 v[230:231], v[14:15], v[230:231], v[14:15] op_sel:[1,0,0] op_sel_hi:[1,1,0]
    v_cvt_pk_f16_f32 v48, v224, v225
    v_cvt_pk_f16_f32 v49, v226, v227
    v_cvt_pk_f16_f32 v50, v228, v229
    v_cvt_pk_f16_f32 v51, v230, v231
    v_lshlrev_b32_e64 v232, 16, v52
    v_and_b32 v233, 0xffff0000, v52
    v_lshlrev_b32_e64 v234, 16, v53
    v_and_b32 v235, 0xffff0000, v53
    v_lshlrev_b32_e64 v236, 16, v54
    v_and_b32 v237, 0xffff0000, v54
    v_lshlrev_b32_e64 v238, 16, v55
    v_and_b32 v239, 0xffff0000, v55
    v_pk_fma_f32 v[232:233], v[14:15], v[232:233], v[14:15] op_sel:[1,0,0] op_sel_hi:[1,1,0]
    v_pk_fma_f32 v[234:235], v[14:15], v[234:235], v[14:15] op_sel:[1,0,0] op_sel_hi:[1,1,0]
    v_pk_fma_f32 v[236:237], v[14:15], v[236:237], v[14:15] op_sel:[1,0,0] op_sel_hi:[1,1,0]
    v_pk_fma_f32 v[238:239], v[14:15], v[238:239], v[14:15] op_sel:[1,0,0] op_sel_hi:[1,1,0]
    v_cvt_pk_f16_f32 v52, v232, v233
    v_cvt_pk_f16_f32 v53, v234, v235
    v_cvt_pk_f16_f32 v54, v236, v237
    v_cvt_pk_f16_f32 v55, v238, v239
    v_lshlrev_b32_e64 v224, 16, v56
    v_and_b32 v225, 0xffff0000, v56
    v_lshlrev_b32_e64 v226, 16, v57
    v_and_b32 v227, 0xffff0000, v57
    v_lshlrev_b32_e64 v228, 16, v58
    v_and_b32 v229, 0xffff0000, v58
    v_lshlrev_b32_e64 v230, 16, v59
    v_and_b32 v231, 0xffff0000, v59
    v_pk_fma_f32 v[224:225], v[14:15], v[224:225], v[14:15] op_sel:[1,0,0] op_sel_hi:[1,1,0]
    v_pk_fma_f32 v[226:227], v[14:15], v[226:227], v[14:15] op_sel:[1,0,0] op_sel_hi:[1,1,0]
    v_pk_fma_f32 v[228:229], v[14:15], v[228:229], v[14:15] op_sel:[1,0,0] op_sel_hi:[1,1,0]
    v_pk_fma_f32 v[230:231], v[14:15], v[230:231], v[14:15] op_sel:[1,0,0] op_sel_hi:[1,1,0]
    v_cvt_pk_f16_f32 v56, v224, v225
    v_cvt_pk_f16_f32 v57, v226, v227
    v_cvt_pk_f16_f32 v58, v228, v229
    v_cvt_pk_f16_f32 v59, v230, v231
    v_lshlrev_b32_e64 v232, 16, v60
    v_and_b32 v233, 0xffff0000, v60
    v_lshlrev_b32_e64 v234, 16, v61
    v_and_b32 v235, 0xffff0000, v61
    v_lshlrev_b32_e64 v236, 16, v62
    v_and_b32 v237, 0xffff0000, v62
    v_lshlrev_b32_e64 v238, 16, v63
    v_and_b32 v239, 0xffff0000, v63
    v_pk_fma_f32 v[232:233], v[14:15], v[232:233], v[14:15] op_sel:[1,0,0] op_sel_hi:[1,1,0]
    v_pk_fma_f32 v[234:235], v[14:15], v[234:235], v[14:15] op_sel:[1,0,0] op_sel_hi:[1,1,0]
    v_pk_fma_f32 v[236:237], v[14:15], v[236:237], v[14:15] op_sel:[1,0,0] op_sel_hi:[1,1,0]
    v_pk_fma_f32 v[238:239], v[14:15], v[238:239], v[14:15] op_sel:[1,0,0] op_sel_hi:[1,1,0]
    v_cvt_pk_f16_f32 v60, v232, v233
    v_cvt_pk_f16_f32 v61, v234, v235
    v_cvt_pk_f16_f32 v62, v236, v237
    v_cvt_pk_f16_f32 v63, v238, v239
    v_lshlrev_b32_e64 v224, 16, v64
    v_and_b32 v225, 0xffff0000, v64
    v_lshlrev_b32_e64 v226, 16, v65
    v_and_b32 v227, 0xffff0000, v65
    v_lshlrev_b32_e64 v228, 16, v66
    v_and_b32 v229, 0xffff0000, v66
    v_lshlrev_b32_e64 v230, 16, v67
    v_and_b32 v231, 0xffff0000, v67
    v_pk_fma_f32 v[224:225], v[14:15], v[224:225], v[14:15] op_sel:[1,0,0] op_sel_hi:[1,1,0]
    v_pk_fma_f32 v[226:227], v[14:15], v[226:227], v[14:15] op_sel:[1,0,0] op_sel_hi:[1,1,0]
    v_pk_fma_f32 v[228:229], v[14:15], v[228:229], v[14:15] op_sel:[1,0,0] op_sel_hi:[1,1,0]
    v_pk_fma_f32 v[230:231], v[14:15], v[230:231], v[14:15] op_sel:[1,0,0] op_sel_hi:[1,1,0]
    v_cvt_pk_f16_f32 v64, v224, v225
    v_cvt_pk_f16_f32 v65, v226, v227
    v_cvt_pk_f16_f32 v66, v228, v229
    v_cvt_pk_f16_f32 v67, v230, v231
    v_lshlrev_b32_e64 v232, 16, v68
    v_and_b32 v233, 0xffff0000, v68
    v_lshlrev_b32_e64 v234, 16, v69
    v_and_b32 v235, 0xffff0000, v69
    v_lshlrev_b32_e64 v236, 16, v70
    v_and_b32 v237, 0xffff0000, v70
    v_lshlrev_b32_e64 v238, 16, v71
    v_and_b32 v239, 0xffff0000, v71
    v_pk_fma_f32 v[232:233], v[14:15], v[232:233], v[14:15] op_sel:[1,0,0] op_sel_hi:[1,1,0]
    v_pk_fma_f32 v[234:235], v[14:15], v[234:235], v[14:15] op_sel:[1,0,0] op_sel_hi:[1,1,0]
    v_pk_fma_f32 v[236:237], v[14:15], v[236:237], v[14:15] op_sel:[1,0,0] op_sel_hi:[1,1,0]
    v_pk_fma_f32 v[238:239], v[14:15], v[238:239], v[14:15] op_sel:[1,0,0] op_sel_hi:[1,1,0]
    v_cvt_pk_f16_f32 v68, v232, v233
    v_cvt_pk_f16_f32 v69, v234, v235
    v_cvt_pk_f16_f32 v70, v236, v237
    v_cvt_pk_f16_f32 v71, v238, v239
    v_lshlrev_b32_e64 v224, 16, v72
    v_and_b32 v225, 0xffff0000, v72
    v_lshlrev_b32_e64 v226, 16, v73
    v_and_b32 v227, 0xffff0000, v73
    v_lshlrev_b32_e64 v228, 16, v74
    v_and_b32 v229, 0xffff0000, v74
    v_lshlrev_b32_e64 v230, 16, v75
    v_and_b32 v231, 0xffff0000, v75
    v_pk_fma_f32 v[224:225], v[14:15], v[224:225], v[14:15] op_sel:[1,0,0] op_sel_hi:[1,1,0]
    v_pk_fma_f32 v[226:227], v[14:15], v[226:227], v[14:15] op_sel:[1,0,0] op_sel_hi:[1,1,0]
    v_pk_fma_f32 v[228:229], v[14:15], v[228:229], v[14:15] op_sel:[1,0,0] op_sel_hi:[1,1,0]
    v_pk_fma_f32 v[230:231], v[14:15], v[230:231], v[14:15] op_sel:[1,0,0] op_sel_hi:[1,1,0]
    v_cvt_pk_f16_f32 v72, v224, v225
    v_cvt_pk_f16_f32 v73, v226, v227
    v_cvt_pk_f16_f32 v74, v228, v229
    v_cvt_pk_f16_f32 v75, v230, v231
    v_lshlrev_b32_e64 v232, 16, v76
    v_and_b32 v233, 0xffff0000, v76
    v_lshlrev_b32_e64 v234, 16, v77
    v_and_b32 v235, 0xffff0000, v77
    v_lshlrev_b32_e64 v236, 16, v78
    v_and_b32 v237, 0xffff0000, v78
    v_lshlrev_b32_e64 v238, 16, v79
    v_and_b32 v239, 0xffff0000, v79
    v_pk_fma_f32 v[232:233], v[14:15], v[232:233], v[14:15] op_sel:[1,0,0] op_sel_hi:[1,1,0]
    v_pk_fma_f32 v[234:235], v[14:15], v[234:235], v[14:15] op_sel:[1,0,0] op_sel_hi:[1,1,0]
    v_pk_fma_f32 v[236:237], v[14:15], v[236:237], v[14:15] op_sel:[1,0,0] op_sel_hi:[1,1,0]
    v_pk_fma_f32 v[238:239], v[14:15], v[238:239], v[14:15] op_sel:[1,0,0] op_sel_hi:[1,1,0]
    v_cvt_pk_f16_f32 v76, v232, v233
    v_cvt_pk_f16_f32 v77, v234, v235
    v_cvt_pk_f16_f32 v78, v236, v237
    v_cvt_pk_f16_f32 v79, v238, v239
    v_lshlrev_b32_e64 v224, 16, v80
    v_and_b32 v225, 0xffff0000, v80
    v_lshlrev_b32_e64 v226, 16, v81
    v_and_b32 v227, 0xffff0000, v81
    v_lshlrev_b32_e64 v228, 16, v82
    v_and_b32 v229, 0xffff0000, v82
    v_lshlrev_b32_e64 v230, 16, v83
    v_and_b32 v231, 0xffff0000, v83
    v_pk_fma_f32 v[224:225], v[14:15], v[224:225], v[14:15] op_sel:[1,0,0] op_sel_hi:[1,1,0]
    v_pk_fma_f32 v[226:227], v[14:15], v[226:227], v[14:15] op_sel:[1,0,0] op_sel_hi:[1,1,0]
    v_pk_fma_f32 v[228:229], v[14:15], v[228:229], v[14:15] op_sel:[1,0,0] op_sel_hi:[1,1,0]
    v_pk_fma_f32 v[230:231], v[14:15], v[230:231], v[14:15] op_sel:[1,0,0] op_sel_hi:[1,1,0]
    v_cvt_pk_f16_f32 v80, v224, v225
    v_cvt_pk_f16_f32 v81, v226, v227
    v_cvt_pk_f16_f32 v82, v228, v229
    v_cvt_pk_f16_f32 v83, v230, v231
    v_lshlrev_b32_e64 v232, 16, v84
    v_and_b32 v233, 0xffff0000, v84
    v_lshlrev_b32_e64 v234, 16, v85
    v_and_b32 v235, 0xffff0000, v85
    v_lshlrev_b32_e64 v236, 16, v86
    v_and_b32 v237, 0xffff0000, v86
    v_lshlrev_b32_e64 v238, 16, v87
    v_and_b32 v239, 0xffff0000, v87
    v_pk_fma_f32 v[232:233], v[14:15], v[232:233], v[14:15] op_sel:[1,0,0] op_sel_hi:[1,1,0]
    v_pk_fma_f32 v[234:235], v[14:15], v[234:235], v[14:15] op_sel:[1,0,0] op_sel_hi:[1,1,0]
    v_pk_fma_f32 v[236:237], v[14:15], v[236:237], v[14:15] op_sel:[1,0,0] op_sel_hi:[1,1,0]
    v_pk_fma_f32 v[238:239], v[14:15], v[238:239], v[14:15] op_sel:[1,0,0] op_sel_hi:[1,1,0]
    v_cvt_pk_f16_f32 v84, v232, v233
    v_cvt_pk_f16_f32 v85, v234, v235
    v_cvt_pk_f16_f32 v86, v236, v237
    v_cvt_pk_f16_f32 v87, v238, v239
    v_lshlrev_b32_e64 v224, 16, v88
    v_and_b32 v225, 0xffff0000, v88
    v_lshlrev_b32_e64 v226, 16, v89
    v_and_b32 v227, 0xffff0000, v89
    v_lshlrev_b32_e64 v228, 16, v90
    v_and_b32 v229, 0xffff0000, v90
    v_lshlrev_b32_e64 v230, 16, v91
    v_and_b32 v231, 0xffff0000, v91
    v_pk_fma_f32 v[224:225], v[14:15], v[224:225], v[14:15] op_sel:[1,0,0] op_sel_hi:[1,1,0]
    v_pk_fma_f32 v[226:227], v[14:15], v[226:227], v[14:15] op_sel:[1,0,0] op_sel_hi:[1,1,0]
    v_pk_fma_f32 v[228:229], v[14:15], v[228:229], v[14:15] op_sel:[1,0,0] op_sel_hi:[1,1,0]
    v_pk_fma_f32 v[230:231], v[14:15], v[230:231], v[14:15] op_sel:[1,0,0] op_sel_hi:[1,1,0]
    v_cvt_pk_f16_f32 v88, v224, v225
    v_cvt_pk_f16_f32 v89, v226, v227
    v_cvt_pk_f16_f32 v90, v228, v229
    v_cvt_pk_f16_f32 v91, v230, v231
    v_lshlrev_b32_e64 v232, 16, v92
    v_and_b32 v233, 0xffff0000, v92
    v_lshlrev_b32_e64 v234, 16, v93
    v_and_b32 v235, 0xffff0000, v93
    v_lshlrev_b32_e64 v236, 16, v94
    v_and_b32 v237, 0xffff0000, v94
    v_lshlrev_b32_e64 v238, 16, v95
    v_and_b32 v239, 0xffff0000, v95
    v_pk_fma_f32 v[232:233], v[14:15], v[232:233], v[14:15] op_sel:[1,0,0] op_sel_hi:[1,1,0]
    v_pk_fma_f32 v[234:235], v[14:15], v[234:235], v[14:15] op_sel:[1,0,0] op_sel_hi:[1,1,0]
    v_pk_fma_f32 v[236:237], v[14:15], v[236:237], v[14:15] op_sel:[1,0,0] op_sel_hi:[1,1,0]
    v_pk_fma_f32 v[238:239], v[14:15], v[238:239], v[14:15] op_sel:[1,0,0] op_sel_hi:[1,1,0]
    v_cvt_pk_f16_f32 v92, v232, v233
    v_cvt_pk_f16_f32 v93, v234, v235
    v_cvt_pk_f16_f32 v94, v236, v237
    v_cvt_pk_f16_f32 v95, v238, v239
    s_setprio 0
    s_cmp_eq_u32 s55, zlit_b-zlit_a+(0)
    s_waitcnt lgkmcnt(0)
    s_barrier
    s_cbranch_scc0 kf_kernel_a_vpl
    ds_read_b128 v[192:195], v6 offset:0
    ds_read_b128 v[200:203], v6 offset:20480
    ds_read_b128 v[196:199], v6 offset:16
    ds_read_b128 v[204:207], v6 offset:20496
    ds_read_b128 v[208:211], v6 offset:64
    ds_read_b128 v[216:219], v6 offset:20544
    ds_read_b128 v[212:215], v6 offset:80
    ds_read_b128 v[220:223], v6 offset:20560
    ds_read_b64_tr_b16 v[160:161], v4 offset:512
    ds_read_b64_tr_b16 v[162:163], v4 offset:20992
    ds_read_b64_tr_b16 v[164:165], v4 offset:768
    ds_read_b64_tr_b16 v[166:167], v4 offset:21248
    s_waitcnt lgkmcnt(8)
    v_fma_mix_f32 v224, v16, v192, v200 op_sel:[0,0,0] op_sel_hi:[1,0,0]
    v_fma_mix_f32 v225, v16, v193, v201 op_sel:[1,0,0] op_sel_hi:[1,0,0]
    v_fma_mix_f32 v226, v17, v194, v202 op_sel:[0,0,0] op_sel_hi:[1,0,0]
    v_fma_mix_f32 v227, v17, v195, v203 op_sel:[1,0,0] op_sel_hi:[1,0,0]
    v_fma_mix_f32 v228, v18, v196, v204 op_sel:[0,0,0] op_sel_hi:[1,0,0]
    v_fma_mix_f32 v229, v18, v197, v205 op_sel:[1,0,0] op_sel_hi:[1,0,0]
    v_fma_mix_f32 v230, v19, v198, v206 op_sel:[0,0,0] op_sel_hi:[1,0,0]
    v_fma_mix_f32 v231, v19, v199, v207 op_sel:[1,0,0] op_sel_hi:[1,0,0]
    v_cvt_pk_bf16_f32 v16, v224, v225
    v_cvt_pk_bf16_f32 v17, v226, v227
    v_cvt_pk_bf16_f32 v18, v228, v229
    v_cvt_pk_bf16_f32 v19, v230, v231
    s_add_u32 m0, s70, zlit_b-zlit_a+(0)
    s_nop 0
    buffer_load_dwordx4 v12, s[12:15], s71 offen lds
    buffer_load_dwordx4 v13, s[12:15], s71 offen offset:1024 lds
    s_add_u32 s71, s71, 61440
    s_cmp_ge_u32 s71, s43
    s_cselect_b32 s51, 1228800, 0
    s_sub_u32 s71, s71, s51
    s_add_u32 m0, s70, 2048
    s_nop 0
    buffer_load_dwordx4 v12, s[12:15], s71 offen lds
    buffer_load_dwordx4 v13, s[12:15], s71 offen offset:1024 lds
    s_add_u32 s71, s71, 61440
    s_cmp_ge_u32 s71, s43
    s_cselect_b32 s51, 1228800, 0
    s_sub_u32 s71, s71, s51
    s_waitcnt lgkmcnt(2)
    v_mfma_f32_32x32x16_bf16 v[128:143], v[160:163], v[16:19], 0
    ds_read_b64_tr_b16 v[168:169], v4 offset:2560
    ds_read_b64_tr_b16 v[170:171], v4 offset:23040
    ds_read_b128 v[192:195], v6 offset:128
    ds_read_b128 v[200:203], v6 offset:20608
    v_fma_mix_f32 v232, v20, v208, v216 op_sel:[0,0,0] op_sel_hi:[1,0,0]
    v_fma_mix_f32 v233, v20, v209, v217 op_sel:[1,0,0] op_sel_hi:[1,0,0]
    v_fma_mix_f32 v234, v21, v210, v218 op_sel:[0,0,0] op_sel_hi:[1,0,0]
    v_fma_mix_f32 v235, v21, v211, v219 op_sel:[1,0,0] op_sel_hi:[1,0,0]
    v_fma_mix_f32 v236, v22, v212, v220 op_sel:[0,0,0] op_sel_hi:[1,0,0]
    v_fma_mix_f32 v237, v22, v213, v221 op_sel:[1,0,0] op_sel_hi:[1,0,0]
    s_waitcnt lgkmcnt(4)
    v_mfma_f32_32x32x16_bf16 v[144:159], v[164:167], v[16:19], 0
    ds_read_b64_tr_b16 v[172:173], v4 offset:2816
    ds_read_b64_tr_b16 v[174:175], v4 offset:23296
    ds_read_b128 v[196:199], v6 offset:144
    ds_read_b128 v[204:207], v6 offset:20624
    v_fma_mix_f32 v238, v23, v214, v222 op_sel:[0,0,0] op_sel_hi:[1,0,0]
    v_fma_mix_f32 v239, v23, v215, v223 op_sel:[1,0,0] op_sel_hi:[1,0,0]
    v_cvt_pk_bf16_f32 v20, v232, v233
    v_cvt_pk_bf16_f32 v21, v234, v235
    v_cvt_pk_bf16_f32 v22, v236, v237
    v_cvt_pk_bf16_f32 v23, v238, v239
    s_add_u32 m0, s70, 4096
    s_nop 0
    buffer_load_dwordx4 v12, s[12:15], s71 offen lds
    buffer_load_dwordx4 v13, s[12:15], s71 offen offset:1024 lds
    s_add_u32 s71, s71, 61440
    s_cmp_ge_u32 s71, s43
    s_cselect_b32 s51, 1228800, 0
    s_sub_u32 s71, s71, s51
    s_add_u32 m0, s70, 6144
    s_nop 0
    buffer_load_dwordx4 v12, s[12:15], s71 offen lds
    buffer_load_dwordx4 v13, s[12:15], s71 offen offset:1024 lds
    s_add_u32 s71, s71, 61440
    s_cmp_ge_u32 s71, s43
    s_cselect_b32 s51, 1228800, 0
    s_sub_u32 s71, s71, s51
    s_waitcnt lgkmcnt(6)
    v_mfma_f32_32x32x16_bf16 v[128:143], v[168:171], v[20:23], v[128:143]
    ds_read_b64_tr_b16 v[176:177], v4 offset:4608
    ds_read_b64_tr_b16 v[178:179], v4 offset:25088
    ds_read_b128 v[208:211], v6 offset:192
    ds_read_b128 v[216:219], v6 offset:20672
    s_waitcnt lgkmcnt(4)
    v_fma_mix_f32 v224, v24, v192, v200 op_sel:[0,0,0] op_sel_hi:[1,0,0]
    v_fma_mix_f32 v225, v24, v193, v201 op_sel:[1,0,0] op_sel_hi:[1,0,0]
    v_fma_mix_f32 v226, v25, v194, v202 op_sel:[0,0,0] op_sel_hi:[1,0,0]
    v_fma_mix_f32 v227, v25, v195, v203 op_sel:[1,0,0] op_sel_hi:[1,0,0]
    v_fma_mix_f32 v228, v26, v196, v204 op_sel:[0,0,0] op_sel_hi:[1,0,0]
    v_fma_mix_f32 v229, v26, v197, v205 op_sel:[1,0,0] op_sel_hi:[1,0,0]
    v_mfma_f32_32x32x16_bf16 v[144:159], v[172:175], v[20:23], v[144:159]
    ds_read_b64_tr_b16 v[180:181], v4 offset:4864
    ds_read_b64_tr_b16 v[182:183], v4 offset:25344
    ds_read_b128 v[212:215], v6 offset:208
    ds_read_b128 v[220:223], v6 offset:20688
    v_fma_mix_f32 v230, v27, v198, v206 op_sel:[0,0,0] op_sel_hi:[1,0,0]
    v_fma_mix_f32 v231, v27, v199, v207 op_sel:[1,0,0] op_sel_hi:[1,0,0]
    v_cvt_pk_bf16_f32 v24, v224, v225
    v_cvt_pk_bf16_f32 v25, v226, v227
    v_cvt_pk_bf16_f32 v26, v228, v229
    v_cvt_pk_bf16_f32 v27, v230, v231
    s_add_u32 m0, s70, 8192
    s_nop 0
    buffer_load_dwordx4 v12, s[12:15], s71 offen lds
    buffer_load_dwordx4 v13, s[12:15], s71 offen offset:1024 lds
    s_add_u32 s71, s71, 61440
    s_cmp_ge_u32 s71, s43
    s_cselect_b32 s51, 1228800, 0
    s_sub_u32 s71, s71, s51
    s_add_u32 m0, s70, 10240
    s_nop 0
    buffer_load_dwordx4 v12, s[12:15], s71 offen lds
    buffer_load_dwordx4 v13, s[12:15], s71 offen offset:1024 lds
    s_add_u32 s71, s71, 61440
    s_cmp_ge_u32 s71, s43
    s_cselect_b32 s51, 1228800, 0
    s_sub_u32 s71, s71, s51
    s_waitcnt lgkmcnt(6)
    v_mfma_f32_32x32x16_bf16 v[128:143], v[176:179], v[24:27], v[128:143]
    ds_read_b64_tr_b16 v[184:185], v4 offset:6656
    ds_read_b64_tr_b16 v[186:187], v4 offset:27136
    ds_read_b64_tr_b16 v[188:189], v4 offset:6912
    ds_read_b64_tr_b16 v[190:191], v4 offset:27392
    ds_read_b128 v[192:195], v6 offset:256
    ds_read_b128 v[200:203], v6 offset:20736
    s_waitcnt lgkmcnt(6)
    v_fma_mix_f32 v232, v28, v208, v216 op_sel:[0,0,0] op_sel_hi:[1,0,0]
    v_fma_mix_f32 v233, v28, v209, v217 op_sel:[1,0,0] op_sel_hi:[1,0,0]
    v_fma_mix_f32 v234, v29, v210, v218 op_sel:[0,0,0] op_sel_hi:[1,0,0]
    v_fma_mix_f32 v235, v29, v211, v219 op_sel:[1,0,0] op_sel_hi:[1,0,0]
    v_fma_mix_f32 v236, v30, v212, v220 op_sel:[0,0,0] op_sel_hi:[1,0,0]
    v_fma_mix_f32 v237, v30, v213, v221 op_sel:[1,0,0] op_sel_hi:[1,0,0]
    v_mfma_f32_32x32x16_bf16 v[144:159], v[180:183], v[24:27], v[144:159]
    ds_read_b64_tr_b16 v[160:161], v4 offset:0
    ds_read_b64_tr_b16 v[162:163], v4 offset:20480
    ds_read_b64_tr_b16 v[164:165], v4 offset:256
    ds_read_b64_tr_b16 v[166:167], v4 offset:20736
    ds_read_b128 v[196:199], v6 offset:272
    ds_read_b128 v[204:207], v6 offset:20752
    v_fma_mix_f32 v238, v31, v214, v222 op_sel:[0,0,0] op_sel_hi:[1,0,0]
    v_fma_mix_f32 v239, v31, v215, v223 op_sel:[1,0,0] op_sel_hi:[1,0,0]
    v_cvt_pk_bf16_f32 v28, v232, v233
    v_cvt_pk_bf16_f32 v29, v234, v235
    v_cvt_pk_bf16_f32 v30, v236, v237
    v_cvt_pk_bf16_f32 v31, v238, v239
    s_barrier
    s_add_u32 m0, s70, 12288
    s_nop 0
    buffer_load_dwordx4 v12, s[12:15], s71 offen lds
    buffer_load_dwordx4 v13, s[12:15], s71 offen offset:1024 lds
    s_add_u32 s71, s71, 61440
    s_cmp_ge_u32 s71, s43
    s_cselect_b32 s51, 1228800, 0
    s_sub_u32 s71, s71, s51
    s_add_u32 m0, s70, 14336
    s_nop 0
    buffer_load_dwordx4 v12, s[12:15], s71 offen lds
    buffer_load_dwordx4 v13, s[12:15], s71 offen offset:1024 lds
    s_add_u32 s71, s71, 61440
    s_cmp_ge_u32 s71, s43
    s_cselect_b32 s51, 1228800, 0
    s_sub_u32 s71, s71, s51
    s_waitcnt lgkmcnt(10)
    v_mfma_f32_32x32x16_bf16 v[128:143], v[184:187], v[28:31], v[128:143]
    ds_read_b64_tr_b16 v[168:169], v4 offset:8704
    ds_read_b64_tr_b16 v[170:171], v4 offset:29184
    ds_read_b128 v[208:211], v6 offset:320
    ds_read_b128 v[216:219], v6 offset:20800
    s_waitcnt lgkmcnt(4)
    v_fma_mix_f32 v224, v32, v192, v200 op_sel:[0,0,0] op_sel_hi:[1,0,0]
    v_fma_mix_f32 v225, v32, v193, v201 op_sel:[1,0,0] op_sel_hi:[1,0,0]
    v_fma_mix_f32 v226, v33, v194, v202 op_sel:[0,0,0] op_sel_hi:[1,0,0]
    v_mfma_f32_32x32x16_bf16 v[144:159], v[188:191], v[28:31], v[144:159]
    ds_read_b64_tr_b16 v[172:173], v4 offset:8960
    ds_read_b64_tr_b16 v[174:175], v4 offset:29440
    ds_read_b128 v[212:215], v6 offset:336
    ds_read_b128 v[220:223], v6 offset:20816
    v_fma_mix_f32 v227, v33, v195, v203 op_sel:[1,0,0] op_sel_hi:[1,0,0]
    v_fma_mix_f32 v228, v34, v196, v204 op_sel:[0,0,0] op_sel_hi:[1,0,0]
    v_fma_mix_f32 v229, v34, v197, v205 op_sel:[1,0,0] op_sel_hi:[1,0,0]
    v_mfma_f32_32x32x16_bf16 v[96:111], v[160:163], v[16:19], 0
    ds_read_b64_tr_b16 v[176:177], v4 offset:2048
    ds_read_b64_tr_b16 v[178:179], v4 offset:22528
    v_fma_mix_f32 v230, v35, v198, v206 op_sel:[0,0,0] op_sel_hi:[1,0,0]
    v_fma_mix_f32 v231, v35, v199, v207 op_sel:[1,0,0] op_sel_hi:[1,0,0]
    v_cvt_pk_bf16_f32 v32, v224, v225
    v_mfma_f32_32x32x16_bf16 v[112:127], v[164:167], v[16:19], 0
    ds_read_b64_tr_b16 v[180:181], v4 offset:2304
    ds_read_b64_tr_b16 v[182:183], v4 offset:22784
    v_cvt_pk_bf16_f32 v33, v226, v227
    v_cvt_pk_bf16_f32 v34, v228, v229
    v_cvt_pk_bf16_f32 v35, v230, v231
    s_add_u32 m0, s70, 16384
    s_nop 0
    buffer_load_dwordx4 v12, s[12:15], s71 offen lds
    buffer_load_dwordx4 v13, s[12:15], s71 offen offset:1024 lds
    s_mov_b32 exec_hi, s82
    buffer_load_dword v240, v10, s[44:47], s75 offen nt
    s_add_u32 s75, s75, s78
    buffer_load_dword v241, v10, s[44:47], s75 offen nt
    s_add_u32 s75, s75, s78
    s_mov_b32 exec_hi, -1
    s_waitcnt lgkmcnt(10)
    v_mfma_f32_32x32x16_bf16 v[128:143], v[168:171], v[32:35], v[128:143]
    ds_read_b64_tr_b16 v[184:185], v4 offset:10752
    ds_read_b64_tr_b16 v[186:187], v4 offset:31232
    ds_read_b128 v[192:195], v6 offset:384
    ds_read_b128 v[200:203], v6 offset:20864
    s_waitcnt lgkmcnt(8)
    v_fma_mix_f32 v232, v36, v208, v216 op_sel:[0,0,0] op_sel_hi:[1,0,0]
    v_fma_mix_f32 v233, v36, v209, v217 op_sel:[1,0,0] op_sel_hi:[1,0,0]
    v_fma_mix_f32 v234, v37, v210, v218 op_sel:[0,0,0] op_sel_hi:[1,0,0]
    v_mfma_f32_32x32x16_bf16 v[144:159], v[172:175], v[32:35], v[144:159]
    ds_read_b64_tr_b16 v[188:189], v4 offset:11008
    ds_read_b64_tr_b16 v[190:191], v4 offset:31488
    ds_read_b128 v[196:199], v6 offset:400
    ds_read_b128 v[204:207], v6 offset:20880
    v_fma_mix_f32 v235, v37, v211, v219 op_sel:[1,0,0] op_sel_hi:[1,0,0]
    v_fma_mix_f32 v236, v38, v212, v220 op_sel:[0,0,0] op_sel_hi:[1,0,0]
    v_fma_mix_f32 v237, v38, v213, v221 op_sel:[1,0,0] op_sel_hi:[1,0,0]
    s_waitcnt lgkmcnt(10)
    v_mfma_f32_32x32x16_bf16 v[96:111], v[176:179], v[20:23], v[96:111]
    ds_read_b64_tr_b16 v[160:161], v4 offset:4096
    ds_read_b64_tr_b16 v[162:163], v4 offset:24576
    v_fma_mix_f32 v238, v39, v214, v222 op_sel:[0,0,0] op_sel_hi:[1,0,0]
    v_fma_mix_f32 v239, v39, v215, v223 op_sel:[1,0,0] op_sel_hi:[1,0,0]
    v_cvt_pk_bf16_f32 v36, v232, v233
    s_waitcnt lgkmcnt(10)
    v_mfma_f32_32x32x16_bf16 v[112:127], v[180:183], v[20:23], v[112:127]
    ds_read_b64_tr_b16 v[164:165], v4 offset:4352
    ds_read_b64_tr_b16 v[166:167], v4 offset:24832
    v_cvt_pk_bf16_f32 v37, v234, v235
    v_cvt_pk_bf16_f32 v38, v236, v237
    v_cvt_pk_bf16_f32 v39, v238, v239
    s_mov_b32 exec_hi, s82
    buffer_load_dword v242, v10, s[44:47], s75 offen nt
    s_add_u32 s75, s75, s78
    buffer_load_dword v243, v10, s[44:47], s75 offen nt
    s_mul_i32 s51, s78, 3
    s_sub_u32 s51, s77, s51
    s_add_u32 s75, s75, s51
    s_mov_b32 exec_hi, -1
    s_waitcnt lgkmcnt(10)
    v_mfma_f32_32x32x16_bf16 v[128:143], v[184:187], v[36:39], v[128:143]
    ds_read_b64_tr_b16 v[168:169], v4 offset:12800
    ds_read_b64_tr_b16 v[170:171], v4 offset:33280
    ds_read_b128 v[208:211], v6 offset:448
    ds_read_b128 v[216:219], v6 offset:20928
    s_waitcnt lgkmcnt(8)
    v_fma_mix_f32 v224, v40, v192, v200 op_sel:[0,0,0] op_sel_hi:[1,0,0]
    v_fma_mix_f32 v225, v40, v193, v201 op_sel:[1,0,0] op_sel_hi:[1,0,0]
    v_fma_mix_f32 v226, v41, v194, v202 op_sel:[0,0,0] op_sel_hi:[1,0,0]
    v_mfma_f32_32x32x16_bf16 v[144:159], v[188:191], v[36:39], v[144:159]
    ds_read_b64_tr_b16 v[172:173], v4 offset:13056
    ds_read_b64_tr_b16 v[174:175], v4 offset:33536
    ds_read_b128 v[212:215], v6 offset:464
    ds_read_b128 v[220:223], v6 offset:20944
    v_fma_mix_f32 v227, v41, v195, v203 op_sel:[1,0,0] op_sel_hi:[1,0,0]
    v_fma_mix_f32 v228, v42, v196, v204 op_sel:[0,0,0] op_sel_hi:[1,0,0]
    v_fma_mix_f32 v229, v42, v197, v205 op_sel:[1,0,0] op_sel_hi:[1,0,0]
    s_waitcnt lgkmcnt(10)
    v_mfma_f32_32x32x16_bf16 v[96:111], v[160:163], v[24:27], v[96:111]
    ds_read_b64_tr_b16 v[176:177], v4 offset:6144
    ds_read_b64_tr_b16 v[178:179], v4 offset:26624
    v_fma_mix_f32 v230, v43, v198, v206 op_sel:[0,0,0] op_sel_hi:[1,0,0]
    v_fma_mix_f32 v231, v43, v199, v207 op_sel:[1,0,0] op_sel_hi:[1,0,0]
    v_cvt_pk_bf16_f32 v40, v224, v225
    s_waitcnt lgkmcnt(10)
    v_mfma_f32_32x32x16_bf16 v[112:127], v[164:167], v[24:27], v[112:127]
    ds_read_b64_tr_b16 v[180:181], v4 offset:6400
    ds_read_b64_tr_b16 v[182:183], v4 offset:26880
    v_cvt_pk_bf16_f32 v41, v226, v227
    v_cvt_pk_bf16_f32 v42, v228, v229
    v_cvt_pk_bf16_f32 v43, v230, v231
    s_mov_b32 exec_hi, s82
    buffer_load_dword v244, v10, s[44:47], s75 offen nt
    s_add_u32 s75, s75, s78
    buffer_load_dword v245, v10, s[44:47], s75 offen nt
    s_add_u32 s75, s75, s78
    s_mov_b32 exec_hi, -1
    s_waitcnt lgkmcnt(10)
    v_mfma_f32_32x32x16_bf16 v[128:143], v[168:171], v[40:43], v[128:143]
    ds_read_b64_tr_b16 v[184:185], v4 offset:14848
    ds_read_b64_tr_b16 v[186:187], v4 offset:35328
    ds_read_b128 v[192:195], v6 offset:512
    ds_read_b128 v[200:203], v6 offset:20992
    s_waitcnt lgkmcnt(8)
    v_fma_mix_f32 v232, v44, v208, v216 op_sel:[0,0,0] op_sel_hi:[1,0,0]
    v_fma_mix_f32 v233, v44, v209, v217 op_sel:[1,0,0] op_sel_hi:[1,0,0]
    v_fma_mix_f32 v234, v45, v210, v218 op_sel:[0,0,0] op_sel_hi:[1,0,0]
    v_mfma_f32_32x32x16_bf16 v[144:159], v[172:175], v[40:43], v[144:159]
    ds_read_b64_tr_b16 v[188:189], v4 offset:15104
    ds_read_b64_tr_b16 v[190:191], v4 offset:35584
    ds_read_b128 v[196:199], v6 offset:528
    ds_read_b128 v[204:207], v6 offset:21008
    v_fma_mix_f32 v235, v45, v211, v219 op_sel:[1,0,0] op_sel_hi:[1,0,0]
    v_fma_mix_f32 v236, v46, v212, v220 op_sel:[0,0,0] op_sel_hi:[1,0,0]
    v_fma_mix_f32 v237, v46, v213, v221 op_sel:[1,0,0] op_sel_hi:[1,0,0]
    s_waitcnt lgkmcnt(10)
    v_mfma_f32_32x32x16_bf16 v[96:111], v[176:179], v[28:31], v[96:111]
    ds_read_b64_tr_b16 v[160:161], v4 offset:8192
    ds_read_b64_tr_b16 v[162:163], v4 offset:28672
    v_fma_mix_f32 v238, v47, v214, v222 op_sel:[0,0,0] op_sel_hi:[1,0,0]
    v_fma_mix_f32 v239, v47, v215, v223 op_sel:[1,0,0] op_sel_hi:[1,0,0]
    v_cvt_pk_bf16_f32 v44, v232, v233
    s_waitcnt lgkmcnt(10)
    v_mfma_f32_32x32x16_bf16 v[112:127], v[180:183], v[28:31], v[112:127]
    ds_read_b64_tr_b16 v[164:165], v4 offset:8448
    ds_read_b64_tr_b16 v[166:167], v4 offset:28928
    v_cvt_pk_bf16_f32 v45, v234, v235
    v_cvt_pk_bf16_f32 v46, v236, v237
    v_cvt_pk_bf16_f32 v47, v238, v239
    s_mov_b32 exec_hi, s82
    buffer_load_dword v246, v10, s[44:47], s75 offen nt
    s_add_u32 s75, s75, s78
    buffer_load_dword v247, v10, s[44:47], s75 offen nt
    s_mov_b32 exec_hi, zlit_b-zlit_a+(-1)
    s_waitcnt lgkmcnt(10)
    v_mfma_f32_32x32x16_bf16 v[128:143], v[184:187], v[44:47], v[128:143]
    ds_read_b64_tr_b16 v[168:169], v4 offset:16896
    ds_read_b64_tr_b16 v[170:171], v4 offset:37376
    ds_read_b128 v[208:211], v6 offset:576
    ds_read_b128 v[216:219], v6 offset:21056
    s_waitcnt lgkmcnt(8)
    v_fma_mix_f32 v224, v48, v192, v200 op_sel:[0,0,0] op_sel_hi:[1,0,0]
    v_fma_mix_f32 v225, v48, v193, v201 op_sel:[1,0,0] op_sel_hi:[1,0,0]
    v_fma_mix_f32 v226, v49, v194, v202 op_sel:[0,0,0] op_sel_hi:[1,0,0]
    v_mfma_f32_32x32x16_bf16 v[144:159], v[188:191], v[44:47], v[144:159]
    ds_read_b64_tr_b16 v[172:173], v4 offset:17152
    ds_read_b64_tr_b16 v[174:175], v4 offset:37632
    ds_read_b128 v[212:215], v6 offset:592
    ds_read_b128 v[220:223], v6 offset:21072
    v_fma_mix_f32 v227, v49, v195, v203 op_sel:[1,0,0] op_sel_hi:[1,0,0]
    v_fma_mix_f32 v228, v50, v196, v204 op_sel:[0,0,0] op_sel_hi:[1,0,0]
    v_fma_mix_f32 v229, v50, v197, v205 op_sel:[1,0,0] op_sel_hi:[1,0,0]
    s_waitcnt lgkmcnt(10)
    v_mfma_f32_32x32x16_bf16 v[96:111], v[160:163], v[32:35], v[96:111]
    ds_read_b64_tr_b16 v[176:177], v4 offset:10240
    ds_read_b64_tr_b16 v[178:179], v4 offset:30720
    v_fma_mix_f32 v230, v51, v198, v206 op_sel:[0,0,0] op_sel_hi:[1,0,0]
    v_fma_mix_f32 v231, v51, v199, v207 op_sel:[1,0,0] op_sel_hi:[1,0,0]
    v_cvt_pk_bf16_f32 v48, v224, v225
    s_waitcnt lgkmcnt(10)
    v_mfma_f32_32x32x16_bf16 v[112:127], v[164:167], v[32:35], v[112:127]
    ds_read_b64_tr_b16 v[180:181], v4 offset:10496
    ds_read_b64_tr_b16 v[182:183], v4 offset:30976
    v_cvt_pk_bf16_f32 v49, v226, v227
    v_cvt_pk_bf16_f32 v50, v228, v229
    v_cvt_pk_bf16_f32 v51, v230, v231
    s_waitcnt vmcnt(18)
    s_barrier
    s_waitcnt lgkmcnt(10)
    v_mfma_f32_32x32x16_bf16 v[128:143], v[168:171], v[48:51], v[128:143]
    ds_read_b64_tr_b16 v[184:185], v5 offset:512
    ds_read_b64_tr_b16 v[186:187], v5 offset:20992
    ds_read_b128 v[192:195], v6 offset:640
    ds_read_b128 v[200:203], v6 offset:21120
    s_waitcnt lgkmcnt(8)
    v_fma_mix_f32 v232, v52, v208, v216 op_sel:[0,0,0] op_sel_hi:[1,0,0]
    v_fma_mix_f32 v233, v52, v209, v217 op_sel:[1,0,0] op_sel_hi:[1,0,0]
    v_fma_mix_f32 v234, v53, v210, v218 op_sel:[0,0,0] op_sel_hi:[1,0,0]
    v_mfma_f32_32x32x16_bf16 v[144:159], v[172:175], v[48:51], v[144:159]
    ds_read_b64_tr_b16 v[188:189], v5 offset:768
    ds_read_b64_tr_b16 v[190:191], v5 offset:21248
    ds_read_b128 v[196:199], v6 offset:656
    ds_read_b128 v[204:207], v6 offset:21136
    v_fma_mix_f32 v235, v53, v211, v219 op_sel:[1,0,0] op_sel_hi:[1,0,0]
    v_fma_mix_f32 v236, v54, v212, v220 op_sel:[0,0,0] op_sel_hi:[1,0,0]
    v_fma_mix_f32 v237, v54, v213, v221 op_sel:[1,0,0] op_sel_hi:[1,0,0]
    s_waitcnt lgkmcnt(10)
    v_mfma_f32_32x32x16_bf16 v[96:111], v[176:179], v[36:39], v[96:111]
    ds_read_b64_tr_b16 v[160:161], v4 offset:12288
    ds_read_b64_tr_b16 v[162:163], v4 offset:32768
    v_fma_mix_f32 v238, v55, v214, v222 op_sel:[0,0,0] op_sel_hi:[1,0,0]
    v_fma_mix_f32 v239, v55, v215, v223 op_sel:[1,0,0] op_sel_hi:[1,0,0]
    v_cvt_pk_bf16_f32 v52, v232, v233
    s_waitcnt lgkmcnt(10)
    v_mfma_f32_32x32x16_bf16 v[112:127], v[180:183], v[36:39], v[112:127]
    ds_read_b64_tr_b16 v[164:165], v4 offset:12544
    ds_read_b64_tr_b16 v[166:167], v4 offset:33024
    v_cvt_pk_bf16_f32 v53, v234, v235
    v_cvt_pk_bf16_f32 v54, v236, v237
    v_cvt_pk_bf16_f32 v55, v238, v239
    s_waitcnt lgkmcnt(10)
    s_nop 0
    v_mfma_f32_32x32x16_bf16 v[128:143], v[184:187], v[52:55], v[128:143]
    ds_read_b64_tr_b16 v[168:169], v5 offset:2560
    ds_read_b64_tr_b16 v[170:171], v5 offset:23040
    ds_read_b128 v[208:211], v6 offset:704
    ds_read_b128 v[216:219], v6 offset:21184
    s_waitcnt lgkmcnt(8)
    v_fma_mix_f32 v224, v56, v192, v200 op_sel:[0,0,0] op_sel_hi:[1,0,0]
    v_fma_mix_f32 v225, v56, v193, v201 op_sel:[1,0,0] op_sel_hi:[1,0,0]
    v_fma_mix_f32 v226, v57, v194, v202 op_sel:[0,0,0] op_sel_hi:[1,0,0]
    v_mfma_f32_32x32x16_bf16 v[144:159], v[188:191], v[52:55], v[144:159]
    ds_read_b64_tr_b16 v[172:173], v5 offset:2816
    ds_read_b64_tr_b16 v[174:175], v5 offset:23296
    ds_read_b128 v[212:215], v6 offset:720
    ds_read_b128 v[220:223], v6 offset:21200
    v_fma_mix_f32 v227, v57, v195, v203 op_sel:[1,0,0] op_sel_hi:[1,0,0]
    v_fma_mix_f32 v228, v58, v196, v204 op_sel:[0,0,0] op_sel_hi:[1,0,0]
    v_fma_mix_f32 v229, v58, v197, v205 op_sel:[1,0,0] op_sel_hi:[1,0,0]
    s_waitcnt lgkmcnt(10)
    v_mfma_f32_32x32x16_bf16 v[96:111], v[160:163], v[40:43], v[96:111]
    ds_read_b64_tr_b16 v[176:177], v4 offset:14336
    ds_read_b64_tr_b16 v[178:179], v4 offset:34816
    v_fma_mix_f32 v230, v59, v198, v206 op_sel:[0,0,0] op_sel_hi:[1,0,0]
    v_fma_mix_f32 v231, v59, v199, v207 op_sel:[1,0,0] op_sel_hi:[1,0,0]
    v_cvt_pk_bf16_f32 v56, v224, v225
    s_waitcnt lgkmcnt(10)
    v_mfma_f32_32x32x16_bf16 v[112:127], v[164:167], v[40:43], v[112:127]
    ds_read_b64_tr_b16 v[180:181], v4 offset:14592
    ds_read_b64_tr_b16 v[182:183], v4 offset:35072
    v_cvt_pk_bf16_f32 v57, v226, v227
    v_cvt_pk_bf16_f32 v58, v228, v229
    v_cvt_pk_bf16_f32 v59, v230, v231
    s_waitcnt lgkmcnt(10)
    s_nop 0
    v_mfma_f32_32x32x16_bf16 v[128:143], v[168:171], v[56:59], v[128:143]
    ds_read_b64_tr_b16 v[184:185], v5 offset:4608
    ds_read_b64_tr_b16 v[186:187], v5 offset:25088
    ds_read_b128 v[192:195], v6 offset:768
    ds_read_b128 v[200:203], v6 offset:21248
    s_waitcnt lgkmcnt(8)
    v_fma_mix_f32 v232, v60, v208, v216 op_sel:[0,0,0] op_sel_hi:[1,0,0]
    v_fma_mix_f32 v233, v60, v209, v217 op_sel:[1,0,0] op_sel_hi:[1,0,0]
    v_fma_mix_f32 v234, v61, v210, v218 op_sel:[0,0,0] op_sel_hi:[1,0,0]
    v_mfma_f32_32x32x16_bf16 v[144:159], v[172:175], v[56:59], v[144:159]
    ds_read_b64_tr_b16 v[188:189], v5 offset:4864
    ds_read_b64_tr_b16 v[190:191], v5 offset:25344
    ds_read_b128 v[196:199], v6 offset:784
    ds_read_b128 v[204:207], v6 offset:21264
    v_fma_mix_f32 v235, v61, v211, v219 op_sel:[1,0,0] op_sel_hi:[1,0,0]
    v_fma_mix_f32 v236, v62, v212, v220 op_sel:[0,0,0] op_sel_hi:[1,0,0]
    v_fma_mix_f32 v237, v62, v213, v221 op_sel:[1,0,0] op_sel_hi:[1,0,0]
    s_waitcnt lgkmcnt(10)
    v_mfma_f32_32x32x16_bf16 v[96:111], v[176:179], v[44:47], v[96:111]
    ds_read_b64_tr_b16 v[160:161], v4 offset:16384
    ds_read_b64_tr_b16 v[162:163], v4 offset:36864
    v_fma_mix_f32 v238, v63, v214, v222 op_sel:[0,0,0] op_sel_hi:[1,0,0]
    v_fma_mix_f32 v239, v63, v215, v223 op_sel:[1,0,0] op_sel_hi:[1,0,0]
    v_cvt_pk_bf16_f32 v60, v232, v233
    s_waitcnt lgkmcnt(10)
    v_mfma_f32_32x32x16_bf16 v[112:127], v[180:183], v[44:47], v[112:127]
    ds_read_b64_tr_b16 v[164:165], v4 offset:16640
    ds_read_b64_tr_b16 v[166:167], v4 offset:37120
    v_cvt_pk_bf16_f32 v61, v234, v235
    v_cvt_pk_bf16_f32 v62, v236, v237
    v_cvt_pk_bf16_f32 v63, v238, v239
    s_waitcnt lgkmcnt(10)
    s_nop 0
    v_mfma_f32_32x32x16_bf16 v[128:143], v[184:187], v[60:63], v[128:143]
    ds_read_b64_tr_b16 v[168:169], v5 offset:6656
    ds_read_b64_tr_b16 v[170:171], v5 offset:27136
    ds_read_b128 v[208:211], v6 offset:832
    ds_read_b128 v[216:219], v6 offset:21312
    s_waitcnt lgkmcnt(8)
    v_fma_mix_f32 v224, v64, v192, v200 op_sel:[0,0,0] op_sel_hi:[1,0,0]
    v_fma_mix_f32 v225, v64, v193, v201 op_sel:[1,0,0] op_sel_hi:[1,0,0]
    v_fma_mix_f32 v226, v65, v194, v202 op_sel:[0,0,0] op_sel_hi:[1,0,0]
    v_mfma_f32_32x32x16_bf16 v[144:159], v[188:191], v[60:63], v[144:159]
    ds_read_b64_tr_b16 v[172:173], v5 offset:6912
    ds_read_b64_tr_b16 v[174:175], v5 offset:27392
    ds_read_b128 v[212:215], v6 offset:848
    ds_read_b128 v[220:223], v6 offset:21328
    v_fma_mix_f32 v227, v65, v195, v203 op_sel:[1,0,0] op_sel_hi:[1,0,0]
    v_fma_mix_f32 v228, v66, v196, v204 op_sel:[0,0,0] op_sel_hi:[1,0,0]
    v_fma_mix_f32 v229, v66, v197, v205 op_sel:[1,0,0] op_sel_hi:[1,0,0]
    s_waitcnt lgkmcnt(10)
    v_mfma_f32_32x32x16_bf16 v[96:111], v[160:163], v[48:51], v[96:111]
    ds_read_b64_tr_b16 v[176:177], v5 offset:0
    ds_read_b64_tr_b16 v[178:179], v5 offset:20480
    v_fma_mix_f32 v230, v67, v198, v206 op_sel:[0,0,0] op_sel_hi:[1,0,0]
    v_fma_mix_f32 v231, v67, v199, v207 op_sel:[1,0,0] op_sel_hi:[1,0,0]
    v_cvt_pk_bf16_f32 v64, v224, v225
    s_waitcnt lgkmcnt(10)
    v_mfma_f32_32x32x16_bf16 v[112:127], v[164:167], v[48:51], v[112:127]
    ds_read_b64_tr_b16 v[180:181], v5 offset:256
    ds_read_b64_tr_b16 v[182:183], v5 offset:20736
    v_cvt_pk_bf16_f32 v65, v226, v227
    v_cvt_pk_bf16_f32 v66, v228, v229
    v_cvt_pk_bf16_f32 v67, v230, v231
    s_waitcnt vmcnt(8)
    s_barrier
    s_waitcnt lgkmcnt(10)
    v_mfma_f32_32x32x16_bf16 v[128:143], v[168:171], v[64:67], v[128:143]
    ds_read_b64_tr_b16 v[184:185], v5 offset:8704
    ds_read_b64_tr_b16 v[186:187], v5 offset:29184
    ds_read_b128 v[192:195], v6 offset:896
    ds_read_b128 v[200:203], v6 offset:21376
    s_waitcnt lgkmcnt(8)
    v_fma_mix_f32 v232, v68, v208, v216 op_sel:[0,0,0] op_sel_hi:[1,0,0]
    v_fma_mix_f32 v233, v68, v209, v217 op_sel:[1,0,0] op_sel_hi:[1,0,0]
    v_fma_mix_f32 v234, v69, v210, v218 op_sel:[0,0,0] op_sel_hi:[1,0,0]
    v_mfma_f32_32x32x16_bf16 v[144:159], v[172:175], v[64:67], v[144:159]
    ds_read_b64_tr_b16 v[188:189], v5 offset:8960
    ds_read_b64_tr_b16 v[190:191], v5 offset:29440
    ds_read_b128 v[196:199], v6 offset:912
    ds_read_b128 v[204:207], v6 offset:21392
    v_fma_mix_f32 v235, v69, v211, v219 op_sel:[1,0,0] op_sel_hi:[1,0,0]
    v_fma_mix_f32 v236, v70, v212, v220 op_sel:[0,0,0] op_sel_hi:[1,0,0]
    v_fma_mix_f32 v237, v70, v213, v221 op_sel:[1,0,0] op_sel_hi:[1,0,0]
    s_waitcnt lgkmcnt(10)
    v_mfma_f32_32x32x16_bf16 v[96:111], v[176:179], v[52:55], v[96:111]
    ds_read_b64_tr_b16 v[160:161], v5 offset:2048
    ds_read_b64_tr_b16 v[162:163], v5 offset:22528
    v_fma_mix_f32 v238, v71, v214, v222 op_sel:[0,0,0] op_sel_hi:[1,0,0]
    v_fma_mix_f32 v239, v71, v215, v223 op_sel:[1,0,0] op_sel_hi:[1,0,0]
    v_cvt_pk_bf16_f32 v68, v232, v233
    s_waitcnt lgkmcnt(10)
    v_mfma_f32_32x32x16_bf16 v[112:127], v[180:183], v[52:55], v[112:127]
    ds_read_b64_tr_b16 v[164:165], v5 offset:2304
    ds_read_b64_tr_b16 v[166:167], v5 offset:22784
    v_cvt_pk_bf16_f32 v69, v234, v235
    v_cvt_pk_bf16_f32 v70, v236, v237
    v_cvt_pk_bf16_f32 v71, v238, v239
    s_waitcnt vmcnt(0)
    v_perm_b32 v248, v241, v240, s80
    v_perm_b32 v252, v241, v240, s81
    v_perm_b32 v249, v243, v242, s80
    v_perm_b32 v253, v243, v242, s81
    v_perm_b32 v250, v245, v244, s80
    v_perm_b32 v254, v245, v244, s81
    v_perm_b32 v251, v247, v246, s80
    v_perm_b32 v255, v247, v246, s81
    s_mov_b32 exec_hi, s82
    buffer_store_dwordx4 v[248:251], v11, s[8:11], s79 offen offset:0 sc1
    buffer_store_dwordx4 v[252:255], v11, s[8:11], s79 offen offset:16 sc1
    s_mov_b32 exec_hi, -1
    s_waitcnt lgkmcnt(10)
    v_mfma_f32_32x32x16_bf16 v[128:143], v[184:187], v[68:71], v[128:143]
    ds_read_b64_tr_b16 v[168:169], v5 offset:10752
    ds_read_b64_tr_b16 v[170:171], v5 offset:31232
    ds_read_b128 v[208:211], v6 offset:960
    ds_read_b128 v[216:219], v6 offset:21440
    s_waitcnt lgkmcnt(8)
    v_fma_mix_f32 v224, v72, v192, v200 op_sel:[0,0,0] op_sel_hi:[1,0,0]
    v_fma_mix_f32 v225, v72, v193, v201 op_sel:[1,0,0] op_sel_hi:[1,0,0]
    v_fma_mix_f32 v226, v73, v194, v202 op_sel:[0,0,0] op_sel_hi:[1,0,0]
    v_mfma_f32_32x32x16_bf16 v[144:159], v[188:191], v[68:71], v[144:159]
    ds_read_b64_tr_b16 v[172:173], v5 offset:11008
    ds_read_b64_tr_b16 v[174:175], v5 offset:31488
    ds_read_b128 v[212:215], v6 offset:976
    ds_read_b128 v[220:223], v6 offset:21456
    v_fma_mix_f32 v227, v73, v195, v203 op_sel:[1,0,0] op_sel_hi:[1,0,0]
    v_fma_mix_f32 v228, v74, v196, v204 op_sel:[0,0,0] op_sel_hi:[1,0,0]
    v_fma_mix_f32 v229, v74, v197, v205 op_sel:[1,0,0] op_sel_hi:[1,0,0]
    s_waitcnt lgkmcnt(10)
    v_mfma_f32_32x32x16_bf16 v[96:111], v[160:163], v[56:59], v[96:111]
    ds_read_b64_tr_b16 v[176:177], v5 offset:4096
    ds_read_b64_tr_b16 v[178:179], v5 offset:24576
    v_fma_mix_f32 v230, v75, v198, v206 op_sel:[0,0,0] op_sel_hi:[1,0,0]
    v_fma_mix_f32 v231, v75, v199, v207 op_sel:[1,0,0] op_sel_hi:[1,0,0]
    v_cvt_pk_bf16_f32 v72, v224, v225
    s_waitcnt lgkmcnt(10)
    v_mfma_f32_32x32x16_bf16 v[112:127], v[164:167], v[56:59], v[112:127]
    ds_read_b64_tr_b16 v[180:181], v5 offset:4352
    ds_read_b64_tr_b16 v[182:183], v5 offset:24832
    v_cvt_pk_bf16_f32 v73, v226, v227
    v_cvt_pk_bf16_f32 v74, v228, v229
    v_cvt_pk_bf16_f32 v75, v230, v231
    s_waitcnt lgkmcnt(10)
    s_nop 0
    v_mfma_f32_32x32x16_bf16 v[128:143], v[168:171], v[72:75], v[128:143]
    ds_read_b64_tr_b16 v[184:185], v5 offset:12800
    ds_read_b64_tr_b16 v[186:187], v5 offset:33280
    ds_read_b128 v[192:195], v6 offset:1024
    ds_read_b128 v[200:203], v6 offset:21504
    s_waitcnt lgkmcnt(8)
    v_fma_mix_f32 v232, v76, v208, v216 op_sel:[0,0,0] op_sel_hi:[1,0,0]
    v_fma_mix_f32 v233, v76, v209, v217 op_sel:[1,0,0] op_sel_hi:[1,0,0]
    v_fma_mix_f32 v234, v77, v210, v218 op_sel:[0,0,0] op_sel_hi:[1,0,0]
    v_mfma_f32_32x32x16_bf16 v[144:159], v[172:175], v[72:75], v[144:159]
    ds_read_b64_tr_b16 v[188:189], v5 offset:13056
    ds_read_b64_tr_b16 v[190:191], v5 offset:33536
    ds_read_b128 v[196:199], v6 offset:1040
    ds_read_b128 v[204:207], v6 offset:21520
    v_fma_mix_f32 v235, v77, v211, v219 op_sel:[1,0,0] op_sel_hi:[1,0,0]
    v_fma_mix_f32 v236, v78, v212, v220 op_sel:[0,0,0] op_sel_hi:[1,0,0]
    v_fma_mix_f32 v237, v78, v213, v221 op_sel:[1,0,0] op_sel_hi:[1,0,0]
    s_waitcnt lgkmcnt(10)
    v_mfma_f32_32x32x16_bf16 v[96:111], v[176:179], v[60:63], v[96:111]
    ds_read_b64_tr_b16 v[160:161], v5 offset:6144
    ds_read_b64_tr_b16 v[162:163], v5 offset:26624
    v_fma_mix_f32 v238, v79, v214, v222 op_sel:[0,0,0] op_sel_hi:[1,0,0]
    v_fma_mix_f32 v239, v79, v215, v223 op_sel:[1,0,0] op_sel_hi:[1,0,0]
    v_cvt_pk_bf16_f32 v76, v232, v233
    s_waitcnt lgkmcnt(10)
    v_mfma_f32_32x32x16_bf16 v[112:127], v[180:183], v[60:63], v[112:127]
    ds_read_b64_tr_b16 v[164:165], v5 offset:6400
    ds_read_b64_tr_b16 v[166:167], v5 offset:26880
    v_cvt_pk_bf16_f32 v77, v234, v235
    v_cvt_pk_bf16_f32 v78, v236, v237
    v_cvt_pk_bf16_f32 v79, v238, v239
    s_waitcnt lgkmcnt(10)
    s_nop 0
    v_mfma_f32_32x32x16_bf16 v[128:143], v[184:187], v[76:79], v[128:143]
    ds_read_b64_tr_b16 v[168:169], v5 offset:14848
    ds_read_b64_tr_b16 v[170:171], v5 offset:35328
    ds_read_b128 v[208:211], v6 offset:1088
    ds_read_b128 v[216:219], v6 offset:21568
    s_waitcnt lgkmcnt(8)
    v_fma_mix_f32 v224, v80, v192, v200 op_sel:[0,0,0] op_sel_hi:[1,0,0]
    v_fma_mix_f32 v225, v80, v193, v201 op_sel:[1,0,0] op_sel_hi:[1,0,0]
    v_fma_mix_f32 v226, v81, v194, v202 op_sel:[0,0,0] op_sel_hi:[1,0,0]
    v_mfma_f32_32x32x16_bf16 v[144:159], v[188:191], v[76:79], v[144:159]
    ds_read_b64_tr_b16 v[172:173], v5 offset:15104
    ds_read_b64_tr_b16 v[174:175], v5 offset:35584
    ds_read_b128 v[212:215], v6 offset:1104
    ds_read_b128 v[220:223], v6 offset:21584
    v_fma_mix_f32 v227, v81, v195, v203 op_sel:[1,0,0] op_sel_hi:[1,0,0]
    v_fma_mix_f32 v228, v82, v196, v204 op_sel:[0,0,0] op_sel_hi:[1,0,0]
    v_fma_mix_f32 v229, v82, v197, v205 op_sel:[1,0,0] op_sel_hi:[1,0,0]
    s_waitcnt lgkmcnt(10)
    v_mfma_f32_32x32x16_bf16 v[96:111], v[160:163], v[64:67], v[96:111]
    ds_read_b64_tr_b16 v[176:177], v5 offset:8192
    ds_read_b64_tr_b16 v[178:179], v5 offset:28672
    v_fma_mix_f32 v230, v83, v198, v206 op_sel:[0,0,0] op_sel_hi:[1,0,0]
    v_fma_mix_f32 v231, v83, v199, v207 op_sel:[1,0,0] op_sel_hi:[1,0,0]
    v_cvt_pk_bf16_f32 v80, v224, v225
    s_waitcnt lgkmcnt(10)
    v_mfma_f32_32x32x16_bf16 v[112:127], v[164:167], v[64:67], v[112:127]
    ds_read_b64_tr_b16 v[180:181], v5 offset:8448
    ds_read_b64_tr_b16 v[182:183], v5 offset:28928
    v_cvt_pk_bf16_f32 v81, v226, v227
    v_cvt_pk_bf16_f32 v82, v228, v229
    v_cvt_pk_bf16_f32 v83, v230, v231
    s_waitcnt lgkmcnt(10)
    s_nop 0
    v_mfma_f32_32x32x16_bf16 v[128:143], v[168:171], v[80:83], v[128:143]
    ds_read_b64_tr_b16 v[184:185], v5 offset:16896
    ds_read_b64_tr_b16 v[186:187], v5 offset:37376
    ds_read_b128 v[192:195], v6 offset:1152
    ds_read_b128 v[200:203], v6 offset:21632
    s_waitcnt lgkmcnt(8)
    v_fma_mix_f32 v232, v84, v208, v216 op_sel:[0,0,0] op_sel_hi:[1,0,0]
    v_fma_mix_f32 v233, v84, v209, v217 op_sel:[1,0,0] op_sel_hi:[1,0,0]
    v_fma_mix_f32 v234, v85, v210, v218 op_sel:[0,0,0] op_sel_hi:[1,0,0]
    v_mfma_f32_32x32x16_bf16 v[144:159], v[172:175], v[80:83], v[144:159]
    ds_read_b64_tr_b16 v[188:189], v5 offset:17152
    ds_read_b64_tr_b16 v[190:191], v5 offset:37632
    ds_read_b128 v[196:199], v6 offset:1168
    ds_read_b128 v[204:207], v6 offset:21648
    v_fma_mix_f32 v235, v85, v211, v219 op_sel:[1,0,0] op_sel_hi:[1,0,0]
    v_fma_mix_f32 v236, v86, v212, v220 op_sel:[0,0,0] op_sel_hi:[1,0,0]
    v_fma_mix_f32 v237, v86, v213, v221 op_sel:[1,0,0] op_sel_hi:[1,0,0]
    s_waitcnt lgkmcnt(10)
    v_mfma_f32_32x32x16_bf16 v[96:111], v[176:179], v[68:71], v[96:111]
    ds_read_b64_tr_b16 v[160:161], v5 offset:10240
    ds_read_b64_tr_b16 v[162:163], v5 offset:30720
    v_fma_mix_f32 v238, v87, v214, v222 op_sel:[0,0,0] op_sel_hi:[1,0,0]
    v_fma_mix_f32 v239, v87, v215, v223 op_sel:[1,0,0] op_sel_hi:[1,0,0]
    v_cvt_pk_bf16_f32 v84, v232, v233
    s_waitcnt lgkmcnt(10)
    v_mfma_f32_32x32x16_bf16 v[112:127], v[180:183], v[68:71], v[112:127]
    ds_read_b64_tr_b16 v[164:165], v5 offset:10496
    ds_read_b64_tr_b16 v[166:167], v5 offset:30976
    v_cvt_pk_bf16_f32 v85, v234, v235
    v_cvt_pk_bf16_f32 v86, v236, v237
    v_cvt_pk_bf16_f32 v87, v238, v239
    s_barrier
    s_waitcnt lgkmcnt(10)
    v_mfma_f32_32x32x16_bf16 v[128:143], v[184:187], v[84:87], v[128:143]
    ds_read_b64_tr_b16 v[168:169], v4 offset:512
    ds_read_b64_tr_b16 v[170:171], v4 offset:20992
    ds_read_b128 v[208:211], v6 offset:1216
    ds_read_b128 v[216:219], v6 offset:21696
    s_waitcnt lgkmcnt(8)
    v_fma_mix_f32 v224, v88, v192, v200 op_sel:[0,0,0] op_sel_hi:[1,0,0]
    v_fma_mix_f32 v225, v88, v193, v201 op_sel:[1,0,0] op_sel_hi:[1,0,0]
    v_fma_mix_f32 v226, v89, v194, v202 op_sel:[0,0,0] op_sel_hi:[1,0,0]
    v_mfma_f32_32x32x16_bf16 v[144:159], v[188:191], v[84:87], v[144:159]
    ds_read_b64_tr_b16 v[172:173], v4 offset:768
    ds_read_b64_tr_b16 v[174:175], v4 offset:21248
    ds_read_b128 v[212:215], v6 offset:1232
    ds_read_b128 v[220:223], v6 offset:21712
    v_fma_mix_f32 v227, v89, v195, v203 op_sel:[1,0,0] op_sel_hi:[1,0,0]
    v_fma_mix_f32 v228, v90, v196, v204 op_sel:[0,0,0] op_sel_hi:[1,0,0]
    v_fma_mix_f32 v229, v90, v197, v205 op_sel:[1,0,0] op_sel_hi:[1,0,0]
    s_waitcnt lgkmcnt(10)
    v_mfma_f32_32x32x16_bf16 v[96:111], v[160:163], v[72:75], v[96:111]
    ds_read_b64_tr_b16 v[176:177], v5 offset:12288
    ds_read_b64_tr_b16 v[178:179], v5 offset:32768
    v_fma_mix_f32 v230, v91, v198, v206 op_sel:[0,0,0] op_sel_hi:[1,0,0]
    v_fma_mix_f32 v231, v91, v199, v207 op_sel:[1,0,0] op_sel_hi:[1,0,0]
    v_cvt_pk_bf16_f32 v88, v224, v225
    s_waitcnt lgkmcnt(10)
    v_mfma_f32_32x32x16_bf16 v[112:127], v[164:167], v[72:75], v[112:127]
    ds_read_b64_tr_b16 v[180:181], v5 offset:12544
    ds_read_b64_tr_b16 v[182:183], v5 offset:33024
    v_cvt_pk_bf16_f32 v89, v226, v227
    v_cvt_pk_bf16_f32 v90, v228, v229
    v_cvt_pk_bf16_f32 v91, v230, v231
    s_waitcnt lgkmcnt(10)
    s_nop 0
    v_mfma_f32_32x32x16_bf16 v[128:143], v[168:171], v[88:91], v[128:143]
    ds_read_b64_tr_b16 v[184:185], v4 offset:2560
    ds_read_b64_tr_b16 v[186:187], v4 offset:23040
    s_waitcnt lgkmcnt(6)
    v_fma_mix_f32 v232, v92, v208, v216 op_sel:[0,0,0] op_sel_hi:[1,0,0]
    v_fma_mix_f32 v233, v92, v209, v217 op_sel:[1,0,0] op_sel_hi:[1,0,0]
    v_fma_mix_f32 v234, v93, v210, v218 op_sel:[0,0,0] op_sel_hi:[1,0,0]
    v_mfma_f32_32x32x16_bf16 v[144:159], v[172:175], v[88:91], v[144:159]
    ds_read_b64_tr_b16 v[188:189], v4 offset:2816
    ds_read_b64_tr_b16 v[190:191], v4 offset:23296
    v_fma_mix_f32 v235, v93, v211, v219 op_sel:[1,0,0] op_sel_hi:[1,0,0]
    v_fma_mix_f32 v236, v94, v212, v220 op_sel:[0,0,0] op_sel_hi:[1,0,0]
    v_fma_mix_f32 v237, v94, v213, v221 op_sel:[1,0,0] op_sel_hi:[1,0,0]
    s_waitcnt lgkmcnt(6)
    v_mfma_f32_32x32x16_bf16 v[96:111], v[176:179], v[76:79], v[96:111]
    ds_read_b64_tr_b16 v[160:161], v5 offset:14336
    ds_read_b64_tr_b16 v[162:163], v5 offset:34816
    v_fma_mix_f32 v238, v95, v214, v222 op_sel:[0,0,0] op_sel_hi:[1,0,0]
    v_fma_mix_f32 v239, v95, v215, v223 op_sel:[1,0,0] op_sel_hi:[1,0,0]
    v_cvt_pk_bf16_f32 v92, v232, v233
    s_waitcnt lgkmcnt(6)
    v_mfma_f32_32x32x16_bf16 v[112:127], v[180:183], v[76:79], v[112:127]
    ds_read_b64_tr_b16 v[164:165], v5 offset:14592
    ds_read_b64_tr_b16 v[166:167], v5 offset:35072
    v_cvt_pk_bf16_f32 v93, v234, v235
    v_cvt_pk_bf16_f32 v94, v236, v237
    v_cvt_pk_bf16_f32 v95, v238, v239
    s_waitcnt lgkmcnt(6)
    s_nop 0
    v_mfma_f32_32x32x16_bf16 v[128:143], v[184:187], v[92:95], v[128:143]
    ds_read_b64_tr_b16 v[168:169], v5 offset:16384
    ds_read_b64_tr_b16 v[170:171], v5 offset:36864
    s_waitcnt lgkmcnt(6)
    v_mfma_f32_32x32x16_bf16 v[144:159], v[188:191], v[92:95], v[144:159]
    ds_read_b64_tr_b16 v[172:173], v5 offset:16640
    ds_read_b64_tr_b16 v[174:175], v5 offset:37120
    s_waitcnt lgkmcnt(6)
    v_mfma_f32_32x32x16_bf16 v[96:111], v[160:163], v[80:83], v[96:111]
    s_waitcnt lgkmcnt(4)
    v_mfma_f32_32x32x16_bf16 v[112:127], v[164:167], v[80:83], v[112:127]
    s_waitcnt lgkmcnt(2)
    v_mfma_f32_32x32x16_bf16 v[96:111], v[168:171], v[84:87], v[96:111]
    ds_read_b64_tr_b16 v[176:177], v4 offset:0
    ds_read_b64_tr_b16 v[178:179], v4 offset:20480
    s_waitcnt lgkmcnt(2)
    v_mfma_f32_32x32x16_bf16 v[112:127], v[172:175], v[84:87], v[112:127]
    ds_read_b64_tr_b16 v[180:181], v4 offset:256
    ds_read_b64_tr_b16 v[182:183], v4 offset:20736
    ds_write_b128 v7, v[128:131] offset:0
    ds_write_b128 v7, v[132:135] offset:1024
    s_waitcnt lgkmcnt(4)
    v_mfma_f32_32x32x16_bf16 v[96:111], v[176:179], v[88:91], v[96:111]
    ds_read_b64_tr_b16 v[184:185], v4 offset:2048
    ds_read_b64_tr_b16 v[186:187], v4 offset:22528
    ds_write_b128 v7, v[136:139] offset:2048
    ds_write_b128 v7, v[140:143] offset:3072
    s_waitcnt lgkmcnt(6)
    v_mfma_f32_32x32x16_bf16 v[112:127], v[180:183], v[88:91], v[112:127]
    ds_read_b64_tr_b16 v[188:189], v4 offset:2304
    ds_read_b64_tr_b16 v[190:191], v4 offset:22784
    ds_write_b128 v7, v[144:147] offset:4096
    ds_write_b128 v7, v[148:151] offset:5120
    s_waitcnt lgkmcnt(6)
    v_mfma_f32_32x32x16_bf16 v[96:111], v[184:187], v[92:95], v[96:111]
    ds_write_b128 v7, v[152:155] offset:6144
    ds_write_b128 v7, v[156:159] offset:7168
    s_waitcnt lgkmcnt(4)
    v_mfma_f32_32x32x16_bf16 v[112:127], v[188:191], v[92:95], v[112:127]
    s_waitcnt lgkmcnt(0)
    s_barrier
    ds_read_b128 v[128:131], v0 offset:0
    ds_read_b128 v[132:135], v0 offset:1024
    ds_read_b128 v[136:139], v0 offset:2048
    ds_read_b128 v[140:143], v0 offset:3072
    ds_read_b128 v[144:147], v0 offset:4096
    ds_read_b128 v[148:151], v0 offset:5120
    ds_read_b128 v[152:155], v0 offset:6144
    ds_read_b128 v[156:159], v0 offset:7168
    s_branch kf_kernel_a_epn
kf_kernel_a_vpl:
    ds_read_b128 v[192:195], v6 offset:0
    ds_read_b128 v[200:203], v6 offset:20480
    ds_read_b128 v[196:199], v6 offset:16
    ds_read_b128 v[204:207], v6 offset:20496
    ds_read_b128 v[208:211], v6 offset:64
    ds_read_b128 v[216:219], v6 offset:20544
    ds_read_b128 v[212:215], v6 offset:80
    ds_read_b128 v[220:223], v6 offset:20560
    ds_read_b64_tr_b16 v[160:161], v4 offset:512
    ds_read_b64_tr_b16 v[162:163], v4 offset:20992
    ds_read_b64_tr_b16 v[164:165], v4 offset:768
    ds_read_b64_tr_b16 v[166:167], v4 offset:21248
    s_waitcnt lgkmcnt(8)
    v_fma_mix_f32 v224, v16, v192, v200 op_sel:[0,0,0] op_sel_hi:[1,0,0]
    v_fma_mix_f32 v225, v16, v193, v201 op_sel:[1,0,0] op_sel_hi:[1,0,0]
    v_fma_mix_f32 v226, v17, v194, v202 op_sel:[0,0,0] op_sel_hi:[1,0,0]
    v_fma_mix_f32 v227, v17, v195, v203 op_sel:[1,0,0] op_sel_hi:[1,0,0]
    v_fma_mix_f32 v228, v18, v196, v204 op_sel:[0,0,0] op_sel_hi:[1,0,0]
    v_fma_mix_f32 v229, v18, v197, v205 op_sel:[1,0,0] op_sel_hi:[1,0,0]
    v_fma_mix_f32 v230, v19, v198, v206 op_sel:[0,0,0] op_sel_hi:[1,0,0]
    v_fma_mix_f32 v231, v19, v199, v207 op_sel:[1,0,0] op_sel_hi:[1,0,0]
    v_cvt_pk_bf16_f32 v16, v224, v225
    v_cvt_pk_bf16_f32 v17, v226, v227
    v_cvt_pk_bf16_f32 v18, v228, v229
    v_cvt_pk_bf16_f32 v19, v230, v231
    s_add_u32 m0, s70, zlit_b-zlit_a+(0)
    s_nop 0
    buffer_load_dwordx4 v12, s[12:15], s71 offen lds
    buffer_load_dwordx4 v13, s[12:15], s71 offen offset:1024 lds
    s_add_u32 s71, s71, 61440
    s_cmp_ge_u32 s71, s43
    s_cselect_b32 s51, 1228800, 0
    s_sub_u32 s71, s71, s51
    s_add_u32 m0, s70, 2048
    s_nop 0
    buffer_load_dwordx4 v12, s[12:15], s71 offen lds
    buffer_load_dwordx4 v13, s[12:15], s71 offen offset:1024 lds
    s_add_u32 s71, s71, 61440
    s_cmp_ge_u32 s71, s43
    s_cselect_b32 s51, 1228800, 0
    s_sub_u32 s71, s71, s51
    s_waitcnt lgkmcnt(2)
    v_mfma_f32_32x32x16_bf16 v[128:143], v[16:19], v[160:163], 0
    ds_read_b64_tr_b16 v[168:169], v4 offset:2560
    ds_read_b64_tr_b16 v[170:171], v4 offset:23040
    ds_read_b128 v[192:195], v6 offset:128
    ds_read_b128 v[200:203], v6 offset:20608
    v_fma_mix_f32 v232, v20, v208, v216 op_sel:[0,0,0] op_sel_hi:[1,0,0]
    v_fma_mix_f32 v233, v20, v209, v217 op_sel:[1,0,0] op_sel_hi:[1,0,0]
    v_fma_mix_f32 v234, v21, v210, v218 op_sel:[0,0,0] op_sel_hi:[1,0,0]
    v_fma_mix_f32 v235, v21, v211, v219 op_sel:[1,0,0] op_sel_hi:[1,0,0]
    v_fma_mix_f32 v236, v22, v212, v220 op_sel:[0,0,0] op_sel_hi:[1,0,0]
    v_fma_mix_f32 v237, v22, v213, v221 op_sel:[1,0,0] op_sel_hi:[1,0,0]
    s_waitcnt lgkmcnt(4)
    v_mfma_f32_32x32x16_bf16 v[144:159], v[16:19], v[164:167], 0
    ds_read_b64_tr_b16 v[172:173], v4 offset:2816
    ds_read_b64_tr_b16 v[174:175], v4 offset:23296
    ds_read_b128 v[196:199], v6 offset:144
    ds_read_b128 v[204:207], v6 offset:20624
    v_fma_mix_f32 v238, v23, v214, v222 op_sel:[0,0,0] op_sel_hi:[1,0,0]
    v_fma_mix_f32 v239, v23, v215, v223 op_sel:[1,0,0] op_sel_hi:[1,0,0]
    v_cvt_pk_bf16_f32 v20, v232, v233
    v_cvt_pk_bf16_f32 v21, v234, v235
    v_cvt_pk_bf16_f32 v22, v236, v237
    v_cvt_pk_bf16_f32 v23, v238, v239
    s_add_u32 m0, s70, 4096
    s_nop 0
    buffer_load_dwordx4 v12, s[12:15], s71 offen lds
    buffer_load_dwordx4 v13, s[12:15], s71 offen offset:1024 lds
    s_add_u32 s71, s71, 61440
    s_cmp_ge_u32 s71, s43
    s_cselect_b32 s51, 1228800, 0
    s_sub_u32 s71, s71, s51
    s_add_u32 m0, s70, 6144
    s_nop 0
    buffer_load_dwordx4 v12, s[12:15], s71 offen lds
    buffer_load_dwordx4 v13, s[12:15], s71 offen offset:1024 lds
    s_add_u32 s71, s71, 61440
    s_cmp_ge_u32 s71, s43
    s_cselect_b32 s51, 1228800, 0
    s_sub_u32 s71, s71, s51
    s_waitcnt lgkmcnt(6)
    v_mfma_f32_32x32x16_bf16 v[128:143], v[20:23], v[168:171], v[128:143]
    ds_read_b64_tr_b16 v[176:177], v4 offset:4608
    ds_read_b64_tr_b16 v[178:179], v4 offset:25088
    ds_read_b128 v[208:211], v6 offset:192
    ds_read_b128 v[216:219], v6 offset:20672
    s_waitcnt lgkmcnt(4)
    v_fma_mix_f32 v224, v24, v192, v200 op_sel:[0,0,0] op_sel_hi:[1,0,0]
    v_fma_mix_f32 v225, v24, v193, v201 op_sel:[1,0,0] op_sel_hi:[1,0,0]
    v_fma_mix_f32 v226, v25, v194, v202 op_sel:[0,0,0] op_sel_hi:[1,0,0]
    v_fma_mix_f32 v227, v25, v195, v203 op_sel:[1,0,0] op_sel_hi:[1,0,0]
    v_fma_mix_f32 v228, v26, v196, v204 op_sel:[0,0,0] op_sel_hi:[1,0,0]
    v_fma_mix_f32 v229, v26, v197, v205 op_sel:[1,0,0] op_sel_hi:[1,0,0]
    v_mfma_f32_32x32x16_bf16 v[144:159], v[20:23], v[172:175], v[144:159]
    ds_read_b64_tr_b16 v[180:181], v4 offset:4864
    ds_read_b64_tr_b16 v[182:183], v4 offset:25344
    ds_read_b128 v[212:215], v6 offset:208
    ds_read_b128 v[220:223], v6 offset:20688
    v_fma_mix_f32 v230, v27, v198, v206 op_sel:[0,0,0] op_sel_hi:[1,0,0]
    v_fma_mix_f32 v231, v27, v199, v207 op_sel:[1,0,0] op_sel_hi:[1,0,0]
    v_cvt_pk_bf16_f32 v24, v224, v225
    v_cvt_pk_bf16_f32 v25, v226, v227
    v_cvt_pk_bf16_f32 v26, v228, v229
    v_cvt_pk_bf16_f32 v27, v230, v231
    s_add_u32 m0, s70, 8192
    s_nop 0
    buffer_load_dwordx4 v12, s[12:15], s71 offen lds
    buffer_load_dwordx4 v13, s[12:15], s71 offen offset:1024 lds
    s_add_u32 s71, s71, 61440
    s_cmp_ge_u32 s71, s43
    s_cselect_b32 s51, 1228800, 0
    s_sub_u32 s71, s71, s51
    s_add_u32 m0, s70, 10240
    s_nop 0
    buffer_load_dwordx4 v12, s[12:15], s71 offen lds
    buffer_load_dwordx4 v13, s[12:15], s71 offen offset:1024 lds
    s_add_u32 s71, s71, 61440
    s_cmp_ge_u32 s71, s43
    s_cselect_b32 s51, 1228800, 0
    s_sub_u32 s71, s71, s51
    s_waitcnt lgkmcnt(6)
    v_mfma_f32_32x32x16_bf16 v[128:143], v[24:27], v[176:179], v[128:143]
    ds_read_b64_tr_b16 v[184:185], v4 offset:6656
    ds_read_b64_tr_b16 v[186:187], v4 offset:27136
    ds_read_b64_tr_b16 v[188:189], v4 offset:6912
    ds_read_b64_tr_b16 v[190:191], v4 offset:27392
    ds_read_b128 v[192:195], v6 offset:256
    ds_read_b128 v[200:203], v6 offset:20736
    s_waitcnt lgkmcnt(6)
    v_fma_mix_f32 v232, v28, v208, v216 op_sel:[0,0,0] op_sel_hi:[1,0,0]
    v_fma_mix_f32 v233, v28, v209, v217 op_sel:[1,0,0] op_sel_hi:[1,0,0]
    v_fma_mix_f32 v234, v29, v210, v218 op_sel:[0,0,0] op_sel_hi:[1,0,0]
    v_fma_mix_f32 v235, v29, v211, v219 op_sel:[1,0,0] op_sel_hi:[1,0,0]
    v_fma_mix_f32 v236, v30, v212, v220 op_sel:[0,0,0] op_sel_hi:[1,0,0]
    v_fma_mix_f32 v237, v30, v213, v221 op_sel:[1,0,0] op_sel_hi:[1,0,0]
    v_mfma_f32_32x32x16_bf16 v[144:159], v[24:27], v[180:183], v[144:159]
    ds_read_b64_tr_b16 v[160:161], v4 offset:0
    ds_read_b64_tr_b16 v[162:163], v4 offset:20480
    ds_read_b64_tr_b16 v[164:165], v4 offset:256
    ds_read_b64_tr_b16 v[166:167], v4 offset:20736
    ds_read_b128 v[196:199], v6 offset:272
    ds_read_b128 v[204:207], v6 offset:20752
    v_fma_mix_f32 v238, v31, v214, v222 op_sel:[0,0,0] op_sel_hi:[1,0,0]
    v_fma_mix_f32 v239, v31, v215, v223 op_sel:[1,0,0] op_sel_hi:[1,0,0]
    v_cvt_pk_bf16_f32 v28, v232, v233
    v_cvt_pk_bf16_f32 v29, v234, v235
    v_cvt_pk_bf16_f32 v30, v236, v237
    v_cvt_pk_bf16_f32 v31, v238, v239
    s_barrier
    s_add_u32 m0, s70, 12288
    s_nop 0
    buffer_load_dwordx4 v12, s[12:15], s71 offen lds
    buffer_load_dwordx4 v13, s[12:15], s71 offen offset:1024 lds
    s_add_u32 s71, s71, 61440
    s_cmp_ge_u32 s71, s43
    s_cselect_b32 s51, 1228800, 0
    s_sub_u32 s71, s71, s51
    s_add_u32 m0, s70, 14336
    s_nop 0
    buffer_load_dwordx4 v12, s[12:15], s71 offen lds
    buffer_load_dwordx4 v13, s[12:15], s71 offen offset:1024 lds
    s_add_u32 s71, s71, 61440
    s_cmp_ge_u32 s71, s43
    s_cselect_b32 s51, 1228800, 0
    s_sub_u32 s71, s71, s51
    s_waitcnt lgkmcnt(10)
    v_mfma_f32_32x32x16_bf16 v[128:143], v[28:31], v[184:187], v[128:143]
    ds_read_b64_tr_b16 v[168:169], v4 offset:8704
    ds_read_b64_tr_b16 v[170:171], v4 offset:29184
    ds_read_b128 v[208:211], v6 offset:320
    ds_read_b128 v[216:219], v6 offset:20800
    s_waitcnt lgkmcnt(4)
    v_fma_mix_f32 v224, v32, v192, v200 op_sel:[0,0,0] op_sel_hi:[1,0,0]
    v_fma_mix_f32 v225, v32, v193, v201 op_sel:[1,0,0] op_sel_hi:[1,0,0]
    v_fma_mix_f32 v226, v33, v194, v202 op_sel:[0,0,0] op_sel_hi:[1,0,0]
    v_mfma_f32_32x32x16_bf16 v[144:159], v[28:31], v[188:191], v[144:159]
    ds_read_b64_tr_b16 v[172:173], v4 offset:8960
    ds_read_b64_tr_b16 v[174:175], v4 offset:29440
    ds_read_b128 v[212:215], v6 offset:336
    ds_read_b128 v[220:223], v6 offset:20816
    v_fma_mix_f32 v227, v33, v195, v203 op_sel:[1,0,0] op_sel_hi:[1,0,0]
    v_fma_mix_f32 v228, v34, v196, v204 op_sel:[0,0,0] op_sel_hi:[1,0,0]
    v_fma_mix_f32 v229, v34, v197, v205 op_sel:[1,0,0] op_sel_hi:[1,0,0]
    v_mfma_f32_32x32x16_bf16 v[96:111], v[16:19], v[160:163], 0
    ds_read_b64_tr_b16 v[176:177], v4 offset:2048
    ds_read_b64_tr_b16 v[178:179], v4 offset:22528
    v_fma_mix_f32 v230, v35, v198, v206 op_sel:[0,0,0] op_sel_hi:[1,0,0]
    v_fma_mix_f32 v231, v35, v199, v207 op_sel:[1,0,0] op_sel_hi:[1,0,0]
    v_cvt_pk_bf16_f32 v32, v224, v225
    v_mfma_f32_32x32x16_bf16 v[112:127], v[16:19], v[164:167], 0
    ds_read_b64_tr_b16 v[180:181], v4 offset:2304
    ds_read_b64_tr_b16 v[182:183], v4 offset:22784
    v_cvt_pk_bf16_f32 v33, v226, v227
    v_cvt_pk_bf16_f32 v34, v228, v229
    v_cvt_pk_bf16_f32 v35, v230, v231
    s_add_u32 m0, s70, 16384
    s_nop 0
    buffer_load_dwordx4 v12, s[12:15], s71 offen lds
    buffer_load_dwordx4 v13, s[12:15], s71 offen offset:1024 lds
    s_mov_b32 exec_hi, s82
    buffer_load_dword v240, v10, s[44:47], s75 offen nt
    s_add_u32 s75, s75, s78
    buffer_load_dword v241, v10, s[44:47], s75 offen nt
    s_add_u32 s75, s75, s78
    s_mov_b32 exec_hi, -1
    s_waitcnt lgkmcnt(10)
    v_mfma_f32_32x32x16_bf16 v[128:143], v[32:35], v[168:171], v[128:143]
    ds_read_b64_tr_b16 v[184:185], v4 offset:10752
    ds_read_b64_tr_b16 v[186:187], v4 offset:31232
    ds_read_b128 v[192:195], v6 offset:384
    ds_read_b128 v[200:203], v6 offset:20864
    s_waitcnt lgkmcnt(8)
    v_fma_mix_f32 v232, v36, v208, v216 op_sel:[0,0,0] op_sel_hi:[1,0,0]
    v_fma_mix_f32 v233, v36, v209, v217 op_sel:[1,0,0] op_sel_hi:[1,0,0]
    v_fma_mix_f32 v234, v37, v210, v218 op_sel:[0,0,0] op_sel_hi:[1,0,0]
    v_mfma_f32_32x32x16_bf16 v[144:159], v[32:35], v[172:175], v[144:159]
    ds_read_b64_tr_b16 v[188:189], v4 offset:11008
    ds_read_b64_tr_b16 v[190:191], v4 offset:31488
    ds_read_b128 v[196:199], v6 offset:400
    ds_read_b128 v[204:207], v6 offset:20880
    v_fma_mix_f32 v235, v37, v211, v219 op_sel:[1,0,0] op_sel_hi:[1,0,0]
    v_fma_mix_f32 v236, v38, v212, v220 op_sel:[0,0,0] op_sel_hi:[1,0,0]
    v_fma_mix_f32 v237, v38, v213, v221 op_sel:[1,0,0] op_sel_hi:[1,0,0]
    s_waitcnt lgkmcnt(10)
    v_mfma_f32_32x32x16_bf16 v[96:111], v[20:23], v[176:179], v[96:111]
    ds_read_b64_tr_b16 v[160:161], v4 offset:4096
    ds_read_b64_tr_b16 v[162:163], v4 offset:24576
    v_fma_mix_f32 v238, v39, v214, v222 op_sel:[0,0,0] op_sel_hi:[1,0,0]
    v_fma_mix_f32 v239, v39, v215, v223 op_sel:[1,0,0] op_sel_hi:[1,0,0]
    v_cvt_pk_bf16_f32 v36, v232, v233
    s_waitcnt lgkmcnt(10)
    v_mfma_f32_32x32x16_bf16 v[112:127], v[20:23], v[180:183], v[112:127]
    ds_read_b64_tr_b16 v[164:165], v4 offset:4352
    ds_read_b64_tr_b16 v[166:167], v4 offset:24832
    v_cvt_pk_bf16_f32 v37, v234, v235
    v_cvt_pk_bf16_f32 v38, v236, v237
    v_cvt_pk_bf16_f32 v39, v238, v239
    s_mov_b32 exec_hi, s82
    buffer_load_dword v242, v10, s[44:47], s75 offen nt
    s_add_u32 s75, s75, s78
    buffer_load_dword v243, v10, s[44:47], s75 offen nt
    s_mul_i32 s51, s78, 3
    s_sub_u32 s51, s77, s51
    s_add_u32 s75, s75, s51
    s_mov_b32 exec_hi, -1
    s_waitcnt lgkmcnt(10)
    v_mfma_f32_32x32x16_bf16 v[128:143], v[36:39], v[184:187], v[128:143]
    ds_read_b64_tr_b16 v[168:169], v4 offset:12800
    ds_read_b64_tr_b16 v[170:171], v4 offset:33280
    ds_read_b128 v[208:211], v6 offset:448
    ds_read_b128 v[216:219], v6 offset:20928
    s_waitcnt lgkmcnt(8)
    v_fma_mix_f32 v224, v40, v192, v200 op_sel:[0,0,0] op_sel_hi:[1,0,0]
    v_fma_mix_f32 v225, v40, v193, v201 op_sel:[1,0,0] op_sel_hi:[1,0,0]
    v_fma_mix_f32 v226, v41, v194, v202 op_sel:[0,0,0] op_sel_hi:[1,0,0]
    v_mfma_f32_32x32x16_bf16 v[144:159], v[36:39], v[188:191], v[144:159]
    ds_read_b64_tr_b16 v[172:173], v4 offset:13056
    ds_read_b64_tr_b16 v[174:175], v4 offset:33536
    ds_read_b128 v[212:215], v6 offset:464
    ds_read_b128 v[220:223], v6 offset:20944
    v_fma_mix_f32 v227, v41, v195, v203 op_sel:[1,0,0] op_sel_hi:[1,0,0]
    v_fma_mix_f32 v228, v42, v196, v204 op_sel:[0,0,0] op_sel_hi:[1,0,0]
    v_fma_mix_f32 v229, v42, v197, v205 op_sel:[1,0,0] op_sel_hi:[1,0,0]
    s_waitcnt lgkmcnt(10)
    v_mfma_f32_32x32x16_bf16 v[96:111], v[24:27], v[160:163], v[96:111]
    ds_read_b64_tr_b16 v[176:177], v4 offset:6144
    ds_read_b64_tr_b16 v[178:179], v4 offset:26624
    v_fma_mix_f32 v230, v43, v198, v206 op_sel:[0,0,0] op_sel_hi:[1,0,0]
    v_fma_mix_f32 v231, v43, v199, v207 op_sel:[1,0,0] op_sel_hi:[1,0,0]
    v_cvt_pk_bf16_f32 v40, v224, v225
    s_waitcnt lgkmcnt(10)
    v_mfma_f32_32x32x16_bf16 v[112:127], v[24:27], v[164:167], v[112:127]
    ds_read_b64_tr_b16 v[180:181], v4 offset:6400
    ds_read_b64_tr_b16 v[182:183], v4 offset:26880
    v_cvt_pk_bf16_f32 v41, v226, v227
    v_cvt_pk_bf16_f32 v42, v228, v229
    v_cvt_pk_bf16_f32 v43, v230, v231
    s_mov_b32 exec_hi, s82
    buffer_load_dword v244, v10, s[44:47], s75 offen nt
    s_add_u32 s75, s75, s78
    buffer_load_dword v245, v10, s[44:47], s75 offen nt
    s_add_u32 s75, s75, s78
    s_mov_b32 exec_hi, -1
    s_waitcnt lgkmcnt(10)
    v_mfma_f32_32x32x16_bf16 v[128:143], v[40:43], v[168:171], v[128:143]
    ds_read_b64_tr_b16 v[184:185], v4 offset:14848
    ds_read_b64_tr_b16 v[186:187], v4 offset:35328
    ds_read_b128 v[192:195], v6 offset:512
    ds_read_b128 v[200:203], v6 offset:20992
    s_waitcnt lgkmcnt(8)
    v_fma_mix_f32 v232, v44, v208, v216 op_sel:[0,0,0] op_sel_hi:[1,0,0]
    v_fma_mix_f32 v233, v44, v209, v217 op_sel:[1,0,0] op_sel_hi:[1,0,0]
    v_fma_mix_f32 v234, v45, v210, v218 op_sel:[0,0,0] op_sel_hi:[1,0,0]
    v_mfma_f32_32x32x16_bf16 v[144:159], v[40:43], v[172:175], v[144:159]
    ds_read_b64_tr_b16 v[188:189], v4 offset:15104
    ds_read_b64_tr_b16 v[190:191], v4 offset:35584
    ds_read_b128 v[196:199], v6 offset:528
    ds_read_b128 v[204:207], v6 offset:21008
    v_fma_mix_f32 v235, v45, v211, v219 op_sel:[1,0,0] op_sel_hi:[1,0,0]
    v_fma_mix_f32 v236, v46, v212, v220 op_sel:[0,0,0] op_sel_hi:[1,0,0]
    v_fma_mix_f32 v237, v46, v213, v221 op_sel:[1,0,0] op_sel_hi:[1,0,0]
    s_waitcnt lgkmcnt(10)
    v_mfma_f32_32x32x16_bf16 v[96:111], v[28:31], v[176:179], v[96:111]
    ds_read_b64_tr_b16 v[160:161], v4 offset:8192
    ds_read_b64_tr_b16 v[162:163], v4 offset:28672
    v_fma_mix_f32 v238, v47, v214, v222 op_sel:[0,0,0] op_sel_hi:[1,0,0]
    v_fma_mix_f32 v239, v47, v215, v223 op_sel:[1,0,0] op_sel_hi:[1,0,0]
    v_cvt_pk_bf16_f32 v44, v232, v233
    s_waitcnt lgkmcnt(10)
    v_mfma_f32_32x32x16_bf16 v[112:127], v[28:31], v[180:183], v[112:127]
    ds_read_b64_tr_b16 v[164:165], v4 offset:8448
    ds_read_b64_tr_b16 v[166:167], v4 offset:28928
    v_cvt_pk_bf16_f32 v45, v234, v235
    v_cvt_pk_bf16_f32 v46, v236, v237
    v_cvt_pk_bf16_f32 v47, v238, v239
    s_mov_b32 exec_hi, s82
    buffer_load_dword v246, v10, s[44:47], s75 offen nt
    s_add_u32 s75, s75, s78
    buffer_load_dword v247, v10, s[44:47], s75 offen nt
    s_mov_b32 exec_hi, zlit_b-zlit_a+(-1)
    s_waitcnt lgkmcnt(10)
    v_mfma_f32_32x32x16_bf16 v[128:143], v[44:47], v[184:187], v[128:143]
    ds_read_b64_tr_b16 v[168:169], v4 offset:16896
    ds_read_b64_tr_b16 v[170:171], v4 offset:37376
    ds_read_b128 v[208:211], v6 offset:576
    ds_read_b128 v[216:219], v6 offset:21056
    s_waitcnt lgkmcnt(8)
    v_fma_mix_f32 v224, v48, v192, v200 op_sel:[0,0,0] op_sel_hi:[1,0,0]
    v_fma_mix_f32 v225, v48, v193, v201 op_sel:[1,0,0] op_sel_hi:[1,0,0]
    v_fma_mix_f32 v226, v49, v194, v202 op_sel:[0,0,0] op_sel_hi:[1,0,0]
    v_mfma_f32_32x32x16_bf16 v[144:159], v[44:47], v[188:191], v[144:159]
    ds_read_b64_tr_b16 v[172:173], v4 offset:17152
    ds_read_b64_tr_b16 v[174:175], v4 offset:37632
    ds_read_b128 v[212:215], v6 offset:592
    ds_read_b128 v[220:223], v6 offset:21072
    v_fma_mix_f32 v227, v49, v195, v203 op_sel:[1,0,0] op_sel_hi:[1,0,0]
    v_fma_mix_f32 v228, v50, v196, v204 op_sel:[0,0,0] op_sel_hi:[1,0,0]
    v_fma_mix_f32 v229, v50, v197, v205 op_sel:[1,0,0] op_sel_hi:[1,0,0]
    s_waitcnt lgkmcnt(10)
    v_mfma_f32_32x32x16_bf16 v[96:111], v[32:35], v[160:163], v[96:111]
    ds_read_b64_tr_b16 v[176:177], v4 offset:10240
    ds_read_b64_tr_b16 v[178:179], v4 offset:30720
    v_fma_mix_f32 v230, v51, v198, v206 op_sel:[0,0,0] op_sel_hi:[1,0,0]
    v_fma_mix_f32 v231, v51, v199, v207 op_sel:[1,0,0] op_sel_hi:[1,0,0]
    v_cvt_pk_bf16_f32 v48, v224, v225
    s_waitcnt lgkmcnt(10)
    v_mfma_f32_32x32x16_bf16 v[112:127], v[32:35], v[164:167], v[112:127]
    ds_read_b64_tr_b16 v[180:181], v4 offset:10496
    ds_read_b64_tr_b16 v[182:183], v4 offset:30976
    v_cvt_pk_bf16_f32 v49, v226, v227
    v_cvt_pk_bf16_f32 v50, v228, v229
    v_cvt_pk_bf16_f32 v51, v230, v231
    s_waitcnt vmcnt(18)
    s_barrier
    s_waitcnt lgkmcnt(10)
    v_mfma_f32_32x32x16_bf16 v[128:143], v[48:51], v[168:171], v[128:143]
    ds_read_b64_tr_b16 v[184:185], v5 offset:512
    ds_read_b64_tr_b16 v[186:187], v5 offset:20992
    ds_read_b128 v[192:195], v6 offset:640
    ds_read_b128 v[200:203], v6 offset:21120
    s_waitcnt lgkmcnt(8)
    v_fma_mix_f32 v232, v52, v208, v216 op_sel:[0,0,0] op_sel_hi:[1,0,0]
    v_fma_mix_f32 v233, v52, v209, v217 op_sel:[1,0,0] op_sel_hi:[1,0,0]
    v_fma_mix_f32 v234, v53, v210, v218 op_sel:[0,0,0] op_sel_hi:[1,0,0]
    v_mfma_f32_32x32x16_bf16 v[144:159], v[48:51], v[172:175], v[144:159]
    ds_read_b64_tr_b16 v[188:189], v5 offset:768
    ds_read_b64_tr_b16 v[190:191], v5 offset:21248
    ds_read_b128 v[196:199], v6 offset:656
    ds_read_b128 v[204:207], v6 offset:21136
    v_fma_mix_f32 v235, v53, v211, v219 op_sel:[1,0,0] op_sel_hi:[1,0,0]
    v_fma_mix_f32 v236, v54, v212, v220 op_sel:[0,0,0] op_sel_hi:[1,0,0]
    v_fma_mix_f32 v237, v54, v213, v221 op_sel:[1,0,0] op_sel_hi:[1,0,0]
    s_waitcnt lgkmcnt(10)
    v_mfma_f32_32x32x16_bf16 v[96:111], v[36:39], v[176:179], v[96:111]
    ds_read_b64_tr_b16 v[160:161], v4 offset:12288
    ds_read_b64_tr_b16 v[162:163], v4 offset:32768
    v_fma_mix_f32 v238, v55, v214, v222 op_sel:[0,0,0] op_sel_hi:[1,0,0]
    v_fma_mix_f32 v239, v55, v215, v223 op_sel:[1,0,0] op_sel_hi:[1,0,0]
    v_cvt_pk_bf16_f32 v52, v232, v233
    s_waitcnt lgkmcnt(10)
    v_mfma_f32_32x32x16_bf16 v[112:127], v[36:39], v[180:183], v[112:127]
    ds_read_b64_tr_b16 v[164:165], v4 offset:12544
    ds_read_b64_tr_b16 v[166:167], v4 offset:33024
    v_cvt_pk_bf16_f32 v53, v234, v235
    v_cvt_pk_bf16_f32 v54, v236, v237
    v_cvt_pk_bf16_f32 v55, v238, v239
    s_waitcnt lgkmcnt(10)
    s_nop 0
    v_mfma_f32_32x32x16_bf16 v[128:143], v[52:55], v[184:187], v[128:143]
    ds_read_b64_tr_b16 v[168:169], v5 offset:2560
    ds_read_b64_tr_b16 v[170:171], v5 offset:23040
    ds_read_b128 v[208:211], v6 offset:704
    ds_read_b128 v[216:219], v6 offset:21184
    s_waitcnt lgkmcnt(8)
    v_fma_mix_f32 v224, v56, v192, v200 op_sel:[0,0,0] op_sel_hi:[1,0,0]
    v_fma_mix_f32 v225, v56, v193, v201 op_sel:[1,0,0] op_sel_hi:[1,0,0]
    v_fma_mix_f32 v226, v57, v194, v202 op_sel:[0,0,0] op_sel_hi:[1,0,0]
    v_mfma_f32_32x32x16_bf16 v[144:159], v[52:55], v[188:191], v[144:159]
    ds_read_b64_tr_b16 v[172:173], v5 offset:2816
    ds_read_b64_tr_b16 v[174:175], v5 offset:23296
    ds_read_b128 v[212:215], v6 offset:720
    ds_read_b128 v[220:223], v6 offset:21200
    v_fma_mix_f32 v227, v57, v195, v203 op_sel:[1,0,0] op_sel_hi:[1,0,0]
    v_fma_mix_f32 v228, v58, v196, v204 op_sel:[0,0,0] op_sel_hi:[1,0,0]
    v_fma_mix_f32 v229, v58, v197, v205 op_sel:[1,0,0] op_sel_hi:[1,0,0]
    s_waitcnt lgkmcnt(10)
    v_mfma_f32_32x32x16_bf16 v[96:111], v[40:43], v[160:163], v[96:111]
    ds_read_b64_tr_b16 v[176:177], v4 offset:14336
    ds_read_b64_tr_b16 v[178:179], v4 offset:34816
    v_fma_mix_f32 v230, v59, v198, v206 op_sel:[0,0,0] op_sel_hi:[1,0,0]
    v_fma_mix_f32 v231, v59, v199, v207 op_sel:[1,0,0] op_sel_hi:[1,0,0]
    v_cvt_pk_bf16_f32 v56, v224, v225
    s_waitcnt lgkmcnt(10)
    v_mfma_f32_32x32x16_bf16 v[112:127], v[40:43], v[164:167], v[112:127]
    ds_read_b64_tr_b16 v[180:181], v4 offset:14592
    ds_read_b64_tr_b16 v[182:183], v4 offset:35072
    v_cvt_pk_bf16_f32 v57, v226, v227
    v_cvt_pk_bf16_f32 v58, v228, v229
    v_cvt_pk_bf16_f32 v59, v230, v231
    s_waitcnt lgkmcnt(10)
    s_nop 0
    v_mfma_f32_32x32x16_bf16 v[128:143], v[56:59], v[168:171], v[128:143]
    ds_read_b64_tr_b16 v[184:185], v5 offset:4608
    ds_read_b64_tr_b16 v[186:187], v5 offset:25088
    ds_read_b128 v[192:195], v6 offset:768
    ds_read_b128 v[200:203], v6 offset:21248
    s_waitcnt lgkmcnt(8)
    v_fma_mix_f32 v232, v60, v208, v216 op_sel:[0,0,0] op_sel_hi:[1,0,0]
    v_fma_mix_f32 v233, v60, v209, v217 op_sel:[1,0,0] op_sel_hi:[1,0,0]
    v_fma_mix_f32 v234, v61, v210, v218 op_sel:[0,0,0] op_sel_hi:[1,0,0]
    v_mfma_f32_32x32x16_bf16 v[144:159], v[56:59], v[172:175], v[144:159]
    ds_read_b64_tr_b16 v[188:189], v5 offset:4864
    ds_read_b64_tr_b16 v[190:191], v5 offset:25344
    ds_read_b128 v[196:199], v6 offset:784
    ds_read_b128 v[204:207], v6 offset:21264
    v_fma_mix_f32 v235, v61, v211, v219 op_sel:[1,0,0] op_sel_hi:[1,0,0]
    v_fma_mix_f32 v236, v62, v212, v220 op_sel:[0,0,0] op_sel_hi:[1,0,0]
    v_fma_mix_f32 v237, v62, v213, v221 op_sel:[1,0,0] op_sel_hi:[1,0,0]
    s_waitcnt lgkmcnt(10)
    v_mfma_f32_32x32x16_bf16 v[96:111], v[44:47], v[176:179], v[96:111]
    ds_read_b64_tr_b16 v[160:161], v4 offset:16384
    ds_read_b64_tr_b16 v[162:163], v4 offset:36864
    v_fma_mix_f32 v238, v63, v214, v222 op_sel:[0,0,0] op_sel_hi:[1,0,0]
    v_fma_mix_f32 v239, v63, v215, v223 op_sel:[1,0,0] op_sel_hi:[1,0,0]
    v_cvt_pk_bf16_f32 v60, v232, v233
    s_waitcnt lgkmcnt(10)
    v_mfma_f32_32x32x16_bf16 v[112:127], v[44:47], v[180:183], v[112:127]
    ds_read_b64_tr_b16 v[164:165], v4 offset:16640
    ds_read_b64_tr_b16 v[166:167], v4 offset:37120
    v_cvt_pk_bf16_f32 v61, v234, v235
    v_cvt_pk_bf16_f32 v62, v236, v237
    v_cvt_pk_bf16_f32 v63, v238, v239
    s_waitcnt lgkmcnt(10)
    s_nop 0
    v_mfma_f32_32x32x16_bf16 v[128:143], v[60:63], v[184:187], v[128:143]
    ds_read_b64_tr_b16 v[168:169], v5 offset:6656
    ds_read_b64_tr_b16 v[170:171], v5 offset:27136
    ds_read_b128 v[208:211], v6 offset:832
    ds_read_b128 v[216:219], v6 offset:21312
    s_waitcnt lgkmcnt(8)
    v_fma_mix_f32 v224, v64, v192, v200 op_sel:[0,0,0] op_sel_hi:[1,0,0]
    v_fma_mix_f32 v225, v64, v193, v201 op_sel:[1,0,0] op_sel_hi:[1,0,0]
    v_fma_mix_f32 v226, v65, v194, v202 op_sel:[0,0,0] op_sel_hi:[1,0,0]
    v_mfma_f32_32x32x16_bf16 v[144:159], v[60:63], v[188:191], v[144:159]
    ds_read_b64_tr_b16 v[172:173], v5 offset:6912
    ds_read_b64_tr_b16 v[174:175], v5 offset:27392
    ds_read_b128 v[212:215], v6 offset:848
    ds_read_b128 v[220:223], v6 offset:21328
    v_fma_mix_f32 v227, v65, v195, v203 op_sel:[1,0,0] op_sel_hi:[1,0,0]
    v_fma_mix_f32 v228, v66, v196, v204 op_sel:[0,0,0] op_sel_hi:[1,0,0]
    v_fma_mix_f32 v229, v66, v197, v205 op_sel:[1,0,0] op_sel_hi:[1,0,0]
    s_waitcnt lgkmcnt(10)
    v_mfma_f32_32x32x16_bf16 v[96:111], v[48:51], v[160:163], v[96:111]
    ds_read_b64_tr_b16 v[176:177], v5 offset:0
    ds_read_b64_tr_b16 v[178:179], v5 offset:20480
    v_fma_mix_f32 v230, v67, v198, v206 op_sel:[0,0,0] op_sel_hi:[1,0,0]
    v_fma_mix_f32 v231, v67, v199, v207 op_sel:[1,0,0] op_sel_hi:[1,0,0]
    v_cvt_pk_bf16_f32 v64, v224, v225
    s_waitcnt lgkmcnt(10)
    v_mfma_f32_32x32x16_bf16 v[112:127], v[48:51], v[164:167], v[112:127]
    ds_read_b64_tr_b16 v[180:181], v5 offset:256
    ds_read_b64_tr_b16 v[182:183], v5 offset:20736
    v_cvt_pk_bf16_f32 v65, v226, v227
    v_cvt_pk_bf16_f32 v66, v228, v229
    v_cvt_pk_bf16_f32 v67, v230, v231
    s_waitcnt vmcnt(8)
    s_barrier
    s_waitcnt lgkmcnt(10)
    v_mfma_f32_32x32x16_bf16 v[128:143], v[64:67], v[168:171], v[128:143]
    ds_read_b64_tr_b16 v[184:185], v5 offset:8704
    ds_read_b64_tr_b16 v[186:187], v5 offset:29184
    ds_read_b128 v[192:195], v6 offset:896
    ds_read_b128 v[200:203], v6 offset:21376
    s_waitcnt lgkmcnt(8)
    v_fma_mix_f32 v232, v68, v208, v216 op_sel:[0,0,0] op_sel_hi:[1,0,0]
    v_fma_mix_f32 v233, v68, v209, v217 op_sel:[1,0,0] op_sel_hi:[1,0,0]
    v_fma_mix_f32 v234, v69, v210, v218 op_sel:[0,0,0] op_sel_hi:[1,0,0]
    v_mfma_f32_32x32x16_bf16 v[144:159], v[64:67], v[172:175], v[144:159]
    ds_read_b64_tr_b16 v[188:189], v5 offset:8960
    ds_read_b64_tr_b16 v[190:191], v5 offset:29440
    ds_read_b128 v[196:199], v6 offset:912
    ds_read_b128 v[204:207], v6 offset:21392
    v_fma_mix_f32 v235, v69, v211, v219 op_sel:[1,0,0] op_sel_hi:[1,0,0]
    v_fma_mix_f32 v236, v70, v212, v220 op_sel:[0,0,0] op_sel_hi:[1,0,0]
    v_fma_mix_f32 v237, v70, v213, v221 op_sel:[1,0,0] op_sel_hi:[1,0,0]
    s_waitcnt lgkmcnt(10)
    v_mfma_f32_32x32x16_bf16 v[96:111], v[52:55], v[176:179], v[96:111]
    ds_read_b64_tr_b16 v[160:161], v5 offset:2048
    ds_read_b64_tr_b16 v[162:163], v5 offset:22528
    v_fma_mix_f32 v238, v71, v214, v222 op_sel:[0,0,0] op_sel_hi:[1,0,0]
    v_fma_mix_f32 v239, v71, v215, v223 op_sel:[1,0,0] op_sel_hi:[1,0,0]
    v_cvt_pk_bf16_f32 v68, v232, v233
    s_waitcnt lgkmcnt(10)
    v_mfma_f32_32x32x16_bf16 v[112:127], v[52:55], v[180:183], v[112:127]
    ds_read_b64_tr_b16 v[164:165], v5 offset:2304
    ds_read_b64_tr_b16 v[166:167], v5 offset:22784
    v_cvt_pk_bf16_f32 v69, v234, v235
    v_cvt_pk_bf16_f32 v70, v236, v237
    v_cvt_pk_bf16_f32 v71, v238, v239
    s_waitcnt vmcnt(0)
    v_perm_b32 v248, v241, v240, s80
    v_perm_b32 v252, v241, v240, s81
    v_perm_b32 v249, v243, v242, s80
    v_perm_b32 v253, v243, v242, s81
    v_perm_b32 v250, v245, v244, s80
    v_perm_b32 v254, v245, v244, s81
    v_perm_b32 v251, v247, v246, s80
    v_perm_b32 v255, v247, v246, s81
    s_mov_b32 exec_hi, s82
    buffer_store_dwordx4 v[248:251], v11, s[8:11], s79 offen offset:0 sc1
    buffer_store_dwordx4 v[252:255], v11, s[8:11], s79 offen offset:16 sc1
    s_mov_b32 exec_hi, -1
    s_waitcnt lgkmcnt(10)
    v_mfma_f32_32x32x16_bf16 v[128:143], v[68:71], v[184:187], v[128:143]
    ds_read_b64_tr_b16 v[168:169], v5 offset:10752
    ds_read_b64_tr_b16 v[170:171], v5 offset:31232
    ds_read_b128 v[208:211], v6 offset:960
    ds_read_b128 v[216:219], v6 offset:21440
    s_waitcnt lgkmcnt(8)
    v_fma_mix_f32 v224, v72, v192, v200 op_sel:[0,0,0] op_sel_hi:[1,0,0]
    v_fma_mix_f32 v225, v72, v193, v201 op_sel:[1,0,0] op_sel_hi:[1,0,0]
    v_fma_mix_f32 v226, v73, v194, v202 op_sel:[0,0,0] op_sel_hi:[1,0,0]
    v_mfma_f32_32x32x16_bf16 v[144:159], v[68:71], v[188:191], v[144:159]
    ds_read_b64_tr_b16 v[172:173], v5 offset:11008
    ds_read_b64_tr_b16 v[174:175], v5 offset:31488
    ds_read_b128 v[212:215], v6 offset:976
    ds_read_b128 v[220:223], v6 offset:21456
    v_fma_mix_f32 v227, v73, v195, v203 op_sel:[1,0,0] op_sel_hi:[1,0,0]
    v_fma_mix_f32 v228, v74, v196, v204 op_sel:[0,0,0] op_sel_hi:[1,0,0]
    v_fma_mix_f32 v229, v74, v197, v205 op_sel:[1,0,0] op_sel_hi:[1,0,0]
    s_waitcnt lgkmcnt(10)
    v_mfma_f32_32x32x16_bf16 v[96:111], v[56:59], v[160:163], v[96:111]
    ds_read_b64_tr_b16 v[176:177], v5 offset:4096
    ds_read_b64_tr_b16 v[178:179], v5 offset:24576
    v_fma_mix_f32 v230, v75, v198, v206 op_sel:[0,0,0] op_sel_hi:[1,0,0]
    v_fma_mix_f32 v231, v75, v199, v207 op_sel:[1,0,0] op_sel_hi:[1,0,0]
    v_cvt_pk_bf16_f32 v72, v224, v225
    s_waitcnt lgkmcnt(10)
    v_mfma_f32_32x32x16_bf16 v[112:127], v[56:59], v[164:167], v[112:127]
    ds_read_b64_tr_b16 v[180:181], v5 offset:4352
    ds_read_b64_tr_b16 v[182:183], v5 offset:24832
    v_cvt_pk_bf16_f32 v73, v226, v227
    v_cvt_pk_bf16_f32 v74, v228, v229
    v_cvt_pk_bf16_f32 v75, v230, v231
    s_waitcnt lgkmcnt(10)
    s_nop 0
    v_mfma_f32_32x32x16_bf16 v[128:143], v[72:75], v[168:171], v[128:143]
    ds_read_b64_tr_b16 v[184:185], v5 offset:12800
    ds_read_b64_tr_b16 v[186:187], v5 offset:33280
    ds_read_b128 v[192:195], v6 offset:1024
    ds_read_b128 v[200:203], v6 offset:21504
    s_waitcnt lgkmcnt(8)
    v_fma_mix_f32 v232, v76, v208, v216 op_sel:[0,0,0] op_sel_hi:[1,0,0]
    v_fma_mix_f32 v233, v76, v209, v217 op_sel:[1,0,0] op_sel_hi:[1,0,0]
    v_fma_mix_f32 v234, v77, v210, v218 op_sel:[0,0,0] op_sel_hi:[1,0,0]
    v_mfma_f32_32x32x16_bf16 v[144:159], v[72:75], v[172:175], v[144:159]
    ds_read_b64_tr_b16 v[188:189], v5 offset:13056
    ds_read_b64_tr_b16 v[190:191], v5 offset:33536
    ds_read_b128 v[196:199], v6 offset:1040
    ds_read_b128 v[204:207], v6 offset:21520
    v_fma_mix_f32 v235, v77, v211, v219 op_sel:[1,0,0] op_sel_hi:[1,0,0]
    v_fma_mix_f32 v236, v78, v212, v220 op_sel:[0,0,0] op_sel_hi:[1,0,0]
    v_fma_mix_f32 v237, v78, v213, v221 op_sel:[1,0,0] op_sel_hi:[1,0,0]
    s_waitcnt lgkmcnt(10)
    v_mfma_f32_32x32x16_bf16 v[96:111], v[60:63], v[176:179], v[96:111]
    ds_read_b64_tr_b16 v[160:161], v5 offset:6144
    ds_read_b64_tr_b16 v[162:163], v5 offset:26624
    v_fma_mix_f32 v238, v79, v214, v222 op_sel:[0,0,0] op_sel_hi:[1,0,0]
    v_fma_mix_f32 v239, v79, v215, v223 op_sel:[1,0,0] op_sel_hi:[1,0,0]
    v_cvt_pk_bf16_f32 v76, v232, v233
    s_waitcnt lgkmcnt(10)
    v_mfma_f32_32x32x16_bf16 v[112:127], v[60:63], v[180:183], v[112:127]
    ds_read_b64_tr_b16 v[164:165], v5 offset:6400
    ds_read_b64_tr_b16 v[166:167], v5 offset:26880
    v_cvt_pk_bf16_f32 v77, v234, v235
    v_cvt_pk_bf16_f32 v78, v236, v237
    v_cvt_pk_bf16_f32 v79, v238, v239
    s_waitcnt lgkmcnt(10)
    s_nop 0
    v_mfma_f32_32x32x16_bf16 v[128:143], v[76:79], v[184:187], v[128:143]
    ds_read_b64_tr_b16 v[168:169], v5 offset:14848
    ds_read_b64_tr_b16 v[170:171], v5 offset:35328
    ds_read_b128 v[208:211], v6 offset:1088
    ds_read_b128 v[216:219], v6 offset:21568
    s_waitcnt lgkmcnt(8)
    v_fma_mix_f32 v224, v80, v192, v200 op_sel:[0,0,0] op_sel_hi:[1,0,0]
    v_fma_mix_f32 v225, v80, v193, v201 op_sel:[1,0,0] op_sel_hi:[1,0,0]
    v_fma_mix_f32 v226, v81, v194, v202 op_sel:[0,0,0] op_sel_hi:[1,0,0]
    v_mfma_f32_32x32x16_bf16 v[144:159], v[76:79], v[188:191], v[144:159]
    ds_read_b64_tr_b16 v[172:173], v5 offset:15104
    ds_read_b64_tr_b16 v[174:175], v5 offset:35584
    ds_read_b128 v[212:215], v6 offset:1104
    ds_read_b128 v[220:223], v6 offset:21584
    v_fma_mix_f32 v227, v81, v195, v203 op_sel:[1,0,0] op_sel_hi:[1,0,0]
    v_fma_mix_f32 v228, v82, v196, v204 op_sel:[0,0,0] op_sel_hi:[1,0,0]
    v_fma_mix_f32 v229, v82, v197, v205 op_sel:[1,0,0] op_sel_hi:[1,0,0]
    s_waitcnt lgkmcnt(10)
    v_mfma_f32_32x32x16_bf16 v[96:111], v[64:67], v[160:163], v[96:111]
    ds_read_b64_tr_b16 v[176:177], v5 offset:8192
    ds_read_b64_tr_b16 v[178:179], v5 offset:28672
    v_fma_mix_f32 v230, v83, v198, v206 op_sel:[0,0,0] op_sel_hi:[1,0,0]
    v_fma_mix_f32 v231, v83, v199, v207 op_sel:[1,0,0] op_sel_hi:[1,0,0]
    v_cvt_pk_bf16_f32 v80, v224, v225
    s_waitcnt lgkmcnt(10)
    v_mfma_f32_32x32x16_bf16 v[112:127], v[64:67], v[164:167], v[112:127]
    ds_read_b64_tr_b16 v[180:181], v5 offset:8448
    ds_read_b64_tr_b16 v[182:183], v5 offset:28928
    v_cvt_pk_bf16_f32 v81, v226, v227
    v_cvt_pk_bf16_f32 v82, v228, v229
    v_cvt_pk_bf16_f32 v83, v230, v231
    s_waitcnt lgkmcnt(10)
    s_nop 0
    v_mfma_f32_32x32x16_bf16 v[128:143], v[80:83], v[168:171], v[128:143]
    ds_read_b64_tr_b16 v[184:185], v5 offset:16896
    ds_read_b64_tr_b16 v[186:187], v5 offset:37376
    ds_read_b128 v[192:195], v6 offset:1152
    ds_read_b128 v[200:203], v6 offset:21632
    s_waitcnt lgkmcnt(8)
    v_fma_mix_f32 v232, v84, v208, v216 op_sel:[0,0,0] op_sel_hi:[1,0,0]
    v_fma_mix_f32 v233, v84, v209, v217 op_sel:[1,0,0] op_sel_hi:[1,0,0]
    v_fma_mix_f32 v234, v85, v210, v218 op_sel:[0,0,0] op_sel_hi:[1,0,0]
    v_mfma_f32_32x32x16_bf16 v[144:159], v[80:83], v[172:175], v[144:159]
    ds_read_b64_tr_b16 v[188:189], v5 offset:17152
    ds_read_b64_tr_b16 v[190:191], v5 offset:37632
    ds_read_b128 v[196:199], v6 offset:1168
    ds_read_b128 v[204:207], v6 offset:21648
    v_fma_mix_f32 v235, v85, v211, v219 op_sel:[1,0,0] op_sel_hi:[1,0,0]
    v_fma_mix_f32 v236, v86, v212, v220 op_sel:[0,0,0] op_sel_hi:[1,0,0]
    v_fma_mix_f32 v237, v86, v213, v221 op_sel:[1,0,0] op_sel_hi:[1,0,0]
    s_waitcnt lgkmcnt(10)
    v_mfma_f32_32x32x16_bf16 v[96:111], v[68:71], v[176:179], v[96:111]
    ds_read_b64_tr_b16 v[160:161], v5 offset:10240
    ds_read_b64_tr_b16 v[162:163], v5 offset:30720
    v_fma_mix_f32 v238, v87, v214, v222 op_sel:[0,0,0] op_sel_hi:[1,0,0]
    v_fma_mix_f32 v239, v87, v215, v223 op_sel:[1,0,0] op_sel_hi:[1,0,0]
    v_cvt_pk_bf16_f32 v84, v232, v233
    s_waitcnt lgkmcnt(10)
    v_mfma_f32_32x32x16_bf16 v[112:127], v[68:71], v[180:183], v[112:127]
    ds_read_b64_tr_b16 v[164:165], v5 offset:10496
    ds_read_b64_tr_b16 v[166:167], v5 offset:30976
    v_cvt_pk_bf16_f32 v85, v234, v235
    v_cvt_pk_bf16_f32 v86, v236, v237
    v_cvt_pk_bf16_f32 v87, v238, v239
    s_barrier
    s_waitcnt lgkmcnt(10)
    v_mfma_f32_32x32x16_bf16 v[128:143], v[84:87], v[184:187], v[128:143]
    ds_read_b64_tr_b16 v[168:169], v4 offset:512
    ds_read_b64_tr_b16 v[170:171], v4 offset:20992
    ds_read_b128 v[208:211], v6 offset:1216
    ds_read_b128 v[216:219], v6 offset:21696
    s_waitcnt lgkmcnt(8)
    v_fma_mix_f32 v224, v88, v192, v200 op_sel:[0,0,0] op_sel_hi:[1,0,0]
    v_fma_mix_f32 v225, v88, v193, v201 op_sel:[1,0,0] op_sel_hi:[1,0,0]
    v_fma_mix_f32 v226, v89, v194, v202 op_sel:[0,0,0] op_sel_hi:[1,0,0]
    v_mfma_f32_32x32x16_bf16 v[144:159], v[84:87], v[188:191], v[144:159]
    ds_read_b64_tr_b16 v[172:173], v4 offset:768
    ds_read_b64_tr_b16 v[174:175], v4 offset:21248
    ds_read_b128 v[212:215], v6 offset:1232
    ds_read_b128 v[220:223], v6 offset:21712
    v_fma_mix_f32 v227, v89, v195, v203 op_sel:[1,0,0] op_sel_hi:[1,0,0]
    v_fma_mix_f32 v228, v90, v196, v204 op_sel:[0,0,0] op_sel_hi:[1,0,0]
    v_fma_mix_f32 v229, v90, v197, v205 op_sel:[1,0,0] op_sel_hi:[1,0,0]
    s_waitcnt lgkmcnt(10)
    v_mfma_f32_32x32x16_bf16 v[96:111], v[72:75], v[160:163], v[96:111]
    ds_read_b64_tr_b16 v[176:177], v5 offset:12288
    ds_read_b64_tr_b16 v[178:179], v5 offset:32768
    v_fma_mix_f32 v230, v91, v198, v206 op_sel:[0,0,0] op_sel_hi:[1,0,0]
    v_fma_mix_f32 v231, v91, v199, v207 op_sel:[1,0,0] op_sel_hi:[1,0,0]
    v_cvt_pk_bf16_f32 v88, v224, v225
    s_waitcnt lgkmcnt(10)
    v_mfma_f32_32x32x16_bf16 v[112:127], v[72:75], v[164:167], v[112:127]
    ds_read_b64_tr_b16 v[180:181], v5 offset:12544
    ds_read_b64_tr_b16 v[182:183], v5 offset:33024
    v_cvt_pk_bf16_f32 v89, v226, v227
    v_cvt_pk_bf16_f32 v90, v228, v229
    v_cvt_pk_bf16_f32 v91, v230, v231
    s_waitcnt lgkmcnt(10)
    s_nop 0
    v_mfma_f32_32x32x16_bf16 v[128:143], v[88:91], v[168:171], v[128:143]
    ds_read_b64_tr_b16 v[184:185], v4 offset:2560
    ds_read_b64_tr_b16 v[186:187], v4 offset:23040
    s_waitcnt lgkmcnt(6)
    v_fma_mix_f32 v232, v92, v208, v216 op_sel:[0,0,0] op_sel_hi:[1,0,0]
    v_fma_mix_f32 v233, v92, v209, v217 op_sel:[1,0,0] op_sel_hi:[1,0,0]
    v_fma_mix_f32 v234, v93, v210, v218 op_sel:[0,0,0] op_sel_hi:[1,0,0]
    v_mfma_f32_32x32x16_bf16 v[144:159], v[88:91], v[172:175], v[144:159]
    ds_read_b64_tr_b16 v[188:189], v4 offset:2816
    ds_read_b64_tr_b16 v[190:191], v4 offset:23296
    v_fma_mix_f32 v235, v93, v211, v219 op_sel:[1,0,0] op_sel_hi:[1,0,0]
    v_fma_mix_f32 v236, v94, v212, v220 op_sel:[0,0,0] op_sel_hi:[1,0,0]
    v_fma_mix_f32 v237, v94, v213, v221 op_sel:[1,0,0] op_sel_hi:[1,0,0]
    s_waitcnt lgkmcnt(6)
    v_mfma_f32_32x32x16_bf16 v[96:111], v[76:79], v[176:179], v[96:111]
    ds_read_b64_tr_b16 v[160:161], v5 offset:14336
    ds_read_b64_tr_b16 v[162:163], v5 offset:34816
    v_fma_mix_f32 v238, v95, v214, v222 op_sel:[0,0,0] op_sel_hi:[1,0,0]
    v_fma_mix_f32 v239, v95, v215, v223 op_sel:[1,0,0] op_sel_hi:[1,0,0]
    v_cvt_pk_bf16_f32 v92, v232, v233
    s_waitcnt lgkmcnt(6)
    v_mfma_f32_32x32x16_bf16 v[112:127], v[76:79], v[180:183], v[112:127]
    ds_read_b64_tr_b16 v[164:165], v5 offset:14592
    ds_read_b64_tr_b16 v[166:167], v5 offset:35072
    v_cvt_pk_bf16_f32 v93, v234, v235
    v_cvt_pk_bf16_f32 v94, v236, v237
    v_cvt_pk_bf16_f32 v95, v238, v239
    s_waitcnt lgkmcnt(6)
    s_nop 0
    v_mfma_f32_32x32x16_bf16 v[128:143], v[92:95], v[184:187], v[128:143]
    ds_read_b64_tr_b16 v[168:169], v5 offset:16384
    ds_read_b64_tr_b16 v[170:171], v5 offset:36864
    s_waitcnt lgkmcnt(6)
    v_mfma_f32_32x32x16_bf16 v[144:159], v[92:95], v[188:191], v[144:159]
    ds_read_b64_tr_b16 v[172:173], v5 offset:16640
    ds_read_b64_tr_b16 v[174:175], v5 offset:37120
    s_waitcnt lgkmcnt(6)
    v_mfma_f32_32x32x16_bf16 v[96:111], v[80:83], v[160:163], v[96:111]
    s_waitcnt lgkmcnt(4)
    v_mfma_f32_32x32x16_bf16 v[112:127], v[80:83], v[164:167], v[112:127]
    s_waitcnt lgkmcnt(2)
    v_mfma_f32_32x32x16_bf16 v[96:111], v[84:87], v[168:171], v[96:111]
    ds_read_b64_tr_b16 v[176:177], v4 offset:0
    ds_read_b64_tr_b16 v[178:179], v4 offset:20480
    s_waitcnt lgkmcnt(2)
    v_mfma_f32_32x32x16_bf16 v[112:127], v[84:87], v[172:175], v[112:127]
    ds_read_b64_tr_b16 v[180:181], v4 offset:256
    ds_read_b64_tr_b16 v[182:183], v4 offset:20736
    ds_write_b128 v7, v[128:131] offset:0
    ds_write_b128 v7, v[132:135] offset:1024
    s_waitcnt lgkmcnt(4)
    v_mfma_f32_32x32x16_bf16 v[96:111], v[88:91], v[176:179], v[96:111]
    ds_read_b64_tr_b16 v[184:185], v4 offset:2048
    ds_read_b64_tr_b16 v[186:187], v4 offset:22528
    ds_write_b128 v7, v[136:139] offset:2048
    ds_write_b128 v7, v[140:143] offset:3072
    s_waitcnt lgkmcnt(6)
    v_mfma_f32_32x32x16_bf16 v[112:127], v[88:91], v[180:183], v[112:127]
    ds_read_b64_tr_b16 v[188:189], v4 offset:2304
    ds_read_b64_tr_b16 v[190:191], v4 offset:22784
    ds_write_b128 v7, v[144:147] offset:4096
    ds_write_b128 v7, v[148:151] offset:5120
    s_waitcnt lgkmcnt(6)
    v_mfma_f32_32x32x16_bf16 v[96:111], v[92:95], v[184:187], v[96:111]
    ds_write_b128 v7, v[152:155] offset:6144
    ds_write_b128 v7, v[156:159] offset:7168
    s_waitcnt lgkmcnt(4)
    v_mfma_f32_32x32x16_bf16 v[112:127], v[92:95], v[188:191], v[112:127]
    s_waitcnt lgkmcnt(0)
    s_barrier
    ds_read_b128 v[128:131], v0 offset:0
    ds_read_b128 v[132:135], v0 offset:1024
    ds_read_b128 v[136:139], v0 offset:2048
    ds_read_b128 v[140:143], v0 offset:3072
    ds_read_b128 v[144:147], v0 offset:4096
    ds_read_b128 v[148:151], v0 offset:5120
    ds_read_b128 v[152:155], v0 offset:6144
    ds_read_b128 v[156:159], v0 offset:7168
    s_branch kf_kernel_a_epv
kf_kernel_a_epn:
    s_cmp_eq_u32 s56, 0
    s_cbranch_scc0 kf_kernel_a_ph1
    s_mov_b32 s72, 13037568
    s_mov_b32 s62, 15134720
    s_mov_b32 s66, zlit_b-zlit_a+(3)
    s_mov_b32 s63, 15167488
    s_mov_b32 s67, zlit_b-zlit_a+(3)
    s_mov_b32 s64, 15200256
    s_mov_b32 s68, zlit_b-zlit_a+(3)
    s_mov_b32 s65, 13430784
    s_mov_b32 s69, 4
    s_branch kf_kernel_a_phd
kf_kernel_a_ph1:
    s_cmp_eq_u32 s56, 1
    s_cbranch_scc0 kf_kernel_a_ph2
    s_mov_b32 s72, 13496320
    s_mov_b32 s62, 13431296
    s_mov_b32 s66, zlit_b-zlit_a+(4)
    s_mov_b32 s63, 15233024
    s_mov_b32 s67, zlit_b-zlit_a+(3)
    s_mov_b32 s64, 15265792
    s_mov_b32 s68, zlit_b-zlit_a+(3)
    s_mov_b32 s65, 15298560
    s_mov_b32 s69, 3
    s_branch kf_kernel_a_phd
kf_kernel_a_ph2:
    s_cmp_eq_u32 s56, 2
    s_cbranch_scc0 kf_kernel_a_ph3
    s_mov_b32 s72, 13889536
    s_mov_b32 s62, 15331328
    s_mov_b32 s66, zlit_b-zlit_a+(3)
    s_mov_b32 s63, 15364096
    s_mov_b32 s67, zlit_b-zlit_a+(3)
    s_mov_b32 s64, 15396864
    s_mov_b32 s68, zlit_b-zlit_a+(3)
    s_mov_b32 s65, 15429632
    s_mov_b32 s69, 3
    s_branch kf_kernel_a_phd
kf_kernel_a_ph3:
    s_cmp_eq_u32 s56, 3
    s_cbranch_scc0 kf_kernel_a_ph4
    s_mov_b32 s72, 14282752
    s_mov_b32 s62, 15462400
    s_mov_b32 s66, zlit_b-zlit_a+(3)
    s_mov_b32 s63, 15495168
    s_mov_b32 s67, zlit_b-zlit_a+(3)
    s_mov_b32 s64, 15527936
    s_mov_b32 s68, zlit_b-zlit_a+(3)
    s_mov_b32 s65, 14675968
    s_mov_b32 s69, 4
    s_branch kf_kernel_a_phd
kf_kernel_a_ph4:
    s_mov_b32 s72, 14741504
    s_mov_b32 s62, 14676480
    s_mov_b32 s66, zlit_b-zlit_a+(4)
    s_mov_b32 s63, 15560704
    s_mov_b32 s67, zlit_b-zlit_a+(3)
    s_mov_b32 s64, 15593472
    s_mov_b32 s68, zlit_b-zlit_a+(3)
    s_mov_b32 s65, 15626240
    s_mov_b32 s69, 3
kf_kernel_a_phd:
    s_cmp_ge_u32 s50, 5
    s_cselect_b32 s52, 2621440, 0
    s_cselect_b32 s58, 1.0, 0x3ea52b5c
    s_cselect_b32 s59, 1.0, 0x3ea52b5c
    s_lshl_b32 s51, s49, 10
    s_add_u32 s72, s72, s51
    s_add_u32 s72, s72, s52
    s_lshl_b32 s51, s53, 18
    s_add_u32 s72, s72, s51
    s_lshl_b32 s51, s49, 6
    v_and_b32 v4, 31, v2
    v_lshlrev_b32 v4, 4, v4
    s_lshl_b32 s66, s51, s66
    s_add_u32 s62, s62, s52
    s_add_u32 s62, s62, s66
    s_lshl_b32 s67, s51, s67
    s_add_u32 s63, s63, s52
    s_add_u32 s63, s63, s67
    s_lshl_b32 s68, s51, s68
    s_add_u32 s64, s64, s52
    s_add_u32 s64, s64, s68
    s_lshl_b32 s69, s51, s69
    s_add_u32 s65, s65, s52
    s_add_u32 s65, s65, s69
    v_add_u32 v12, s62, v4
    v_add_u32 v13, s64, v4
    s_mov_b32 exec_lo, 0
    v_add_u32 v12, s63, v4
    v_add_u32 v13, s65, v4
    s_mov_b32 exec_lo, zlit_b-zlit_a+(-1)
    s_waitcnt lgkmcnt(6)
    v_pk_add_f32 v[96:97], v[96:97], v[128:129]
    v_pk_add_f32 v[98:99], v[98:99], v[130:131]
    v_pk_add_f32 v[100:101], v[100:101], v[132:133]
    v_pk_add_f32 v[102:103], v[102:103], v[134:135]
    v_cvt_pk_bf16_f32 v160, v96, v97
    v_cvt_pk_bf16_f32 v161, v98, v99
    v_cvt_pk_bf16_f32 v162, v100, v101
    v_cvt_pk_bf16_f32 v163, v102, v103
    buffer_store_dwordx4 v[160:163], v3, s[8:11], s72 offen sc1
    s_add_u32 s72, s72, 65536
    s_waitcnt lgkmcnt(4)
    v_pk_add_f32 v[104:105], v[104:105], v[136:137]
    v_pk_add_f32 v[106:107], v[106:107], v[138:139]
    v_pk_add_f32 v[108:109], v[108:109], v[140:141]
    v_pk_add_f32 v[110:111], v[110:111], v[142:143]
    v_cvt_pk_bf16_f32 v164, v104, v105
    v_cvt_pk_bf16_f32 v165, v106, v107
    v_cvt_pk_bf16_f32 v166, v108, v109
    v_cvt_pk_bf16_f32 v167, v110, v111
    buffer_store_dwordx4 v[164:167], v3, s[8:11], s72 offen sc1
    s_add_u32 s72, s72, 65536
    s_cmp_eq_u32 s53, 1
    s_cbranch_scc1 kf_kernel_a_singles
    s_waitcnt lgkmcnt(2)
    v_pk_add_f32 v[112:113], v[112:113], v[144:145]
    v_pk_add_f32 v[114:115], v[114:115], v[146:147]
    v_pk_add_f32 v[116:117], v[116:117], v[148:149]
    v_pk_add_f32 v[118:119], v[118:119], v[150:151]
    v_cvt_pk_bf16_f32 v168, v112, v113
    v_cvt_pk_bf16_f32 v169, v114, v115
    v_cvt_pk_bf16_f32 v170, v116, v117
    v_cvt_pk_bf16_f32 v171, v118, v119
    buffer_store_dwordx4 v[168:171], v3, s[8:11], s72 offen sc1
    s_add_u32 s72, s72, 65536
    s_waitcnt lgkmcnt(0)
    v_pk_add_f32 v[120:121], v[120:121], v[152:153]
    v_pk_add_f32 v[122:123], v[122:123], v[154:155]
    v_pk_add_f32 v[124:125], v[124:125], v[156:157]
    v_pk_add_f32 v[126:127], v[126:127], v[158:159]
    v_cvt_pk_bf16_f32 v172, v120, v121
    v_cvt_pk_bf16_f32 v173, v122, v123
    v_cvt_pk_bf16_f32 v174, v124, v125
    v_cvt_pk_bf16_f32 v175, v126, v127
    buffer_store_dwordx4 v[172:175], v3, s[8:11], s72 offen sc1
    s_branch kf_kernel_a_end
kf_kernel_a_singles:
    s_waitcnt lgkmcnt(2)
    v_pk_add_f32 v[112:113], v[112:113], v[144:145]
    v_pk_add_f32 v[114:115], v[114:115], v[146:147]
    v_pk_add_f32 v[116:117], v[116:117], v[148:149]
    v_pk_add_f32 v[118:119], v[118:119], v[150:151]
    v_cvt_pk_bf16_f32 v168, v112, v113
    v_cvt_pk_bf16_f32 v169, v114, v115
    v_cvt_pk_bf16_f32 v170, v116, v117
    v_cvt_pk_bf16_f32 v171, v118, v119
    s_nop 1
    v_permlane32_swap_b32 v168, v170
    v_permlane32_swap_b32 v169, v171
    buffer_store_dwordx4 v[168:171], v12, s[8:11], 0 offen sc1
    s_waitcnt lgkmcnt(0)
    v_pk_add_f32 v[120:121], v[120:121], v[152:153]
    v_pk_add_f32 v[122:123], v[122:123], v[154:155]
    v_pk_add_f32 v[124:125], v[124:125], v[156:157]
    v_pk_add_f32 v[126:127], v[126:127], v[158:159]
    v_cvt_pk_bf16_f32 v172, v120, v121
    v_cvt_pk_bf16_f32 v173, v122, v123
    v_cvt_pk_bf16_f32 v174, v124, v125
    v_cvt_pk_bf16_f32 v175, v126, v127
    s_nop 1
    v_permlane32_swap_b32 v172, v174
    v_permlane32_swap_b32 v173, v175
    buffer_store_dwordx4 v[172:175], v13, s[8:11], 0 offen sc1
    s_branch kf_kernel_a_end
kf_kernel_a_epv:
    s_sub_u32 s51, s50, 10
    s_lshl_b32 s51, s51, 7
    s_lshl_b32 s52, s53, 6
    s_add_u32 s51, s51, s52
    v_lshrrev_b32 v8, 5, v2
    v_and_b32_e64 v9, 31, v2
    v_mul_u32_u24 v8, 320, v8
    s_mov_b32 s52, 81600
    v_add_u32_e64 v4, s51, v9
    v_mul_u32_u24 v5, 3277, v4
    v_lshrrev_b32_e64 v5, 16, v5
    v_mul_lo_u32 v5, v5, s52
    v_lshl_add_u32 v5, v4, 4, v5
    v_add_u32 v12, v5, v8
    s_add_u32 s51, s51, 32
    v_add_u32_e64 v4, s51, v9
    v_mul_u32_u24 v5, 3277, v4
    v_lshrrev_b32_e64 v5, 16, v5
    v_mul_lo_u32 v5, v5, s52
    v_lshl_add_u32 v5, v4, 4, v5
    v_add_u32 v13, v5, v8
    s_add_u32 s51, s51, 32
    s_mul_i32 s72, s49, 1280
    s_add_u32 s72, s72, 18280448
    s_waitcnt lgkmcnt(6)
    v_pk_add_f32 v[96:97], v[96:97], v[128:129]
    v_pk_add_f32 v[98:99], v[98:99], v[130:131]
    v_pk_add_f32 v[100:101], v[100:101], v[132:133]
    v_pk_add_f32 v[102:103], v[102:103], v[134:135]
    v_cvt_pk_bf16_f32 v160, v96, v97
    v_cvt_pk_bf16_f32 v161, v98, v99
    v_cvt_pk_bf16_f32 v162, v100, v101
    v_cvt_pk_bf16_f32 v163, v102, v103
    buffer_store_dwordx4 v[160:163], v12, s[8:11], s72 offen offset:0 sc1
    s_waitcnt lgkmcnt(4)
    v_pk_add_f32 v[104:105], v[104:105], v[136:137]
    v_pk_add_f32 v[106:107], v[106:107], v[138:139]
    v_pk_add_f32 v[108:109], v[108:109], v[140:141]
    v_pk_add_f32 v[110:111], v[110:111], v[142:143]
    v_cvt_pk_bf16_f32 v164, v104, v105
    v_cvt_pk_bf16_f32 v165, v106, v107
    v_cvt_pk_bf16_f32 v166, v108, v109
    v_cvt_pk_bf16_f32 v167, v110, v111
    buffer_store_dwordx4 v[164:167], v12, s[8:11], s72 offen offset:640 sc1
    s_waitcnt lgkmcnt(2)
    v_pk_add_f32 v[112:113], v[112:113], v[144:145]
    v_pk_add_f32 v[114:115], v[114:115], v[146:147]
    v_pk_add_f32 v[116:117], v[116:117], v[148:149]
    v_pk_add_f32 v[118:119], v[118:119], v[150:151]
    v_cvt_pk_bf16_f32 v168, v112, v113
    v_cvt_pk_bf16_f32 v169, v114, v115
    v_cvt_pk_bf16_f32 v170, v116, v117
    v_cvt_pk_bf16_f32 v171, v118, v119
    buffer_store_dwordx4 v[168:171], v13, s[8:11], s72 offen offset:0 sc1
    s_waitcnt lgkmcnt(0)
    v_pk_add_f32 v[120:121], v[120:121], v[152:153]
    v_pk_add_f32 v[122:123], v[122:123], v[154:155]
    v_pk_add_f32 v[124:125], v[124:125], v[156:157]
    v_pk_add_f32 v[126:127], v[126:127], v[158:159]
    v_cvt_pk_bf16_f32 v172, v120, v121
    v_cvt_pk_bf16_f32 v173, v122, v123
    v_cvt_pk_bf16_f32 v174, v124, v125
    v_cvt_pk_bf16_f32 v175, v126, v127
    buffer_store_dwordx4 v[172:175], v13, s[8:11], s72 offen offset:640 sc1
    s_branch kf_kernel_a_end
kf_kernel_a_exit:
    s_endpgm
kf_kernel_a_prod:
    v_mul_u32_u24 v22, 13, v2
    v_lshrrev_b32 v22, 8, v22
    v_mul_u32_u24 v4, 20, v22
    v_sub_u32 v4, v2, v4
    s_mul_i32 s51, s48, 3
    v_add_u32 v22, s51, v22
    v_mul_u32_u24 v6, 640, v22
    v_lshl_add_u32 v6, v4, 5, v6
    v_mul_u32_u24 v5, 7680, v22
    v_lshl_add_u32 v4, v4, 4, v5
    v_lshlrev_b32_e64 v5, 1, v22
    s_mul_i32 s58, s2, 320
    s_add_u32 s58, s58, 2560
    s_mov_b32 exec_hi, 0x0fffffff
    s_waitcnt lgkmcnt(0)
    s_mov_b32 s12, s34
    s_mov_b32 s13, s35
    s_mov_b32 s14, 4915200
    s_mov_b32 s15, 0x00020000
    s_mov_b32 s4, s32
    s_mov_b32 s5, s33
    s_mov_b32 s6, 1280
    s_mov_b32 s7, 0x00020000
    s_mov_b32 s8, s40
    s_mov_b32 s9, s41
    s_mov_b32 s10, 268435456
    s_mov_b32 s11, 0x00020000
    v_mov_b32 v23, 28672
    buffer_load_dword v23, v23, s[8:11], 0 offen sc1
    s_mov_b32 s101, 0x40000000
    s_mov_b32 s61, s48
    buffer_load_dwordx4 v[24:27], v4, s[12:15], s58 offen nt
    s_add_u32 s58, s58, 184320
    buffer_load_dwordx4 v[28:31], v4, s[12:15], s58 offen nt
    s_add_u32 s58, s58, 184320
    buffer_load_dwordx4 v[32:35], v4, s[12:15], s58 offen nt
    s_add_u32 s58, s58, 184320
    buffer_load_dwordx4 v[36:39], v4, s[12:15], s58 offen nt
    s_add_u32 s58, s58, 184320
    buffer_load_ushort v132, v5, s[4:7], 0 offen offset:0
    buffer_load_ushort v133, v5, s[4:7], 0 offen offset:48
    buffer_load_ushort v134, v5, s[4:7], 0 offen offset:96
    buffer_load_ushort v135, v5, s[4:7], 0 offen offset:144
    buffer_load_ushort v136, v5, s[4:7], 0 offen offset:192
    buffer_load_ushort v137, v5, s[4:7], 0 offen offset:240
    buffer_load_ushort v138, v5, s[4:7], 0 offen offset:288
    buffer_load_ushort v139, v5, s[4:7], 0 offen offset:336
    buffer_load_ushort v140, v5, s[4:7], 0 offen offset:384
    buffer_load_ushort v141, v5, s[4:7], 0 offen offset:432
    buffer_load_ushort v142, v5, s[4:7], 0 offen offset:480
    buffer_load_ushort v143, v5, s[4:7], 0 offen offset:528
    buffer_load_ushort v144, v5, s[4:7], 0 offen offset:576
    buffer_load_ushort v145, v5, s[4:7], 0 offen offset:624
    buffer_load_ushort v146, v5, s[4:7], 0 offen offset:672
    buffer_load_ushort v147, v5, s[4:7], 0 offen offset:720
    buffer_load_ushort v148, v5, s[4:7], 0 offen offset:768
    buffer_load_ushort v149, v5, s[4:7], 0 offen offset:816
    buffer_load_ushort v150, v5, s[4:7], 0 offen offset:864
    buffer_load_ushort v151, v5, s[4:7], 0 offen offset:912
    buffer_load_ushort v152, v5, s[4:7], 0 offen offset:960
    buffer_load_ushort v153, v5, s[4:7], 0 offen offset:1008
    buffer_load_ushort v154, v5, s[4:7], 0 offen offset:1056
    buffer_load_ushort v155, v5, s[4:7], 0 offen offset:1104
    buffer_load_ushort v156, v5, s[4:7], 0 offen offset:1152
    buffer_load_ushort v157, v5, s[4:7], 0 offen offset:1200
    buffer_load_ushort v158, v5, s[4:7], 0 offen offset:1248
    buffer_load_dwordx4 v[40:43], v4, s[12:15], s58 offen nt
    s_add_u32 s58, s58, 184320
    buffer_load_dwordx4 v[44:47], v4, s[12:15], s58 offen nt
    s_add_u32 s58, s58, 184320
    buffer_load_dwordx4 v[48:51], v4, s[12:15], s58 offen nt
    s_add_u32 s58, s58, 184320
    buffer_load_dwordx4 v[52:55], v4, s[12:15], s58 offen nt
    s_add_u32 s58, s58, 184320
    buffer_load_dwordx4 v[56:59], v4, s[12:15], s58 offen nt
    s_add_u32 s58, s58, 184320
    buffer_load_dwordx4 v[60:63], v4, s[12:15], s58 offen nt
    s_add_u32 s58, s58, 184320
    buffer_load_dwordx4 v[64:67], v4, s[12:15], s58 offen nt
    s_add_u32 s58, s58, 184320
    buffer_load_dwordx4 v[68:71], v4, s[12:15], s58 offen nt
    s_add_u32 s58, s58, 184320
    buffer_load_dwordx4 v[72:75], v4, s[12:15], s58 offen nt
    s_add_u32 s58, s58, 184320
    buffer_load_dwordx4 v[76:79], v4, s[12:15], s58 offen nt
    s_add_u32 s58, s58, 184320
    buffer_load_dwordx4 v[80:83], v4, s[12:15], s58 offen nt
    s_add_u32 s58, s58, 184320
    buffer_load_dwordx4 v[84:87], v4, s[12:15], s58 offen nt
    s_add_u32 s58, s58, 184320
    buffer_load_dwordx4 v[88:91], v4, s[12:15], s58 offen nt
    s_add_u32 s58, s58, 184320
    buffer_load_dwordx4 v[92:95], v4, s[12:15], s58 offen nt
    s_add_u32 s58, s58, 184320
    buffer_load_dwordx4 v[96:99], v4, s[12:15], s58 offen nt
    s_add_u32 s58, s58, 184320
    buffer_load_dwordx4 v[100:103], v4, s[12:15], s58 offen nt
    s_add_u32 s58, s58, 184320
    buffer_load_dwordx4 v[104:107], v4, s[12:15], s58 offen nt
    s_add_u32 s58, s58, 184320
    buffer_load_dwordx4 v[108:111], v4, s[12:15], s58 offen nt
    s_add_u32 s58, s58, 184320
    buffer_load_dwordx4 v[112:115], v4, s[12:15], s58 offen nt
    s_add_u32 s58, s58, 184320
    buffer_load_dwordx4 v[116:119], v4, s[12:15], s58 offen nt
    s_add_u32 s58, s58, 184320
    buffer_load_dwordx4 v[120:123], v4, s[12:15], s58 offen nt
    s_add_u32 s58, s58, 184320
    buffer_load_dwordx4 v[124:127], v4, s[12:15], s58 offen nt
    s_add_u32 s58, s58, 184320
    buffer_load_dwordx4 v[128:131], v4, s[12:15], s58 offen nt
    s_waitcnt vmcnt(23)
    v_readfirstlane_b32 s100, v23
    s_nop 0
    s_add_u32 s100, s100, 0x01010101
    v_lshlrev_b32 v132, 16, v132
    v_lshlrev_b32 v133, 16, v133
    v_lshlrev_b32 v134, 16, v134
    v_lshlrev_b32 v135, 16, v135
    v_lshlrev_b32 v136, 16, v136
    v_lshlrev_b32 v137, 16, v137
    v_lshlrev_b32 v138, 16, v138
    v_lshlrev_b32 v139, 16, v139
    v_lshlrev_b32 v140, 16, v140
    v_lshlrev_b32 v141, 16, v141
    v_lshlrev_b32 v142, 16, v142
    v_lshlrev_b32 v143, 16, v143
    v_lshlrev_b32 v144, 16, v144
    v_lshlrev_b32 v145, 16, v145
    v_lshlrev_b32 v146, 16, v146
    v_lshlrev_b32 v147, 16, v147
    v_lshlrev_b32 v148, 16, v148
    v_lshlrev_b32 v149, 16, v149
    v_lshlrev_b32 v150, 16, v150
    v_lshlrev_b32 v151, 16, v151
    v_lshlrev_b32 v152, 16, v152
    v_lshlrev_b32 v153, 16, v153
    v_lshlrev_b32 v154, 16, v154
    v_lshlrev_b32 v155, 16, v155
    v_lshlrev_b32 v156, 16, v156
    v_lshlrev_b32 v157, 16, v157
    v_lshlrev_b32_e64 v158, 16, v158
    v_mul_f32 v159, 0xbfb8aa3b, v132
    v_mul_f32 v160, 0xbfb8aa3b, v133
    v_mul_f32 v161, 0xbfb8aa3b, v134
    v_mul_f32 v162, 0xbfb8aa3b, v135
    v_mul_f32 v163, 0xbfb8aa3b, v136
    v_mul_f32 v164, 0xbfb8aa3b, v137
    v_mul_f32 v165, 0xbfb8aa3b, v138
    v_mul_f32 v166, 0xbfb8aa3b, v139
    v_mul_f32 v167, 0xbfb8aa3b, v140
    v_mul_f32 v168, 0xbfb8aa3b, v141
    v_mul_f32 v169, 0xbfb8aa3b, v142
    v_mul_f32 v170, 0xbfb8aa3b, v143
    v_mul_f32 v171, 0xbfb8aa3b, v144
    v_mul_f32 v172, 0xbfb8aa3b, v145
    v_mul_f32 v173, 0xbfb8aa3b, v146
    v_mul_f32 v174, 0xbfb8aa3b, v147
    v_mul_f32 v175, 0xbfb8aa3b, v148
    v_mul_f32 v176, 0xbfb8aa3b, v149
    v_mul_f32 v177, 0xbfb8aa3b, v150
    v_mul_f32 v178, 0xbfb8aa3b, v151
    v_mul_f32 v179, 0xbfb8aa3b, v152
    v_mul_f32 v180, 0xbfb8aa3b, v153
    v_mul_f32 v181, 0xbfb8aa3b, v154
    v_mul_f32 v182, 0xbfb8aa3b, v155
    v_mul_f32 v183, 0xbfb8aa3b, v156
    v_mul_f32 v184, 0xbfb8aa3b, v157
    v_mul_f32 v185, 0xbfb8aa3b, v158
    v_exp_f32 v159, v159
    v_exp_f32 v160, v160
    v_exp_f32 v161, v161
    v_exp_f32 v162, v162
    v_exp_f32 v163, v163
    v_exp_f32 v164, v164
    v_exp_f32 v165, v165
    v_exp_f32 v166, v166
    v_exp_f32 v167, v167
    v_exp_f32 v168, v168
    v_exp_f32 v169, v169
    v_exp_f32 v170, v170
    v_exp_f32 v171, v171
    v_exp_f32 v172, v172
    v_exp_f32 v173, v173
    v_exp_f32 v174, v174
    v_exp_f32 v175, v175
    v_exp_f32 v176, v176
    v_exp_f32 v177, v177
    v_exp_f32 v178, v178
    v_exp_f32 v179, v179
    v_exp_f32 v180, v180
    v_exp_f32 v181, v181
    v_exp_f32 v182, v182
    v_exp_f32 v183, v183
    v_exp_f32 v184, v184
    v_exp_f32 v185, v185
    v_add_f32 v159, 1.0, v159
    v_add_f32 v160, 1.0, v160
    v_add_f32 v161, 1.0, v161
    v_add_f32 v162, 1.0, v162
    v_add_f32 v163, 1.0, v163
    v_add_f32 v164, 1.0, v164
    v_add_f32 v165, 1.0, v165
    v_add_f32 v166, 1.0, v166
    v_add_f32 v167, 1.0, v167
    v_add_f32 v168, 1.0, v168
    v_add_f32 v169, 1.0, v169
    v_add_f32 v170, 1.0, v170
    v_add_f32 v171, 1.0, v171
    v_add_f32 v172, 1.0, v172
    v_add_f32 v173, 1.0, v173
    v_add_f32 v174, 1.0, v174
    v_add_f32 v175, 1.0, v175
    v_add_f32 v176, 1.0, v176
    v_add_f32 v177, 1.0, v177
    v_add_f32 v178, 1.0, v178
    v_add_f32 v179, 1.0, v179
    v_add_f32 v180, 1.0, v180
    v_add_f32 v181, 1.0, v181
    v_add_f32 v182, 1.0, v182
    v_add_f32 v183, 1.0, v183
    v_add_f32 v184, 1.0, v184
    v_add_f32 v185, 1.0, v185
    v_rcp_f32 v159, v159
    v_rcp_f32 v160, v160
    v_rcp_f32 v161, v161
    v_rcp_f32 v162, v162
    v_rcp_f32 v163, v163
    v_rcp_f32 v164, v164
    v_rcp_f32 v165, v165
    v_rcp_f32 v166, v166
    v_rcp_f32 v167, v167
    v_rcp_f32 v168, v168
    v_rcp_f32 v169, v169
    v_rcp_f32 v170, v170
    v_rcp_f32 v171, v171
    v_rcp_f32 v172, v172
    v_rcp_f32 v173, v173
    v_rcp_f32 v174, v174
    v_rcp_f32 v175, v175
    v_rcp_f32 v176, v176
    v_rcp_f32 v177, v177
    v_rcp_f32 v178, v178
    v_rcp_f32 v179, v179
    v_rcp_f32 v180, v180
    v_rcp_f32 v181, v181
    v_rcp_f32 v182, v182
    v_rcp_f32 v183, v183
    v_rcp_f32 v184, v184
    v_rcp_f32 v185, v185
    v_mul_f32 v132, v132, v159
    v_mul_f32 v133, v133, v160
    v_mul_f32 v134, v134, v161
    v_mul_f32 v135, v135, v162
    v_mul_f32 v136, v136, v163
    v_mul_f32 v137, v137, v164
    v_mul_f32 v138, v138, v165
    v_mul_f32 v139, v139, v166
    v_mul_f32 v140, v140, v167
    v_mul_f32 v141, v141, v168
    v_mul_f32 v142, v142, v169
    v_mul_f32 v143, v143, v170
    v_mul_f32 v144, v144, v171
    v_mul_f32 v145, v145, v172
    v_mul_f32 v146, v146, v173
    v_mul_f32 v147, v147, v174
    v_mul_f32 v148, v148, v175
    v_mul_f32 v149, v149, v176
    v_mul_f32 v150, v150, v177
    v_mul_f32 v151, v151, v178
    v_mul_f32 v152, v152, v179
    v_mul_f32 v153, v153, v180
    v_mul_f32 v154, v154, v181
    v_mul_f32 v155, v155, v182
    v_mul_f32 v156, v156, v183
    v_mul_f32 v157, v157, v184
    v_mul_f32 v158, v158, v185
    v_cvt_pk_bf16_f32 v132, v132, 0
    v_cvt_pk_bf16_f32 v133, v133, 0
    v_cvt_pk_bf16_f32 v134, v134, 0
    v_cvt_pk_bf16_f32 v135, v135, 0
    v_cvt_pk_bf16_f32 v136, v136, 0
    v_cvt_pk_bf16_f32 v137, v137, 0
    v_cvt_pk_bf16_f32 v138, v138, 0
    v_cvt_pk_bf16_f32 v139, v139, 0
    v_cvt_pk_bf16_f32 v140, v140, 0
    v_cvt_pk_bf16_f32 v141, v141, 0
    v_cvt_pk_bf16_f32 v142, v142, 0
    v_cvt_pk_bf16_f32 v143, v143, 0
    v_cvt_pk_bf16_f32 v144, v144, 0
    v_cvt_pk_bf16_f32 v145, v145, 0
    v_cvt_pk_bf16_f32 v146, v146, 0
    v_cvt_pk_bf16_f32 v147, v147, 0
    v_cvt_pk_bf16_f32 v148, v148, 0
    v_cvt_pk_bf16_f32 v149, v149, 0
    v_cvt_pk_bf16_f32 v150, v150, 0
    v_cvt_pk_bf16_f32 v151, v151, 0
    v_cvt_pk_bf16_f32 v152, v152, 0
    v_cvt_pk_bf16_f32 v153, v153, 0
    v_cvt_pk_bf16_f32 v154, v154, 0
    v_cvt_pk_bf16_f32 v155, v155, 0
    v_cvt_pk_bf16_f32 v156, v156, 0
    v_cvt_pk_bf16_f32 v157, v157, 0
    v_cvt_pk_bf16_f32 v158, v158, 0
    v_lshlrev_b32 v159, 16, v132
    v_lshlrev_b32 v160, 16, v133
    v_lshlrev_b32 v161, 16, v134
    v_lshlrev_b32 v162, 16, v135
    v_lshlrev_b32 v163, 16, v136
    v_lshlrev_b32 v164, 16, v137
    v_lshlrev_b32 v165, 16, v138
    v_lshlrev_b32 v166, 16, v139
    v_lshlrev_b32 v167, 16, v140
    v_lshlrev_b32 v168, 16, v141
    v_lshlrev_b32 v169, 16, v142
    v_lshlrev_b32 v170, 16, v143
    v_lshlrev_b32 v171, 16, v144
    v_lshlrev_b32 v172, 16, v145
    v_lshlrev_b32 v173, 16, v146
    v_lshlrev_b32 v174, 16, v147
    v_lshlrev_b32 v175, 16, v148
    v_lshlrev_b32 v176, 16, v149
    v_lshlrev_b32 v177, 16, v150
    v_lshlrev_b32 v178, 16, v151
    v_lshlrev_b32 v179, 16, v152
    v_lshlrev_b32 v180, 16, v153
    v_lshlrev_b32 v181, 16, v154
    v_lshlrev_b32 v182, 16, v155
    v_lshlrev_b32 v183, 16, v156
    v_lshlrev_b32 v184, 16, v157
    v_lshlrev_b32_e64 v185, 16, v158
    v_dot2_f32_bf16 v8, v24, v132, 0
    v_dot2_f32_bf16 v9, v24, v159, 0
    v_dot2_f32_bf16 v10, v25, v132, 0
    v_dot2_f32_bf16 v11, v25, v159, 0
    v_dot2_f32_bf16 v12, v26, v132, 0
    v_dot2_f32_bf16 v13, v26, v159, 0
    v_dot2_f32_bf16 v14, v27, v132, 0
    v_dot2_f32_bf16 v15, v27, v159, 0
    v_dot2_f32_bf16 v8, v28, v133, v8
    v_dot2_f32_bf16 v9, v28, v160, v9
    v_dot2_f32_bf16 v10, v29, v133, v10
    v_dot2_f32_bf16 v11, v29, v160, v11
    v_dot2_f32_bf16 v12, v30, v133, v12
    v_dot2_f32_bf16 v13, v30, v160, v13
    v_dot2_f32_bf16 v14, v31, v133, v14
    v_dot2_f32_bf16 v15, v31, v160, v15
    v_dot2_f32_bf16 v8, v32, v134, v8
    v_dot2_f32_bf16 v9, v32, v161, v9
    v_dot2_f32_bf16 v10, v33, v134, v10
    v_dot2_f32_bf16 v11, v33, v161, v11
    v_dot2_f32_bf16 v12, v34, v134, v12
    v_dot2_f32_bf16 v13, v34, v161, v13
    v_dot2_f32_bf16 v14, v35, v134, v14
    v_dot2_f32_bf16 v15, v35, v161, v15
    v_dot2_f32_bf16 v8, v36, v135, v8
    v_dot2_f32_bf16 v9, v36, v162, v9
    v_dot2_f32_bf16 v10, v37, v135, v10
    v_dot2_f32_bf16 v11, v37, v162, v11
    v_dot2_f32_bf16 v12, v38, v135, v12
    v_dot2_f32_bf16 v13, v38, v162, v13
    v_dot2_f32_bf16 v14, v39, v135, v14
    v_dot2_f32_bf16 v15, v39, v162, v15
    s_waitcnt vmcnt(22)
    v_dot2_f32_bf16 v8, v40, v136, v8
    v_dot2_f32_bf16 v9, v40, v163, v9
    v_dot2_f32_bf16 v10, v41, v136, v10
    v_dot2_f32_bf16 v11, v41, v163, v11
    v_dot2_f32_bf16 v12, v42, v136, v12
    v_dot2_f32_bf16 v13, v42, v163, v13
    v_dot2_f32_bf16 v14, v43, v136, v14
    v_dot2_f32_bf16 v15, v43, v163, v15
    s_waitcnt vmcnt(21)
    v_dot2_f32_bf16 v8, v44, v137, v8
    v_dot2_f32_bf16 v9, v44, v164, v9
    v_dot2_f32_bf16 v10, v45, v137, v10
    v_dot2_f32_bf16 v11, v45, v164, v11
    v_dot2_f32_bf16 v12, v46, v137, v12
    v_dot2_f32_bf16 v13, v46, v164, v13
    v_dot2_f32_bf16 v14, v47, v137, v14
    v_dot2_f32_bf16 v15, v47, v164, v15
    s_waitcnt vmcnt(20)
    v_dot2_f32_bf16 v8, v48, v138, v8
    v_dot2_f32_bf16 v9, v48, v165, v9
    v_dot2_f32_bf16 v10, v49, v138, v10
    v_dot2_f32_bf16 v11, v49, v165, v11
    v_dot2_f32_bf16 v12, v50, v138, v12
    v_dot2_f32_bf16 v13, v50, v165, v13
    v_dot2_f32_bf16 v14, v51, v138, v14
    v_dot2_f32_bf16 v15, v51, v165, v15
    s_waitcnt vmcnt(19)
    v_dot2_f32_bf16 v8, v52, v139, v8
    v_dot2_f32_bf16 v9, v52, v166, v9
    v_dot2_f32_bf16 v10, v53, v139, v10
    v_dot2_f32_bf16 v11, v53, v166, v11
    v_dot2_f32_bf16 v12, v54, v139, v12
    v_dot2_f32_bf16 v13, v54, v166, v13
    v_dot2_f32_bf16 v14, v55, v139, v14
    v_dot2_f32_bf16 v15, v55, v166, v15
    s_waitcnt vmcnt(18)
    v_dot2_f32_bf16 v8, v56, v140, v8
    v_dot2_f32_bf16 v9, v56, v167, v9
    v_dot2_f32_bf16 v10, v57, v140, v10
    v_dot2_f32_bf16 v11, v57, v167, v11
    v_dot2_f32_bf16 v12, v58, v140, v12
    v_dot2_f32_bf16 v13, v58, v167, v13
    v_dot2_f32_bf16 v14, v59, v140, v14
    v_dot2_f32_bf16 v15, v59, v167, v15
    s_waitcnt vmcnt(17)
    v_dot2_f32_bf16 v8, v60, v141, v8
    v_dot2_f32_bf16 v9, v60, v168, v9
    v_dot2_f32_bf16 v10, v61, v141, v10
    v_dot2_f32_bf16 v11, v61, v168, v11
    v_dot2_f32_bf16 v12, v62, v141, v12
    v_dot2_f32_bf16 v13, v62, v168, v13
    v_dot2_f32_bf16 v14, v63, v141, v14
    v_dot2_f32_bf16 v15, v63, v168, v15
    s_waitcnt vmcnt(16)
    v_dot2_f32_bf16 v8, v64, v142, v8
    v_dot2_f32_bf16 v9, v64, v169, v9
    v_dot2_f32_bf16 v10, v65, v142, v10
    v_dot2_f32_bf16 v11, v65, v169, v11
    v_dot2_f32_bf16 v12, v66, v142, v12
    v_dot2_f32_bf16 v13, v66, v169, v13
    v_dot2_f32_bf16 v14, v67, v142, v14
    v_dot2_f32_bf16 v15, v67, v169, v15
    s_waitcnt vmcnt(15)
    v_dot2_f32_bf16 v8, v68, v143, v8
    v_dot2_f32_bf16 v9, v68, v170, v9
    v_dot2_f32_bf16 v10, v69, v143, v10
    v_dot2_f32_bf16 v11, v69, v170, v11
    v_dot2_f32_bf16 v12, v70, v143, v12
    v_dot2_f32_bf16 v13, v70, v170, v13
    v_dot2_f32_bf16 v14, v71, v143, v14
    v_dot2_f32_bf16 v15, v71, v170, v15
    s_waitcnt vmcnt(14)
    v_dot2_f32_bf16 v8, v72, v144, v8
    v_dot2_f32_bf16 v9, v72, v171, v9
    v_dot2_f32_bf16 v10, v73, v144, v10
    v_dot2_f32_bf16 v11, v73, v171, v11
    v_dot2_f32_bf16 v12, v74, v144, v12
    v_dot2_f32_bf16 v13, v74, v171, v13
    v_dot2_f32_bf16 v14, v75, v144, v14
    v_dot2_f32_bf16 v15, v75, v171, v15
    s_waitcnt vmcnt(13)
    v_dot2_f32_bf16 v8, v76, v145, v8
    v_dot2_f32_bf16 v9, v76, v172, v9
    v_dot2_f32_bf16 v10, v77, v145, v10
    v_dot2_f32_bf16 v11, v77, v172, v11
    v_dot2_f32_bf16 v12, v78, v145, v12
    v_dot2_f32_bf16 v13, v78, v172, v13
    v_dot2_f32_bf16 v14, v79, v145, v14
    v_dot2_f32_bf16 v15, v79, v172, v15
    s_waitcnt vmcnt(12)
    v_dot2_f32_bf16 v8, v80, v146, v8
    v_dot2_f32_bf16 v9, v80, v173, v9
    v_dot2_f32_bf16 v10, v81, v146, v10
    v_dot2_f32_bf16 v11, v81, v173, v11
    v_dot2_f32_bf16 v12, v82, v146, v12
    v_dot2_f32_bf16 v13, v82, v173, v13
    v_dot2_f32_bf16 v14, v83, v146, v14
    v_dot2_f32_bf16 v15, v83, v173, v15
    s_waitcnt vmcnt(11)
    v_dot2_f32_bf16 v8, v84, v147, v8
    v_dot2_f32_bf16 v9, v84, v174, v9
    v_dot2_f32_bf16 v10, v85, v147, v10
    v_dot2_f32_bf16 v11, v85, v174, v11
    v_dot2_f32_bf16 v12, v86, v147, v12
    v_dot2_f32_bf16 v13, v86, v174, v13
    v_dot2_f32_bf16 v14, v87, v147, v14
    v_dot2_f32_bf16 v15, v87, v174, v15
    s_waitcnt vmcnt(10)
    v_dot2_f32_bf16 v8, v88, v148, v8
    v_dot2_f32_bf16 v9, v88, v175, v9
    v_dot2_f32_bf16 v10, v89, v148, v10
    v_dot2_f32_bf16 v11, v89, v175, v11
    v_dot2_f32_bf16 v12, v90, v148, v12
    v_dot2_f32_bf16 v13, v90, v175, v13
    v_dot2_f32_bf16 v14, v91, v148, v14
    v_dot2_f32_bf16 v15, v91, v175, v15
    s_waitcnt vmcnt(9)
    v_dot2_f32_bf16 v8, v92, v149, v8
    v_dot2_f32_bf16 v9, v92, v176, v9
    v_dot2_f32_bf16 v10, v93, v149, v10
    v_dot2_f32_bf16 v11, v93, v176, v11
    v_dot2_f32_bf16 v12, v94, v149, v12
    v_dot2_f32_bf16 v13, v94, v176, v13
    v_dot2_f32_bf16 v14, v95, v149, v14
    v_dot2_f32_bf16 v15, v95, v176, v15
    s_waitcnt vmcnt(8)
    v_dot2_f32_bf16 v8, v96, v150, v8
    v_dot2_f32_bf16 v9, v96, v177, v9
    v_dot2_f32_bf16 v10, v97, v150, v10
    v_dot2_f32_bf16 v11, v97, v177, v11
    v_dot2_f32_bf16 v12, v98, v150, v12
    v_dot2_f32_bf16 v13, v98, v177, v13
    v_dot2_f32_bf16 v14, v99, v150, v14
    v_dot2_f32_bf16 v15, v99, v177, v15
    s_waitcnt vmcnt(7)
    v_dot2_f32_bf16 v8, v100, v151, v8
    v_dot2_f32_bf16 v9, v100, v178, v9
    v_dot2_f32_bf16 v10, v101, v151, v10
    v_dot2_f32_bf16 v11, v101, v178, v11
    v_dot2_f32_bf16 v12, v102, v151, v12
    v_dot2_f32_bf16 v13, v102, v178, v13
    v_dot2_f32_bf16 v14, v103, v151, v14
    v_dot2_f32_bf16 v15, v103, v178, v15
    s_waitcnt vmcnt(6)
    v_dot2_f32_bf16 v8, v104, v152, v8
    v_dot2_f32_bf16 v9, v104, v179, v9
    v_dot2_f32_bf16 v10, v105, v152, v10
    v_dot2_f32_bf16 v11, v105, v179, v11
    v_dot2_f32_bf16 v12, v106, v152, v12
    v_dot2_f32_bf16 v13, v106, v179, v13
    v_dot2_f32_bf16 v14, v107, v152, v14
    v_dot2_f32_bf16 v15, v107, v179, v15
    s_waitcnt vmcnt(5)
    v_dot2_f32_bf16 v8, v108, v153, v8
    v_dot2_f32_bf16 v9, v108, v180, v9
    v_dot2_f32_bf16 v10, v109, v153, v10
    v_dot2_f32_bf16 v11, v109, v180, v11
    v_dot2_f32_bf16 v12, v110, v153, v12
    v_dot2_f32_bf16 v13, v110, v180, v13
    v_dot2_f32_bf16 v14, v111, v153, v14
    v_dot2_f32_bf16 v15, v111, v180, v15
    s_waitcnt vmcnt(4)
    v_dot2_f32_bf16 v8, v112, v154, v8
    v_dot2_f32_bf16 v9, v112, v181, v9
    v_dot2_f32_bf16 v10, v113, v154, v10
    v_dot2_f32_bf16 v11, v113, v181, v11
    v_dot2_f32_bf16 v12, v114, v154, v12
    v_dot2_f32_bf16 v13, v114, v181, v13
    v_dot2_f32_bf16 v14, v115, v154, v14
    v_dot2_f32_bf16 v15, v115, v181, v15
    s_waitcnt vmcnt(3)
    v_dot2_f32_bf16 v8, v116, v155, v8
    v_dot2_f32_bf16 v9, v116, v182, v9
    v_dot2_f32_bf16 v10, v117, v155, v10
    v_dot2_f32_bf16 v11, v117, v182, v11
    v_dot2_f32_bf16 v12, v118, v155, v12
    v_dot2_f32_bf16 v13, v118, v182, v13
    v_dot2_f32_bf16 v14, v119, v155, v14
    v_dot2_f32_bf16 v15, v119, v182, v15
    s_waitcnt vmcnt(2)
    v_dot2_f32_bf16 v8, v120, v156, v8
    v_dot2_f32_bf16 v9, v120, v183, v9
    v_dot2_f32_bf16 v10, v121, v156, v10
    v_dot2_f32_bf16 v11, v121, v183, v11
    v_dot2_f32_bf16 v12, v122, v156, v12
    v_dot2_f32_bf16 v13, v122, v183, v13
    v_dot2_f32_bf16 v14, v123, v156, v14
    v_dot2_f32_bf16 v15, v123, v183, v15
    s_waitcnt vmcnt(1)
    v_dot2_f32_bf16 v8, v124, v157, v8
    v_dot2_f32_bf16 v9, v124, v184, v9
    v_dot2_f32_bf16 v10, v125, v157, v10
    v_dot2_f32_bf16 v11, v125, v184, v11
    v_dot2_f32_bf16 v12, v126, v157, v12
    v_dot2_f32_bf16 v13, v126, v184, v13
    v_dot2_f32_bf16 v14, v127, v157, v14
    v_dot2_f32_bf16 v15, v127, v184, v15
    s_waitcnt vmcnt(0)
    v_dot2_f32_bf16 v8, v128, v158, v8
    v_dot2_f32_bf16 v9, v128, v185, v9
    v_dot2_f32_bf16 v10, v129, v158, v10
    v_dot2_f32_bf16 v11, v129, v185, v11
    v_dot2_f32_bf16 v12, v130, v158, v12
    v_dot2_f32_bf16 v13, v130, v185, v13
    v_dot2_f32_bf16 v14, v131, v158, v14
    v_dot2_f32_bf16 v15, v131, v185, v15
    ds_write_b128 v6, v[8:11]
    s_nop 1
    ds_write_b128 v6, v[12:15] offset:16
    s_mov_b64 exec, -1
    v_mul_u32_u24 v7, 410, v0
    v_lshrrev_b32 v7, 16, v7
    v_mul_u32_u24 v7, 4480, v7
    v_lshl_add_u32 v7, v0, 2, v7
    s_waitcnt lgkmcnt(0)
    s_barrier
    ds_read_b32 v24, v7 offset:0
    ds_read_b32 v25, v7 offset:640
    ds_read_b32 v26, v7 offset:1280
    ds_read_b32 v27, v7 offset:1920
    ds_read_b32 v28, v7 offset:2560
    ds_read_b32 v29, v7 offset:3200
    ds_read_b32 v30, v7 offset:3840
    ds_read_b32 v31, v7 offset:4480
    v_lshlrev_b32 v8, 2, v0
    s_waitcnt lgkmcnt(0)
    v_add_f32 v24, v24, v28
    v_add_f32 v25, v25, v29
    v_add_f32 v26, v26, v30
    v_add_f32 v27, v27, v31
    v_add_f32 v24, v24, v26
    v_add_f32 v25, v25, v27
    v_add_f32_e64 v24, v24, v25
    ds_write_b32 v8, v24 offset:20480
    s_waitcnt lgkmcnt(0)
    s_barrier
    s_cmp_eq_u32 s48, 0
    s_cbranch_scc0 kf_kernel_a_end
    s_mov_b32 exec_hi, 0xff
    ds_read_b128 v[8:11], v3 offset:20480
    ds_read_b128 v[12:15], v3 offset:21120
    ds_read_b128 v[16:19], v3 offset:21760
    s_waitcnt lgkmcnt(0)
    v_pk_add_f32 v[8:9], v[8:9], v[12:13]
    v_pk_add_f32 v[10:11], v[10:11], v[14:15]
    v_pk_add_f32 v[8:9], v[8:9], v[16:17]
    v_pk_add_f32 v[10:11], v[10:11], v[18:19]
    v_cvt_pk_bf16_f32 v9, v8, v9
    v_cvt_pk_bf16_f32 v11, v10, v11
    v_lshlrev_b32 v8, 16, v9
    v_and_b32 v9, 0xffff0000, v9
    v_lshlrev_b32_e64 v10, 16, v11
    v_and_b32 v11, 0xffff0000, v11
    s_lshr_b32 s51, s2, 2
    s_cmp_eq_u32 s51, 2
    s_cselect_b32 s51, 1.0, 0
    v_add_f32 v8, s51, v8
    v_add_f32 v9, s51, v9
    v_add_f32 v10, s51, v10
    v_add_f32_e64 v11, s51, v11
    v_cvt_pk_bf16_f32 v9, v8, v9
    v_cvt_pk_bf16_f32 v11, v10, v11
    v_lshlrev_b32_e64 v8, 16, v9
    v_and_b32 v9, 0xffff0000, v9
    v_lshlrev_b32_e64 v10, 16, v11
    v_and_b32 v11, 0xffff0000, v11
    s_mul_i32 s51, s2, 640
    s_add_u32 s51, s51, 37888
    buffer_store_dwordx4 v[8:11], v3, s[8:11], s51 offen sc1
    s_sub_u32 s51, s2, 4
    s_cmp_lt_u32 s51, zlit_b-zlit_a+(8)
    s_cbranch_scc0 kf_kernel_a_end
    v_cvt_pk_bf16_f32 v12, v8, v9
    v_cvt_pk_bf16_f32 v13, v10, v11
    v_cmp_le_u32 vcc, 20, v2
    s_nop 1
    v_cndmask_b32 v14, 0, 1, vcc
    v_mul_u32_u24 v15, 20, v14
    v_sub_u32 v15, v2, v15
    v_and_b32 v16, 3, v15
    v_lshrrev_b32 v15, 2, v15
    v_lshlrev_b32_e64 v17, 8, v14
    v_lshl_add_u32 v17, v15, 3, v17
    v_add_u32 v18, 104, v17
    v_cmp_lt_u32 vcc, 2, v15
    s_nop 1
    v_cndmask_b32 v17, v17, v18, vcc
    v_lshlrev_b32 v18, 3, v14
    v_add_u32 v18, 512, v18
    v_cmp_eq_u32 vcc, 2, v15
    s_nop 1
    v_cndmask_b32_e64 v17, v17, v18, vcc
    v_lshl_add_u32 v17, v16, 4, v17
    s_and_b32 s52, s51, zlit_b-zlit_a+(3)
    s_mul_i32 s52, s52, 640
    s_cmp_lt_u32 s51, 4
    s_cselect_b32 s51, 64, zlit_b-zlit_a+(0)
    s_add_u32 s51, s51, s52
    s_add_u32 s51, s51, 49152
    buffer_store_dwordx2 v[12:13], v17, s[8:11], s51 offen sc1
kf_kernel_a_end:
    s_mov_b64 exec, -1
    s_load_dwordx2 s[8:9], s[0:1], 96
    s_load_dwordx2 s[12:13], s[0:1], 40
    s_load_dwordx2 s[4:5], s[0:1], 56
    s_load_dwordx2 s[80:81], s[0:1], 0
    s_and_b32 s67, s2, 7
    s_lshl_b32 s65, s67, 2
    s_lshr_b32 s67, s2, 3
    s_and_b32 s67, s67, 3
    s_add_u32 s65, s65, s67
    s_lshr_b32 s66, s2, 5
    s_lshl_b32 s66, s66, 3
    s_mov_b32 s64, s61
    v_and_b32 v4, 31, v2
    v_lshlrev_b32 v4, 4, v4
    v_lshrrev_b32 v123, 5, v2
    v_lshl_add_u32 v4, v123, 3, v4
    v_lshlrev_b32 v123, 3, v2
    s_lshr_b32 s3, s65, 1
    s_add_u32 s66, s66, s64
    s_lshl_b32 s87, s65, 16
    s_add_u32 s87, s87, 15659008
    s_lshl_b32 s88, s3, zlit_b-zlit_a+(15)
    s_add_u32 s88, s88, 17756160
    s_mul_i32 s89, s65, 81920
    s_add_u32 s89, s89, 18280448
    s_lshl_b32 s84, s64, 10
    s_add_u32 s72, s87, s84
    s_mov_b32 s75, 8192
    s_add_u32 s85, s84, 8192
    s_add_u32 s67, s88, s84
    s_add_u32 s68, s89, s84
    s_sub_u32 s68, s68, 4096
    s_cmp_lt_u32 s64, zlit_b-zlit_a+(4)
    s_cselect_b32 s73, s67, s68
    s_movk_i32 s76, 4096
    s_cselect_b32 s76, s76, 10240
    s_add_u32 s67, s68, 8192
    s_add_u32 s86, s84, 16384
    s_cmp_lt_u32 s64, zlit_b-zlit_a+(6)
    s_cselect_b32 s74, s67, s68
    s_cselect_b32 s86, s86, s85
    s_mov_b32 s77, 10240
    s_mov_b32 s10, 268435456
    s_mov_b32 s11, 0x00020000
    s_lshl_b32 s67, s65, 6
    s_add_u32 s67, s67, s66
    s_lshl_b32 s67, s67, zlit_b-zlit_a+(10)
    s_add_u32 s67, s67, 13037568
    s_lshl_b32 s68, s3, 6
    s_add_u32 s68, s68, s66
    s_lshl_b32 s68, s68, zlit_b-zlit_a+(9)
    s_add_u32 s68, s68, 15134720
    s_mul_i32 s30, s65, 20
    s_lshr_b32 s29, s30, 4
    s_and_b32 s29, s29, zlit_b-zlit_a+(8)
    s_lshl_b32 s28, 0xff, s29
    s_add_u32 s30, s30, 19
    s_lshr_b32 s29, s30, 4
    s_and_b32 s29, s29, zlit_b-zlit_a+(8)
    s_lshl_b32 s29, 0xff, s29
    s_or_b32 s28, s28, s29
    s_lshr_b32 s29, s2, 5
    s_lshl_b32 s30, 0x0101, s29
    s_and_b32 s30, s30, s28
    s_lshl_b32 s70, s28, 16
    s_or_b32 s30, s30, s70
    s_lshl_b32 s70, s65, 3
    s_and_b32 s29, s29, 0
    s_add_u32 s29, s29, s70
    s_lshl_b32 s29, s29, zlit_b-zlit_a+(9)
    s_add_u32 s29, s29, 36143104
    s_lshl_b32 s63, s2, zlit_b-zlit_a+(2)
    s_add_u32 s63, s63, 36278272
    v_lshlrev_b32 v120, 9, v2
    v_lshlrev_b32 v121, 10, v2
    v_mov_b32 v122, s100
    s_mov_b32 s70, 0
    s_cmp_eq_u32 s64, 0
    s_waitcnt vmcnt(0) lgkmcnt(0)
    s_barrier
    s_cbranch_scc0 kf_kernel_b_go0
    s_mov_b32 exec_lo, 0x1010101
    s_mov_b32 exec_hi, 0x1010101
    buffer_store_dword v122, v120, s[8:11], s101 offen sc1
    s_mov_b64 exec, 0xff
    buffer_store_dword v122, v121, s[8:11], s63 offen sc1
    s_mov_b32 exec_lo, s30
    s_mov_b32 exec_hi, s28
kf_kernel_b_poll0:
    buffer_load_dwordx2 v[124:125], v123, s[8:11], s29 offen sc1
    s_add_u32 s70, s70, zlit_b-zlit_a+(1)
    s_cmp_lt_u32 s70, 0x40000
    s_waitcnt vmcnt(0)
    v_xor_b32 v124, v124, v122
    v_bitop3_b32 v124, v124, v125, v122 bitop3:0xf6
    v_cmp_ne_u32_e64 vcc, 0, v124
    s_cbranch_vccz kf_kernel_b_go0
    s_sleep 1
    s_cbranch_scc1 kf_kernel_b_poll0
kf_kernel_b_go0:
    s_mov_b64 exec, -1
    s_barrier
    s_waitcnt lgkmcnt(0)
    buffer_load_dwordx4 v[12:15], v3, s[8:11], s67 offen sc1
    buffer_load_dwordx2 v[10:11], v4, s[8:11], s68 offen sc1
    s_add_u32 m0, s84, 0
    s_nop 0
    buffer_load_dwordx4 v3, s[8:11], s72 offen sc1 lds
    s_add_u32 s72, s72, s75
    s_add_u32 m0, s85, zlit_b-zlit_a+(0)
    s_nop 0
    buffer_load_dwordx4 v3, s[8:11], s73 offen sc1 lds
    s_add_u32 s73, s73, s76
    s_add_u32 m0, s86, zlit_b-zlit_a+(0)
    s_nop 0
    buffer_load_dwordx4 v3, s[8:11], s74 offen sc1 lds
    s_add_u32 s74, s74, s77
    s_add_u32 m0, s84, 22528
    s_nop 0
    buffer_load_dwordx4 v3, s[8:11], s72 offen sc1 lds
    s_add_u32 s72, s72, s75
    s_add_u32 m0, s85, 22528
    s_nop 0
    buffer_load_dwordx4 v3, s[8:11], s73 offen sc1 lds
    s_add_u32 s73, s73, s76
    s_add_u32 m0, s86, 22528
    s_nop 0
    buffer_load_dwordx4 v3, s[8:11], s74 offen sc1 lds
    s_add_u32 s74, s74, s77
    s_and_b32 s16, s2, 6
    s_lshl_b32 s16, s16, zlit_b-zlit_a+(2)
    s_bfe_u32 s67, s2, 0x30003
    s_add_u32 s16, s16, s67
    s_and_b32 s17, s2, 1
    s_lshl_b32 s17, s17, 2
    s_lshr_b32 s67, s2, 6
    s_add_u32 s17, s17, s67
    s_and_b32 s25, s2, 6
    s_lshl_b32 s25, s25, zlit_b-zlit_a+(2)
    s_bfe_u32 s67, s2, 0x30003
    s_add_u32 s25, s25, s67
    s_and_b32 s26, s2, 1
    s_lshl_b32 s26, s26, 2
    s_lshr_b32 s67, s2, zlit_b-zlit_a+(6)
    s_add_u32 s26, s26, s67
    s_mov_b32 s14, 8388608
    s_mov_b32 s15, 0x00020000
    s_mov_b32 s6, 1105920
    s_mov_b32 s7, 0x00020000
    s_mov_b32 s82, 2621440
    s_mov_b32 s83, 0x00020000
    s_mul_i32 s27, s26, 102400
    s_add_u32 s27, s27, 2674688
    s_add_u32 s27, s27, s84
    s_mov_b32 s78, 0x000fffff
    s_mov_b32 s79, 0x000fffff
    v_lshrrev_b32 v116, 5, v2
    v_and_b32_e64 v9, 31, v2
    v_mul_u32_u24 v5, 320, v116
    v_lshl_add_u32 v5, v9, 4, v5
    v_cmp_eq_u32_e64 vcc, 20, v9
    v_mov_b32 v84, 0x3f803f80
    s_nop 0
    v_cndmask_b32 v84, 0, v84, vcc
    v_mov_b32 v100, v84
    v_mov_b32 v64, 0
    v_mov_b32 v101, v84
    v_mov_b32 v65, 0
    v_mov_b32 v102, v84
    v_mov_b32 v66, 0
    v_mov_b32 v103, v84
    v_mov_b32 v67, 0
    v_mov_b32 v104, v84
    v_mov_b32 v68, 0
    v_mov_b32 v105, v84
    v_mov_b32 v69, 0
    v_mov_b32 v106, v84
    v_mov_b32 v70, 0
    v_mov_b32 v107, v84
    v_mov_b32 v71, 0
    v_mov_b32 v108, v84
    v_mov_b32 v72, 0
    v_mov_b32 v109, v84
    v_mov_b32 v73, 0
    v_mov_b32 v110, v84
    v_mov_b32 v74, 0
    v_mov_b32 v111, v84
    v_mov_b32 v75, 0
    v_mov_b32 v112, v84
    v_mov_b32 v76, 0
    v_mov_b32 v113, v84
    v_mov_b32 v77, 0
    v_mov_b32 v114, v84
    v_mov_b32 v78, 0
    v_mov_b32 v115, v84
    v_mov_b32 v79, 0
    v_add_u32 v6, 162816, v3
    ds_write_b128 v6, v[64:67]
    v_mov_b32_e64 v6, v3
    v_add_u32 v7, 8192, v4
    v_add_u32 v8, 12288, v5
    v_and_b32 v131, 15, v2
    v_lshrrev_b32 v130, 4, v2
    v_lshlrev_b32_e64 v128, 12, v131
    v_lshl_add_u32 v128, v130, 4, v128
    s_lshl_b32 s28, s2, 3
    s_add_u32 s28, s28, s64
    s_lshr_b32 s30, s28, 4
    s_and_b32 s29, s28, 15
    s_lshl_b32 s71, s30, 16
    s_lshl_b32 s67, s29, 8
    s_add_u32 s71, s71, s67
    s_lshr_b32 s18, s30, 2
    s_and_b32 s67, s18, 0
    s_sub_u32 s67, s29, s67
    s_and_b32 s67, s67, 3
    s_and_b32 s68, s29, 12
    s_or_b32 s67, s67, s68
    s_lshl_b32 s18, s18, 18
    s_lshl_b32 s67, s67, 14
    s_add_u32 s18, s18, s67
    s_lshr_b32 s67, s29, 2
    s_xor_b32 s67, s67, s30
    s_and_b32 s67, s67, 3
    s_lshl_b32 s67, s67, zlit_b-zlit_a+(10)
    s_add_u32 s18, s18, s67
    s_add_u32 s18, s18, 4648960
    v_mul_u32_u24 v129, 5120, v130
    v_lshl_add_u32 v129, v131, 2, v129
    s_lshl_b32 s28, s64, 8
    s_add_u32 s28, s28, s2
    s_mul_i32 s29, s28, 3277
    s_lshr_b32 s29, s29, 16
    s_mul_i32 s67, s29, 20
    s_sub_u32 s21, s28, s67
    s_mul_i32 s30, s29, 37
    s_lshr_b32 s30, s30, 8
    s_mul_i32 s67, s30, 7
    s_sub_u32 s31, s29, s67
    s_lshl_b32 s19, s31, 5
    s_cmp_ge_u32 s31, 3
    s_cselect_b32 s67, 16, 0
    s_add_u32 s19, s19, s67
    s_cmp_lt_u32 s31, 6
    s_cselect_b32 s19, s19, 96
    s_cselect_b32 s20, 16, 112
    s_mul_i32 s30, s30, 224
    s_add_u32 s19, s19, s30
    s_mul_i32 s19, s19, 1280
    s_lshl_b32 s67, s21, zlit_b-zlit_a+(6)
    s_add_u32 s19, s19, s67
    s_cmp_lt_u32 s28, 560
    s_cselect_b32 s19, s19, 0x40000000
    s_mul_i32 s20, s20, 1280
    s_add_u32 s20, s20, s19
    s_lshl_b32 s21, s21, zlit_b-zlit_a+(1)
    s_mul_i32 s29, s29, 5120
    s_add_u32 s29, s29, 3502080
    s_cmp_lt_u32 s28, 560
    s_cselect_b32 s70, s29, 0x40000000
    v_lshrrev_b32 v156, 3, v131
    v_add_u32_e64 v156, s21, v156
    v_mul_u32_u24 v157, 205, v156
    v_lshrrev_b32_e64 v157, 10, v157
    v_mul_u32_u24 v157, 138240, v157
    v_lshl_add_u32 v156, v156, 10, v157
    v_lshl_add_u32 v156, v130, 8, v156
    v_and_b32_e64 v157, 7, v2
    v_lshl_add_u32 v156, v157, 5, v156
    s_lshr_b32 s67, s64, 2
    s_lshl_b32 s22, s17, 1
    s_sub_u32 s22, s22, s67
    s_add_u32 s22, s22, 1
    s_mul_i32 s22, s22, 143360
    s_and_b32 s67, s64, zlit_b-zlit_a+(3)
    s_mul_i32 s68, s67, 40960
    s_add_u32 s22, s22, s68
    s_add_u32 s22, s22, 315392
    s_cmp_eq_u32 s67, zlit_b-zlit_a+(3)
    s_movk_i32 s23, 4096
    s_cselect_b32 s23, 3221209088, s23
    s_cselect_b32 s68, 0x40000000, 0
    s_add_u32 s22, s22, s68
    s_lshl_b32 s24, s67, zlit_b-zlit_a+(10)
    s_add_u32 s68, s24, 49152
    v_add_u32_e64 v131, s68, v3
    s_add_u32 s24, s24, 157696
    s_mul_i32 s68, s26, 320
    s_add_u32 s68, s68, 37888
    v_add_u32_e64 v130, s68, v3
    v_add_u32 v85, 4800, v130
    v_cmp_le_u32 vcc, 20, v2
    s_nop 1
    v_cndmask_b32_e64 v130, v130, v85, vcc
    v_add_u32 v85, 2240, v130
    v_cmp_le_u32 vcc, 40, v2
    s_nop 1
    v_cndmask_b32 v130, v130, v85, vcc
    s_cmp_eq_u32 s67, 3
    s_cselect_b64 vcc, -1, 0
    v_cndmask_b32 v130, v131, v130, vcc
    s_and_b32 s63, s2, 7
    s_lshl_b32 s63, s63, 10
    s_add_u32 s63, s63, 36278272
    s_add_u32 s62, s2, s64
    s_cmp_eq_u32 s62, 0
    s_mov_b32 s62, 28672
    s_cselect_b32 s62, s62, 0x40000000
    s_and_b32 s67, s65, 1
    v_cmp_eq_u32 vcc, s67, v116
    s_waitcnt vmcnt(6)
    s_nop 0
    v_cndmask_b32 v10, 0, v10, vcc
    v_cndmask_b32_e64 v11, 0, v11, vcc
    s_waitcnt vmcnt(3)
    s_barrier
    ds_read_b128 v[88:91], v6 offset:0
    ds_read_b64 v[96:97], v7 offset:0
    ds_read_b128 v[92:95], v6 offset:1024
    ds_read_b64 v[98:99], v7 offset:512
    s_mov_b64 exec, s[78:79]
    ds_read_b128 v[100:103], v8 offset:0
    ds_read_b128 v[104:107], v8 offset:640
    s_mov_b64 exec, -1
    s_add_u32 m0, s84, 45056
    s_nop 0
    buffer_load_dwordx4 v3, s[8:11], s72 offen sc1 lds
    s_add_u32 s72, s72, s75
    s_add_u32 m0, s85, 45056
    s_nop 0
    buffer_load_dwordx4 v3, s[8:11], s73 offen sc1 lds
    s_add_u32 s73, s73, s76
    s_add_u32 m0, s86, 45056
    s_nop 0
    buffer_load_dwordx4 v3, s[8:11], s74 offen sc1 lds
    s_add_u32 s74, s74, s77
    s_waitcnt lgkmcnt(4)
    v_mfma_f32_32x32x16_bf16 v[32:47], v[88:91], v[12:15], 0
    v_mfma_f32_32x32x8bf16_1k v[32:47], v[96:97], v[10:11], v[32:47]
    s_nop 11
    v_max3_f32 v84, v32, v33, v34
    v_max3_f32 v85, v35, v36, v37
    v_max3_f32 v84, v84, v38, v39
    v_max3_f32 v85, v85, v40, v41
    v_max3_f32 v84, v84, v42, v43
    v_max3_f32 v85, v85, v44, v45
    v_max3_f32 v84, v84, v46, v47
    v_max_f32 v84, v84, v85
    v_mov_b32 v85, v84
    v_mov_b32 v86, v84
    s_nop 1
    v_permlane32_swap_b32 v85, v86
    v_max_f32 v85, v85, v86
    v_sub_f32 v16, 0, v85
    v_mov_b32 v17, v16
    v_mov_b32 v18, v16
    v_mov_b32 v19, v16
    v_mov_b32 v20, v16
    v_mov_b32 v21, v16
    v_mov_b32 v22, v16
    v_mov_b32 v23, v16
    v_mov_b32 v24, v16
    v_mov_b32 v25, v16
    v_mov_b32 v26, v16
    v_mov_b32 v27, v16
    v_mov_b32 v28, v16
    v_mov_b32 v29, v16
    v_mov_b32 v30, v16
    v_mov_b32 v31, v16
    v_mov_b32 v84, 0
    v_mov_b32 v85, 0
    v_mov_b32 v86, 0
    v_mov_b32 v87, 0
    v_mfma_f32_32x32x16_bf16 v[32:47], v[88:91], v[12:15], v[16:31]
    v_mfma_f32_32x32x8bf16_1k v[32:47], v[96:97], v[10:11], v[32:47]
    s_waitcnt lgkmcnt(2)
    s_nop 7
    v_mfma_f32_32x32x16_bf16 v[48:63], v[92:95], v[12:15], v[16:31]
    s_nop 1
    v_exp_f32 v32, v32
    v_exp_f32 v33, v33
    v_exp_f32 v34, v34
    v_exp_f32_e64 v35, v35
    v_mfma_f32_32x32x16_bf16 v[64:79], v[112:115], v[84:87], v[64:79]
    s_setprio 3
    s_add_u32 m0, s84, 67584
    s_nop 0
    buffer_load_dwordx4 v3, s[8:11], s72 offen sc1 lds
    s_add_u32 s72, s72, s75
    v_exp_f32 v36, v36
    v_exp_f32 v37, v37
    v_exp_f32 v38, v38
    v_exp_f32_e64 v39, v39
    v_cvt_pk_bf16_f32 v80, v32, v33
    v_cvt_pk_bf16_f32 v81, v34, v35
    v_cvt_pk_bf16_f32 v82, v36, v37
    v_cvt_pk_bf16_f32 v83, v38, v39
    v_mfma_f32_32x32x8bf16_1k v[48:63], v[98:99], v[10:11], v[48:63]
    ds_read_b128 v[88:91], v6 offset:2048
    ds_read_b64 v[96:97], v7 offset:1024
    s_add_u32 m0, s85, 67584
    s_nop 0
    buffer_load_dwordx4 v3, s[8:11], s73 offen sc1 lds
    s_add_u32 s73, s73, s76
    v_exp_f32 v40, v40
    v_exp_f32 v41, v41
    v_exp_f32 v42, v42
    v_exp_f32_e64 v43, v43
    s_waitcnt lgkmcnt(2)
    v_mfma_f32_32x32x16_bf16 v[64:79], v[100:103], v[80:83], v[64:79]
    s_add_u32 m0, s86, 67584
    s_nop 0
    buffer_load_dwordx4 v3, s[8:11], s74 offen sc1 lds
    s_add_u32 s74, s74, s77
    v_exp_f32 v44, v44
    s_mov_b64 exec, s[78:79]
    ds_read_b128 v[108:111], v8 offset:1280
    ds_read_b128 v[112:115], v8 offset:1920
    s_mov_b64 exec, -1
    v_exp_f32 v45, v45
    v_exp_f32 v46, v46
    v_exp_f32_e64 v47, v47
    s_waitcnt lgkmcnt(2)
    v_cvt_pk_bf16_f32 v84, v40, v41
    v_cvt_pk_bf16_f32 v85, v42, v43
    v_cvt_pk_bf16_f32 v86, v44, v45
    v_cvt_pk_bf16_f32 v87, v46, v47
    v_mfma_f32_32x32x16_bf16 v[32:47], v[88:91], v[12:15], v[16:31]
    v_exp_f32 v48, v48
    v_exp_f32 v49, v49
    v_exp_f32 v50, v50
    v_exp_f32 v51, v51
    v_mfma_f32_32x32x16_bf16 v[64:79], v[104:107], v[84:87], v[64:79]
    s_setprio 2
    s_add_u32 m0, s84, 90112
    s_nop 0
    buffer_load_dwordx4 v3, s[8:11], s72 offen sc1 lds
    s_add_u32 s72, s72, s75
    v_exp_f32 v52, v52
    v_exp_f32 v53, v53
    v_exp_f32 v54, v54
    v_exp_f32_e64 v55, v55
    v_cvt_pk_bf16_f32 v80, v48, v49
    v_cvt_pk_bf16_f32 v81, v50, v51
    v_cvt_pk_bf16_f32 v82, v52, v53
    v_cvt_pk_bf16_f32 v83, v54, v55
    v_mfma_f32_32x32x8bf16_1k v[32:47], v[96:97], v[10:11], v[32:47]
    ds_read_b128 v[92:95], v6 offset:3072
    ds_read_b64 v[98:99], v7 offset:1536
    s_add_u32 m0, s85, 90112
    s_nop 0
    buffer_load_dwordx4 v3, s[8:11], s73 offen sc1 lds
    s_add_u32 s73, s73, s76
    v_exp_f32 v56, v56
    v_exp_f32 v57, v57
    v_exp_f32 v58, v58
    v_exp_f32_e64 v59, v59
    s_waitcnt lgkmcnt(2)
    v_mfma_f32_32x32x16_bf16 v[64:79], v[108:111], v[80:83], v[64:79]
    s_add_u32 m0, s86, 90112
    s_nop 0
    buffer_load_dwordx4 v3, s[8:11], s74 offen sc1 lds
    s_add_u32 s74, s74, s77
    v_exp_f32 v60, v60
    s_mov_b64 exec, s[78:79]
    ds_read_b128 v[100:103], v8 offset:2560
    ds_read_b128 v[104:107], v8 offset:3200
    s_mov_b64 exec, -1
    v_exp_f32 v61, v61
    v_exp_f32 v62, v62
    v_exp_f32_e64 v63, v63
    s_waitcnt lgkmcnt(2)
    v_cvt_pk_bf16_f32 v84, v56, v57
    v_cvt_pk_bf16_f32 v85, v58, v59
    v_cvt_pk_bf16_f32 v86, v60, v61
    v_cvt_pk_bf16_f32 v87, v62, v63
    v_mfma_f32_32x32x16_bf16 v[48:63], v[92:95], v[12:15], v[16:31]
    v_exp_f32 v32, v32
    v_exp_f32 v33, v33
    v_exp_f32 v34, v34
    v_exp_f32 v35, v35
    v_mfma_f32_32x32x16_bf16 v[64:79], v[112:115], v[84:87], v[64:79]
    s_setprio 1
    s_add_u32 m0, s84, 112640
    s_nop 0
    buffer_load_dwordx4 v3, s[8:11], s72 offen sc1 lds
    s_add_u32 s72, s72, s75
    v_exp_f32 v36, v36
    v_exp_f32 v37, v37
    v_exp_f32 v38, v38
    v_exp_f32_e64 v39, v39
    v_cvt_pk_bf16_f32 v80, v32, v33
    v_cvt_pk_bf16_f32 v81, v34, v35
    v_cvt_pk_bf16_f32 v82, v36, v37
    v_cvt_pk_bf16_f32 v83, v38, v39
    v_mfma_f32_32x32x8bf16_1k v[48:63], v[98:99], v[10:11], v[48:63]
    ds_read_b128 v[88:91], v6 offset:4096
    ds_read_b64 v[96:97], v7 offset:2048
    s_add_u32 m0, s85, 112640
    s_nop 0
    buffer_load_dwordx4 v3, s[8:11], s73 offen sc1 lds
    s_add_u32 s73, s73, s76
    v_exp_f32 v40, v40
    v_exp_f32 v41, v41
    v_exp_f32 v42, v42
    v_exp_f32_e64 v43, v43
    s_waitcnt lgkmcnt(2)
    v_mfma_f32_32x32x16_bf16 v[64:79], v[100:103], v[80:83], v[64:79]
    s_add_u32 m0, s86, 112640
    s_nop 0
    buffer_load_dwordx4 v3, s[8:11], s74 offen sc1 lds
    s_add_u32 s74, s74, s77
    v_exp_f32 v44, v44
    s_mov_b64 exec, s[78:79]
    ds_read_b128 v[108:111], v8 offset:3840
    ds_read_b128 v[112:115], v8 offset:4480
    s_mov_b64 exec, -1
    v_exp_f32 v45, v45
    v_exp_f32 v46, v46
    v_exp_f32_e64 v47, v47
    s_waitcnt lgkmcnt(2)
    v_cvt_pk_bf16_f32 v84, v40, v41
    v_cvt_pk_bf16_f32 v85, v42, v43
    v_cvt_pk_bf16_f32 v86, v44, v45
    v_cvt_pk_bf16_f32 v87, v46, v47
    v_mfma_f32_32x32x16_bf16 v[32:47], v[88:91], v[12:15], v[16:31]
    v_exp_f32 v48, v48
    v_exp_f32 v49, v49
    v_exp_f32 v50, v50
    v_exp_f32 v51, v51
    v_mfma_f32_32x32x16_bf16 v[64:79], v[104:107], v[84:87], v[64:79]
    s_setprio 0
    s_add_u32 m0, s84, 135168
    s_nop 0
    buffer_load_dwordx4 v3, s[8:11], s72 offen sc1 lds
    s_add_u32 s72, s72, s75
    v_exp_f32 v52, v52
    v_exp_f32 v53, v53
    v_exp_f32 v54, v54
    v_exp_f32_e64 v55, v55
    v_cvt_pk_bf16_f32 v80, v48, v49
    v_cvt_pk_bf16_f32 v81, v50, v51
    v_cvt_pk_bf16_f32 v82, v52, v53
    v_cvt_pk_bf16_f32 v83, v54, v55
    v_mfma_f32_32x32x8bf16_1k v[32:47], v[96:97], v[10:11], v[32:47]
    ds_read_b128 v[92:95], v6 offset:5120
    ds_read_b64 v[98:99], v7 offset:2560
    s_add_u32 m0, s85, 135168
    s_nop 0
    buffer_load_dwordx4 v3, s[8:11], s73 offen sc1 lds
    s_add_u32 s73, s73, s76
    v_exp_f32 v56, v56
    v_exp_f32 v57, v57
    v_exp_f32 v58, v58
    v_exp_f32_e64 v59, v59
    s_waitcnt lgkmcnt(2)
    v_mfma_f32_32x32x16_bf16 v[64:79], v[108:111], v[80:83], v[64:79]
    s_add_u32 m0, s86, 135168
    s_nop 0
    buffer_load_dwordx4 v3, s[8:11], s74 offen sc1 lds
    s_add_u32 s74, s74, s77
    v_exp_f32 v60, v60
    s_mov_b64 exec, s[78:79]
    ds_read_b128 v[100:103], v8 offset:5120
    ds_read_b128 v[104:107], v8 offset:5760
    s_mov_b64 exec, -1
    v_exp_f32 v61, v61
    v_exp_f32 v62, v62
    v_exp_f32_e64 v63, v63
    s_waitcnt lgkmcnt(2)
    v_cvt_pk_bf16_f32 v84, v56, v57
    v_cvt_pk_bf16_f32 v85, v58, v59
    v_cvt_pk_bf16_f32 v86, v60, v61
    v_cvt_pk_bf16_f32 v87, v62, v63
    v_mfma_f32_32x32x16_bf16 v[48:63], v[92:95], v[12:15], v[16:31]
    v_exp_f32 v32, v32
    v_exp_f32 v33, v33
    v_exp_f32 v34, v34
    v_exp_f32 v35, v35
    v_mfma_f32_32x32x16_bf16 v[64:79], v[112:115], v[84:87], v[64:79]
    s_setprio 3
    buffer_load_dwordx4 v[160:163], v3, s[8:11], s63 offen sc1
    v_exp_f32 v36, v36
    v_exp_f32 v37, v37
    v_exp_f32 v38, v38
    v_exp_f32_e64 v39, v39
    v_cvt_pk_bf16_f32 v80, v32, v33
    v_cvt_pk_bf16_f32 v81, v34, v35
    v_cvt_pk_bf16_f32 v82, v36, v37
    v_cvt_pk_bf16_f32 v83, v38, v39
    v_mfma_f32_32x32x8bf16_1k v[48:63], v[98:99], v[10:11], v[48:63]
    ds_read_b128 v[88:91], v6 offset:6144
    ds_read_b64 v[96:97], v7 offset:3072
    v_exp_f32 v40, v40
    v_exp_f32 v41, v41
    v_exp_f32 v42, v42
    v_exp_f32_e64 v43, v43
    s_waitcnt lgkmcnt(2)
    v_mfma_f32_32x32x16_bf16 v[64:79], v[100:103], v[80:83], v[64:79]
    v_exp_f32 v44, v44
    s_mov_b64 exec, s[78:79]
    ds_read_b128 v[108:111], v8 offset:6400
    ds_read_b128 v[112:115], v8 offset:7040
    s_mov_b64 exec, -1
    v_exp_f32 v45, v45
    v_exp_f32 v46, v46
    v_exp_f32_e64 v47, v47
    s_waitcnt lgkmcnt(2)
    v_cvt_pk_bf16_f32 v84, v40, v41
    v_cvt_pk_bf16_f32 v85, v42, v43
    v_cvt_pk_bf16_f32 v86, v44, v45
    v_cvt_pk_bf16_f32 v87, v46, v47
    v_mfma_f32_32x32x16_bf16 v[32:47], v[88:91], v[12:15], v[16:31]
    v_exp_f32 v48, v48
    v_exp_f32 v49, v49
    v_exp_f32 v50, v50
    v_exp_f32 v51, v51
    v_mfma_f32_32x32x16_bf16 v[64:79], v[104:107], v[84:87], v[64:79]
    s_setprio 2
    v_exp_f32 v52, v52
    v_exp_f32 v53, v53
    v_exp_f32 v54, v54
    v_exp_f32_e64 v55, v55
    v_cvt_pk_bf16_f32 v80, v48, v49
    v_cvt_pk_bf16_f32 v81, v50, v51
    v_cvt_pk_bf16_f32 v82, v52, v53
    v_cvt_pk_bf16_f32 v83, v54, v55
    v_mfma_f32_32x32x8bf16_1k v[32:47], v[96:97], v[10:11], v[32:47]
    ds_read_b128 v[92:95], v6 offset:7168
    ds_read_b64 v[98:99], v7 offset:3584
    v_exp_f32 v56, v56
    v_exp_f32 v57, v57
    v_exp_f32 v58, v58
    v_exp_f32_e64 v59, v59
    s_waitcnt lgkmcnt(2)
    v_mfma_f32_32x32x16_bf16 v[64:79], v[108:111], v[80:83], v[64:79]
    v_exp_f32 v60, v60
    s_mov_b64 exec, s[78:79]
    ds_read_b128 v[100:103], v8 offset:7680
    ds_read_b128 v[104:107], v8 offset:8320
    s_mov_b64 exec, -1
    v_exp_f32 v61, v61
    v_exp_f32 v62, v62
    v_exp_f32_e64 v63, v63
    s_waitcnt lgkmcnt(2)
    v_cvt_pk_bf16_f32 v84, v56, v57
    v_cvt_pk_bf16_f32 v85, v58, v59
    v_cvt_pk_bf16_f32 v86, v60, v61
    v_cvt_pk_bf16_f32 v87, v62, v63
    v_mfma_f32_32x32x16_bf16 v[48:63], v[92:95], v[12:15], v[16:31]
    v_exp_f32 v32, v32
    v_exp_f32 v33, v33
    v_exp_f32 v34, v34
    v_exp_f32 v35, v35
    v_mfma_f32_32x32x16_bf16 v[64:79], v[112:115], v[84:87], v[64:79]
    s_setprio 1
    s_waitcnt vmcnt(16)
    s_barrier
    buffer_load_dwordx4 v[132:135], v128, s[12:15], s71 offen offset:0 nt
    v_exp_f32 v36, v36
    v_exp_f32 v37, v37
    v_exp_f32 v38, v38
    v_exp_f32_e64 v39, v39
    v_cvt_pk_bf16_f32 v80, v32, v33
    v_cvt_pk_bf16_f32 v81, v34, v35
    v_cvt_pk_bf16_f32 v82, v36, v37
    v_cvt_pk_bf16_f32 v83, v38, v39
    v_mfma_f32_32x32x8bf16_1k v[48:63], v[98:99], v[10:11], v[48:63]
    ds_read_b128 v[88:91], v6 offset:22528
    ds_read_b64 v[96:97], v7 offset:22528
    v_exp_f32 v40, v40
    v_exp_f32 v41, v41
    v_exp_f32 v42, v42
    v_exp_f32_e64 v43, v43
    s_waitcnt lgkmcnt(2)
    v_mfma_f32_32x32x16_bf16 v[64:79], v[100:103], v[80:83], v[64:79]
    v_exp_f32 v44, v44
    s_mov_b64 exec, s[78:79]
    ds_read_b128 v[108:111], v8 offset:8960
    ds_read_b128 v[112:115], v8 offset:9600
    s_mov_b64 exec, -1
    v_exp_f32 v45, v45
    v_exp_f32 v46, v46
    v_exp_f32_e64 v47, v47
    s_waitcnt lgkmcnt(2)
    v_cvt_pk_bf16_f32 v84, v40, v41
    v_cvt_pk_bf16_f32 v85, v42, v43
    v_cvt_pk_bf16_f32 v86, v44, v45
    v_cvt_pk_bf16_f32 v87, v46, v47
    v_mfma_f32_32x32x16_bf16 v[32:47], v[88:91], v[12:15], v[16:31]
    v_exp_f32 v48, v48
    v_exp_f32 v49, v49
    v_exp_f32 v50, v50
    v_exp_f32 v51, v51
    v_mfma_f32_32x32x16_bf16 v[64:79], v[104:107], v[84:87], v[64:79]
    s_setprio 0
    buffer_load_dwordx4 v[136:139], v128, s[12:15], s71 offen offset:64 nt
    v_exp_f32 v52, v52
    v_exp_f32 v53, v53
    v_exp_f32 v54, v54
    v_exp_f32_e64 v55, v55
    v_cvt_pk_bf16_f32 v80, v48, v49
    v_cvt_pk_bf16_f32 v81, v50, v51
    v_cvt_pk_bf16_f32 v82, v52, v53
    v_cvt_pk_bf16_f32 v83, v54, v55
    v_mfma_f32_32x32x8bf16_1k v[32:47], v[96:97], v[10:11], v[32:47]
    ds_read_b128 v[92:95], v6 offset:23552
    ds_read_b64 v[98:99], v7 offset:23040
    v_exp_f32 v56, v56
    v_exp_f32 v57, v57
    v_exp_f32 v58, v58
    v_exp_f32_e64 v59, v59
    s_waitcnt lgkmcnt(2)
    v_mfma_f32_32x32x16_bf16 v[64:79], v[108:111], v[80:83], v[64:79]
    v_exp_f32 v60, v60
    s_mov_b64 exec, s[78:79]
    ds_read_b128 v[100:103], v8 offset:22528
    ds_read_b128 v[104:107], v8 offset:23168
    s_mov_b64 exec, -1
    v_exp_f32 v61, v61
    v_exp_f32 v62, v62
    v_exp_f32_e64 v63, v63
    s_waitcnt lgkmcnt(2)
    v_cvt_pk_bf16_f32 v84, v56, v57
    v_cvt_pk_bf16_f32 v85, v58, v59
    v_cvt_pk_bf16_f32 v86, v60, v61
    v_cvt_pk_bf16_f32 v87, v62, v63
    v_mfma_f32_32x32x16_bf16 v[48:63], v[92:95], v[12:15], v[16:31]
    v_exp_f32 v32, v32
    v_exp_f32 v33, v33
    v_exp_f32 v34, v34
    v_exp_f32 v35, v35
    v_mfma_f32_32x32x16_bf16 v[64:79], v[112:115], v[84:87], v[64:79]
    s_setprio 3
    buffer_load_dwordx4 v[140:143], v128, s[12:15], s71 offen offset:128 nt
    v_exp_f32 v36, v36
    v_exp_f32 v37, v37
    v_exp_f32 v38, v38
    v_exp_f32_e64 v39, v39
    v_cvt_pk_bf16_f32 v80, v32, v33
    v_cvt_pk_bf16_f32 v81, v34, v35
    v_cvt_pk_bf16_f32 v82, v36, v37
    v_cvt_pk_bf16_f32 v83, v38, v39
    v_mfma_f32_32x32x8bf16_1k v[48:63], v[98:99], v[10:11], v[48:63]
    ds_read_b128 v[88:91], v6 offset:24576
    ds_read_b64 v[96:97], v7 offset:23552
    v_exp_f32 v40, v40
    v_exp_f32 v41, v41
    v_exp_f32 v42, v42
    v_exp_f32_e64 v43, v43
    s_waitcnt lgkmcnt(2)
    v_mfma_f32_32x32x16_bf16 v[64:79], v[100:103], v[80:83], v[64:79]
    v_exp_f32 v44, v44
    s_mov_b64 exec, s[78:79]
    ds_read_b128 v[108:111], v8 offset:23808
    ds_read_b128 v[112:115], v8 offset:24448
    s_mov_b64 exec, -1
    v_exp_f32 v45, v45
    v_exp_f32 v46, v46
    v_exp_f32_e64 v47, v47
    s_waitcnt lgkmcnt(2)
    v_cvt_pk_bf16_f32 v84, v40, v41
    v_cvt_pk_bf16_f32 v85, v42, v43
    v_cvt_pk_bf16_f32 v86, v44, v45
    v_cvt_pk_bf16_f32 v87, v46, v47
    v_mfma_f32_32x32x16_bf16 v[32:47], v[88:91], v[12:15], v[16:31]
    v_exp_f32 v48, v48
    v_exp_f32 v49, v49
    v_exp_f32 v50, v50
    v_exp_f32 v51, v51
    v_mfma_f32_32x32x16_bf16 v[64:79], v[104:107], v[84:87], v[64:79]
    s_setprio 2
    buffer_load_dwordx4 v[144:147], v128, s[12:15], s71 offen offset:192 nt
    v_exp_f32 v52, v52
    v_exp_f32 v53, v53
    v_exp_f32 v54, v54
    v_exp_f32_e64 v55, v55
    v_cvt_pk_bf16_f32 v80, v48, v49
    v_cvt_pk_bf16_f32 v81, v50, v51
    v_cvt_pk_bf16_f32 v82, v52, v53
    v_cvt_pk_bf16_f32 v83, v54, v55
    v_mfma_f32_32x32x8bf16_1k v[32:47], v[96:97], v[10:11], v[32:47]
    ds_read_b128 v[92:95], v6 offset:25600
    ds_read_b64 v[98:99], v7 offset:24064
    s_waitcnt vmcnt(4)
    v_xor_b32 v160, s100, v160
    v_bitop3_b32 v160, v160, v161, s100 bitop3:0xf6
    v_bitop3_b32 v160, v160, v162, s100 bitop3:0xf6
    v_bitop3_b32 v160, v160, v163, s100 bitop3:0xf6
    v_cmp_ne_u32 vcc, 0, v160
    s_cbranch_vccnz kf_kernel_b_ac1
kf_kernel_b_ac2:
    v_mov_b32 v160, s100
    s_mov_b64 exec, 1
    buffer_store_dword v160, v3, s[8:11], s62 offen sc1
    s_mov_b64 exec, -1
    v_exp_f32 v56, v56
    v_exp_f32 v57, v57
    v_exp_f32 v58, v58
    v_exp_f32 v59, v59
    s_waitcnt lgkmcnt(2)
    v_mfma_f32_32x32x16_bf16 v[64:79], v[108:111], v[80:83], v[64:79]
    v_exp_f32 v60, v60
    s_mov_b64 exec, s[78:79]
    ds_read_b128 v[100:103], v8 offset:25088
    ds_read_b128 v[104:107], v8 offset:25728
    s_mov_b64 exec, -1
    v_exp_f32 v61, v61
    v_exp_f32 v62, v62
    v_exp_f32_e64 v63, v63
    s_waitcnt lgkmcnt(2)
    v_cvt_pk_bf16_f32 v84, v56, v57
    v_cvt_pk_bf16_f32 v85, v58, v59
    v_cvt_pk_bf16_f32 v86, v60, v61
    v_cvt_pk_bf16_f32 v87, v62, v63
    v_mfma_f32_32x32x16_bf16 v[48:63], v[92:95], v[12:15], v[16:31]
    v_exp_f32 v32, v32
    v_exp_f32 v33, v33
    v_exp_f32 v34, v34
    v_exp_f32 v35, v35
    v_mfma_f32_32x32x16_bf16 v[64:79], v[112:115], v[84:87], v[64:79]
    s_setprio 1
    s_mov_b32 m0, s24
    s_nop 0
    buffer_load_dwordx4 v130, s[8:11], 0 offen sc1 lds
    v_exp_f32 v36, v36
    v_exp_f32 v37, v37
    v_exp_f32 v38, v38
    v_exp_f32_e64 v39, v39
    v_cvt_pk_bf16_f32 v80, v32, v33
    v_cvt_pk_bf16_f32 v81, v34, v35
    v_cvt_pk_bf16_f32 v82, v36, v37
    v_cvt_pk_bf16_f32 v83, v38, v39
    v_mfma_f32_32x32x8bf16_1k v[48:63], v[98:99], v[10:11], v[48:63]
    ds_read_b128 v[88:91], v6 offset:26624
    ds_read_b64 v[96:97], v7 offset:24576
    buffer_load_dword v148, v129, s[4:7], s19 offen offset:0 nt
    v_exp_f32 v40, v40
    v_exp_f32 v41, v41
    v_exp_f32 v42, v42
    v_exp_f32_e64 v43, v43
    s_waitcnt lgkmcnt(2)
    v_mfma_f32_32x32x16_bf16 v[64:79], v[100:103], v[80:83], v[64:79]
    v_exp_f32 v44, v44
    s_mov_b64 exec, s[78:79]
    ds_read_b128 v[108:111], v8 offset:26368
    ds_read_b128 v[112:115], v8 offset:27008
    s_mov_b64 exec, -1
    v_exp_f32 v45, v45
    v_exp_f32 v46, v46
    v_exp_f32_e64 v47, v47
    s_waitcnt lgkmcnt(2)
    v_cvt_pk_bf16_f32 v84, v40, v41
    v_cvt_pk_bf16_f32 v85, v42, v43
    v_cvt_pk_bf16_f32 v86, v44, v45
    v_cvt_pk_bf16_f32 v87, v46, v47
    v_mfma_f32_32x32x16_bf16 v[32:47], v[88:91], v[12:15], v[16:31]
    v_exp_f32 v48, v48
    v_exp_f32 v49, v49
    v_exp_f32 v50, v50
    v_exp_f32 v51, v51
    v_mfma_f32_32x32x16_bf16 v[64:79], v[104:107], v[84:87], v[64:79]
    s_setprio 0
    buffer_load_dword v149, v129, s[4:7], s19 offen offset:1280 nt
    v_exp_f32 v52, v52
    v_exp_f32 v53, v53
    v_exp_f32 v54, v54
    v_exp_f32_e64 v55, v55
    v_cvt_pk_bf16_f32 v80, v48, v49
    v_cvt_pk_bf16_f32 v81, v50, v51
    v_cvt_pk_bf16_f32 v82, v52, v53
    v_cvt_pk_bf16_f32 v83, v54, v55
    v_mfma_f32_32x32x8bf16_1k v[32:47], v[96:97], v[10:11], v[32:47]
    ds_read_b128 v[92:95], v6 offset:27648
    ds_read_b64 v[98:99], v7 offset:25088
    buffer_load_dword v150, v129, s[4:7], s19 offen offset:2560 nt
    v_exp_f32 v56, v56
    v_exp_f32 v57, v57
    v_exp_f32 v58, v58
    v_exp_f32_e64 v59, v59
    s_waitcnt lgkmcnt(2)
    v_mfma_f32_32x32x16_bf16 v[64:79], v[108:111], v[80:83], v[64:79]
    v_exp_f32 v60, v60
    s_mov_b64 exec, s[78:79]
    ds_read_b128 v[100:103], v8 offset:27648
    ds_read_b128 v[104:107], v8 offset:28288
    s_mov_b64 exec, -1
    v_exp_f32 v61, v61
    v_exp_f32 v62, v62
    v_exp_f32_e64 v63, v63
    s_waitcnt lgkmcnt(2)
    v_cvt_pk_bf16_f32 v84, v56, v57
    v_cvt_pk_bf16_f32 v85, v58, v59
    v_cvt_pk_bf16_f32 v86, v60, v61
    v_cvt_pk_bf16_f32 v87, v62, v63
    v_mfma_f32_32x32x16_bf16 v[48:63], v[92:95], v[12:15], v[16:31]
    v_exp_f32 v32, v32
    v_exp_f32 v33, v33
    v_exp_f32 v34, v34
    v_exp_f32 v35, v35
    v_mfma_f32_32x32x16_bf16 v[64:79], v[112:115], v[84:87], v[64:79]
    s_setprio 3
    buffer_load_dword v151, v129, s[4:7], s19 offen offset:3840 nt
    v_exp_f32 v36, v36
    v_exp_f32 v37, v37
    v_exp_f32 v38, v38
    v_exp_f32_e64 v39, v39
    v_cvt_pk_bf16_f32 v80, v32, v33
    v_cvt_pk_bf16_f32 v81, v34, v35
    v_cvt_pk_bf16_f32 v82, v36, v37
    v_cvt_pk_bf16_f32 v83, v38, v39
    v_mfma_f32_32x32x8bf16_1k v[48:63], v[98:99], v[10:11], v[48:63]
    ds_read_b128 v[88:91], v6 offset:28672
    ds_read_b64 v[96:97], v7 offset:25600
    buffer_load_dword v152, v129, s[4:7], s20 offen offset:0 nt
    v_exp_f32 v40, v40
    v_exp_f32 v41, v41
    v_exp_f32 v42, v42
    v_exp_f32_e64 v43, v43
    s_waitcnt lgkmcnt(2)
    v_mfma_f32_32x32x16_bf16 v[64:79], v[100:103], v[80:83], v[64:79]
    v_exp_f32 v44, v44
    s_mov_b64 exec, s[78:79]
    ds_read_b128 v[108:111], v8 offset:28928
    ds_read_b128 v[112:115], v8 offset:29568
    s_mov_b64 exec, -1
    v_exp_f32 v45, v45
    v_exp_f32 v46, v46
    v_exp_f32_e64 v47, v47
    s_waitcnt lgkmcnt(2)
    v_cvt_pk_bf16_f32 v84, v40, v41
    v_cvt_pk_bf16_f32 v85, v42, v43
    v_cvt_pk_bf16_f32 v86, v44, v45
    v_cvt_pk_bf16_f32 v87, v46, v47
    v_mfma_f32_32x32x16_bf16 v[32:47], v[88:91], v[12:15], v[16:31]
    v_exp_f32 v48, v48
    v_exp_f32 v49, v49
    v_exp_f32 v50, v50
    v_exp_f32 v51, v51
    v_mfma_f32_32x32x16_bf16 v[64:79], v[104:107], v[84:87], v[64:79]
    s_setprio 2
    buffer_load_dword v153, v129, s[4:7], s20 offen offset:1280 nt
    v_exp_f32 v52, v52
    v_exp_f32 v53, v53
    v_exp_f32 v54, v54
    v_exp_f32_e64 v55, v55
    v_cvt_pk_bf16_f32 v80, v48, v49
    v_cvt_pk_bf16_f32 v81, v50, v51
    v_cvt_pk_bf16_f32 v82, v52, v53
    v_cvt_pk_bf16_f32 v83, v54, v55
    v_mfma_f32_32x32x8bf16_1k v[32:47], v[96:97], v[10:11], v[32:47]
    ds_read_b128 v[92:95], v6 offset:29696
    ds_read_b64 v[98:99], v7 offset:26112
    buffer_load_dword v154, v129, s[4:7], s20 offen offset:2560 nt
    v_exp_f32 v56, v56
    v_exp_f32 v57, v57
    v_exp_f32 v58, v58
    v_exp_f32_e64 v59, v59
    s_waitcnt lgkmcnt(2)
    v_mfma_f32_32x32x16_bf16 v[64:79], v[108:111], v[80:83], v[64:79]
    v_exp_f32 v60, v60
    s_mov_b64 exec, s[78:79]
    ds_read_b128 v[100:103], v8 offset:30208
    ds_read_b128 v[104:107], v8 offset:30848
    s_mov_b64 exec, -1
    v_exp_f32 v61, v61
    v_exp_f32 v62, v62
    v_exp_f32_e64 v63, v63
    s_waitcnt lgkmcnt(2)
    v_cvt_pk_bf16_f32 v84, v56, v57
    v_cvt_pk_bf16_f32 v85, v58, v59
    v_cvt_pk_bf16_f32 v86, v60, v61
    v_cvt_pk_bf16_f32 v87, v62, v63
    v_mfma_f32_32x32x16_bf16 v[48:63], v[92:95], v[12:15], v[16:31]
    v_exp_f32 v32, v32
    v_exp_f32 v33, v33
    v_exp_f32 v34, v34
    v_exp_f32 v35, v35
    v_mfma_f32_32x32x16_bf16 v[64:79], v[112:115], v[84:87], v[64:79]
    s_setprio 1
    s_waitcnt vmcnt(26)
    s_barrier
    s_add_u32 m0, s84, zlit_b-zlit_a+(0)
    s_nop 0
    buffer_load_dwordx4 v3, s[8:11], s72 offen sc1 lds
    s_add_u32 s72, s72, s75
    v_exp_f32 v36, v36
    v_exp_f32 v37, v37
    v_exp_f32 v38, v38
    v_exp_f32_e64 v39, v39
    v_cvt_pk_bf16_f32 v80, v32, v33
    v_cvt_pk_bf16_f32 v81, v34, v35
    v_cvt_pk_bf16_f32 v82, v36, v37
    v_cvt_pk_bf16_f32 v83, v38, v39
    v_mfma_f32_32x32x8bf16_1k v[48:63], v[98:99], v[10:11], v[48:63]
    v_add_u32 v6, 45056, v3
    v_add_u32 v7, 53248, v4
    ds_read_b128 v[88:91], v6 offset:0
    ds_read_b64 v[96:97], v7 offset:0
    s_add_u32 m0, s85, 0
    s_nop 0
    buffer_load_dwordx4 v3, s[8:11], s73 offen sc1 lds
    s_add_u32 s73, s73, s76
    v_exp_f32 v40, v40
    v_exp_f32 v41, v41
    v_exp_f32 v42, v42
    v_exp_f32 v43, v43
    s_waitcnt lgkmcnt(2)
    v_mfma_f32_32x32x16_bf16 v[64:79], v[100:103], v[80:83], v[64:79]
    s_add_u32 m0, s86, 0
    s_nop 0
    buffer_load_dwordx4 v3, s[8:11], s74 offen sc1 lds
    s_add_u32 s74, s74, s77
    v_exp_f32_e64 v44, v44
    s_mov_b64 exec, s[78:79]
    ds_read_b128 v[108:111], v8 offset:31488
    ds_read_b128 v[112:115], v8 offset:32128
    s_mov_b64 exec, -1
    v_exp_f32 v45, v45
    v_exp_f32 v46, v46
    v_exp_f32_e64 v47, v47
    s_waitcnt lgkmcnt(2)
    v_cvt_pk_bf16_f32 v84, v40, v41
    v_cvt_pk_bf16_f32 v85, v42, v43
    v_cvt_pk_bf16_f32 v86, v44, v45
    v_cvt_pk_bf16_f32 v87, v46, v47
    v_mfma_f32_32x32x16_bf16 v[32:47], v[88:91], v[12:15], v[16:31]
    v_exp_f32 v48, v48
    v_exp_f32 v49, v49
    v_exp_f32 v50, v50
    v_exp_f32 v51, v51
    v_mfma_f32_32x32x16_bf16 v[64:79], v[104:107], v[84:87], v[64:79]
    s_setprio 0
    buffer_load_dword v155, v129, s[4:7], s20 offen offset:3840 nt
    v_exp_f32 v52, v52
    v_exp_f32 v53, v53
    v_exp_f32 v54, v54
    v_exp_f32_e64 v55, v55
    v_cvt_pk_bf16_f32 v80, v48, v49
    v_cvt_pk_bf16_f32 v81, v50, v51
    v_cvt_pk_bf16_f32 v82, v52, v53
    v_cvt_pk_bf16_f32 v83, v54, v55
    v_mfma_f32_32x32x8bf16_1k v[32:47], v[96:97], v[10:11], v[32:47]
    ds_read_b128 v[92:95], v6 offset:1024
    ds_read_b64 v[98:99], v7 offset:512
    v_exp_f32 v56, v56
    v_exp_f32 v57, v57
    v_exp_f32 v58, v58
    v_exp_f32_e64 v59, v59
    s_waitcnt lgkmcnt(2)
    v_mfma_f32_32x32x16_bf16 v[64:79], v[108:111], v[80:83], v[64:79]
    v_add_u32 v8, 57344, v5
    v_exp_f32 v60, v60
    s_mov_b64 exec, s[78:79]
    ds_read_b128 v[100:103], v8 offset:0
    ds_read_b128 v[104:107], v8 offset:640
    s_mov_b64 exec, -1
    v_exp_f32 v61, v61
    v_exp_f32 v62, v62
    v_exp_f32_e64 v63, v63
    s_waitcnt lgkmcnt(2)
    v_cvt_pk_bf16_f32 v84, v56, v57
    v_cvt_pk_bf16_f32 v85, v58, v59
    v_cvt_pk_bf16_f32 v86, v60, v61
    v_cvt_pk_bf16_f32 v87, v62, v63
    v_mfma_f32_32x32x16_bf16 v[48:63], v[92:95], v[12:15], v[16:31]
    v_exp_f32 v32, v32
    v_exp_f32 v33, v33
    v_exp_f32 v34, v34
    v_exp_f32 v35, v35
    v_mfma_f32_32x32x16_bf16 v[64:79], v[112:115], v[84:87], v[64:79]
    s_setprio 3
    buffer_load_dwordx4 v[160:163], v3, s[8:11], s22 offen offset:0 sc1
    v_exp_f32 v36, v36
    v_exp_f32 v37, v37
    v_exp_f32 v38, v38
    v_exp_f32_e64 v39, v39
    v_cvt_pk_bf16_f32 v80, v32, v33
    v_cvt_pk_bf16_f32 v81, v34, v35
    v_cvt_pk_bf16_f32 v82, v36, v37
    v_cvt_pk_bf16_f32 v83, v38, v39
    v_mfma_f32_32x32x8bf16_1k v[48:63], v[98:99], v[10:11], v[48:63]
    ds_read_b128 v[88:91], v6 offset:2048
    ds_read_b64 v[96:97], v7 offset:1024
    v_exp_f32 v40, v40
    v_exp_f32 v41, v41
    v_exp_f32 v42, v42
    v_exp_f32_e64 v43, v43
    s_waitcnt lgkmcnt(2)
    v_mfma_f32_32x32x16_bf16 v[64:79], v[100:103], v[80:83], v[64:79]
    v_exp_f32 v44, v44
    s_mov_b64 exec, s[78:79]
    ds_read_b128 v[108:111], v8 offset:1280
    ds_read_b128 v[112:115], v8 offset:1920
    s_mov_b64 exec, -1
    v_exp_f32 v45, v45
    v_exp_f32 v46, v46
    v_exp_f32_e64 v47, v47
    s_waitcnt lgkmcnt(2)
    v_cvt_pk_bf16_f32 v84, v40, v41
    v_cvt_pk_bf16_f32 v85, v42, v43
    v_cvt_pk_bf16_f32 v86, v44, v45
    v_cvt_pk_bf16_f32 v87, v46, v47
    v_mfma_f32_32x32x16_bf16 v[32:47], v[88:91], v[12:15], v[16:31]
    v_exp_f32 v48, v48
    v_exp_f32 v49, v49
    v_exp_f32 v50, v50
    v_exp_f32 v51, v51
    v_mfma_f32_32x32x16_bf16 v[64:79], v[104:107], v[84:87], v[64:79]
    s_setprio 2
    buffer_load_dwordx4 v[164:167], v3, s[8:11], s22 offen offset:1024 sc1
    v_exp_f32 v52, v52
    v_exp_f32 v53, v53
    v_exp_f32 v54, v54
    v_exp_f32_e64 v55, v55
    v_cvt_pk_bf16_f32 v80, v48, v49
    v_cvt_pk_bf16_f32 v81, v50, v51
    v_cvt_pk_bf16_f32 v82, v52, v53
    v_cvt_pk_bf16_f32 v83, v54, v55
    v_mfma_f32_32x32x8bf16_1k v[32:47], v[96:97], v[10:11], v[32:47]
    ds_read_b128 v[92:95], v6 offset:3072
    ds_read_b64 v[98:99], v7 offset:1536
    v_exp_f32 v56, v56
    v_exp_f32 v57, v57
    v_exp_f32 v58, v58
    v_exp_f32_e64 v59, v59
    s_waitcnt lgkmcnt(2)
    v_mfma_f32_32x32x16_bf16 v[64:79], v[108:111], v[80:83], v[64:79]
    v_exp_f32 v60, v60
    s_mov_b64 exec, s[78:79]
    ds_read_b128 v[100:103], v8 offset:2560
    ds_read_b128 v[104:107], v8 offset:3200
    s_mov_b64 exec, -1
    v_exp_f32 v61, v61
    v_exp_f32 v62, v62
    v_exp_f32_e64 v63, v63
    s_waitcnt lgkmcnt(2)
    v_cvt_pk_bf16_f32 v84, v56, v57
    v_cvt_pk_bf16_f32 v85, v58, v59
    v_cvt_pk_bf16_f32 v86, v60, v61
    v_cvt_pk_bf16_f32 v87, v62, v63
    v_mfma_f32_32x32x16_bf16 v[48:63], v[92:95], v[12:15], v[16:31]
    v_exp_f32 v32, v32
    v_exp_f32 v33, v33
    v_exp_f32 v34, v34
    v_exp_f32 v35, v35
    v_mfma_f32_32x32x16_bf16 v[64:79], v[112:115], v[84:87], v[64:79]
    s_setprio 1
    buffer_load_dwordx4 v[168:171], v3, s[8:11], s22 offen offset:2048 sc1
    v_exp_f32 v36, v36
    v_exp_f32 v37, v37
    v_exp_f32 v38, v38
    v_exp_f32_e64 v39, v39
    v_cvt_pk_bf16_f32 v80, v32, v33
    v_cvt_pk_bf16_f32 v81, v34, v35
    v_cvt_pk_bf16_f32 v82, v36, v37
    v_cvt_pk_bf16_f32 v83, v38, v39
    v_mfma_f32_32x32x8bf16_1k v[48:63], v[98:99], v[10:11], v[48:63]
    ds_read_b128 v[88:91], v6 offset:4096
    ds_read_b64 v[96:97], v7 offset:2048
    v_exp_f32 v40, v40
    v_exp_f32 v41, v41
    v_exp_f32 v42, v42
    v_exp_f32_e64 v43, v43
    s_waitcnt lgkmcnt(2)
    v_mfma_f32_32x32x16_bf16 v[64:79], v[100:103], v[80:83], v[64:79]
    v_exp_f32 v44, v44
    s_mov_b64 exec, s[78:79]
    ds_read_b128 v[108:111], v8 offset:3840
    ds_read_b128 v[112:115], v8 offset:4480
    s_mov_b64 exec, -1
    v_exp_f32 v45, v45
    v_exp_f32 v46, v46
    v_exp_f32_e64 v47, v47
    s_waitcnt lgkmcnt(2)
    v_cvt_pk_bf16_f32 v84, v40, v41
    v_cvt_pk_bf16_f32 v85, v42, v43
    v_cvt_pk_bf16_f32 v86, v44, v45
    v_cvt_pk_bf16_f32 v87, v46, v47
    v_mfma_f32_32x32x16_bf16 v[32:47], v[88:91], v[12:15], v[16:31]
    v_exp_f32 v48, v48
    v_exp_f32 v49, v49
    v_exp_f32 v50, v50
    v_exp_f32 v51, v51
    v_mfma_f32_32x32x16_bf16 v[64:79], v[104:107], v[84:87], v[64:79]
    s_setprio 0
    buffer_load_dwordx4 v[172:175], v3, s[8:11], s22 offen offset:3072 sc1
    s_add_u32 s22, s22, 4096
    v_exp_f32 v52, v52
    v_exp_f32 v53, v53
    v_exp_f32 v54, v54
    v_exp_f32_e64 v55, v55
    v_cvt_pk_bf16_f32 v80, v48, v49
    v_cvt_pk_bf16_f32 v81, v50, v51
    v_cvt_pk_bf16_f32 v82, v52, v53
    v_cvt_pk_bf16_f32 v83, v54, v55
    v_mfma_f32_32x32x8bf16_1k v[32:47], v[96:97], v[10:11], v[32:47]
    ds_read_b128 v[92:95], v6 offset:5120
    ds_read_b64 v[98:99], v7 offset:2560
    v_exp_f32 v56, v56
    v_exp_f32 v57, v57
    v_exp_f32 v58, v58
    v_exp_f32_e64 v59, v59
    s_waitcnt lgkmcnt(2)
    v_mfma_f32_32x32x16_bf16 v[64:79], v[108:111], v[80:83], v[64:79]
    v_exp_f32 v60, v60
    s_mov_b64 exec, s[78:79]
    ds_read_b128 v[100:103], v8 offset:5120
    ds_read_b128 v[104:107], v8 offset:5760
    s_mov_b64 exec, -1
    v_exp_f32 v61, v61
    v_exp_f32 v62, v62
    v_exp_f32_e64 v63, v63
    s_waitcnt lgkmcnt(2)
    v_cvt_pk_bf16_f32 v84, v56, v57
    v_cvt_pk_bf16_f32 v85, v58, v59
    v_cvt_pk_bf16_f32 v86, v60, v61
    v_cvt_pk_bf16_f32 v87, v62, v63
    v_mfma_f32_32x32x16_bf16 v[48:63], v[92:95], v[12:15], v[16:31]
    v_exp_f32 v32, v32
    v_exp_f32 v33, v33
    v_exp_f32 v34, v34
    v_exp_f32 v35, v35
    v_mfma_f32_32x32x16_bf16 v[64:79], v[112:115], v[84:87], v[64:79]
    s_setprio 3
    buffer_load_dwordx4 v[176:179], v3, s[8:11], s22 offen offset:0 sc1
    v_exp_f32 v36, v36
    v_exp_f32 v37, v37
    v_exp_f32 v38, v38
    v_exp_f32_e64 v39, v39
    v_cvt_pk_bf16_f32 v80, v32, v33
    v_cvt_pk_bf16_f32 v81, v34, v35
    v_cvt_pk_bf16_f32 v82, v36, v37
    v_cvt_pk_bf16_f32 v83, v38, v39
    v_mfma_f32_32x32x8bf16_1k v[48:63], v[98:99], v[10:11], v[48:63]
    ds_read_b128 v[88:91], v6 offset:6144
    ds_read_b64 v[96:97], v7 offset:3072
    v_exp_f32 v40, v40
    v_exp_f32 v41, v41
    v_exp_f32 v42, v42
    v_exp_f32_e64 v43, v43
    s_waitcnt lgkmcnt(2)
    v_mfma_f32_32x32x16_bf16 v[64:79], v[100:103], v[80:83], v[64:79]
    v_exp_f32 v44, v44
    s_mov_b64 exec, s[78:79]
    ds_read_b128 v[108:111], v8 offset:6400
    ds_read_b128 v[112:115], v8 offset:7040
    s_mov_b64 exec, -1
    v_exp_f32 v45, v45
    v_exp_f32 v46, v46
    v_exp_f32_e64 v47, v47
    s_waitcnt lgkmcnt(2)
    v_cvt_pk_bf16_f32 v84, v40, v41
    v_cvt_pk_bf16_f32 v85, v42, v43
    v_cvt_pk_bf16_f32 v86, v44, v45
    v_cvt_pk_bf16_f32 v87, v46, v47
    v_mfma_f32_32x32x16_bf16 v[32:47], v[88:91], v[12:15], v[16:31]
    v_exp_f32 v48, v48
    v_exp_f32 v49, v49
    v_exp_f32 v50, v50
    v_exp_f32 v51, v51
    v_mfma_f32_32x32x16_bf16 v[64:79], v[104:107], v[84:87], v[64:79]
    s_setprio 2
    buffer_load_dwordx4 v[180:183], v3, s[8:11], s22 offen offset:1024 sc1
    v_exp_f32 v52, v52
    v_exp_f32 v53, v53
    v_exp_f32 v54, v54
    v_exp_f32_e64 v55, v55
    v_cvt_pk_bf16_f32 v80, v48, v49
    v_cvt_pk_bf16_f32 v81, v50, v51
    v_cvt_pk_bf16_f32 v82, v52, v53
    v_cvt_pk_bf16_f32 v83, v54, v55
    v_mfma_f32_32x32x8bf16_1k v[32:47], v[96:97], v[10:11], v[32:47]
    ds_read_b128 v[92:95], v6 offset:7168
    ds_read_b64 v[98:99], v7 offset:3584
    v_exp_f32 v56, v56
    v_exp_f32 v57, v57
    v_exp_f32 v58, v58
    v_exp_f32_e64 v59, v59
    s_waitcnt lgkmcnt(2)
    v_mfma_f32_32x32x16_bf16 v[64:79], v[108:111], v[80:83], v[64:79]
    v_exp_f32 v60, v60
    s_mov_b64 exec, s[78:79]
    ds_read_b128 v[100:103], v8 offset:7680
    ds_read_b128 v[104:107], v8 offset:8320
    s_mov_b64 exec, -1
    v_exp_f32 v61, v61
    v_exp_f32 v62, v62
    v_exp_f32_e64 v63, v63
    s_waitcnt lgkmcnt(2)
    v_cvt_pk_bf16_f32 v84, v56, v57
    v_cvt_pk_bf16_f32 v85, v58, v59
    v_cvt_pk_bf16_f32 v86, v60, v61
    v_cvt_pk_bf16_f32 v87, v62, v63
    v_mfma_f32_32x32x16_bf16 v[48:63], v[92:95], v[12:15], v[16:31]
    v_exp_f32 v32, v32
    v_exp_f32 v33, v33
    v_exp_f32 v34, v34
    v_exp_f32 v35, v35
    v_mfma_f32_32x32x16_bf16 v[64:79], v[112:115], v[84:87], v[64:79]
    s_setprio 1
    s_waitcnt vmcnt(24)
    s_barrier
    buffer_load_dwordx4 v[184:187], v3, s[8:11], s22 offen offset:2048 sc1
    v_exp_f32 v36, v36
    v_exp_f32 v37, v37
    v_exp_f32 v38, v38
    v_exp_f32_e64 v39, v39
    v_cvt_pk_bf16_f32 v80, v32, v33
    v_cvt_pk_bf16_f32 v81, v34, v35
    v_cvt_pk_bf16_f32 v82, v36, v37
    v_cvt_pk_bf16_f32 v83, v38, v39
    v_mfma_f32_32x32x8bf16_1k v[48:63], v[98:99], v[10:11], v[48:63]
    ds_read_b128 v[88:91], v6 offset:22528
    ds_read_b64 v[96:97], v7 offset:22528
    v_exp_f32 v40, v40
    v_exp_f32 v41, v41
    v_exp_f32 v42, v42
    v_exp_f32_e64 v43, v43
    s_waitcnt lgkmcnt(2)
    v_mfma_f32_32x32x16_bf16 v[64:79], v[100:103], v[80:83], v[64:79]
    v_exp_f32 v44, v44
    s_mov_b64 exec, s[78:79]
    ds_read_b128 v[108:111], v8 offset:8960
    ds_read_b128 v[112:115], v8 offset:9600
    s_mov_b64 exec, -1
    v_exp_f32 v45, v45
    v_exp_f32 v46, v46
    v_exp_f32_e64 v47, v47
    s_waitcnt lgkmcnt(2)
    v_cvt_pk_bf16_f32 v84, v40, v41
    v_cvt_pk_bf16_f32 v85, v42, v43
    v_cvt_pk_bf16_f32 v86, v44, v45
    v_cvt_pk_bf16_f32 v87, v46, v47
    v_mfma_f32_32x32x16_bf16 v[32:47], v[88:91], v[12:15], v[16:31]
    v_exp_f32 v48, v48
    v_exp_f32 v49, v49
    v_exp_f32 v50, v50
    v_exp_f32 v51, v51
    v_mfma_f32_32x32x16_bf16 v[64:79], v[104:107], v[84:87], v[64:79]
    s_setprio 0
    s_waitcnt vmcnt(23)
    buffer_store_dwordx4 v[132:135], v3, s[8:11], s18 offen sc1
    s_add_u32 s18, s18, 4096
    v_exp_f32 v52, v52
    v_exp_f32 v53, v53
    v_exp_f32 v54, v54
    v_exp_f32 v55, v55
    v_cvt_pk_bf16_f32 v80, v48, v49
    v_cvt_pk_bf16_f32 v81, v50, v51
    v_cvt_pk_bf16_f32 v82, v52, v53
    v_cvt_pk_bf16_f32 v83, v54, v55
    v_mfma_f32_32x32x8bf16_1k v[32:47], v[96:97], v[10:11], v[32:47]
    ds_read_b128 v[92:95], v6 offset:23552
    ds_read_b64 v[98:99], v7 offset:23040
    v_exp_f32 v56, v56
    v_exp_f32 v57, v57
    v_exp_f32 v58, v58
    v_exp_f32_e64 v59, v59
    s_waitcnt lgkmcnt(2)
    v_mfma_f32_32x32x16_bf16 v[64:79], v[108:111], v[80:83], v[64:79]
    v_exp_f32 v60, v60
    s_mov_b64 exec, s[78:79]
    ds_read_b128 v[100:103], v8 offset:22528
    ds_read_b128 v[104:107], v8 offset:23168
    s_mov_b64 exec, -1
    v_exp_f32 v61, v61
    v_exp_f32 v62, v62
    v_exp_f32_e64 v63, v63
    s_waitcnt lgkmcnt(2)
    v_cvt_pk_bf16_f32 v84, v56, v57
    v_cvt_pk_bf16_f32 v85, v58, v59
    v_cvt_pk_bf16_f32 v86, v60, v61
    v_cvt_pk_bf16_f32 v87, v62, v63
    v_mfma_f32_32x32x16_bf16 v[48:63], v[92:95], v[12:15], v[16:31]
    v_exp_f32 v32, v32
    v_exp_f32 v33, v33
    v_exp_f32 v34, v34
    v_exp_f32 v35, v35
    v_mfma_f32_32x32x16_bf16 v[64:79], v[112:115], v[84:87], v[64:79]
    s_setprio 3
    s_waitcnt vmcnt(23)
    buffer_store_dwordx4 v[136:139], v3, s[8:11], s18 offen sc1
    s_add_u32 s18, s18, 4096
    v_exp_f32 v36, v36
    v_exp_f32 v37, v37
    v_exp_f32 v38, v38
    v_exp_f32 v39, v39
    v_cvt_pk_bf16_f32 v80, v32, v33
    v_cvt_pk_bf16_f32 v81, v34, v35
    v_cvt_pk_bf16_f32 v82, v36, v37
    v_cvt_pk_bf16_f32 v83, v38, v39
    v_mfma_f32_32x32x8bf16_1k v[48:63], v[98:99], v[10:11], v[48:63]
    ds_read_b128 v[88:91], v6 offset:24576
    ds_read_b64 v[96:97], v7 offset:23552
    v_exp_f32 v40, v40
    v_exp_f32 v41, v41
    v_exp_f32 v42, v42
    v_exp_f32_e64 v43, v43
    s_waitcnt lgkmcnt(2)
    v_mfma_f32_32x32x16_bf16 v[64:79], v[100:103], v[80:83], v[64:79]
    v_exp_f32 v44, v44
    s_mov_b64 exec, s[78:79]
    ds_read_b128 v[108:111], v8 offset:23808
    ds_read_b128 v[112:115], v8 offset:24448
    s_mov_b64 exec, -1
    v_exp_f32 v45, v45
    v_exp_f32 v46, v46
    v_exp_f32_e64 v47, v47
    s_waitcnt lgkmcnt(2)
    v_cvt_pk_bf16_f32 v84, v40, v41
    v_cvt_pk_bf16_f32 v85, v42, v43
    v_cvt_pk_bf16_f32 v86, v44, v45
    v_cvt_pk_bf16_f32 v87, v46, v47
    v_mfma_f32_32x32x16_bf16 v[32:47], v[88:91], v[12:15], v[16:31]
    v_exp_f32 v48, v48
    v_exp_f32 v49, v49
    v_exp_f32 v50, v50
    v_exp_f32 v51, v51
    v_mfma_f32_32x32x16_bf16 v[64:79], v[104:107], v[84:87], v[64:79]
    s_setprio 2
    s_waitcnt vmcnt(23)
    buffer_store_dwordx4 v[140:143], v3, s[8:11], s18 offen sc1
    s_add_u32 s18, s18, 4096
    v_exp_f32 v52, v52
    v_exp_f32 v53, v53
    v_exp_f32 v54, v54
    v_exp_f32 v55, v55
    v_cvt_pk_bf16_f32 v80, v48, v49
    v_cvt_pk_bf16_f32 v81, v50, v51
    v_cvt_pk_bf16_f32 v82, v52, v53
    v_cvt_pk_bf16_f32 v83, v54, v55
    v_mfma_f32_32x32x8bf16_1k v[32:47], v[96:97], v[10:11], v[32:47]
    ds_read_b128 v[92:95], v6 offset:25600
    ds_read_b64 v[98:99], v7 offset:24064
    v_exp_f32 v56, v56
    v_exp_f32 v57, v57
    v_exp_f32 v58, v58
    v_exp_f32_e64 v59, v59
    s_waitcnt lgkmcnt(2)
    v_mfma_f32_32x32x16_bf16 v[64:79], v[108:111], v[80:83], v[64:79]
    v_exp_f32 v60, v60
    s_mov_b64 exec, s[78:79]
    ds_read_b128 v[100:103], v8 offset:25088
    ds_read_b128 v[104:107], v8 offset:25728
    s_mov_b64 exec, -1
    v_exp_f32 v61, v61
    v_exp_f32 v62, v62
    v_exp_f32_e64 v63, v63
    s_waitcnt lgkmcnt(2)
    v_cvt_pk_bf16_f32 v84, v56, v57
    v_cvt_pk_bf16_f32 v85, v58, v59
    v_cvt_pk_bf16_f32 v86, v60, v61
    v_cvt_pk_bf16_f32 v87, v62, v63
    v_mfma_f32_32x32x16_bf16 v[48:63], v[92:95], v[12:15], v[16:31]
    v_exp_f32 v32, v32
    v_exp_f32 v33, v33
    v_exp_f32 v34, v34
    v_exp_f32 v35, v35
    v_mfma_f32_32x32x16_bf16 v[64:79], v[112:115], v[84:87], v[64:79]
    s_setprio 1
    s_waitcnt vmcnt(23)
    buffer_store_dwordx4 v[144:147], v3, s[8:11], s18 offen sc1
    s_add_u32 s18, s18, 4096
    v_exp_f32 v36, v36
    v_exp_f32 v37, v37
    v_exp_f32 v38, v38
    v_exp_f32 v39, v39
    v_cvt_pk_bf16_f32 v80, v32, v33
    v_cvt_pk_bf16_f32 v81, v34, v35
    v_cvt_pk_bf16_f32 v82, v36, v37
    v_cvt_pk_bf16_f32 v83, v38, v39
    v_mfma_f32_32x32x8bf16_1k v[48:63], v[98:99], v[10:11], v[48:63]
    ds_read_b128 v[88:91], v6 offset:26624
    ds_read_b64 v[96:97], v7 offset:24576
    v_exp_f32 v40, v40
    v_exp_f32 v41, v41
    v_exp_f32 v42, v42
    v_exp_f32_e64 v43, v43
    s_waitcnt lgkmcnt(2)
    v_mfma_f32_32x32x16_bf16 v[64:79], v[100:103], v[80:83], v[64:79]
    v_exp_f32 v44, v44
    s_mov_b64 exec, s[78:79]
    ds_read_b128 v[108:111], v8 offset:26368
    ds_read_b128 v[112:115], v8 offset:27008
    s_mov_b64 exec, -1
    v_exp_f32 v45, v45
    v_exp_f32 v46, v46
    v_exp_f32_e64 v47, v47
    s_waitcnt lgkmcnt(2)
    v_cvt_pk_bf16_f32 v84, v40, v41
    v_cvt_pk_bf16_f32 v85, v42, v43
    v_cvt_pk_bf16_f32 v86, v44, v45
    v_cvt_pk_bf16_f32 v87, v46, v47
    v_mfma_f32_32x32x16_bf16 v[32:47], v[88:91], v[12:15], v[16:31]
    v_exp_f32 v48, v48
    v_exp_f32 v49, v49
    v_exp_f32 v50, v50
    v_exp_f32 v51, v51
    v_mfma_f32_32x32x16_bf16 v[64:79], v[104:107], v[84:87], v[64:79]
    s_setprio 0
    buffer_load_dwordx4 v[188:191], v3, s[8:11], s22 offen offset:3072 sc1
    s_add_u32 s22, s22, 4096
    v_exp_f32 v52, v52
    v_exp_f32 v53, v53
    v_exp_f32 v54, v54
    v_exp_f32_e64 v55, v55
    v_cvt_pk_bf16_f32 v80, v48, v49
    v_cvt_pk_bf16_f32 v81, v50, v51
    v_cvt_pk_bf16_f32 v82, v52, v53
    v_cvt_pk_bf16_f32 v83, v54, v55
    v_mfma_f32_32x32x8bf16_1k v[32:47], v[96:97], v[10:11], v[32:47]
    ds_read_b128 v[92:95], v6 offset:27648
    ds_read_b64 v[98:99], v7 offset:25088
    v_exp_f32 v56, v56
    v_exp_f32 v57, v57
    v_exp_f32 v58, v58
    v_exp_f32_e64 v59, v59
    s_waitcnt lgkmcnt(2)
    v_mfma_f32_32x32x16_bf16 v[64:79], v[108:111], v[80:83], v[64:79]
    v_exp_f32 v60, v60
    s_mov_b64 exec, s[78:79]
    ds_read_b128 v[100:103], v8 offset:27648
    ds_read_b128 v[104:107], v8 offset:28288
    s_mov_b64 exec, -1
    v_exp_f32 v61, v61
    v_exp_f32 v62, v62
    v_exp_f32_e64 v63, v63
    s_waitcnt lgkmcnt(2)
    v_cvt_pk_bf16_f32 v84, v56, v57
    v_cvt_pk_bf16_f32 v85, v58, v59
    v_cvt_pk_bf16_f32 v86, v60, v61
    v_cvt_pk_bf16_f32 v87, v62, v63
    v_mfma_f32_32x32x16_bf16 v[48:63], v[92:95], v[12:15], v[16:31]
    v_exp_f32 v32, v32
    v_exp_f32 v33, v33
    v_exp_f32 v34, v34
    v_exp_f32 v35, v35
    v_mfma_f32_32x32x16_bf16 v[64:79], v[112:115], v[84:87], v[64:79]
    s_setprio 3
    s_waitcnt vmcnt(12)
    s_mov_b32 s67, 0x05040100
    v_perm_b32 v132, v149, v148, s67
    v_perm_b32 v133, v151, v150, s67
    v_perm_b32 v134, v153, v152, s67
    v_perm_b32 v135, v155, v154, s67
    buffer_store_dwordx4 v[132:135], v156, s[8:11], s70 offen offset:0 sc1
    v_exp_f32 v36, v36
    v_exp_f32 v37, v37
    v_exp_f32 v38, v38
    v_exp_f32 v39, v39
    v_cvt_pk_bf16_f32 v80, v32, v33
    v_cvt_pk_bf16_f32 v81, v34, v35
    v_cvt_pk_bf16_f32 v82, v36, v37
    v_cvt_pk_bf16_f32 v83, v38, v39
    v_mfma_f32_32x32x8bf16_1k v[48:63], v[98:99], v[10:11], v[48:63]
    ds_read_b128 v[88:91], v6 offset:28672
    ds_read_b64 v[96:97], v7 offset:25600
    v_exp_f32 v40, v40
    v_exp_f32 v41, v41
    v_exp_f32 v42, v42
    v_exp_f32_e64 v43, v43
    s_waitcnt lgkmcnt(2)
    v_mfma_f32_32x32x16_bf16 v[64:79], v[100:103], v[80:83], v[64:79]
    v_exp_f32 v44, v44
    s_mov_b64 exec, s[78:79]
    ds_read_b128 v[108:111], v8 offset:28928
    ds_read_b128 v[112:115], v8 offset:29568
    s_mov_b64 exec, -1
    v_exp_f32 v45, v45
    v_exp_f32 v46, v46
    v_exp_f32_e64 v47, v47
    s_waitcnt lgkmcnt(2)
    v_cvt_pk_bf16_f32 v84, v40, v41
    v_cvt_pk_bf16_f32 v85, v42, v43
    v_cvt_pk_bf16_f32 v86, v44, v45
    v_cvt_pk_bf16_f32 v87, v46, v47
    v_mfma_f32_32x32x16_bf16 v[32:47], v[88:91], v[12:15], v[16:31]
    v_exp_f32 v48, v48
    v_exp_f32 v49, v49
    v_exp_f32 v50, v50
    v_exp_f32 v51, v51
    v_mfma_f32_32x32x16_bf16 v[64:79], v[104:107], v[84:87], v[64:79]
    s_setprio 2
    s_waitcnt vmcnt(13)
    s_mov_b32 s67, 0x07060302
    v_perm_b32 v136, v149, v148, s67
    v_perm_b32 v137, v151, v150, s67
    v_perm_b32 v138, v153, v152, s67
    v_perm_b32 v139, v155, v154, s67
    buffer_store_dwordx4 v[136:139], v156, s[8:11], s70 offen offset:16 sc1
    v_exp_f32 v52, v52
    v_exp_f32 v53, v53
    v_exp_f32 v54, v54
    v_exp_f32 v55, v55
    v_cvt_pk_bf16_f32 v80, v48, v49
    v_cvt_pk_bf16_f32 v81, v50, v51
    v_cvt_pk_bf16_f32 v82, v52, v53
    v_cvt_pk_bf16_f32 v83, v54, v55
    v_mfma_f32_32x32x8bf16_1k v[32:47], v[96:97], v[10:11], v[32:47]
    ds_read_b128 v[92:95], v6 offset:29696
    ds_read_b64 v[98:99], v7 offset:26112
    v_exp_f32 v56, v56
    v_exp_f32 v57, v57
    v_exp_f32 v58, v58
    v_exp_f32_e64 v59, v59
    s_waitcnt lgkmcnt(2)
    v_mfma_f32_32x32x16_bf16 v[64:79], v[108:111], v[80:83], v[64:79]
    v_exp_f32 v60, v60
    s_mov_b64 exec, s[78:79]
    ds_read_b128 v[100:103], v8 offset:30208
    ds_read_b128 v[104:107], v8 offset:30848
    s_mov_b64 exec, -1
    v_exp_f32 v61, v61
    v_exp_f32 v62, v62
    v_exp_f32_e64 v63, v63
    s_waitcnt lgkmcnt(2)
    v_cvt_pk_bf16_f32 v84, v56, v57
    v_cvt_pk_bf16_f32 v85, v58, v59
    v_cvt_pk_bf16_f32 v86, v60, v61
    v_cvt_pk_bf16_f32 v87, v62, v63
    v_mfma_f32_32x32x16_bf16 v[48:63], v[92:95], v[12:15], v[16:31]
    v_exp_f32 v32, v32
    v_exp_f32 v33, v33
    v_exp_f32 v34, v34
    v_exp_f32 v35, v35
    v_mfma_f32_32x32x16_bf16 v[64:79], v[112:115], v[84:87], v[64:79]
    s_setprio 1
    buffer_load_dwordx4 v[192:195], v3, s[8:11], s22 offen offset:0 sc1
    v_exp_f32 v36, v36
    v_exp_f32 v37, v37
    v_exp_f32 v38, v38
    v_exp_f32_e64 v39, v39
    v_cvt_pk_bf16_f32 v80, v32, v33
    v_cvt_pk_bf16_f32 v81, v34, v35
    v_cvt_pk_bf16_f32 v82, v36, v37
    v_cvt_pk_bf16_f32 v83, v38, v39
    v_mfma_f32_32x32x8bf16_1k v[48:63], v[98:99], v[10:11], v[48:63]
    v_add_u32 v6, 90112, v3
    v_add_u32 v7, 98304, v4
    ds_read_b128 v[88:91], v6 offset:0
    ds_read_b64 v[96:97], v7 offset:0
    v_exp_f32 v40, v40
    v_exp_f32 v41, v41
    v_exp_f32 v42, v42
    v_exp_f32_e64 v43, v43
    s_waitcnt lgkmcnt(2)
    v_mfma_f32_32x32x16_bf16 v[64:79], v[100:103], v[80:83], v[64:79]
    v_exp_f32 v44, v44
    s_mov_b64 exec, s[78:79]
    ds_read_b128 v[108:111], v8 offset:31488
    ds_read_b128 v[112:115], v8 offset:32128
    s_mov_b64 exec, -1
    v_exp_f32 v45, v45
    v_exp_f32 v46, v46
    v_exp_f32_e64 v47, v47
    s_waitcnt lgkmcnt(2)
    v_cvt_pk_bf16_f32 v84, v40, v41
    v_cvt_pk_bf16_f32 v85, v42, v43
    v_cvt_pk_bf16_f32 v86, v44, v45
    v_cvt_pk_bf16_f32 v87, v46, v47
    v_mfma_f32_32x32x16_bf16 v[32:47], v[88:91], v[12:15], v[16:31]
    v_exp_f32 v48, v48
    v_exp_f32 v49, v49
    v_exp_f32 v50, v50
    v_exp_f32 v51, v51
    v_mfma_f32_32x32x16_bf16 v[64:79], v[104:107], v[84:87], v[64:79]
    s_setprio 0
    buffer_load_dwordx4 v[196:199], v3, s[8:11], s22 offen offset:1024 sc1
    v_exp_f32 v52, v52
    v_exp_f32 v53, v53
    v_exp_f32 v54, v54
    v_exp_f32_e64 v55, v55
    v_cvt_pk_bf16_f32 v80, v48, v49
    v_cvt_pk_bf16_f32 v81, v50, v51
    v_cvt_pk_bf16_f32 v82, v52, v53
    v_cvt_pk_bf16_f32 v83, v54, v55
    v_mfma_f32_32x32x8bf16_1k v[32:47], v[96:97], v[10:11], v[32:47]
    ds_read_b128 v[92:95], v6 offset:1024
    ds_read_b64 v[98:99], v7 offset:512
    v_exp_f32 v56, v56
    v_exp_f32 v57, v57
    v_exp_f32 v58, v58
    v_exp_f32_e64 v59, v59
    s_waitcnt lgkmcnt(2)
    v_mfma_f32_32x32x16_bf16 v[64:79], v[108:111], v[80:83], v[64:79]
    v_add_u32 v8, 102400, v5
    v_exp_f32 v60, v60
    s_mov_b64 exec, s[78:79]
    ds_read_b128 v[100:103], v8 offset:0
    ds_read_b128 v[104:107], v8 offset:640
    s_mov_b64 exec, -1
    v_exp_f32 v61, v61
    v_exp_f32 v62, v62
    v_exp_f32_e64 v63, v63
    s_waitcnt lgkmcnt(2)
    v_cvt_pk_bf16_f32 v84, v56, v57
    v_cvt_pk_bf16_f32 v85, v58, v59
    v_cvt_pk_bf16_f32 v86, v60, v61
    v_cvt_pk_bf16_f32 v87, v62, v63
    v_mfma_f32_32x32x16_bf16 v[48:63], v[92:95], v[12:15], v[16:31]
    v_exp_f32 v32, v32
    v_exp_f32 v33, v33
    v_exp_f32 v34, v34
    v_exp_f32 v35, v35
    v_mfma_f32_32x32x16_bf16 v[64:79], v[112:115], v[84:87], v[64:79]
    s_setprio 3
    s_barrier
    s_add_u32 m0, s84, 22528
    s_nop 0
    buffer_load_dwordx4 v3, s[8:11], s27 offen sc1 lds
    s_add_u32 s27, s27, 8192
    v_exp_f32 v36, v36
    v_exp_f32 v37, v37
    v_exp_f32 v38, v38
    v_exp_f32_e64 v39, v39
    v_cvt_pk_bf16_f32 v80, v32, v33
    v_cvt_pk_bf16_f32 v81, v34, v35
    v_cvt_pk_bf16_f32 v82, v36, v37
    v_cvt_pk_bf16_f32 v83, v38, v39
    v_mfma_f32_32x32x8bf16_1k v[48:63], v[98:99], v[10:11], v[48:63]
    ds_read_b128 v[88:91], v6 offset:2048
    ds_read_b64 v[96:97], v7 offset:1024
    buffer_load_dwordx4 v[200:203], v3, s[8:11], s22 offen offset:2048 sc1
    v_exp_f32 v40, v40
    v_exp_f32 v41, v41
    v_exp_f32 v42, v42
    v_exp_f32_e64 v43, v43
    s_waitcnt lgkmcnt(2)
    v_mfma_f32_32x32x16_bf16 v[64:79], v[100:103], v[80:83], v[64:79]
    v_exp_f32 v44, v44
    s_mov_b64 exec, s[78:79]
    ds_read_b128 v[108:111], v8 offset:1280
    ds_read_b128 v[112:115], v8 offset:1920
    s_mov_b64 exec, -1
    v_exp_f32 v45, v45
    v_exp_f32 v46, v46
    v_exp_f32_e64 v47, v47
    s_waitcnt lgkmcnt(2)
    v_cvt_pk_bf16_f32 v84, v40, v41
    v_cvt_pk_bf16_f32 v85, v42, v43
    v_cvt_pk_bf16_f32 v86, v44, v45
    v_cvt_pk_bf16_f32 v87, v46, v47
    v_mfma_f32_32x32x16_bf16 v[32:47], v[88:91], v[12:15], v[16:31]
    v_exp_f32 v48, v48
    v_exp_f32 v49, v49
    v_exp_f32 v50, v50
    v_exp_f32 v51, v51
    v_mfma_f32_32x32x16_bf16 v[64:79], v[104:107], v[84:87], v[64:79]
    s_setprio 2
    s_add_u32 m0, s84, 30720
    s_nop 0
    buffer_load_dwordx4 v3, s[8:11], s27 offen sc1 lds
    s_add_u32 s27, s27, 8192
    v_exp_f32 v52, v52
    v_exp_f32 v53, v53
    v_exp_f32 v54, v54
    v_exp_f32 v55, v55
    v_cvt_pk_bf16_f32 v80, v48, v49
    v_cvt_pk_bf16_f32 v81, v50, v51
    v_cvt_pk_bf16_f32 v82, v52, v53
    v_cvt_pk_bf16_f32 v83, v54, v55
    v_mfma_f32_32x32x8bf16_1k v[32:47], v[96:97], v[10:11], v[32:47]
    ds_read_b128 v[92:95], v6 offset:3072
    ds_read_b64 v[98:99], v7 offset:1536
    buffer_load_dwordx4 v[204:207], v3, s[8:11], s22 offen offset:3072 sc1
    s_add_u32 s22, s22, 4096
    v_exp_f32 v56, v56
    v_exp_f32 v57, v57
    v_exp_f32 v58, v58
    v_exp_f32_e64 v59, v59
    s_waitcnt lgkmcnt(2)
    v_mfma_f32_32x32x16_bf16 v[64:79], v[108:111], v[80:83], v[64:79]
    v_exp_f32 v60, v60
    s_mov_b64 exec, s[78:79]
    ds_read_b128 v[100:103], v8 offset:2560
    ds_read_b128 v[104:107], v8 offset:3200
    s_mov_b64 exec, -1
    v_exp_f32 v61, v61
    v_exp_f32 v62, v62
    v_exp_f32_e64 v63, v63
    s_waitcnt lgkmcnt(2)
    v_cvt_pk_bf16_f32 v84, v56, v57
    v_cvt_pk_bf16_f32 v85, v58, v59
    v_cvt_pk_bf16_f32 v86, v60, v61
    v_cvt_pk_bf16_f32 v87, v62, v63
    v_mfma_f32_32x32x16_bf16 v[48:63], v[92:95], v[12:15], v[16:31]
    v_exp_f32 v32, v32
    v_exp_f32 v33, v33
    v_exp_f32 v34, v34
    v_exp_f32 v35, v35
    v_mfma_f32_32x32x16_bf16 v[64:79], v[112:115], v[84:87], v[64:79]
    s_setprio 1
    s_add_u32 m0, s84, 38912
    s_nop 0
    buffer_load_dwordx4 v3, s[8:11], s27 offen sc1 lds
    s_add_u32 s27, s27, 8192
    v_exp_f32 v36, v36
    v_exp_f32 v37, v37
    v_exp_f32 v38, v38
    v_exp_f32 v39, v39
    v_cvt_pk_bf16_f32 v80, v32, v33
    v_cvt_pk_bf16_f32 v81, v34, v35
    v_cvt_pk_bf16_f32 v82, v36, v37
    v_cvt_pk_bf16_f32 v83, v38, v39
    v_mfma_f32_32x32x8bf16_1k v[48:63], v[98:99], v[10:11], v[48:63]
    ds_read_b128 v[88:91], v6 offset:4096
    ds_read_b64 v[96:97], v7 offset:2048
    buffer_load_dwordx4 v[208:211], v3, s[8:11], s22 offen offset:0 sc1
    v_exp_f32 v40, v40
    v_exp_f32 v41, v41
    v_exp_f32 v42, v42
    v_exp_f32_e64 v43, v43
    s_waitcnt lgkmcnt(2)
    v_mfma_f32_32x32x16_bf16 v[64:79], v[100:103], v[80:83], v[64:79]
    v_exp_f32 v44, v44
    s_mov_b64 exec, s[78:79]
    ds_read_b128 v[108:111], v8 offset:3840
    ds_read_b128 v[112:115], v8 offset:4480
    s_mov_b64 exec, -1
    v_exp_f32 v45, v45
    v_exp_f32 v46, v46
    v_exp_f32_e64 v47, v47
    s_waitcnt lgkmcnt(2)
    v_cvt_pk_bf16_f32 v84, v40, v41
    v_cvt_pk_bf16_f32 v85, v42, v43
    v_cvt_pk_bf16_f32 v86, v44, v45
    v_cvt_pk_bf16_f32 v87, v46, v47
    v_mfma_f32_32x32x16_bf16 v[32:47], v[88:91], v[12:15], v[16:31]
    v_exp_f32 v48, v48
    v_exp_f32 v49, v49
    v_exp_f32 v50, v50
    v_exp_f32 v51, v51
    v_mfma_f32_32x32x16_bf16 v[64:79], v[104:107], v[84:87], v[64:79]
    s_setprio 0
    s_add_u32 m0, s84, 47104
    s_nop 0
    buffer_load_dwordx4 v3, s[8:11], s27 offen sc1 lds
    s_add_u32 s27, s27, 8192
    v_exp_f32 v52, v52
    v_exp_f32 v53, v53
    v_exp_f32 v54, v54
    v_exp_f32 v55, v55
    v_cvt_pk_bf16_f32 v80, v48, v49
    v_cvt_pk_bf16_f32 v81, v50, v51
    v_cvt_pk_bf16_f32 v82, v52, v53
    v_cvt_pk_bf16_f32 v83, v54, v55
    v_mfma_f32_32x32x8bf16_1k v[32:47], v[96:97], v[10:11], v[32:47]
    ds_read_b128 v[92:95], v6 offset:5120
    ds_read_b64 v[98:99], v7 offset:2560
    buffer_load_dwordx4 v[212:215], v3, s[8:11], s22 offen offset:1024 sc1
    v_exp_f32 v56, v56
    v_exp_f32 v57, v57
    v_exp_f32 v58, v58
    v_exp_f32_e64 v59, v59
    s_waitcnt lgkmcnt(2)
    v_mfma_f32_32x32x16_bf16 v[64:79], v[108:111], v[80:83], v[64:79]
    v_exp_f32 v60, v60
    s_mov_b64 exec, s[78:79]
    ds_read_b128 v[100:103], v8 offset:5120
    ds_read_b128 v[104:107], v8 offset:5760
    s_mov_b64 exec, -1
    v_exp_f32 v61, v61
    v_exp_f32 v62, v62
    v_exp_f32_e64 v63, v63
    s_waitcnt lgkmcnt(2)
    v_cvt_pk_bf16_f32 v84, v56, v57
    v_cvt_pk_bf16_f32 v85, v58, v59
    v_cvt_pk_bf16_f32 v86, v60, v61
    v_cvt_pk_bf16_f32 v87, v62, v63
    v_mfma_f32_32x32x16_bf16 v[48:63], v[92:95], v[12:15], v[16:31]
    v_exp_f32 v32, v32
    v_exp_f32 v33, v33
    v_exp_f32 v34, v34
    v_exp_f32 v35, v35
    v_mfma_f32_32x32x16_bf16 v[64:79], v[112:115], v[84:87], v[64:79]
    s_setprio 3
    s_add_u32 m0, s84, 55296
    s_nop 0
    buffer_load_dwordx4 v3, s[8:11], s27 offen sc1 lds
    s_add_u32 s27, s27, 8192
    v_exp_f32 v36, v36
    v_exp_f32 v37, v37
    v_exp_f32 v38, v38
    v_exp_f32 v39, v39
    v_cvt_pk_bf16_f32 v80, v32, v33
    v_cvt_pk_bf16_f32 v81, v34, v35
    v_cvt_pk_bf16_f32 v82, v36, v37
    v_cvt_pk_bf16_f32 v83, v38, v39
    v_mfma_f32_32x32x8bf16_1k v[48:63], v[98:99], v[10:11], v[48:63]
    ds_read_b128 v[88:91], v6 offset:6144
    ds_read_b64 v[96:97], v7 offset:3072
    buffer_load_dwordx4 v[216:219], v3, s[8:11], s22 offen offset:2048 sc1
    v_exp_f32 v40, v40
    v_exp_f32 v41, v41
    v_exp_f32 v42, v42
    v_exp_f32_e64 v43, v43
    s_waitcnt lgkmcnt(2)
    v_mfma_f32_32x32x16_bf16 v[64:79], v[100:103], v[80:83], v[64:79]
    v_exp_f32 v44, v44
    s_mov_b64 exec, s[78:79]
    ds_read_b128 v[108:111], v8 offset:6400
    ds_read_b128 v[112:115], v8 offset:7040
    s_mov_b64 exec, -1
    v_exp_f32 v45, v45
    v_exp_f32 v46, v46
    v_exp_f32_e64 v47, v47
    s_waitcnt lgkmcnt(2)
    v_cvt_pk_bf16_f32 v84, v40, v41
    v_cvt_pk_bf16_f32 v85, v42, v43
    v_cvt_pk_bf16_f32 v86, v44, v45
    v_cvt_pk_bf16_f32 v87, v46, v47
    v_mfma_f32_32x32x16_bf16 v[32:47], v[88:91], v[12:15], v[16:31]
    v_exp_f32 v48, v48
    v_exp_f32 v49, v49
    v_exp_f32 v50, v50
    v_exp_f32 v51, v51
    v_mfma_f32_32x32x16_bf16 v[64:79], v[104:107], v[84:87], v[64:79]
    s_setprio 2
    s_add_u32 m0, s84, 63488
    s_nop 0
    buffer_load_dwordx4 v3, s[8:11], s27 offen sc1 lds
    s_add_u32 s27, s27, 8192
    v_exp_f32 v52, v52
    v_exp_f32 v53, v53
    v_exp_f32 v54, v54
    v_exp_f32 v55, v55
    v_cvt_pk_bf16_f32 v80, v48, v49
    v_cvt_pk_bf16_f32 v81, v50, v51
    v_cvt_pk_bf16_f32 v82, v52, v53
    v_cvt_pk_bf16_f32 v83, v54, v55
    v_mfma_f32_32x32x8bf16_1k v[32:47], v[96:97], v[10:11], v[32:47]
    ds_read_b128 v[92:95], v6 offset:7168
    ds_read_b64 v[98:99], v7 offset:3584
    buffer_load_dwordx4 v[220:223], v3, s[8:11], s22 offen offset:3072 sc1
    s_add_u32 s22, s22, 4096
    v_exp_f32 v56, v56
    v_exp_f32 v57, v57
    v_exp_f32 v58, v58
    v_exp_f32_e64 v59, v59
    s_waitcnt lgkmcnt(2)
    v_mfma_f32_32x32x16_bf16 v[64:79], v[108:111], v[80:83], v[64:79]
    v_exp_f32 v60, v60
    s_mov_b64 exec, s[78:79]
    ds_read_b128 v[100:103], v8 offset:7680
    ds_read_b128 v[104:107], v8 offset:8320
    s_mov_b64 exec, -1
    v_exp_f32 v61, v61
    v_exp_f32 v62, v62
    v_exp_f32_e64 v63, v63
    s_waitcnt lgkmcnt(2)
    v_cvt_pk_bf16_f32 v84, v56, v57
    v_cvt_pk_bf16_f32 v85, v58, v59
    v_cvt_pk_bf16_f32 v86, v60, v61
    v_cvt_pk_bf16_f32 v87, v62, v63
    v_mfma_f32_32x32x16_bf16 v[48:63], v[92:95], v[12:15], v[16:31]
    v_exp_f32 v32, v32
    v_exp_f32 v33, v33
    v_exp_f32 v34, v34
    v_exp_f32 v35, v35
    v_mfma_f32_32x32x16_bf16 v[64:79], v[112:115], v[84:87], v[64:79]
    s_setprio 1
    s_add_u32 m0, s84, 71680
    s_nop 0
    buffer_load_dwordx4 v3, s[8:11], s27 offen sc1 lds
    s_add_u32 s27, s27, 8192
    v_exp_f32 v36, v36
    v_exp_f32 v37, v37
    v_exp_f32 v38, v38
    v_exp_f32 v39, v39
    v_cvt_pk_bf16_f32 v80, v32, v33
    v_cvt_pk_bf16_f32 v81, v34, v35
    v_cvt_pk_bf16_f32 v82, v36, v37
    v_cvt_pk_bf16_f32 v83, v38, v39
    v_mfma_f32_32x32x8bf16_1k v[48:63], v[98:99], v[10:11], v[48:63]
    ds_read_b128 v[88:91], v6 offset:22528
    ds_read_b64 v[96:97], v7 offset:22528
    buffer_load_dwordx4 v[224:227], v3, s[8:11], s22 offen offset:0 sc1
    v_exp_f32 v40, v40
    v_exp_f32 v41, v41
    v_exp_f32 v42, v42
    v_exp_f32_e64 v43, v43
    s_waitcnt lgkmcnt(2)
    v_mfma_f32_32x32x16_bf16 v[64:79], v[100:103], v[80:83], v[64:79]
    v_exp_f32 v44, v44
    s_mov_b64 exec, s[78:79]
    ds_read_b128 v[108:111], v8 offset:8960
    ds_read_b128 v[112:115], v8 offset:9600
    s_mov_b64 exec, -1
    v_exp_f32 v45, v45
    v_exp_f32 v46, v46
    v_exp_f32_e64 v47, v47
    s_waitcnt lgkmcnt(2)
    v_cvt_pk_bf16_f32 v84, v40, v41
    v_cvt_pk_bf16_f32 v85, v42, v43
    v_cvt_pk_bf16_f32 v86, v44, v45
    v_cvt_pk_bf16_f32 v87, v46, v47
    v_mfma_f32_32x32x16_bf16 v[32:47], v[88:91], v[12:15], v[16:31]
    v_exp_f32 v48, v48
    v_exp_f32 v49, v49
    v_exp_f32 v50, v50
    v_exp_f32 v51, v51
    v_mfma_f32_32x32x16_bf16 v[64:79], v[104:107], v[84:87], v[64:79]
    s_setprio 0
    s_add_u32 m0, s84, 79872
    s_nop 0
    buffer_load_dwordx4 v3, s[8:11], s27 offen sc1 lds
    s_add_u32 s27, s27, 8192
    v_exp_f32 v52, v52
    v_exp_f32 v53, v53
    v_exp_f32 v54, v54
    v_exp_f32 v55, v55
    v_cvt_pk_bf16_f32 v80, v48, v49
    v_cvt_pk_bf16_f32 v81, v50, v51
    v_cvt_pk_bf16_f32 v82, v52, v53
    v_cvt_pk_bf16_f32 v83, v54, v55
    v_mfma_f32_32x32x8bf16_1k v[32:47], v[96:97], v[10:11], v[32:47]
    ds_read_b128 v[92:95], v6 offset:23552
    ds_read_b64 v[98:99], v7 offset:23040
    buffer_load_dwordx4 v[228:231], v3, s[8:11], s22 offen offset:1024 sc1
    v_exp_f32 v56, v56
    v_exp_f32 v57, v57
    v_exp_f32 v58, v58
    v_exp_f32_e64 v59, v59
    s_waitcnt lgkmcnt(2)
    v_mfma_f32_32x32x16_bf16 v[64:79], v[108:111], v[80:83], v[64:79]
    v_exp_f32 v60, v60
    s_mov_b64 exec, s[78:79]
    ds_read_b128 v[100:103], v8 offset:22528
    ds_read_b128 v[104:107], v8 offset:23168
    s_mov_b64 exec, -1
    v_exp_f32 v61, v61
    v_exp_f32 v62, v62
    v_exp_f32_e64 v63, v63
    s_waitcnt lgkmcnt(2)
    v_cvt_pk_bf16_f32 v84, v56, v57
    v_cvt_pk_bf16_f32 v85, v58, v59
    v_cvt_pk_bf16_f32 v86, v60, v61
    v_cvt_pk_bf16_f32 v87, v62, v63
    v_mfma_f32_32x32x16_bf16 v[48:63], v[92:95], v[12:15], v[16:31]
    v_exp_f32 v32, v32
    v_exp_f32 v33, v33
    v_exp_f32 v34, v34
    v_exp_f32 v35, v35
    v_mfma_f32_32x32x16_bf16 v[64:79], v[112:115], v[84:87], v[64:79]
    s_setprio 3
    buffer_load_dwordx4 v[232:235], v3, s[8:11], s22 offen offset:2048 sc1
    v_exp_f32 v36, v36
    v_exp_f32 v37, v37
    v_exp_f32 v38, v38
    v_exp_f32_e64 v39, v39
    v_cvt_pk_bf16_f32 v80, v32, v33
    v_cvt_pk_bf16_f32 v81, v34, v35
    v_cvt_pk_bf16_f32 v82, v36, v37
    v_cvt_pk_bf16_f32 v83, v38, v39
    v_mfma_f32_32x32x8bf16_1k v[48:63], v[98:99], v[10:11], v[48:63]
    ds_read_b128 v[88:91], v6 offset:24576
    ds_read_b64 v[96:97], v7 offset:23552
    buffer_load_dwordx4 v[236:239], v3, s[8:11], s22 offen offset:3072 sc1
    s_add_u32 s22, s22, s23
    v_exp_f32 v40, v40
    v_exp_f32 v41, v41
    v_exp_f32 v42, v42
    v_exp_f32 v43, v43
    s_waitcnt lgkmcnt(2)
    v_mfma_f32_32x32x16_bf16 v[64:79], v[100:103], v[80:83], v[64:79]
    v_exp_f32 v44, v44
    s_mov_b64 exec, s[78:79]
    ds_read_b128 v[108:111], v8 offset:23808
    ds_read_b128 v[112:115], v8 offset:24448
    s_mov_b64 exec, -1
    v_exp_f32 v45, v45
    v_exp_f32 v46, v46
    v_exp_f32_e64 v47, v47
    s_waitcnt lgkmcnt(2)
    v_cvt_pk_bf16_f32 v84, v40, v41
    v_cvt_pk_bf16_f32 v85, v42, v43
    v_cvt_pk_bf16_f32 v86, v44, v45
    v_cvt_pk_bf16_f32 v87, v46, v47
    v_mfma_f32_32x32x16_bf16 v[32:47], v[88:91], v[12:15], v[16:31]
    v_exp_f32 v48, v48
    v_exp_f32 v49, v49
    v_exp_f32 v50, v50
    v_exp_f32 v51, v51
    v_mfma_f32_32x32x16_bf16 v[64:79], v[104:107], v[84:87], v[64:79]
    s_setprio 2
    buffer_load_dwordx4 v[240:243], v3, s[8:11], s22 offen offset:0 sc1
    v_exp_f32 v52, v52
    v_exp_f32 v53, v53
    v_exp_f32 v54, v54
    v_exp_f32_e64 v55, v55
    v_cvt_pk_bf16_f32 v80, v48, v49
    v_cvt_pk_bf16_f32 v81, v50, v51
    v_cvt_pk_bf16_f32 v82, v52, v53
    v_cvt_pk_bf16_f32 v83, v54, v55
    v_mfma_f32_32x32x8bf16_1k v[32:47], v[96:97], v[10:11], v[32:47]
    ds_read_b128 v[92:95], v6 offset:25600
    ds_read_b64 v[98:99], v7 offset:24064
    buffer_load_dwordx4 v[244:247], v3, s[8:11], s22 offen offset:1024 sc1
    v_exp_f32 v56, v56
    v_exp_f32 v57, v57
    v_exp_f32 v58, v58
    v_exp_f32_e64 v59, v59
    s_waitcnt lgkmcnt(2)
    v_mfma_f32_32x32x16_bf16 v[64:79], v[108:111], v[80:83], v[64:79]
    v_exp_f32 v60, v60
    s_mov_b64 exec, s[78:79]
    ds_read_b128 v[100:103], v8 offset:25088
    ds_read_b128 v[104:107], v8 offset:25728
    s_mov_b64 exec, -1
    v_exp_f32 v61, v61
    v_exp_f32 v62, v62
    v_exp_f32_e64 v63, v63
    s_waitcnt lgkmcnt(2)
    v_cvt_pk_bf16_f32 v84, v56, v57
    v_cvt_pk_bf16_f32 v85, v58, v59
    v_cvt_pk_bf16_f32 v86, v60, v61
    v_cvt_pk_bf16_f32 v87, v62, v63
    v_mfma_f32_32x32x16_bf16 v[48:63], v[92:95], v[12:15], v[16:31]
    v_exp_f32 v32, v32
    v_exp_f32 v33, v33
    v_exp_f32 v34, v34
    v_exp_f32 v35, v35
    v_mfma_f32_32x32x16_bf16 v[64:79], v[112:115], v[84:87], v[64:79]
    s_setprio 1
    buffer_load_dwordx4 v[248:251], v3, s[8:11], s22 offen offset:2048 sc1
    v_exp_f32 v36, v36
    v_exp_f32 v37, v37
    v_exp_f32 v38, v38
    v_exp_f32_e64 v39, v39
    v_cvt_pk_bf16_f32 v80, v32, v33
    v_cvt_pk_bf16_f32 v81, v34, v35
    v_cvt_pk_bf16_f32 v82, v36, v37
    v_cvt_pk_bf16_f32 v83, v38, v39
    v_mfma_f32_32x32x8bf16_1k v[48:63], v[98:99], v[10:11], v[48:63]
    ds_read_b128 v[88:91], v6 offset:26624
    ds_read_b64 v[96:97], v7 offset:24576
    buffer_load_dwordx4 v[252:255], v3, s[8:11], s22 offen offset:3072 sc1
    s_add_u32 s22, s22, 4096
    v_exp_f32 v40, v40
    v_exp_f32 v41, v41
    v_exp_f32 v42, v42
    v_exp_f32_e64 v43, v43
    s_waitcnt lgkmcnt(2)
    v_mfma_f32_32x32x16_bf16 v[64:79], v[100:103], v[80:83], v[64:79]
    v_exp_f32 v44, v44
    s_mov_b64 exec, s[78:79]
    ds_read_b128 v[108:111], v8 offset:26368
    ds_read_b128 v[112:115], v8 offset:27008
    s_mov_b64 exec, -1
    v_exp_f32 v45, v45
    v_exp_f32 v46, v46
    v_exp_f32_e64 v47, v47
    s_waitcnt lgkmcnt(2)
    v_cvt_pk_bf16_f32 v84, v40, v41
    v_cvt_pk_bf16_f32 v85, v42, v43
    v_cvt_pk_bf16_f32 v86, v44, v45
    v_cvt_pk_bf16_f32 v87, v46, v47
    v_mfma_f32_32x32x16_bf16 v[32:47], v[88:91], v[12:15], v[16:31]
    v_exp_f32 v48, v48
    v_exp_f32 v49, v49
    v_exp_f32 v50, v50
    v_exp_f32 v51, v51
    v_mfma_f32_32x32x16_bf16 v[64:79], v[104:107], v[84:87], v[64:79]
    s_setprio 0
    buffer_load_dwordx4 v[116:119], v3, s[8:11], s22 offen offset:0 sc1
    v_exp_f32 v52, v52
    v_exp_f32 v53, v53
    v_exp_f32 v54, v54
    v_exp_f32_e64 v55, v55
    v_cvt_pk_bf16_f32 v80, v48, v49
    v_cvt_pk_bf16_f32 v81, v50, v51
    v_cvt_pk_bf16_f32 v82, v52, v53
    v_cvt_pk_bf16_f32 v83, v54, v55
    v_mfma_f32_32x32x8bf16_1k v[32:47], v[96:97], v[10:11], v[32:47]
    ds_read_b128 v[92:95], v6 offset:27648
    ds_read_b64 v[98:99], v7 offset:25088
    buffer_load_dwordx4 v[120:123], v3, s[8:11], s22 offen offset:1024 sc1
    v_exp_f32 v56, v56
    v_exp_f32 v57, v57
    v_exp_f32 v58, v58
    v_exp_f32_e64 v59, v59
    s_waitcnt lgkmcnt(2)
    v_mfma_f32_32x32x16_bf16 v[64:79], v[108:111], v[80:83], v[64:79]
    v_exp_f32 v60, v60
    s_mov_b64 exec, s[78:79]
    ds_read_b128 v[100:103], v8 offset:27648
    ds_read_b128 v[104:107], v8 offset:28288
    s_mov_b64 exec, -1
    v_exp_f32 v61, v61
    v_exp_f32 v62, v62
    v_exp_f32_e64 v63, v63
    s_waitcnt lgkmcnt(2)
    v_cvt_pk_bf16_f32 v84, v56, v57
    v_cvt_pk_bf16_f32 v85, v58, v59
    v_cvt_pk_bf16_f32 v86, v60, v61
    v_cvt_pk_bf16_f32 v87, v62, v63
    v_mfma_f32_32x32x16_bf16 v[48:63], v[92:95], v[12:15], v[16:31]
    v_exp_f32 v32, v32
    v_exp_f32 v33, v33
    v_exp_f32 v34, v34
    v_exp_f32 v35, v35
    v_mfma_f32_32x32x16_bf16 v[64:79], v[112:115], v[84:87], v[64:79]
    s_setprio 3
    buffer_load_dwordx4 v[124:127], v3, s[8:11], s22 offen offset:2048 sc1
    v_exp_f32 v36, v36
    v_exp_f32 v37, v37
    v_exp_f32 v38, v38
    v_exp_f32_e64 v39, v39
    v_cvt_pk_bf16_f32 v80, v32, v33
    v_cvt_pk_bf16_f32 v81, v34, v35
    v_cvt_pk_bf16_f32 v82, v36, v37
    v_cvt_pk_bf16_f32 v83, v38, v39
    v_mfma_f32_32x32x8bf16_1k v[48:63], v[98:99], v[10:11], v[48:63]
    ds_read_b128 v[88:91], v6 offset:28672
    ds_read_b64 v[96:97], v7 offset:25600
    buffer_load_dwordx4 v[128:131], v3, s[8:11], s22 offen offset:3072 sc1
    s_add_u32 s22, s22, 4096
    v_exp_f32 v40, v40
    v_exp_f32 v41, v41
    v_exp_f32 v42, v42
    v_exp_f32_e64 v43, v43
    s_waitcnt lgkmcnt(2)
    v_mfma_f32_32x32x16_bf16 v[64:79], v[100:103], v[80:83], v[64:79]
    v_exp_f32 v44, v44
    s_mov_b64 exec, s[78:79]
    ds_read_b128 v[108:111], v8 offset:28928
    ds_read_b128 v[112:115], v8 offset:29568
    s_mov_b64 exec, -1
    v_exp_f32 v45, v45
    v_exp_f32 v46, v46
    v_exp_f32_e64 v47, v47
    s_waitcnt lgkmcnt(2)
    v_cvt_pk_bf16_f32 v84, v40, v41
    v_cvt_pk_bf16_f32 v85, v42, v43
    v_cvt_pk_bf16_f32 v86, v44, v45
    v_cvt_pk_bf16_f32 v87, v46, v47
    v_mfma_f32_32x32x16_bf16 v[32:47], v[88:91], v[12:15], v[16:31]
    v_exp_f32 v48, v48
    v_exp_f32 v49, v49
    v_exp_f32 v50, v50
    v_exp_f32 v51, v51
    v_mfma_f32_32x32x16_bf16 v[64:79], v[104:107], v[84:87], v[64:79]
    s_setprio 2
    buffer_load_dwordx4 v[140:143], v3, s[8:11], s22 offen offset:0 sc1
    v_exp_f32 v52, v52
    v_exp_f32 v53, v53
    v_exp_f32 v54, v54
    v_exp_f32_e64 v55, v55
    v_cvt_pk_bf16_f32 v80, v48, v49
    v_cvt_pk_bf16_f32 v81, v50, v51
    v_cvt_pk_bf16_f32 v82, v52, v53
    v_cvt_pk_bf16_f32 v83, v54, v55
    v_mfma_f32_32x32x8bf16_1k v[32:47], v[96:97], v[10:11], v[32:47]
    ds_read_b128 v[92:95], v6 offset:29696
    ds_read_b64 v[98:99], v7 offset:26112
    buffer_load_dwordx4 v[144:147], v3, s[8:11], s22 offen offset:1024 sc1
    v_exp_f32 v56, v56
    v_exp_f32 v57, v57
    v_exp_f32 v58, v58
    v_exp_f32_e64 v59, v59
    s_waitcnt lgkmcnt(2)
    v_mfma_f32_32x32x16_bf16 v[64:79], v[108:111], v[80:83], v[64:79]
    v_exp_f32 v60, v60
    s_mov_b64 exec, s[78:79]
    ds_read_b128 v[100:103], v8 offset:30208
    ds_read_b128 v[104:107], v8 offset:30848
    s_mov_b64 exec, -1
    v_exp_f32 v61, v61
    v_exp_f32 v62, v62
    v_exp_f32_e64 v63, v63
    s_waitcnt lgkmcnt(2)
    v_cvt_pk_bf16_f32 v84, v56, v57
    v_cvt_pk_bf16_f32 v85, v58, v59
    v_cvt_pk_bf16_f32 v86, v60, v61
    v_cvt_pk_bf16_f32 v87, v62, v63
    v_mfma_f32_32x32x16_bf16 v[48:63], v[92:95], v[12:15], v[16:31]
    v_exp_f32 v32, v32
    v_exp_f32 v33, v33
    v_exp_f32 v34, v34
    v_exp_f32 v35, v35
    v_mfma_f32_32x32x16_bf16 v[64:79], v[112:115], v[84:87], v[64:79]
    s_setprio 1
    buffer_load_dwordx4 v[148:151], v3, s[8:11], s22 offen offset:2048 sc1
    v_exp_f32 v36, v36
    v_exp_f32 v37, v37
    v_exp_f32 v38, v38
    v_exp_f32_e64 v39, v39
    v_cvt_pk_bf16_f32 v80, v32, v33
    v_cvt_pk_bf16_f32 v81, v34, v35
    v_cvt_pk_bf16_f32 v82, v36, v37
    v_cvt_pk_bf16_f32 v83, v38, v39
    v_mfma_f32_32x32x8bf16_1k v[48:63], v[98:99], v[10:11], v[48:63]
    v_add_u32 v6, 135168, v3
    v_add_u32 v7, 143360, v4
    ds_read_b128 v[88:91], v6 offset:0
    ds_read_b64 v[96:97], v7 offset:0
    buffer_load_dwordx4 v[152:155], v3, s[8:11], s22 offen offset:3072 sc1
    s_add_u32 s22, s22, 4096
    v_exp_f32 v40, v40
    v_exp_f32 v41, v41
    v_exp_f32 v42, v42
    v_exp_f32_e64 v43, v43
    s_waitcnt lgkmcnt(2)
    v_mfma_f32_32x32x16_bf16 v[64:79], v[100:103], v[80:83], v[64:79]
    v_exp_f32 v44, v44
    s_mov_b64 exec, s[78:79]
    ds_read_b128 v[108:111], v8 offset:31488
    ds_read_b128 v[112:115], v8 offset:32128
    s_mov_b64 exec, -1
    v_exp_f32 v45, v45
    v_exp_f32 v46, v46
    v_exp_f32_e64 v47, v47
    s_waitcnt lgkmcnt(2)
    v_cvt_pk_bf16_f32 v84, v40, v41
    v_cvt_pk_bf16_f32 v85, v42, v43
    v_cvt_pk_bf16_f32 v86, v44, v45
    v_cvt_pk_bf16_f32 v87, v46, v47
    v_mfma_f32_32x32x16_bf16 v[32:47], v[88:91], v[12:15], v[16:31]
    v_exp_f32 v48, v48
    v_exp_f32 v49, v49
    v_exp_f32 v50, v50
    v_exp_f32 v51, v51
    v_mfma_f32_32x32x16_bf16 v[64:79], v[104:107], v[84:87], v[64:79]
    s_setprio 0
    buffer_load_dwordx4 v[132:135], v3, s[8:11], s22 offen offset:0 sc1
    v_exp_f32 v52, v52
    v_exp_f32 v53, v53
    v_exp_f32 v54, v54
    v_exp_f32_e64 v55, v55
    v_cvt_pk_bf16_f32 v80, v48, v49
    v_cvt_pk_bf16_f32 v81, v50, v51
    v_cvt_pk_bf16_f32 v82, v52, v53
    v_cvt_pk_bf16_f32 v83, v54, v55
    v_mfma_f32_32x32x8bf16_1k v[32:47], v[96:97], v[10:11], v[32:47]
    ds_read_b128 v[92:95], v6 offset:1024
    ds_read_b64 v[98:99], v7 offset:512
    buffer_load_dwordx4 v[136:139], v3, s[8:11], s22 offen offset:1024 sc1
    v_exp_f32 v56, v56
    v_exp_f32 v57, v57
    v_exp_f32 v58, v58
    v_exp_f32_e64 v59, v59
    s_waitcnt lgkmcnt(2)
    v_mfma_f32_32x32x16_bf16 v[64:79], v[108:111], v[80:83], v[64:79]
    v_add_u32 v8, 147456, v5
    v_exp_f32 v60, v60
    s_mov_b64 exec, s[78:79]
    ds_read_b128 v[100:103], v8 offset:0
    ds_read_b128 v[104:107], v8 offset:640
    s_mov_b64 exec, -1
    v_exp_f32 v61, v61
    v_exp_f32 v62, v62
    v_exp_f32_e64 v63, v63
    s_waitcnt lgkmcnt(2)
    v_cvt_pk_bf16_f32 v84, v56, v57
    v_cvt_pk_bf16_f32 v85, v58, v59
    v_cvt_pk_bf16_f32 v86, v60, v61
    v_cvt_pk_bf16_f32 v87, v62, v63
    v_mfma_f32_32x32x16_bf16 v[48:63], v[92:95], v[12:15], v[16:31]
    v_exp_f32 v32, v32
    v_exp_f32 v33, v33
    v_exp_f32 v34, v34
    v_exp_f32 v35, v35
    v_mfma_f32_32x32x16_bf16 v[64:79], v[112:115], v[84:87], v[64:79]
    s_setprio 3
    s_waitcnt vmcnt(49)
    s_barrier
    s_add_u32 m0, s84, 88064
    s_nop 0
    buffer_load_dwordx4 v3, s[8:11], s27 offen sc1 lds
    s_add_u32 s27, s27, 8192
    v_exp_f32 v36, v36
    v_exp_f32 v37, v37
    v_exp_f32 v38, v38
    v_exp_f32 v39, v39
    v_cvt_pk_bf16_f32 v80, v32, v33
    v_cvt_pk_bf16_f32 v81, v34, v35
    v_cvt_pk_bf16_f32 v82, v36, v37
    v_cvt_pk_bf16_f32 v83, v38, v39
    v_mfma_f32_32x32x8bf16_1k v[48:63], v[98:99], v[10:11], v[48:63]
    ds_read_b128 v[88:91], v6 offset:2048
    ds_read_b64 v[96:97], v7 offset:1024
    buffer_load_dwordx4 v[156:159], v3, s[8:11], s22 offen offset:2048 sc1
    v_exp_f32 v40, v40
    v_exp_f32 v41, v41
    v_exp_f32 v42, v42
    v_exp_f32_e64 v43, v43
    s_waitcnt lgkmcnt(2)
    v_mfma_f32_32x32x16_bf16 v[64:79], v[100:103], v[80:83], v[64:79]
    v_exp_f32 v44, v44
    s_mov_b64 exec, s[78:79]
    ds_read_b128 v[108:111], v8 offset:1280
    ds_read_b128 v[112:115], v8 offset:1920
    s_mov_b64 exec, -1
    v_exp_f32 v45, v45
    v_exp_f32 v46, v46
    v_exp_f32_e64 v47, v47
    s_waitcnt lgkmcnt(2)
    v_cvt_pk_bf16_f32 v84, v40, v41
    v_cvt_pk_bf16_f32 v85, v42, v43
    v_cvt_pk_bf16_f32 v86, v44, v45
    v_cvt_pk_bf16_f32 v87, v46, v47
    v_mfma_f32_32x32x16_bf16 v[32:47], v[88:91], v[12:15], v[16:31]
    v_exp_f32 v48, v48
    v_exp_f32 v49, v49
    v_exp_f32 v50, v50
    v_exp_f32 v51, v51
    v_mfma_f32_32x32x16_bf16 v[64:79], v[104:107], v[84:87], v[64:79]
    s_setprio 2
    s_add_u32 m0, s84, 96256
    s_nop 0
    buffer_load_dwordx4 v3, s[8:11], s27 offen sc1 lds
    s_add_u32 s27, s27, 8192
    v_exp_f32 v52, v52
    v_exp_f32 v53, v53
    v_exp_f32 v54, v54
    v_exp_f32 v55, v55
    v_cvt_pk_bf16_f32 v80, v48, v49
    v_cvt_pk_bf16_f32 v81, v50, v51
    v_cvt_pk_bf16_f32 v82, v52, v53
    v_cvt_pk_bf16_f32 v83, v54, v55
    v_mfma_f32_32x32x8bf16_1k v[32:47], v[96:97], v[10:11], v[32:47]
    ds_read_b128 v[92:95], v6 offset:3072
    ds_read_b64 v[98:99], v7 offset:1536
    v_exp_f32 v56, v56
    v_exp_f32 v57, v57
    v_exp_f32 v58, v58
    v_exp_f32_e64 v59, v59
    s_waitcnt lgkmcnt(2)
    v_mfma_f32_32x32x16_bf16 v[64:79], v[108:111], v[80:83], v[64:79]
    v_exp_f32 v60, v60
    s_mov_b64 exec, s[78:79]
    ds_read_b128 v[100:103], v8 offset:2560
    ds_read_b128 v[104:107], v8 offset:3200
    s_mov_b64 exec, -1
    v_exp_f32 v61, v61
    v_exp_f32 v62, v62
    v_exp_f32_e64 v63, v63
    s_waitcnt lgkmcnt(2)
    v_cvt_pk_bf16_f32 v84, v56, v57
    v_cvt_pk_bf16_f32 v85, v58, v59
    v_cvt_pk_bf16_f32 v86, v60, v61
    v_cvt_pk_bf16_f32 v87, v62, v63
    v_mfma_f32_32x32x16_bf16 v[48:63], v[92:95], v[12:15], v[16:31]
    v_exp_f32 v32, v32
    v_exp_f32 v33, v33
    v_exp_f32 v34, v34
    v_exp_f32 v35, v35
    v_mfma_f32_32x32x16_bf16 v[64:79], v[112:115], v[84:87], v[64:79]
    s_setprio 1
    s_add_u32 m0, s84, 104448
    s_nop 0
    buffer_load_dwordx4 v3, s[8:11], s27 offen sc1 lds
    s_add_u32 s27, s27, 8192
    v_exp_f32 v36, v36
    v_exp_f32 v37, v37
    v_exp_f32 v38, v38
    v_exp_f32 v39, v39
    v_cvt_pk_bf16_f32 v80, v32, v33
    v_cvt_pk_bf16_f32 v81, v34, v35
    v_cvt_pk_bf16_f32 v82, v36, v37
    v_cvt_pk_bf16_f32 v83, v38, v39
    v_mfma_f32_32x32x8bf16_1k v[48:63], v[98:99], v[10:11], v[48:63]
    ds_read_b128 v[88:91], v6 offset:4096
    ds_read_b64 v[96:97], v7 offset:2048
    v_exp_f32 v40, v40
    v_exp_f32 v41, v41
    v_exp_f32 v42, v42
    v_exp_f32_e64 v43, v43
    s_waitcnt lgkmcnt(2)
    v_mfma_f32_32x32x16_bf16 v[64:79], v[100:103], v[80:83], v[64:79]
    v_exp_f32 v44, v44
    s_mov_b64 exec, s[78:79]
    ds_read_b128 v[108:111], v8 offset:3840
    ds_read_b128 v[112:115], v8 offset:4480
    s_mov_b64 exec, -1
    v_exp_f32 v45, v45
    v_exp_f32 v46, v46
    v_exp_f32_e64 v47, v47
    s_waitcnt lgkmcnt(2)
    v_cvt_pk_bf16_f32 v84, v40, v41
    v_cvt_pk_bf16_f32 v85, v42, v43
    v_cvt_pk_bf16_f32 v86, v44, v45
    v_cvt_pk_bf16_f32 v87, v46, v47
    v_mfma_f32_32x32x16_bf16 v[32:47], v[88:91], v[12:15], v[16:31]
    v_exp_f32 v48, v48
    v_exp_f32 v49, v49
    v_exp_f32 v50, v50
    v_exp_f32 v51, v51
    v_mfma_f32_32x32x16_bf16 v[64:79], v[104:107], v[84:87], v[64:79]
    s_setprio 0
    s_add_u32 m0, s84, 112640
    s_nop 0
    buffer_load_dwordx4 v3, s[8:11], s27 offen sc1 lds
    s_add_u32 s27, s27, 8192
    v_exp_f32 v52, v52
    v_exp_f32 v53, v53
    v_exp_f32 v54, v54
    v_exp_f32 v55, v55
    v_cvt_pk_bf16_f32 v80, v48, v49
    v_cvt_pk_bf16_f32 v81, v50, v51
    v_cvt_pk_bf16_f32 v82, v52, v53
    v_cvt_pk_bf16_f32 v83, v54, v55
    v_mfma_f32_32x32x8bf16_1k v[32:47], v[96:97], v[10:11], v[32:47]
    ds_read_b128 v[92:95], v6 offset:5120
    ds_read_b64 v[98:99], v7 offset:2560
    v_exp_f32 v56, v56
    v_exp_f32 v57, v57
    v_exp_f32 v58, v58
    v_exp_f32_e64 v59, v59
    s_waitcnt lgkmcnt(2)
    v_mfma_f32_32x32x16_bf16 v[64:79], v[108:111], v[80:83], v[64:79]
    v_exp_f32 v60, v60
    s_mov_b64 exec, s[78:79]
    ds_read_b128 v[100:103], v8 offset:5120
    ds_read_b128 v[104:107], v8 offset:5760
    s_mov_b64 exec, -1
    v_exp_f32 v61, v61
    v_exp_f32 v62, v62
    v_exp_f32_e64 v63, v63
    s_waitcnt lgkmcnt(2)
    v_cvt_pk_bf16_f32 v84, v56, v57
    v_cvt_pk_bf16_f32 v85, v58, v59
    v_cvt_pk_bf16_f32 v86, v60, v61
    v_cvt_pk_bf16_f32 v87, v62, v63
    v_mfma_f32_32x32x16_bf16 v[48:63], v[92:95], v[12:15], v[16:31]
    v_exp_f32 v32, v32
    v_exp_f32 v33, v33
    v_exp_f32 v34, v34
    v_exp_f32 v35, v35
    v_mfma_f32_32x32x16_bf16 v[64:79], v[112:115], v[84:87], v[64:79]
    s_setprio 3
    s_add_u32 m0, s84, 120832
    s_nop 0
    buffer_load_dwordx4 v3, s[8:11], s27 offen sc1 lds
    s_add_u32 s27, s27, 8192
    v_exp_f32 v36, v36
    v_exp_f32 v37, v37
    v_exp_f32 v38, v38
    v_exp_f32 v39, v39
    v_cvt_pk_bf16_f32 v80, v32, v33
    v_cvt_pk_bf16_f32 v81, v34, v35
    v_cvt_pk_bf16_f32 v82, v36, v37
    v_cvt_pk_bf16_f32 v83, v38, v39
    v_mfma_f32_32x32x8bf16_1k v[48:63], v[98:99], v[10:11], v[48:63]
    ds_read_b128 v[88:91], v6 offset:6144
    ds_read_b64 v[96:97], v7 offset:3072
    v_exp_f32 v40, v40
    v_exp_f32 v41, v41
    v_exp_f32 v42, v42
    v_exp_f32_e64 v43, v43
    s_waitcnt lgkmcnt(2)
    v_mfma_f32_32x32x16_bf16 v[64:79], v[100:103], v[80:83], v[64:79]
    v_exp_f32 v44, v44
    s_mov_b64 exec, s[78:79]
    ds_read_b128 v[108:111], v8 offset:6400
    ds_read_b128 v[112:115], v8 offset:7040
    s_mov_b64 exec, -1
    v_exp_f32 v45, v45
    v_exp_f32 v46, v46
    v_exp_f32_e64 v47, v47
    s_waitcnt lgkmcnt(2)
    v_cvt_pk_bf16_f32 v84, v40, v41
    v_cvt_pk_bf16_f32 v85, v42, v43
    v_cvt_pk_bf16_f32 v86, v44, v45
    v_cvt_pk_bf16_f32 v87, v46, v47
    v_mfma_f32_32x32x16_bf16 v[32:47], v[88:91], v[12:15], v[16:31]
    v_exp_f32 v48, v48
    v_exp_f32 v49, v49
    v_exp_f32 v50, v50
    v_exp_f32 v51, v51
    v_mfma_f32_32x32x16_bf16 v[64:79], v[104:107], v[84:87], v[64:79]
    s_setprio 2
    v_exp_f32 v52, v52
    v_exp_f32 v53, v53
    v_exp_f32 v54, v54
    v_exp_f32_e64 v55, v55
    v_cvt_pk_bf16_f32 v80, v48, v49
    v_cvt_pk_bf16_f32 v81, v50, v51
    v_cvt_pk_bf16_f32 v82, v52, v53
    v_cvt_pk_bf16_f32 v83, v54, v55
    v_mfma_f32_32x32x8bf16_1k v[32:47], v[96:97], v[10:11], v[32:47]
    ds_read_b128 v[92:95], v6 offset:7168
    ds_read_b64 v[98:99], v7 offset:3584
    v_exp_f32 v56, v56
    v_exp_f32 v57, v57
    v_exp_f32 v58, v58
    v_exp_f32_e64 v59, v59
    s_waitcnt lgkmcnt(2)
    v_mfma_f32_32x32x16_bf16 v[64:79], v[108:111], v[80:83], v[64:79]
    v_exp_f32 v60, v60
    s_mov_b64 exec, s[78:79]
    ds_read_b128 v[100:103], v8 offset:7680
    ds_read_b128 v[104:107], v8 offset:8320
    s_mov_b64 exec, -1
    v_exp_f32 v61, v61
    v_exp_f32 v62, v62
    v_exp_f32_e64 v63, v63
    s_waitcnt lgkmcnt(2)
    v_cvt_pk_bf16_f32 v84, v56, v57
    v_cvt_pk_bf16_f32 v85, v58, v59
    v_cvt_pk_bf16_f32 v86, v60, v61
    v_cvt_pk_bf16_f32 v87, v62, v63
    v_mfma_f32_32x32x16_bf16 v[48:63], v[92:95], v[12:15], v[16:31]
    v_exp_f32 v32, v32
    v_exp_f32 v33, v33
    v_exp_f32 v34, v34
    v_exp_f32 v35, v35
    v_mfma_f32_32x32x16_bf16 v[64:79], v[112:115], v[84:87], v[64:79]
    s_setprio 1
    v_exp_f32 v36, v36
    v_exp_f32 v37, v37
    v_exp_f32 v38, v38
    v_exp_f32_e64 v39, v39
    v_cvt_pk_bf16_f32 v80, v32, v33
    v_cvt_pk_bf16_f32 v81, v34, v35
    v_cvt_pk_bf16_f32 v82, v36, v37
    v_cvt_pk_bf16_f32 v83, v38, v39
    v_mfma_f32_32x32x8bf16_1k v[48:63], v[98:99], v[10:11], v[48:63]
    v_add_u32_e64 v6, 0, v3
    v_add_u32 v7, 8192, v4
    ds_read_b128 v[88:91], v6 offset:0
    ds_read_b64 v[96:97], v7 offset:0
    v_exp_f32 v40, v40
    v_exp_f32 v41, v41
    v_exp_f32 v42, v42
    v_exp_f32_e64 v43, v43
    s_waitcnt lgkmcnt(2)
    v_mfma_f32_32x32x16_bf16 v[64:79], v[100:103], v[80:83], v[64:79]
    v_exp_f32 v44, v44
    s_mov_b64 exec, s[78:79]
    ds_read_b128 v[108:111], v8 offset:8960
    ds_read_b128 v[112:115], v8 offset:9600
    s_mov_b64 exec, -1
    v_exp_f32 v45, v45
    v_exp_f32 v46, v46
    v_exp_f32_e64 v47, v47
    s_waitcnt lgkmcnt(2)
    v_cvt_pk_bf16_f32 v84, v40, v41
    v_cvt_pk_bf16_f32 v85, v42, v43
    v_cvt_pk_bf16_f32 v86, v44, v45
    v_cvt_pk_bf16_f32 v87, v46, v47
    v_mfma_f32_32x32x16_bf16 v[32:47], v[88:91], v[12:15], v[16:31]
    v_exp_f32 v48, v48
    v_exp_f32 v49, v49
    v_exp_f32 v50, v50
    v_exp_f32 v51, v51
    v_mfma_f32_32x32x16_bf16 v[64:79], v[104:107], v[84:87], v[64:79]
    s_setprio 0
    v_exp_f32 v52, v52
    v_exp_f32 v53, v53
    v_exp_f32 v54, v54
    v_exp_f32_e64 v55, v55
    v_cvt_pk_bf16_f32 v80, v48, v49
    v_cvt_pk_bf16_f32 v81, v50, v51
    v_cvt_pk_bf16_f32 v82, v52, v53
    v_cvt_pk_bf16_f32 v83, v54, v55
    v_mfma_f32_32x32x8bf16_1k v[32:47], v[96:97], v[10:11], v[32:47]
    ds_read_b128 v[92:95], v6 offset:1024
    ds_read_b64 v[98:99], v7 offset:512
    v_exp_f32 v56, v56
    v_exp_f32 v57, v57
    v_exp_f32 v58, v58
    v_exp_f32_e64 v59, v59
    s_waitcnt lgkmcnt(2)
    v_mfma_f32_32x32x16_bf16 v[64:79], v[108:111], v[80:83], v[64:79]
    v_add_u32 v8, 12288, v5
    v_exp_f32 v60, v60
    s_mov_b64 exec, s[78:79]
    ds_read_b128 v[100:103], v8 offset:0
    ds_read_b128 v[104:107], v8 offset:640
    s_mov_b64 exec, -1
    v_exp_f32 v61, v61
    v_exp_f32 v62, v62
    v_exp_f32_e64 v63, v63
    s_waitcnt lgkmcnt(2)
    v_cvt_pk_bf16_f32 v84, v56, v57
    v_cvt_pk_bf16_f32 v85, v58, v59
    v_cvt_pk_bf16_f32 v86, v60, v61
    v_cvt_pk_bf16_f32 v87, v62, v63
    v_mfma_f32_32x32x16_bf16 v[48:63], v[92:95], v[12:15], v[16:31]
    v_exp_f32 v32, v32
    v_exp_f32 v33, v33
    v_exp_f32 v34, v34
    v_exp_f32 v35, v35
    v_mfma_f32_32x32x16_bf16 v[64:79], v[112:115], v[84:87], v[64:79]
    s_setprio 3
    v_exp_f32 v36, v36
    v_exp_f32 v37, v37
    v_exp_f32 v38, v38
    v_exp_f32_e64 v39, v39
    v_cvt_pk_bf16_f32 v80, v32, v33
    v_cvt_pk_bf16_f32 v81, v34, v35
    v_cvt_pk_bf16_f32 v82, v36, v37
    v_cvt_pk_bf16_f32 v83, v38, v39
    v_mfma_f32_32x32x8bf16_1k v[48:63], v[98:99], v[10:11], v[48:63]
    ds_read_b128 v[88:91], v6 offset:2048
    ds_read_b64 v[96:97], v7 offset:1024
    v_exp_f32 v40, v40
    v_exp_f32 v41, v41
    v_exp_f32 v42, v42
    v_exp_f32_e64 v43, v43
    s_waitcnt lgkmcnt(2)
    v_mfma_f32_32x32x16_bf16 v[64:79], v[100:103], v[80:83], v[64:79]
    v_exp_f32 v44, v44
    s_mov_b64 exec, s[78:79]
    ds_read_b128 v[108:111], v8 offset:1280
    ds_read_b128 v[112:115], v8 offset:1920
    s_mov_b64 exec, -1
    v_exp_f32 v45, v45
    v_exp_f32 v46, v46
    v_exp_f32_e64 v47, v47
    s_waitcnt lgkmcnt(2)
    v_cvt_pk_bf16_f32 v84, v40, v41
    v_cvt_pk_bf16_f32 v85, v42, v43
    v_cvt_pk_bf16_f32 v86, v44, v45
    v_cvt_pk_bf16_f32 v87, v46, v47
    v_mfma_f32_32x32x16_bf16 v[32:47], v[88:91], v[12:15], v[16:31]
    v_exp_f32 v48, v48
    v_exp_f32 v49, v49
    v_exp_f32 v50, v50
    v_exp_f32 v51, v51
    v_mfma_f32_32x32x16_bf16 v[64:79], v[104:107], v[84:87], v[64:79]
    s_setprio 2
    v_exp_f32 v52, v52
    v_exp_f32 v53, v53
    v_exp_f32 v54, v54
    v_exp_f32_e64 v55, v55
    v_cvt_pk_bf16_f32 v80, v48, v49
    v_cvt_pk_bf16_f32 v81, v50, v51
    v_cvt_pk_bf16_f32 v82, v52, v53
    v_cvt_pk_bf16_f32 v83, v54, v55
    v_mfma_f32_32x32x8bf16_1k v[32:47], v[96:97], v[10:11], v[32:47]
    ds_read_b128 v[92:95], v6 offset:3072
    ds_read_b64 v[98:99], v7 offset:1536
    v_exp_f32 v56, v56
    v_exp_f32 v57, v57
    v_exp_f32 v58, v58
    v_exp_f32_e64 v59, v59
    s_waitcnt lgkmcnt(2)
    v_mfma_f32_32x32x16_bf16 v[64:79], v[108:111], v[80:83], v[64:79]
    v_exp_f32 v60, v60
    s_mov_b64 exec, s[78:79]
    ds_read_b128 v[100:103], v8 offset:2560
    ds_read_b128 v[104:107], v8 offset:3200
    s_mov_b64 exec, -1
    v_exp_f32 v61, v61
    v_exp_f32 v62, v62
    v_exp_f32_e64 v63, v63
    s_waitcnt lgkmcnt(2)
    v_cvt_pk_bf16_f32 v84, v56, v57
    v_cvt_pk_bf16_f32 v85, v58, v59
    v_cvt_pk_bf16_f32 v86, v60, v61
    v_cvt_pk_bf16_f32 v87, v62, v63
    v_mfma_f32_32x32x16_bf16 v[48:63], v[92:95], v[12:15], v[16:31]
    v_exp_f32 v32, v32
    v_exp_f32 v33, v33
    v_exp_f32 v34, v34
    v_exp_f32 v35, v35
    v_mfma_f32_32x32x16_bf16 v[64:79], v[112:115], v[84:87], v[64:79]
    s_setprio 1
    s_waitcnt vmcnt(0)
    s_barrier
    v_exp_f32 v36, v36
    v_exp_f32 v37, v37
    v_exp_f32 v38, v38
    v_exp_f32_e64 v39, v39
    v_cvt_pk_bf16_f32 v80, v32, v33
    v_cvt_pk_bf16_f32 v81, v34, v35
    v_cvt_pk_bf16_f32 v82, v36, v37
    v_cvt_pk_bf16_f32 v83, v38, v39
    v_mfma_f32_32x32x8bf16_1k v[48:63], v[98:99], v[10:11], v[48:63]
    ds_read_b128 v[88:91], v6 offset:4096
    ds_read_b64 v[96:97], v7 offset:2048
    v_exp_f32 v40, v40
    v_exp_f32 v41, v41
    v_exp_f32 v42, v42
    v_exp_f32_e64 v43, v43
    s_waitcnt lgkmcnt(2)
    v_mfma_f32_32x32x16_bf16 v[64:79], v[100:103], v[80:83], v[64:79]
    v_exp_f32 v44, v44
    s_mov_b64 exec, s[78:79]
    ds_read_b128 v[108:111], v8 offset:3840
    ds_read_b128 v[112:115], v8 offset:4480
    s_mov_b64 exec, -1
    v_exp_f32 v45, v45
    v_exp_f32 v46, v46
    v_exp_f32_e64 v47, v47
    s_waitcnt lgkmcnt(2)
    v_cvt_pk_bf16_f32 v84, v40, v41
    v_cvt_pk_bf16_f32 v85, v42, v43
    v_cvt_pk_bf16_f32 v86, v44, v45
    v_cvt_pk_bf16_f32 v87, v46, v47
    v_mfma_f32_32x32x16_bf16 v[32:47], v[88:91], v[12:15], v[16:31]
    v_exp_f32 v48, v48
    v_exp_f32 v49, v49
    v_exp_f32 v50, v50
    v_exp_f32 v51, v51
    v_mfma_f32_32x32x16_bf16 v[64:79], v[104:107], v[84:87], v[64:79]
    s_setprio 0
    v_exp_f32 v52, v52
    v_exp_f32 v53, v53
    v_exp_f32 v54, v54
    v_exp_f32_e64 v55, v55
    v_cvt_pk_bf16_f32 v80, v48, v49
    v_cvt_pk_bf16_f32 v81, v50, v51
    v_cvt_pk_bf16_f32 v82, v52, v53
    v_cvt_pk_bf16_f32 v83, v54, v55
    v_mfma_f32_32x32x8bf16_1k v[32:47], v[96:97], v[10:11], v[32:47]
    ds_read_b128 v[92:95], v6 offset:5120
    ds_read_b64 v[98:99], v7 offset:2560
    v_exp_f32 v56, v56
    v_exp_f32 v57, v57
    v_exp_f32 v58, v58
    v_exp_f32_e64 v59, v59
    s_waitcnt lgkmcnt(2)
    v_mfma_f32_32x32x16_bf16 v[64:79], v[108:111], v[80:83], v[64:79]
    v_exp_f32 v60, v60
    s_mov_b64 exec, s[78:79]
    ds_read_b128 v[100:103], v8 offset:5120
    ds_read_b128 v[104:107], v8 offset:5760
    s_mov_b64 exec, -1
    v_exp_f32 v61, v61
    v_exp_f32 v62, v62
    v_exp_f32_e64 v63, v63
    s_waitcnt lgkmcnt(2)
    v_cvt_pk_bf16_f32 v84, v56, v57
    v_cvt_pk_bf16_f32 v85, v58, v59
    v_cvt_pk_bf16_f32 v86, v60, v61
    v_cvt_pk_bf16_f32 v87, v62, v63
    v_mfma_f32_32x32x16_bf16 v[48:63], v[92:95], v[12:15], v[16:31]
    v_exp_f32 v32, v32
    v_exp_f32 v33, v33
    v_exp_f32 v34, v34
    v_exp_f32 v35, v35
    v_mfma_f32_32x32x16_bf16 v[64:79], v[112:115], v[84:87], v[64:79]
    s_setprio 3
    v_exp_f32 v36, v36
    v_exp_f32 v37, v37
    v_exp_f32 v38, v38
    v_exp_f32_e64 v39, v39
    v_cvt_pk_bf16_f32 v80, v32, v33
    v_cvt_pk_bf16_f32 v81, v34, v35
    v_cvt_pk_bf16_f32 v82, v36, v37
    v_cvt_pk_bf16_f32 v83, v38, v39
    v_mfma_f32_32x32x8bf16_1k v[48:63], v[98:99], v[10:11], v[48:63]
    ds_read_b128 v[88:91], v6 offset:6144
    ds_read_b64 v[96:97], v7 offset:3072
    v_exp_f32 v40, v40
    v_exp_f32 v41, v41
    v_exp_f32 v42, v42
    v_exp_f32_e64 v43, v43
    s_waitcnt lgkmcnt(2)
    v_mfma_f32_32x32x16_bf16 v[64:79], v[100:103], v[80:83], v[64:79]
    v_exp_f32 v44, v44
    s_mov_b64 exec, s[78:79]
    ds_read_b128 v[108:111], v8 offset:6400
    ds_read_b128 v[112:115], v8 offset:7040
    s_mov_b64 exec, -1
    v_exp_f32 v45, v45
    v_exp_f32 v46, v46
    v_exp_f32_e64 v47, v47
    s_waitcnt lgkmcnt(2)
    v_cvt_pk_bf16_f32 v84, v40, v41
    v_cvt_pk_bf16_f32 v85, v42, v43
    v_cvt_pk_bf16_f32 v86, v44, v45
    v_cvt_pk_bf16_f32 v87, v46, v47
    v_mfma_f32_32x32x16_bf16 v[32:47], v[88:91], v[12:15], v[16:31]
    v_exp_f32 v48, v48
    v_exp_f32 v49, v49
    v_exp_f32 v50, v50
    v_exp_f32 v51, v51
    v_mfma_f32_32x32x16_bf16 v[64:79], v[104:107], v[84:87], v[64:79]
    s_setprio 2
    v_exp_f32 v52, v52
    v_exp_f32 v53, v53
    v_exp_f32 v54, v54
    v_exp_f32_e64 v55, v55
    v_cvt_pk_bf16_f32 v80, v48, v49
    v_cvt_pk_bf16_f32 v81, v50, v51
    v_cvt_pk_bf16_f32 v82, v52, v53
    v_cvt_pk_bf16_f32 v83, v54, v55
    v_mfma_f32_32x32x8bf16_1k v[32:47], v[96:97], v[10:11], v[32:47]
    ds_read_b128 v[92:95], v6 offset:7168
    ds_read_b64 v[98:99], v7 offset:3584
    v_exp_f32 v56, v56
    v_exp_f32 v57, v57
    v_exp_f32 v58, v58
    v_exp_f32_e64 v59, v59
    s_waitcnt lgkmcnt(2)
    v_mfma_f32_32x32x16_bf16 v[64:79], v[108:111], v[80:83], v[64:79]
    v_exp_f32 v60, v60
    s_mov_b64 exec, s[78:79]
    ds_read_b128 v[100:103], v8 offset:7680
    ds_read_b128 v[104:107], v8 offset:8320
    s_mov_b64 exec, -1
    v_exp_f32 v61, v61
    v_exp_f32 v62, v62
    v_exp_f32_e64 v63, v63
    s_waitcnt lgkmcnt(2)
    v_cvt_pk_bf16_f32 v84, v56, v57
    v_cvt_pk_bf16_f32 v85, v58, v59
    v_cvt_pk_bf16_f32 v86, v60, v61
    v_cvt_pk_bf16_f32 v87, v62, v63
    v_mfma_f32_32x32x16_bf16 v[48:63], v[92:95], v[12:15], v[16:31]
    v_exp_f32 v32, v32
    v_exp_f32 v33, v33
    v_exp_f32 v34, v34
    v_exp_f32 v35, v35
    v_mfma_f32_32x32x16_bf16 v[64:79], v[112:115], v[84:87], v[64:79]
    s_setprio 1
    v_exp_f32 v36, v36
    v_exp_f32 v37, v37
    v_exp_f32 v38, v38
    v_exp_f32_e64 v39, v39
    v_cvt_pk_bf16_f32 v80, v32, v33
    v_cvt_pk_bf16_f32 v81, v34, v35
    v_cvt_pk_bf16_f32 v82, v36, v37
    v_cvt_pk_bf16_f32 v83, v38, v39
    v_mfma_f32_32x32x8bf16_1k v[48:63], v[98:99], v[10:11], v[48:63]
    v_exp_f32 v40, v40
    v_exp_f32 v41, v41
    v_exp_f32 v42, v42
    v_exp_f32_e64 v43, v43
    s_waitcnt lgkmcnt(0)
    v_mfma_f32_32x32x16_bf16 v[64:79], v[100:103], v[80:83], v[64:79]
    v_exp_f32 v44, v44
    s_mov_b64 exec, s[78:79]
    ds_read_b128 v[108:111], v8 offset:8960
    ds_read_b128 v[112:115], v8 offset:9600
    s_mov_b64 exec, -1
    v_exp_f32 v45, v45
    v_exp_f32 v46, v46
    v_exp_f32 v47, v47
    v_cvt_pk_bf16_f32 v84, v40, v41
    v_cvt_pk_bf16_f32 v85, v42, v43
    v_cvt_pk_bf16_f32 v86, v44, v45
    v_cvt_pk_bf16_f32 v87, v46, v47
    v_exp_f32 v48, v48
    v_exp_f32 v49, v49
    v_exp_f32 v50, v50
    v_exp_f32 v51, v51
    v_mfma_f32_32x32x16_bf16 v[64:79], v[104:107], v[84:87], v[64:79]
    s_setprio 0
    v_exp_f32 v52, v52
    v_exp_f32 v53, v53
    v_exp_f32 v54, v54
    v_exp_f32_e64 v55, v55
    v_cvt_pk_bf16_f32 v80, v48, v49
    v_cvt_pk_bf16_f32 v81, v50, v51
    v_cvt_pk_bf16_f32 v82, v52, v53
    v_cvt_pk_bf16_f32 v83, v54, v55
    v_exp_f32 v56, v56
    v_exp_f32 v57, v57
    v_exp_f32 v58, v58
    v_exp_f32_e64 v59, v59
    s_waitcnt lgkmcnt(0)
    v_mfma_f32_32x32x16_bf16 v[64:79], v[108:111], v[80:83], v[64:79]
    v_exp_f32 v60, v60
    v_exp_f32 v61, v61
    v_exp_f32 v62, v62
    v_exp_f32 v63, v63
    v_cvt_pk_bf16_f32 v84, v56, v57
    v_cvt_pk_bf16_f32 v85, v58, v59
    v_cvt_pk_bf16_f32 v86, v60, v61
    v_cvt_pk_bf16_f32 v87, v62, v63
    s_nop 1
    v_mfma_f32_32x32x16_bf16 v[64:79], v[112:115], v[84:87], v[64:79]
    v_lshrrev_b32 v6, 4, v9
    v_mul_u32_u24 v6, 20480, v6
    v_and_b32_e64 v8, 15, v9
    v_lshl_add_u32 v7, v8, 3, v6
    v_lshl_add_u32 v6, v8, 4, v6
    v_lshrrev_b32_e64 v0, 5, v2
    v_lshl_add_u32 v6, v0, 8, v6
    s_waitcnt lgkmcnt(0)
    s_nop 3
    v_mul_f32 v84, 0x4d800000, v72
    v_add_f32 v84, v84, v64
    v_add_f32 v84, v84, v65
    v_add_f32 v84, v84, v66
    v_add_f32 v84, v84, v67
    v_add_f32 v84, v84, v68
    v_add_f32 v84, v84, v69
    v_add_f32 v84, v84, v70
    v_add_f32 v84, v84, v71
    v_add_f32 v84, v84, v72
    v_add_f32 v84, v84, v73
    v_add_f32 v84, v84, v74
    v_add_f32 v84, v84, v75
    v_mov_b32 v85, 0x207
    v_cmp_class_f32 vcc, v84, v85
    s_cbranch_vccnz kf_kernel_b_slow
kf_kernel_b_fin:
    v_mov_b32 v85, v72
    v_mov_b32 v86, v72
    s_nop 1
    v_permlane32_swap_b32 v85, v86
    v_rcp_f32_e64 v86, v86
    s_mul_i32 s67, s66, 40960
    s_add_u32 s67, s67, 20905984
    s_lshl_b32 s68, s65, 9
    s_add_u32 s68, s68, s67
    v_mul_f32 v64, v64, v86
    v_mul_f32 v65, v65, v86
    v_mul_f32 v66, v66, v86
    v_mul_f32 v67, v67, v86
    v_mul_f32 v68, v68, v86
    v_mul_f32 v69, v69, v86
    v_mul_f32 v70, v70, v86
    v_mul_f32 v71, v71, v86
    v_mul_f32 v72, v72, v86
    v_mul_f32 v73, v73, v86
    v_mul_f32 v74, v74, v86
    v_mul_f32 v75, v75, v86
    v_cvt_pk_bf16_f32 v80, v64, v65
    v_cvt_pk_bf16_f32 v81, v66, v67
    v_cvt_pk_bf16_f32 v82, v68, v69
    v_cvt_pk_bf16_f32 v83, v70, v71
    v_cvt_pk_bf16_f32 v84, v72, v73
    v_cvt_pk_bf16_f32 v85, v74, v75
    buffer_store_dwordx4 v[80:83], v6, s[8:11], s68 offen sc1
    s_lshl_b32 s68, s65, 7
    s_add_u32 s67, s67, s68
    s_add_u32 s67, s67, 16384
    s_mov_b32 exec_hi, zlit_b-zlit_a+(0)
    buffer_store_dwordx2 v[84:85], v7, s[8:11], s67 offen sc1
    s_mov_b64 exec, -1
    s_load_dwordx2 s[12:13], s[0:1], 48
    s_lshr_b32 s69, s64, 2
    s_mul_i32 s67, s69, 40960
    s_add_u32 s67, s67, 22528
    v_add_u32_e64 v8, s67, v3
    s_mul_i32 s67, s69, 10240
    s_add_u32 s67, s67, 104448
    v_add_u32_e64 v9, s67, v3
    ds_read_b128 v[76:79], v8 offset:0
    ds_read_b128 v[88:91], v8 offset:1024
    ds_read_b128 v[92:95], v8 offset:2048
    ds_read_b128 v[80:83], v8 offset:3072
    ds_read_b128 v[84:87], v8 offset:4096
    s_and_b32 s28, s64, 3
    s_lshl_b32 s29, s16, 2
    s_add_u32 s29, s29, s28
    s_lshl_b32 s33, s25, 2
    s_add_u32 s33, s33, s28
    v_and_b32 v7, 15, v2
    v_lshrrev_b32_e64 v6, 4, v2
    v_mul_u32_u24 v5, 1280, v7
    v_lshl_add_u32 v5, v6, 3, v5
    s_mul_i32 s32, s33, 20480
    s_mul_i32 s67, s26, 160
    s_add_u32 s32, s32, s67
    s_mul_i32 s67, s69, 96
    s_add_u32 s32, s32, s67
    v_lshlrev_b32 v7, 3, v7
    v_lshlrev_b32 v6, 4, v6
    v_bfe_u32 v4, v2, 4, 1
    v_lshl_add_u32 v4, v0, 2, v4
    v_lshl_add_u32 v4, v4, 7, v7
    s_mul_i32 s30, s33, 20480
    s_add_u32 s30, s30, 20905984
    s_lshl_b32 s67, s69, 11
    s_add_u32 s31, s30, s67
    s_add_u32 s31, s31, 16384
    s_lshl_b32 s67, s69, 13
    s_add_u32 s30, s30, s67
    s_add_u32 s39, s30, 4096
    s_mov_b32 s34, 0xbdd2d3e8
    s_mov_b32 s35, 0xc0135761
    s_mov_b32 s36, 1.0
    s_mov_b32 s37, 1.0
    s_lshl_b32 s38, s16, 18
    s_lshl_b32 s67, s28, zlit_b-zlit_a+(16)
    s_add_u32 s38, s38, s67
    s_add_u32 s38, s38, 4648960
    s_mul_i32 s67, s69, 192
    s_add_u32 s67, s67, 160768
    v_add_u32 v0, s67, v6
    s_lshl_b32 s40, s28, 12
    s_mul_i32 s67, s17, 458752
    s_mul_i32 s68, s28, 114688
    s_add_u32 s67, s67, s68
    s_lshl_b32 s68, s69, zlit_b-zlit_a+(12)
    s_add_u32 s67, s67, s68
    s_add_u32 s67, s67, 26148864
    s_and_b32 s68, s16, zlit_b-zlit_a+(0)
    s_mul_i32 s70, s68, 28672
    s_add_u32 s45, s70, s67
    s_add_u32 s68, s68, 1
    s_and_b32 s68, s68, zlit_b-zlit_a+(3)
    s_add_u32 s46, s45, 7168
    s_add_u32 s47, s45, 14336
    s_add_u32 s48, s45, 21504
    s_mul_i32 s70, s68, 28672
    s_add_u32 s49, s70, s67
    s_add_u32 s68, s68, 1
    s_and_b32 s68, s68, zlit_b-zlit_a+(3)
    s_add_u32 s50, s49, 7168
    s_add_u32 s51, s49, 14336
    s_add_u32 s52, s49, 21504
    s_mul_i32 s70, s68, 28672
    s_add_u32 s53, s70, s67
    s_add_u32 s68, s68, 1
    s_and_b32 s68, s68, zlit_b-zlit_a+(3)
    s_add_u32 s54, s53, 7168
    s_add_u32 s55, s53, 14336
    s_add_u32 s56, s53, 21504
    s_mul_i32 s70, s68, 28672
    s_add_u32 s57, s70, s67
    s_add_u32 s68, s68, 1
    s_and_b32 s68, s68, zlit_b-zlit_a+(3)
    s_add_u32 s58, s57, 7168
    s_add_u32 s59, s57, 14336
    s_add_u32 s60, s57, 21504
    s_setprio 0
    s_and_b32 s41, s2, 31
    s_lshr_b32 s42, s2, 5
    s_and_b32 s43, s25, 3
    s_lshl_b32 s43, s43, 3
    s_add_u32 s43, s43, s26
    s_lshr_b32 s44, s25, 2
    s_lshl_b32 s67, s41, 2
    s_lshl_b32 s70, s42, 12
    s_add_u32 s67, s67, s70
    s_add_u32 s67, s67, 36417536
    s_lshl_b32 s68, s43, 7
    s_lshl_b32 s70, s44, zlit_b-zlit_a+(12)
    s_add_u32 s68, s68, s70
    s_add_u32 s68, s68, 36417536
    v_lshlrev_b32 v56, 7, v2
    v_lshlrev_b32 v57, 2, v2
    v_mov_b32 v58, 1
    s_waitcnt vmcnt(0)
    s_cmp_eq_u32 s64, zlit_b-zlit_a+(3)
    s_barrier
    s_cbranch_scc1 kf_kernel_b_p1
    buffer_load_dwordx2 v[10:11], v5, s[80:83], s32 offen offset:0
    buffer_load_dwordx2 v[12:13], v5, s[80:83], s32 offen offset:32
    buffer_load_dwordx2 v[14:15], v5, s[80:83], s32 offen offset:64
    buffer_load_dwordx4 v[96:99], v3, s[8:11], s22 offen offset:3072 sc1
    s_add_u32 s22, s22, 4096
    buffer_load_dwordx4 v[100:103], v3, s[8:11], s22 offen offset:0 sc1
    buffer_load_dwordx4 v[104:107], v3, s[8:11], s22 offen offset:1024 sc1
    buffer_load_dwordx4 v[108:111], v3, s[8:11], s22 offen offset:2048 sc1
    buffer_load_dwordx4 v[112:115], v3, s[8:11], s22 offen offset:3072 sc1
    s_add_u32 s22, s22, 4096
    s_branch kf_kernel_b_go1
kf_kernel_b_p1:
    s_mov_b32 exec_hi, 0
    s_mov_b32 exec_lo, zlit_b-zlit_a+(-1)
    buffer_store_dword v58, v56, s[8:11], s67 offen sc1
    s_mov_b64 exec, -1
    buffer_load_dwordx2 v[10:11], v5, s[80:83], s32 offen offset:0
    buffer_load_dwordx2 v[12:13], v5, s[80:83], s32 offen offset:32
    buffer_load_dwordx2 v[14:15], v5, s[80:83], s32 offen offset:64
    buffer_load_dwordx4 v[96:99], v3, s[8:11], s22 offen offset:3072 sc1
    s_add_u32 s22, s22, 4096
    buffer_load_dwordx4 v[100:103], v3, s[8:11], s22 offen offset:0 sc1
    buffer_load_dwordx4 v[104:107], v3, s[8:11], s22 offen offset:1024 sc1
    buffer_load_dwordx4 v[108:111], v3, s[8:11], s22 offen offset:2048 sc1
    buffer_load_dwordx4 v[112:115], v3, s[8:11], s22 offen offset:3072 sc1
    s_add_u32 s22, s22, 4096
    s_mov_b32 exec_hi, 0
    s_mov_b32 exec_lo, -1
    s_mov_b32 s70, 0
    buffer_load_dword v59, v57, s[8:11], s68 offen sc1
kf_kernel_b_poll1:
    s_waitcnt vmcnt(0)
    v_cmp_ne_u32 vcc, 1, v59
    s_cbranch_vccz kf_kernel_b_go1
    s_sleep 1
    buffer_load_dword v59, v57, s[8:11], s68 offen sc1
    s_add_u32 s70, s70, zlit_b-zlit_a+(1)
    s_cmp_lt_u32 s70, 0x40000
    s_cbranch_scc1 kf_kernel_b_poll1
kf_kernel_b_go1:
    s_mov_b64 exec, -1
    s_barrier
    buffer_load_dwordx4 v[16:19], v3, s[8:11], s30 offen offset:0 sc1
    buffer_load_dwordx4 v[20:23], v3, s[8:11], s30 offen offset:1024 sc1
    buffer_load_dwordx4 v[24:27], v3, s[8:11], s30 offen offset:2048 sc1
    buffer_load_dwordx4 v[28:31], v3, s[8:11], s30 offen offset:3072 sc1
    buffer_load_dwordx4 v[32:35], v3, s[8:11], s39 offen offset:0 sc1
    buffer_load_dwordx4 v[36:39], v3, s[8:11], s39 offen offset:1024 sc1
    buffer_load_dwordx4 v[40:43], v3, s[8:11], s39 offen offset:2048 sc1
    buffer_load_dwordx4 v[44:47], v3, s[8:11], s39 offen offset:3072 sc1
    buffer_load_dwordx2 v[48:49], v4, s[8:11], s31 offen offset:0 sc1
    buffer_load_dwordx2 v[50:51], v4, s[8:11], s31 offen offset:256 sc1
    buffer_load_dwordx2 v[52:53], v4, s[8:11], s31 offen offset:1024 sc1
    buffer_load_dwordx2 v[54:55], v4, s[8:11], s31 offen offset:1280 sc1
    s_mul_i32 s30, s25, 81920
    s_mul_i32 s67, s26, 10240
    s_add_u32 s30, s30, s67
    s_mul_i32 s67, s28, 2560
    s_add_u32 s30, s30, s67
    s_add_u32 s30, s30, 23527424
    s_lshl_b32 s31, s25, 13
    s_lshl_b32 s67, s26, 10
    s_add_u32 s31, s31, s67
    s_lshl_b32 s67, s28, 8
    s_add_u32 s31, s31, s67
    s_add_u32 s31, s31, 53248
    s_mul_i32 s67, s28, 5120
    s_add_u32 s67, s67, 0
    v_add_u32 v4, s67, v3
    s_waitcnt lgkmcnt(0)
    s_waitcnt vmcnt(11)
    v_mfma_f32_16x16x32_bf16 v[56:59], v[76:79], v[16:19], 0
    ds_read_b128 v[76:79], v8 offset:5120
    v_mfma_f32_16x16x32_bf16 v[60:63], v[88:91], v[16:19], 0
    ds_read_b128 v[88:91], v8 offset:6144
    v_mfma_f32_16x16x32_bf16 v[64:67], v[92:95], v[16:19], 0
    ds_read_b128 v[92:95], v8 offset:7168
    v_mfma_f32_16x16x32_bf16 v[68:71], v[80:83], v[16:19], 0
    ds_read_b128 v[80:83], v8 offset:8192
    v_mfma_f32_16x16x32_bf16 v[72:75], v[84:87], v[16:19], 0
    ds_read_b128 v[84:87], v8 offset:9216
    ds_read_b128 v[16:19], v8 offset:10240
    s_waitcnt vmcnt(10)
    s_waitcnt lgkmcnt(5)
    v_mfma_f32_16x16x32_bf16 v[56:59], v[76:79], v[20:23], v[56:59]
    ds_read_b128 v[76:79], v8 offset:11264
    s_waitcnt lgkmcnt(5)
    v_mfma_f32_16x16x32_bf16 v[60:63], v[88:91], v[20:23], v[60:63]
    ds_read_b128 v[88:91], v8 offset:12288
    s_waitcnt lgkmcnt(5)
    v_mfma_f32_16x16x32_bf16 v[64:67], v[92:95], v[20:23], v[64:67]
    ds_read_b128 v[92:95], v8 offset:13312
    s_waitcnt lgkmcnt(5)
    v_mfma_f32_16x16x32_bf16 v[68:71], v[80:83], v[20:23], v[68:71]
    ds_read_b128 v[80:83], v8 offset:14336
    s_waitcnt lgkmcnt(5)
    v_mfma_f32_16x16x32_bf16 v[72:75], v[84:87], v[20:23], v[72:75]
    ds_read_b128 v[84:87], v8 offset:15360
    ds_read_b128 v[20:23], v8 offset:16384
    s_waitcnt vmcnt(9)
    s_waitcnt lgkmcnt(6)
    v_mfma_f32_16x16x32_bf16 v[56:59], v[16:19], v[24:27], v[56:59]
    ds_read_b128 v[16:19], v8 offset:17408
    s_waitcnt lgkmcnt(6)
    v_mfma_f32_16x16x32_bf16 v[60:63], v[76:79], v[24:27], v[60:63]
    ds_read_b128 v[76:79], v8 offset:18432
    s_waitcnt lgkmcnt(6)
    v_mfma_f32_16x16x32_bf16 v[64:67], v[88:91], v[24:27], v[64:67]
    ds_read_b128 v[88:91], v8 offset:19456
    s_waitcnt lgkmcnt(6)
    v_mfma_f32_16x16x32_bf16 v[68:71], v[92:95], v[24:27], v[68:71]
    ds_read_b128 v[92:95], v8 offset:20480
    s_waitcnt lgkmcnt(6)
    v_mfma_f32_16x16x32_bf16 v[72:75], v[80:83], v[24:27], v[72:75]
    ds_read_b128 v[80:83], v8 offset:21504
    ds_read_b128 v[24:27], v8 offset:22528
    s_waitcnt vmcnt(8)
    s_waitcnt lgkmcnt(7)
    v_mfma_f32_16x16x32_bf16 v[56:59], v[84:87], v[28:31], v[56:59]
    ds_read_b128 v[84:87], v8 offset:23552
    s_waitcnt lgkmcnt(7)
    v_mfma_f32_16x16x32_bf16 v[60:63], v[20:23], v[28:31], v[60:63]
    ds_read_b128 v[20:23], v8 offset:24576
    s_waitcnt lgkmcnt(7)
    v_mfma_f32_16x16x32_bf16 v[64:67], v[16:19], v[28:31], v[64:67]
    ds_read_b128 v[16:19], v8 offset:25600
    s_waitcnt lgkmcnt(7)
    v_mfma_f32_16x16x32_bf16 v[68:71], v[76:79], v[28:31], v[68:71]
    ds_read_b128 v[76:79], v8 offset:26624
    s_waitcnt lgkmcnt(7)
    v_mfma_f32_16x16x32_bf16 v[72:75], v[88:91], v[28:31], v[72:75]
    ds_read_b128 v[88:91], v8 offset:27648
    ds_read_b128 v[28:31], v8 offset:28672
    s_waitcnt vmcnt(7)
    s_waitcnt lgkmcnt(8)
    v_mfma_f32_16x16x32_bf16 v[56:59], v[92:95], v[32:35], v[56:59]
    ds_read_b128 v[92:95], v8 offset:29696
    s_waitcnt lgkmcnt(8)
    v_mfma_f32_16x16x32_bf16 v[60:63], v[80:83], v[32:35], v[60:63]
    ds_read_b128 v[80:83], v8 offset:30720
    s_waitcnt lgkmcnt(8)
    v_mfma_f32_16x16x32_bf16 v[64:67], v[24:27], v[32:35], v[64:67]
    ds_read_b128 v[24:27], v8 offset:31744
    s_waitcnt lgkmcnt(8)
    v_mfma_f32_16x16x32_bf16 v[68:71], v[84:87], v[32:35], v[68:71]
    ds_read_b128 v[84:87], v8 offset:32768
    s_waitcnt lgkmcnt(8)
    v_mfma_f32_16x16x32_bf16 v[72:75], v[20:23], v[32:35], v[72:75]
    ds_read_b128 v[20:23], v8 offset:33792
    ds_read_b128 v[32:35], v8 offset:34816
    s_waitcnt vmcnt(6)
    s_waitcnt lgkmcnt(9)
    v_mfma_f32_16x16x32_bf16 v[56:59], v[16:19], v[36:39], v[56:59]
    ds_read_b128 v[16:19], v8 offset:35840
    s_waitcnt lgkmcnt(9)
    v_mfma_f32_16x16x32_bf16 v[60:63], v[76:79], v[36:39], v[60:63]
    ds_read_b128 v[76:79], v8 offset:36864
    s_waitcnt lgkmcnt(9)
    v_mfma_f32_16x16x32_bf16 v[64:67], v[88:91], v[36:39], v[64:67]
    ds_read_b128 v[88:91], v8 offset:37888
    s_waitcnt lgkmcnt(9)
    v_mfma_f32_16x16x32_bf16 v[68:71], v[28:31], v[36:39], v[68:71]
    ds_read_b128 v[28:31], v8 offset:38912
    s_waitcnt lgkmcnt(9)
    v_mfma_f32_16x16x32_bf16 v[72:75], v[92:95], v[36:39], v[72:75]
    ds_read_b128 v[92:95], v8 offset:39936
    s_waitcnt vmcnt(5)
    s_waitcnt lgkmcnt(9)
    v_mfma_f32_16x16x32_bf16 v[56:59], v[80:83], v[40:43], v[56:59]
    ds_read_b128 v[80:83], v9 offset:0
    s_waitcnt lgkmcnt(9)
    v_mfma_f32_16x16x32_bf16 v[60:63], v[24:27], v[40:43], v[60:63]
    ds_read_b128 v[24:27], v9 offset:1024
    s_waitcnt lgkmcnt(9)
    v_mfma_f32_16x16x32_bf16 v[64:67], v[84:87], v[40:43], v[64:67]
    ds_read_b128 v[84:87], v9 offset:2048
    s_waitcnt lgkmcnt(9)
    v_mfma_f32_16x16x32_bf16 v[68:71], v[20:23], v[40:43], v[68:71]
    ds_read_b128 v[20:23], v9 offset:3072
    s_waitcnt lgkmcnt(9)
    v_mfma_f32_16x16x32_bf16 v[72:75], v[32:35], v[40:43], v[72:75]
    ds_read_b128 v[32:35], v9 offset:4096
    s_waitcnt vmcnt(4)
    s_waitcnt lgkmcnt(9)
    v_mfma_f32_16x16x32_bf16 v[56:59], v[16:19], v[44:47], v[56:59]
    ds_read_b128 v[16:19], v9 offset:5120
    s_waitcnt lgkmcnt(9)
    v_mfma_f32_16x16x32_bf16 v[60:63], v[76:79], v[44:47], v[60:63]
    ds_read_b128 v[76:79], v9 offset:6144
    s_waitcnt lgkmcnt(9)
    v_mfma_f32_16x16x32_bf16 v[64:67], v[88:91], v[44:47], v[64:67]
    ds_read_b128 v[88:91], v9 offset:7168
    s_waitcnt lgkmcnt(9)
    v_mfma_f32_16x16x32_bf16 v[68:71], v[28:31], v[44:47], v[68:71]
    ds_read_b128 v[28:31], v9 offset:8192
    s_waitcnt lgkmcnt(9)
    v_mfma_f32_16x16x32_bf16 v[72:75], v[92:95], v[44:47], v[72:75]
    ds_read_b128 v[92:95], v9 offset:9216
    ds_read_b128 v[36:39], v0 offset:0
    ds_read_b128 v[40:43], v0 offset:64
    ds_read_b128 v[44:47], v0 offset:128
    s_waitcnt vmcnt(2)
    s_waitcnt lgkmcnt(12)
    v_mfma_f32_16x16x32_bf16 v[56:59], v[80:83], v[48:51], v[56:59]
    s_waitcnt lgkmcnt(11)
    v_mfma_f32_16x16x32_bf16 v[60:63], v[24:27], v[48:51], v[60:63]
    s_waitcnt lgkmcnt(10)
    v_mfma_f32_16x16x32_bf16 v[64:67], v[84:87], v[48:51], v[64:67]
    s_waitcnt lgkmcnt(9)
    v_mfma_f32_16x16x32_bf16 v[68:71], v[20:23], v[48:51], v[68:71]
    s_waitcnt lgkmcnt(8)
    v_mfma_f32_16x16x32_bf16 v[72:75], v[32:35], v[48:51], v[72:75]
    ds_read_b128 v[80:83], v0 offset:320
    ds_read_b128 v[24:27], v0 offset:384
    ds_read_b128 v[84:87], v0 offset:448
    s_waitcnt vmcnt(0)
    s_waitcnt lgkmcnt(10)
    v_mfma_f32_16x16x32_bf16 v[56:59], v[16:19], v[52:55], v[56:59]
    s_waitcnt lgkmcnt(9)
    v_mfma_f32_16x16x32_bf16 v[60:63], v[76:79], v[52:55], v[60:63]
    s_waitcnt lgkmcnt(8)
    v_mfma_f32_16x16x32_bf16 v[64:67], v[88:91], v[52:55], v[64:67]
    s_waitcnt lgkmcnt(7)
    v_mfma_f32_16x16x32_bf16 v[68:71], v[28:31], v[52:55], v[68:71]
    s_waitcnt lgkmcnt(6)
    v_mfma_f32_16x16x32_bf16 v[72:75], v[92:95], v[52:55], v[72:75]
    v_mov_b32 v8, 0x3f803f80
    v_lshlrev_b32 v9, 3, v2
    s_cmp_eq_u32 s69, 0
    s_cbranch_scc0 kf_kernel_b_kh1
    s_nop 1
    ds_write_b128 v4, v[68:71] offset:3072
    s_nop 0
    ds_write_b128 v4, v[72:75] offset:4096
    s_cmp_eq_u32 s28, zlit_b-zlit_a+(3)
    s_cbranch_scc0 kf_kernel_b_re0
    s_add_u32 s67, s38, 4096
    buffer_load_dwordx4 v[160:163], v3, s[8:11], s67 offen offset:0 sc1
    buffer_load_dwordx4 v[164:167], v3, s[8:11], s67 offen offset:1024 sc1
    buffer_load_dwordx4 v[168:171], v3, s[8:11], s67 offen offset:2048 sc1
    buffer_load_dwordx4 v[172:175], v3, s[8:11], s67 offen offset:3072 sc1
    s_add_u32 s67, s38, 45056
    buffer_load_dwordx4 v[176:179], v3, s[8:11], s67 offen offset:0 sc1
    buffer_load_dwordx4 v[180:183], v3, s[8:11], s67 offen offset:1024 sc1
    buffer_load_dwordx4 v[184:187], v3, s[8:11], s67 offen offset:2048 sc1
    buffer_load_dwordx4 v[188:191], v3, s[8:11], s67 offen offset:3072 sc1
    s_add_u32 s67, s38, 49152
    buffer_load_dwordx4 v[192:195], v3, s[8:11], s67 offen offset:0 sc1
    buffer_load_dwordx4 v[196:199], v3, s[8:11], s67 offen offset:1024 sc1
    buffer_load_dwordx4 v[200:203], v3, s[8:11], s67 offen offset:2048 sc1
    buffer_load_dwordx4 v[204:207], v3, s[8:11], s67 offen offset:3072 sc1
    s_add_u32 s67, s38, 53248
    buffer_load_dwordx4 v[208:211], v3, s[8:11], s67 offen offset:0 sc1
    buffer_load_dwordx4 v[212:215], v3, s[8:11], s67 offen offset:1024 sc1
    buffer_load_dwordx4 v[216:219], v3, s[8:11], s67 offen offset:2048 sc1
    buffer_load_dwordx4 v[220:223], v3, s[8:11], s67 offen offset:3072 sc1
    s_add_u32 s67, s38, 57344
    buffer_load_dwordx4 v[224:227], v3, s[8:11], s67 offen offset:0 sc1
    buffer_load_dwordx4 v[228:231], v3, s[8:11], s67 offen offset:1024 sc1
    buffer_load_dwordx4 v[232:235], v3, s[8:11], s67 offen offset:2048 sc1
    buffer_load_dwordx4 v[236:239], v3, s[8:11], s67 offen offset:3072 sc1
kf_kernel_b_re0:
    v_lshlrev_b32_e64 v32, 16, v10
    v_and_b32 v33, 0xffff0000, v10
    v_lshlrev_b32_e64 v34, 16, v11
    v_and_b32 v35, 0xffff0000, v11
    v_lshlrev_b32_e64 v48, 16, v12
    v_and_b32 v49, 0xffff0000, v12
    v_lshlrev_b32_e64 v50, 16, v13
    v_and_b32 v51, 0xffff0000, v13
    v_lshlrev_b32_e64 v52, 16, v14
    v_and_b32 v53, 0xffff0000, v14
    v_lshlrev_b32_e64 v54, 16, v15
    v_and_b32 v55, 0xffff0000, v15
    s_waitcnt lgkmcnt(0)
    s_barrier
    ds_read_b128 v[76:79], v4 offset:0
    ds_read_b128 v[88:91], v4 offset:1024
    ds_read_b128 v[92:95], v4 offset:2048
    s_waitcnt lgkmcnt(2)
    v_pk_add_f32 v[56:57], v[56:57], v[76:77]
    v_pk_add_f32 v[58:59], v[58:59], v[78:79]
    v_pk_fma_f32 v[32:33], v[56:57], v[36:37], v[32:33]
    v_pk_fma_f32 v[34:35], v[58:59], v[38:39], v[34:35]
    v_cvt_pk_bf16_f32 v10, v32, v33
    v_cvt_pk_bf16_f32 v11, v34, v35
    v_pk_mul_f32 v[32:33], v[32:33], v[80:81]
    v_pk_mul_f32 v[34:35], v[34:35], v[82:83]
    v_cvt_pk_bf16_f32 v16, v32, v33
    v_cvt_pk_bf16_f32 v17, v34, v35
    s_waitcnt lgkmcnt(1)
    v_pk_add_f32 v[60:61], v[60:61], v[88:89]
    v_pk_add_f32 v[62:63], v[62:63], v[90:91]
    v_pk_fma_f32 v[48:49], v[60:61], v[40:41], v[48:49]
    v_pk_fma_f32 v[50:51], v[62:63], v[42:43], v[50:51]
    v_cvt_pk_bf16_f32 v12, v48, v49
    v_cvt_pk_bf16_f32 v13, v50, v51
    v_pk_mul_f32 v[48:49], v[48:49], v[24:25]
    v_pk_mul_f32 v[50:51], v[50:51], v[26:27]
    v_cvt_pk_bf16_f32 v18, v48, v49
    v_cvt_pk_bf16_f32 v19, v50, v51
    buffer_store_dwordx4 v[16:19], v3, s[8:11], s30 offen offset:0 sc1
    s_waitcnt lgkmcnt(0)
    v_pk_add_f32 v[64:65], v[64:65], v[92:93]
    v_pk_add_f32 v[66:67], v[66:67], v[94:95]
    v_pk_fma_f32 v[52:53], v[64:65], v[44:45], v[52:53]
    v_pk_fma_f32 v[54:55], v[66:67], v[46:47], v[54:55]
    v_cvt_pk_bf16_f32 v14, v52, v53
    v_cvt_pk_bf16_f32 v15, v54, v55
    v_pk_mul_f32 v[52:53], v[52:53], v[84:85]
    v_pk_mul_f32 v[54:55], v[54:55], v[86:87]
    v_cvt_pk_bf16_f32 v20, v52, v53
    v_cvt_pk_bf16_f32 v21, v54, v55
    buffer_store_dwordx2 v[20:21], v9, s[8:11], s30 offen offset:2048 sc1
    v_dot2_f32_bf16 v28, v10, v8, 0
    v_dot2_f32_bf16 v29, v10, v10, 0
    v_dot2_f32_bf16 v28, v11, v8, v28
    v_dot2_f32_bf16 v29, v11, v11, v29
    v_dot2_f32_bf16 v28, v12, v8, v28
    v_dot2_f32_bf16 v29, v12, v12, v29
    v_dot2_f32_bf16 v28, v13, v8, v28
    v_dot2_f32_bf16 v29, v13, v13, v29
    v_dot2_f32_bf16 v28, v14, v8, v28
    v_dot2_f32_bf16 v29, v14, v14, v29
    v_dot2_f32_bf16 v28, v15, v8, v28
    v_dot2_f32_bf16 v29, v15, v15, v29
    s_nop 2
    v_permlane32_swap_b32 v28, v29
    v_add_f32 v28, v28, v29
    v_mov_b32 v29, v28
    s_nop 1
    v_permlane16_swap_b32 v28, v29
    v_add_f32 v28, v28, v29
    v_mov_b32 v29, v28
    s_nop 1
    v_permlane32_swap_b32_e64 v28, v29
    s_mov_b64 exec, 0xffff
    buffer_store_dwordx2 v[28:29], v9, s[8:11], s31 offen offset:0 sc1
    s_mov_b64 exec, -1
    s_cmp_eq_u32 s28, 3
    s_cbranch_scc1 kf_kernel_b_c1_0
    v_and_b32 v0, 1, v2
    v_lshl_add_u32 v0, v0, 6, v6
    v_add_u32 v0, 157696, v0
    v_add_u32 v8, 40960, v3
    v_add_u32 v4, 40960, v9
    s_mul_i32 s39, s16, 81920
    s_mul_i32 s30, s28, 5120
    s_add_u32 s39, s39, s30
    s_add_u32 s39, s39, 23527424
    s_setprio 3
    ds_read_b128 v[56:59], v0 offset:0
    ds_read_b128 v[60:63], v0 offset:128
    ds_read_b128 v[64:67], v0 offset:256
    ds_read_b128 v[68:71], v0 offset:384
    ds_read_b128 v[72:75], v0 offset:512
    ds_read_b128 v[76:79], v0 offset:640
    ds_read_b128 v[80:83], v0 offset:768
    ds_read_b128 v[84:87], v0 offset:896
    s_waitcnt lgkmcnt(7)
    v_mfma_f32_16x16x32_bf16 v[48:51], v[160:163], v[56:59], 0
    v_mfma_f32_16x16x32_bf16 v[52:55], v[164:167], v[56:59], 0
    ds_read_b128 v[56:59], v0 offset:1024
    s_waitcnt lgkmcnt(7)
    v_mfma_f32_16x16x32_bf16 v[48:51], v[168:171], v[60:63], v[48:51]
    v_mfma_f32_16x16x32_bf16 v[52:55], v[172:175], v[60:63], v[52:55]
    ds_read_b128 v[60:63], v0 offset:1152
    s_waitcnt lgkmcnt(7)
    v_mfma_f32_16x16x32_bf16 v[48:51], v[176:179], v[64:67], v[48:51]
    v_mfma_f32_16x16x32_bf16 v[52:55], v[180:183], v[64:67], v[52:55]
    ds_read_b128 v[64:67], v0 offset:1280
    s_waitcnt lgkmcnt(7)
    v_mfma_f32_16x16x32_bf16 v[48:51], v[184:187], v[68:71], v[48:51]
    v_mfma_f32_16x16x32_bf16 v[52:55], v[188:191], v[68:71], v[52:55]
    ds_read_b128 v[68:71], v0 offset:1408
    s_waitcnt lgkmcnt(7)
    v_mfma_f32_16x16x32_bf16 v[48:51], v[192:195], v[72:75], v[48:51]
    v_mfma_f32_16x16x32_bf16 v[52:55], v[196:199], v[72:75], v[52:55]
    ds_read_b128 v[72:75], v0 offset:1536
    s_waitcnt lgkmcnt(7)
    v_mfma_f32_16x16x32_bf16 v[48:51], v[200:203], v[76:79], v[48:51]
    v_mfma_f32_16x16x32_bf16 v[52:55], v[204:207], v[76:79], v[52:55]
    ds_read_b128 v[76:79], v0 offset:1664
    s_waitcnt lgkmcnt(7)
    v_mfma_f32_16x16x32_bf16 v[48:51], v[208:211], v[80:83], v[48:51]
    v_mfma_f32_16x16x32_bf16 v[52:55], v[212:215], v[80:83], v[52:55]
    ds_read_b128 v[80:83], v0 offset:1792
    s_waitcnt lgkmcnt(7)
    v_mfma_f32_16x16x32_bf16 v[48:51], v[216:219], v[84:87], v[48:51]
    v_mfma_f32_16x16x32_bf16 v[52:55], v[220:223], v[84:87], v[52:55]
    ds_read_b128 v[84:87], v0 offset:1920
    s_waitcnt lgkmcnt(7)
    v_mfma_f32_16x16x32_bf16 v[48:51], v[224:227], v[56:59], v[48:51]
    v_mfma_f32_16x16x32_bf16 v[52:55], v[228:231], v[56:59], v[52:55]
    ds_read_b128 v[56:59], v0 offset:2048
    s_waitcnt lgkmcnt(7)
    v_mfma_f32_16x16x32_bf16 v[48:51], v[232:235], v[60:63], v[48:51]
    v_mfma_f32_16x16x32_bf16 v[52:55], v[236:239], v[60:63], v[52:55]
    ds_read_b128 v[60:63], v0 offset:2176
    s_waitcnt lgkmcnt(7)
    v_mfma_f32_16x16x32_bf16 v[48:51], v[240:243], v[64:67], v[48:51]
    v_mfma_f32_16x16x32_bf16 v[52:55], v[244:247], v[64:67], v[52:55]
    ds_read_b128 v[64:67], v0 offset:2304
    s_waitcnt lgkmcnt(7)
    v_mfma_f32_16x16x32_bf16 v[48:51], v[248:251], v[68:71], v[48:51]
    v_mfma_f32_16x16x32_bf16 v[52:55], v[252:255], v[68:71], v[52:55]
    ds_read_b128 v[68:71], v0 offset:2432
    s_waitcnt lgkmcnt(7)
    v_mfma_f32_16x16x32_bf16 v[48:51], v[116:119], v[72:75], v[48:51]
    v_mfma_f32_16x16x32_bf16 v[52:55], v[120:123], v[72:75], v[52:55]
    s_waitcnt lgkmcnt(6)
    v_mfma_f32_16x16x32_bf16 v[48:51], v[124:127], v[76:79], v[48:51]
    v_mfma_f32_16x16x32_bf16 v[52:55], v[128:131], v[76:79], v[52:55]
    s_waitcnt lgkmcnt(5)
    v_mfma_f32_16x16x32_bf16 v[48:51], v[140:143], v[80:83], v[48:51]
    v_mfma_f32_16x16x32_bf16 v[52:55], v[144:147], v[80:83], v[52:55]
    s_waitcnt lgkmcnt(4)
    v_mfma_f32_16x16x32_bf16 v[48:51], v[148:151], v[84:87], v[48:51]
    v_mfma_f32_16x16x32_bf16 v[52:55], v[152:155], v[84:87], v[52:55]
    s_waitcnt lgkmcnt(3)
    v_mfma_f32_16x16x32_bf16 v[48:51], v[132:135], v[56:59], v[48:51]
    v_mfma_f32_16x16x32_bf16 v[52:55], v[136:139], v[56:59], v[52:55]
    s_waitcnt lgkmcnt(2)
    v_mfma_f32_16x16x32_bf16 v[48:51], v[156:159], v[60:63], v[48:51]
    v_mfma_f32_16x16x32_bf16 v[52:55], v[96:99], v[60:63], v[52:55]
    s_waitcnt lgkmcnt(1)
    v_mfma_f32_16x16x32_bf16 v[48:51], v[100:103], v[64:67], v[48:51]
    v_mfma_f32_16x16x32_bf16 v[52:55], v[104:107], v[64:67], v[52:55]
    s_waitcnt lgkmcnt(0)
    v_mfma_f32_16x16x32_bf16 v[48:51], v[108:111], v[68:71], v[48:51]
    v_mfma_f32_16x16x32_bf16 v[52:55], v[112:115], v[68:71], v[52:55]
    s_waitcnt vmcnt(0)
    s_barrier
    s_add_u32 m0, s40, 81920
    s_add_u32 s67, s38, 8192
    buffer_load_dwordx4 v3, s[8:11], s67 offen offset:0 sc1 lds
    buffer_load_dwordx4 v3, s[8:11], s67 offen offset:1024 sc1 lds
    buffer_load_dwordx4 v3, s[8:11], s67 offen offset:2048 sc1 lds
    buffer_load_dwordx4 v3, s[8:11], s67 offen offset:3072 sc1 lds
    s_add_u32 m0, s40, 98304
    s_add_u32 s67, s38, 12288
    buffer_load_dwordx4 v3, s[8:11], s67 offen offset:0 sc1 lds
    buffer_load_dwordx4 v3, s[8:11], s67 offen offset:1024 sc1 lds
    buffer_load_dwordx4 v3, s[8:11], s67 offen offset:2048 sc1 lds
    buffer_load_dwordx4 v3, s[8:11], s67 offen offset:3072 sc1 lds
    s_add_u32 m0, s40, 114688
    s_add_u32 s67, s38, 16384
    buffer_load_dwordx4 v3, s[8:11], s67 offen offset:0 sc1 lds
    buffer_load_dwordx4 v3, s[8:11], s67 offen offset:1024 sc1 lds
    buffer_load_dwordx4 v3, s[8:11], s67 offen offset:2048 sc1 lds
    buffer_load_dwordx4 v3, s[8:11], s67 offen offset:3072 sc1 lds
    s_add_u32 m0, s40, 131072
    s_add_u32 s67, s38, 20480
    buffer_load_dwordx4 v3, s[8:11], s67 offen offset:0 sc1 lds
    buffer_load_dwordx4 v3, s[8:11], s67 offen offset:1024 sc1 lds
    buffer_load_dwordx4 v3, s[8:11], s67 offen offset:2048 sc1 lds
    buffer_load_dwordx4 v3, s[8:11], s67 offen offset:3072 sc1 lds
    s_barrier
    s_barrier
    ds_read_b128 v[56:59], v3 offset:0
    ds_read_b128 v[60:63], v3 offset:2560
    ds_read_b128 v[64:67], v3 offset:5120
    ds_read_b128 v[68:71], v3 offset:7680
    ds_read_b128 v[72:75], v3 offset:1024
    ds_read_b128 v[76:79], v3 offset:3584
    ds_read_b128 v[80:83], v3 offset:6144
    ds_read_b128 v[84:87], v3 offset:8704
    ds_read_b128 v[88:91], v3 offset:10240
    ds_read_b128 v[92:95], v3 offset:12800
    s_waitcnt lgkmcnt(9)
    v_mfma_f32_16x16x32_bf16 v[16:19], v[160:163], v[56:59], 0
    v_mfma_f32_16x16x32_bf16 v[32:35], v[164:167], v[56:59], 0
    ds_read_b128 v[56:59], v3 offset:15360
    s_waitcnt lgkmcnt(9)
    v_mfma_f32_16x16x32_bf16 v[20:23], v[160:163], v[60:63], 0
    v_mfma_f32_16x16x32_bf16 v[36:39], v[164:167], v[60:63], 0
    ds_read_b128 v[60:63], v3 offset:17920
    s_waitcnt lgkmcnt(9)
    v_mfma_f32_16x16x32_bf16 v[24:27], v[160:163], v[64:67], 0
    v_mfma_f32_16x16x32_bf16 v[40:43], v[164:167], v[64:67], 0
    ds_read_b128 v[64:67], v3 offset:11264
    s_waitcnt lgkmcnt(9)
    v_mfma_f32_16x16x32_bf16 v[28:31], v[160:163], v[68:71], 0
    v_mfma_f32_16x16x32_bf16 v[44:47], v[164:167], v[68:71], 0
    ds_read_b128 v[68:71], v3 offset:13824
    s_waitcnt lgkmcnt(9)
    v_mfma_f32_16x16x32_bf16 v[16:19], v[168:171], v[72:75], v[16:19]
    v_mfma_f32_16x16x32_bf16 v[32:35], v[172:175], v[72:75], v[32:35]
    ds_read_b128 v[72:75], v3 offset:16384
    s_waitcnt lgkmcnt(9)
    v_mfma_f32_16x16x32_bf16 v[20:23], v[168:171], v[76:79], v[20:23]
    v_mfma_f32_16x16x32_bf16 v[36:39], v[172:175], v[76:79], v[36:39]
    ds_read_b128 v[76:79], v3 offset:18944
    s_waitcnt lgkmcnt(9)
    v_mfma_f32_16x16x32_bf16 v[24:27], v[168:171], v[80:83], v[24:27]
    v_mfma_f32_16x16x32_bf16 v[40:43], v[172:175], v[80:83], v[40:43]
    ds_read_b64 v[80:81], v9 offset:2048
    ds_read_b64 v[82:83], v9 offset:12288
    s_waitcnt lgkmcnt(10)
    v_mfma_f32_16x16x32_bf16 v[28:31], v[168:171], v[84:87], v[28:31]
    v_mfma_f32_16x16x32_bf16 v[44:47], v[172:175], v[84:87], v[44:47]
    ds_read_b64 v[84:85], v9 offset:4608
    ds_read_b64 v[86:87], v9 offset:14848
    s_waitcnt lgkmcnt(11)
    v_mfma_f32_16x16x32_bf16 v[16:19], v[176:179], v[88:91], v[16:19]
    v_mfma_f32_16x16x32_bf16 v[32:35], v[180:183], v[88:91], v[32:35]
    ds_read_b64 v[88:89], v9 offset:7168
    ds_read_b64 v[90:91], v9 offset:17408
    s_waitcnt lgkmcnt(12)
    v_mfma_f32_16x16x32_bf16 v[20:23], v[176:179], v[92:95], v[20:23]
    v_mfma_f32_16x16x32_bf16 v[36:39], v[180:183], v[92:95], v[36:39]
    ds_read_b64 v[92:93], v9 offset:9728
    ds_read_b64 v[94:95], v9 offset:19968
    s_waitcnt lgkmcnt(13)
    v_mfma_f32_16x16x32_bf16 v[24:27], v[176:179], v[56:59], v[24:27]
    v_mfma_f32_16x16x32_bf16 v[40:43], v[180:183], v[56:59], v[40:43]
    s_barrier
    ds_read_b128 v[56:59], v3 offset:20480
    s_waitcnt lgkmcnt(13)
    v_mfma_f32_16x16x32_bf16 v[28:31], v[176:179], v[60:63], v[28:31]
    v_mfma_f32_16x16x32_bf16 v[44:47], v[180:183], v[60:63], v[44:47]
    ds_read_b128 v[60:63], v3 offset:23040
    s_waitcnt lgkmcnt(13)
    v_mfma_f32_16x16x32_bf16 v[16:19], v[184:187], v[64:67], v[16:19]
    v_mfma_f32_16x16x32_bf16 v[32:35], v[188:191], v[64:67], v[32:35]
    ds_read_b128 v[64:67], v3 offset:25600
    s_waitcnt lgkmcnt(13)
    v_mfma_f32_16x16x32_bf16 v[20:23], v[184:187], v[68:71], v[20:23]
    v_mfma_f32_16x16x32_bf16 v[36:39], v[188:191], v[68:71], v[36:39]
    ds_read_b128 v[68:71], v3 offset:28160
    s_waitcnt lgkmcnt(13)
    v_mfma_f32_16x16x32_bf16 v[24:27], v[184:187], v[72:75], v[24:27]
    v_mfma_f32_16x16x32_bf16 v[40:43], v[188:191], v[72:75], v[40:43]
    ds_read_b128 v[72:75], v3 offset:21504
    s_waitcnt lgkmcnt(13)
    v_mfma_f32_16x16x32_bf16 v[28:31], v[184:187], v[76:79], v[28:31]
    v_mfma_f32_16x16x32_bf16 v[44:47], v[188:191], v[76:79], v[44:47]
    ds_read_b128 v[76:79], v3 offset:24064
    s_waitcnt lgkmcnt(12)
    v_mfma_f32_16x16x32_bf16 v[16:19], v[192:195], v[80:83], v[16:19]
    v_mfma_f32_16x16x32_bf16 v[32:35], v[196:199], v[80:83], v[32:35]
    ds_read_b128 v[80:83], v3 offset:26624
    s_waitcnt lgkmcnt(11)
    v_mfma_f32_16x16x32_bf16 v[20:23], v[192:195], v[84:87], v[20:23]
    v_mfma_f32_16x16x32_bf16 v[36:39], v[196:199], v[84:87], v[36:39]
    ds_read_b128 v[84:87], v3 offset:29184
    s_waitcnt lgkmcnt(10)
    v_mfma_f32_16x16x32_bf16 v[24:27], v[192:195], v[88:91], v[24:27]
    v_mfma_f32_16x16x32_bf16 v[40:43], v[196:199], v[88:91], v[40:43]
    ds_read_b128 v[88:91], v3 offset:30720
    s_waitcnt lgkmcnt(9)
    v_mfma_f32_16x16x32_bf16 v[28:31], v[192:195], v[92:95], v[28:31]
    v_mfma_f32_16x16x32_bf16 v[44:47], v[196:199], v[92:95], v[44:47]
    ds_read_b128 v[92:95], v3 offset:33280
    s_waitcnt lgkmcnt(9)
    v_mfma_f32_16x16x32_bf16 v[16:19], v[200:203], v[56:59], v[16:19]
    v_mfma_f32_16x16x32_bf16 v[32:35], v[204:207], v[56:59], v[32:35]
    ds_read_b128 v[56:59], v3 offset:35840
    s_waitcnt lgkmcnt(9)
    v_mfma_f32_16x16x32_bf16 v[20:23], v[200:203], v[60:63], v[20:23]
    v_mfma_f32_16x16x32_bf16 v[36:39], v[204:207], v[60:63], v[36:39]
    ds_read_b128 v[60:63], v3 offset:38400
    s_waitcnt lgkmcnt(9)
    v_mfma_f32_16x16x32_bf16 v[24:27], v[200:203], v[64:67], v[24:27]
    v_mfma_f32_16x16x32_bf16 v[40:43], v[204:207], v[64:67], v[40:43]
    ds_read_b128 v[64:67], v3 offset:31744
    s_waitcnt lgkmcnt(9)
    v_mfma_f32_16x16x32_bf16 v[28:31], v[200:203], v[68:71], v[28:31]
    v_mfma_f32_16x16x32_bf16 v[44:47], v[204:207], v[68:71], v[44:47]
    ds_read_b128 v[68:71], v3 offset:34304
    s_waitcnt lgkmcnt(9)
    v_mfma_f32_16x16x32_bf16 v[16:19], v[208:211], v[72:75], v[16:19]
    v_mfma_f32_16x16x32_bf16 v[32:35], v[212:215], v[72:75], v[32:35]
    ds_read_b128 v[72:75], v3 offset:36864
    s_waitcnt lgkmcnt(9)
    v_mfma_f32_16x16x32_bf16 v[20:23], v[208:211], v[76:79], v[20:23]
    v_mfma_f32_16x16x32_bf16 v[36:39], v[212:215], v[76:79], v[36:39]
    ds_read_b128 v[76:79], v3 offset:39424
    s_waitcnt lgkmcnt(9)
    v_mfma_f32_16x16x32_bf16 v[24:27], v[208:211], v[80:83], v[24:27]
    v_mfma_f32_16x16x32_bf16 v[40:43], v[212:215], v[80:83], v[40:43]
    ds_read_b64 v[80:81], v9 offset:22528
    ds_read_b64 v[82:83], v9 offset:32768
    s_waitcnt lgkmcnt(10)
    v_mfma_f32_16x16x32_bf16 v[28:31], v[208:211], v[84:87], v[28:31]
    v_mfma_f32_16x16x32_bf16 v[44:47], v[212:215], v[84:87], v[44:47]
    ds_read_b64 v[84:85], v9 offset:25088
    ds_read_b64 v[86:87], v9 offset:35328
    s_waitcnt lgkmcnt(11)
    v_mfma_f32_16x16x32_bf16 v[16:19], v[216:219], v[88:91], v[16:19]
    v_mfma_f32_16x16x32_bf16 v[32:35], v[220:223], v[88:91], v[32:35]
    ds_read_b64 v[88:89], v9 offset:27648
    ds_read_b64 v[90:91], v9 offset:37888
    s_waitcnt lgkmcnt(12)
    v_mfma_f32_16x16x32_bf16 v[20:23], v[216:219], v[92:95], v[20:23]
    v_mfma_f32_16x16x32_bf16 v[36:39], v[220:223], v[92:95], v[36:39]
    ds_read_b64 v[92:93], v9 offset:30208
    ds_read_b64 v[94:95], v9 offset:40448
    s_waitcnt lgkmcnt(13)
    v_mfma_f32_16x16x32_bf16 v[24:27], v[216:219], v[56:59], v[24:27]
    v_mfma_f32_16x16x32_bf16 v[40:43], v[220:223], v[56:59], v[40:43]
    s_barrier
    ds_read_b128 v[56:59], v8 offset:0
    s_waitcnt lgkmcnt(13)
    v_mfma_f32_16x16x32_bf16 v[28:31], v[216:219], v[60:63], v[28:31]
    v_mfma_f32_16x16x32_bf16 v[44:47], v[220:223], v[60:63], v[44:47]
    ds_read_b128 v[60:63], v8 offset:2560
    s_waitcnt lgkmcnt(13)
    v_mfma_f32_16x16x32_bf16 v[16:19], v[224:227], v[64:67], v[16:19]
    v_mfma_f32_16x16x32_bf16 v[32:35], v[228:231], v[64:67], v[32:35]
    ds_read_b128 v[64:67], v8 offset:5120
    s_waitcnt lgkmcnt(13)
    v_mfma_f32_16x16x32_bf16 v[20:23], v[224:227], v[68:71], v[20:23]
    v_mfma_f32_16x16x32_bf16 v[36:39], v[228:231], v[68:71], v[36:39]
    ds_read_b128 v[68:71], v8 offset:7680
    s_waitcnt lgkmcnt(13)
    v_mfma_f32_16x16x32_bf16 v[24:27], v[224:227], v[72:75], v[24:27]
    v_mfma_f32_16x16x32_bf16 v[40:43], v[228:231], v[72:75], v[40:43]
    ds_read_b128 v[72:75], v8 offset:1024
    s_waitcnt lgkmcnt(13)
    v_mfma_f32_16x16x32_bf16 v[28:31], v[224:227], v[76:79], v[28:31]
    v_mfma_f32_16x16x32_bf16 v[44:47], v[228:231], v[76:79], v[44:47]
    ds_read_b128 v[76:79], v8 offset:3584
    s_waitcnt lgkmcnt(12)
    v_mfma_f32_16x16x32_bf16 v[16:19], v[232:235], v[80:83], v[16:19]
    v_mfma_f32_16x16x32_bf16 v[32:35], v[236:239], v[80:83], v[32:35]
    ds_read_b128 v[80:83], v8 offset:6144
    s_waitcnt lgkmcnt(11)
    v_mfma_f32_16x16x32_bf16 v[20:23], v[232:235], v[84:87], v[20:23]
    v_mfma_f32_16x16x32_bf16 v[36:39], v[236:239], v[84:87], v[36:39]
    ds_read_b128 v[84:87], v8 offset:8704
    s_waitcnt lgkmcnt(10)
    v_mfma_f32_16x16x32_bf16 v[24:27], v[232:235], v[88:91], v[24:27]
    v_mfma_f32_16x16x32_bf16 v[40:43], v[236:239], v[88:91], v[40:43]
    ds_read_b128 v[88:91], v8 offset:10240
    s_waitcnt lgkmcnt(9)
    v_mfma_f32_16x16x32_bf16 v[28:31], v[232:235], v[92:95], v[28:31]
    v_mfma_f32_16x16x32_bf16 v[44:47], v[236:239], v[92:95], v[44:47]
    ds_read_b128 v[92:95], v8 offset:12800
    s_waitcnt lgkmcnt(9)
    v_mfma_f32_16x16x32_bf16 v[16:19], v[240:243], v[56:59], v[16:19]
    v_mfma_f32_16x16x32_bf16 v[32:35], v[244:247], v[56:59], v[32:35]
    ds_read_b128 v[56:59], v8 offset:15360
    s_waitcnt lgkmcnt(9)
    v_mfma_f32_16x16x32_bf16 v[20:23], v[240:243], v[60:63], v[20:23]
    v_mfma_f32_16x16x32_bf16 v[36:39], v[244:247], v[60:63], v[36:39]
    ds_read_b128 v[60:63], v8 offset:17920
    s_waitcnt lgkmcnt(9)
    v_mfma_f32_16x16x32_bf16 v[24:27], v[240:243], v[64:67], v[24:27]
    v_mfma_f32_16x16x32_bf16 v[40:43], v[244:247], v[64:67], v[40:43]
    ds_read_b128 v[64:67], v8 offset:11264
    s_waitcnt lgkmcnt(9)
    v_mfma_f32_16x16x32_bf16 v[28:31], v[240:243], v[68:71], v[28:31]
    v_mfma_f32_16x16x32_bf16 v[44:47], v[244:247], v[68:71], v[44:47]
    ds_read_b128 v[68:71], v8 offset:13824
    s_waitcnt lgkmcnt(9)
    v_mfma_f32_16x16x32_bf16 v[16:19], v[248:251], v[72:75], v[16:19]
    v_mfma_f32_16x16x32_bf16 v[32:35], v[252:255], v[72:75], v[32:35]
    ds_read_b128 v[72:75], v8 offset:16384
    s_waitcnt lgkmcnt(9)
    v_mfma_f32_16x16x32_bf16 v[20:23], v[248:251], v[76:79], v[20:23]
    v_mfma_f32_16x16x32_bf16 v[36:39], v[252:255], v[76:79], v[36:39]
    ds_read_b128 v[76:79], v8 offset:18944
    s_waitcnt lgkmcnt(9)
    v_mfma_f32_16x16x32_bf16 v[24:27], v[248:251], v[80:83], v[24:27]
    v_mfma_f32_16x16x32_bf16 v[40:43], v[252:255], v[80:83], v[40:43]
    ds_read_b64 v[80:81], v4 offset:2048
    ds_read_b64 v[82:83], v4 offset:12288
    s_waitcnt lgkmcnt(10)
    v_mfma_f32_16x16x32_bf16 v[28:31], v[248:251], v[84:87], v[28:31]
    v_mfma_f32_16x16x32_bf16 v[44:47], v[252:255], v[84:87], v[44:47]
    ds_read_b64 v[84:85], v4 offset:4608
    ds_read_b64 v[86:87], v4 offset:14848
    s_waitcnt lgkmcnt(11)
    v_mfma_f32_16x16x32_bf16 v[16:19], v[116:119], v[88:91], v[16:19]
    v_mfma_f32_16x16x32_bf16 v[32:35], v[120:123], v[88:91], v[32:35]
    ds_read_b64 v[88:89], v4 offset:7168
    ds_read_b64 v[90:91], v4 offset:17408
    s_waitcnt lgkmcnt(12)
    v_mfma_f32_16x16x32_bf16 v[20:23], v[116:119], v[92:95], v[20:23]
    v_mfma_f32_16x16x32_bf16 v[36:39], v[120:123], v[92:95], v[36:39]
    ds_read_b64 v[92:93], v4 offset:9728
    ds_read_b64 v[94:95], v4 offset:19968
    s_waitcnt lgkmcnt(13)
    v_mfma_f32_16x16x32_bf16 v[24:27], v[116:119], v[56:59], v[24:27]
    v_mfma_f32_16x16x32_bf16 v[40:43], v[120:123], v[56:59], v[40:43]
    s_barrier
    ds_read_b128 v[56:59], v8 offset:20480
    s_waitcnt lgkmcnt(13)
    v_mfma_f32_16x16x32_bf16 v[28:31], v[116:119], v[60:63], v[28:31]
    v_mfma_f32_16x16x32_bf16 v[44:47], v[120:123], v[60:63], v[44:47]
    ds_read_b128 v[60:63], v8 offset:23040
    s_waitcnt lgkmcnt(13)
    v_mfma_f32_16x16x32_bf16 v[16:19], v[124:127], v[64:67], v[16:19]
    v_mfma_f32_16x16x32_bf16 v[32:35], v[128:131], v[64:67], v[32:35]
    ds_read_b128 v[64:67], v8 offset:25600
    s_waitcnt lgkmcnt(13)
    v_mfma_f32_16x16x32_bf16 v[20:23], v[124:127], v[68:71], v[20:23]
    v_mfma_f32_16x16x32_bf16 v[36:39], v[128:131], v[68:71], v[36:39]
    ds_read_b128 v[68:71], v8 offset:28160
    s_waitcnt lgkmcnt(13)
    v_mfma_f32_16x16x32_bf16 v[24:27], v[124:127], v[72:75], v[24:27]
    v_mfma_f32_16x16x32_bf16 v[40:43], v[128:131], v[72:75], v[40:43]
    ds_read_b128 v[72:75], v8 offset:21504
    s_waitcnt lgkmcnt(13)
    v_mfma_f32_16x16x32_bf16 v[28:31], v[124:127], v[76:79], v[28:31]
    v_mfma_f32_16x16x32_bf16 v[44:47], v[128:131], v[76:79], v[44:47]
    ds_read_b128 v[76:79], v8 offset:24064
    s_waitcnt lgkmcnt(12)
    v_mfma_f32_16x16x32_bf16 v[16:19], v[140:143], v[80:83], v[16:19]
    v_mfma_f32_16x16x32_bf16 v[32:35], v[144:147], v[80:83], v[32:35]
    ds_read_b128 v[80:83], v8 offset:26624
    s_waitcnt lgkmcnt(11)
    v_mfma_f32_16x16x32_bf16 v[20:23], v[140:143], v[84:87], v[20:23]
    v_mfma_f32_16x16x32_bf16 v[36:39], v[144:147], v[84:87], v[36:39]
    ds_read_b128 v[84:87], v8 offset:29184
    s_waitcnt lgkmcnt(10)
    v_mfma_f32_16x16x32_bf16 v[24:27], v[140:143], v[88:91], v[24:27]
    v_mfma_f32_16x16x32_bf16 v[40:43], v[144:147], v[88:91], v[40:43]
    ds_read_b128 v[88:91], v8 offset:30720
    s_waitcnt lgkmcnt(9)
    v_mfma_f32_16x16x32_bf16 v[28:31], v[140:143], v[92:95], v[28:31]
    v_mfma_f32_16x16x32_bf16 v[44:47], v[144:147], v[92:95], v[44:47]
    ds_read_b128 v[92:95], v8 offset:33280
    s_waitcnt lgkmcnt(9)
    v_mfma_f32_16x16x32_bf16 v[16:19], v[148:151], v[56:59], v[16:19]
    v_mfma_f32_16x16x32_bf16 v[32:35], v[152:155], v[56:59], v[32:35]
    ds_read_b128 v[56:59], v8 offset:35840
    s_waitcnt lgkmcnt(9)
    v_mfma_f32_16x16x32_bf16 v[20:23], v[148:151], v[60:63], v[20:23]
    v_mfma_f32_16x16x32_bf16 v[36:39], v[152:155], v[60:63], v[36:39]
    ds_read_b128 v[60:63], v8 offset:38400
    s_waitcnt lgkmcnt(9)
    v_mfma_f32_16x16x32_bf16 v[24:27], v[148:151], v[64:67], v[24:27]
    v_mfma_f32_16x16x32_bf16 v[40:43], v[152:155], v[64:67], v[40:43]
    ds_read_b128 v[64:67], v8 offset:31744
    s_waitcnt lgkmcnt(9)
    v_mfma_f32_16x16x32_bf16 v[28:31], v[148:151], v[68:71], v[28:31]
    v_mfma_f32_16x16x32_bf16 v[44:47], v[152:155], v[68:71], v[44:47]
    ds_read_b128 v[68:71], v8 offset:34304
    s_waitcnt lgkmcnt(9)
    v_mfma_f32_16x16x32_bf16 v[16:19], v[132:135], v[72:75], v[16:19]
    v_mfma_f32_16x16x32_bf16 v[32:35], v[136:139], v[72:75], v[32:35]
    ds_read_b128 v[72:75], v8 offset:36864
    s_waitcnt lgkmcnt(9)
    v_mfma_f32_16x16x32_bf16 v[20:23], v[132:135], v[76:79], v[20:23]
    v_mfma_f32_16x16x32_bf16 v[36:39], v[136:139], v[76:79], v[36:39]
    ds_read_b128 v[76:79], v8 offset:39424
    s_waitcnt lgkmcnt(9)
    v_mfma_f32_16x16x32_bf16 v[24:27], v[132:135], v[80:83], v[24:27]
    v_mfma_f32_16x16x32_bf16 v[40:43], v[136:139], v[80:83], v[40:43]
    ds_read_b64 v[80:81], v4 offset:22528
    ds_read_b64 v[82:83], v4 offset:32768
    s_waitcnt lgkmcnt(10)
    v_mfma_f32_16x16x32_bf16 v[28:31], v[132:135], v[84:87], v[28:31]
    v_mfma_f32_16x16x32_bf16 v[44:47], v[136:139], v[84:87], v[44:47]
    ds_read_b64 v[84:85], v4 offset:25088
    ds_read_b64 v[86:87], v4 offset:35328
    s_waitcnt lgkmcnt(11)
    v_mfma_f32_16x16x32_bf16 v[16:19], v[156:159], v[88:91], v[16:19]
    v_mfma_f32_16x16x32_bf16 v[32:35], v[96:99], v[88:91], v[32:35]
    ds_read_b64 v[88:89], v4 offset:27648
    ds_read_b64 v[90:91], v4 offset:37888
    s_waitcnt lgkmcnt(12)
    v_mfma_f32_16x16x32_bf16 v[20:23], v[156:159], v[92:95], v[20:23]
    v_mfma_f32_16x16x32_bf16 v[36:39], v[96:99], v[92:95], v[36:39]
    ds_read_b64 v[92:93], v4 offset:30208
    ds_read_b64 v[94:95], v4 offset:40448
    s_waitcnt lgkmcnt(13)
    v_mfma_f32_16x16x32_bf16 v[24:27], v[156:159], v[56:59], v[24:27]
    v_mfma_f32_16x16x32_bf16 v[40:43], v[96:99], v[56:59], v[40:43]
    s_waitcnt lgkmcnt(12)
    v_mfma_f32_16x16x32_bf16 v[28:31], v[156:159], v[60:63], v[28:31]
    v_mfma_f32_16x16x32_bf16 v[44:47], v[96:99], v[60:63], v[44:47]
    s_waitcnt lgkmcnt(11)
    v_mfma_f32_16x16x32_bf16 v[16:19], v[100:103], v[64:67], v[16:19]
    v_mfma_f32_16x16x32_bf16 v[32:35], v[104:107], v[64:67], v[32:35]
    s_waitcnt lgkmcnt(10)
    v_mfma_f32_16x16x32_bf16 v[20:23], v[100:103], v[68:71], v[20:23]
    v_mfma_f32_16x16x32_bf16 v[36:39], v[104:107], v[68:71], v[36:39]
    s_waitcnt lgkmcnt(9)
    v_mfma_f32_16x16x32_bf16 v[24:27], v[100:103], v[72:75], v[24:27]
    v_mfma_f32_16x16x32_bf16 v[40:43], v[104:107], v[72:75], v[40:43]
    s_waitcnt lgkmcnt(8)
    v_mfma_f32_16x16x32_bf16 v[28:31], v[100:103], v[76:79], v[28:31]
    v_mfma_f32_16x16x32_bf16 v[44:47], v[104:107], v[76:79], v[44:47]
    s_waitcnt lgkmcnt(6)
    v_mfma_f32_16x16x32_bf16 v[16:19], v[108:111], v[80:83], v[16:19]
    v_mfma_f32_16x16x32_bf16 v[32:35], v[112:115], v[80:83], v[32:35]
    s_waitcnt lgkmcnt(4)
    v_mfma_f32_16x16x32_bf16 v[20:23], v[108:111], v[84:87], v[20:23]
    v_mfma_f32_16x16x32_bf16 v[36:39], v[112:115], v[84:87], v[36:39]
    s_waitcnt lgkmcnt(2)
    v_mfma_f32_16x16x32_bf16 v[24:27], v[108:111], v[88:91], v[24:27]
    v_mfma_f32_16x16x32_bf16 v[40:43], v[112:115], v[88:91], v[40:43]
    s_waitcnt lgkmcnt(0)
    v_mfma_f32_16x16x32_bf16 v[28:31], v[108:111], v[92:95], v[28:31]
    v_mfma_f32_16x16x32_bf16 v[44:47], v[112:115], v[92:95], v[44:47]
    v_mov_b32 v88, 162816
    v_mov_b32_e64 v89, 1
    s_mov_b64 exec, 1
    ds_add_u32 v88, v89
    s_mov_b64 exec, -1
    v_add_u32 v0, 161792, v7
    ds_read_b64 v[80:81], v0 offset:0
    ds_read_b64 v[82:83], v0 offset:128
    ds_read_b64 v[84:85], v0 offset:256
    ds_read_b64 v[86:87], v0 offset:384
    v_mov_b32_dpp v56, v48 quad_perm:[1,1,3,3] row_mask:0xf bank_mask:0xf
    v_mov_b32_dpp v57, v49 quad_perm:[1,1,3,3] row_mask:0xf bank_mask:0xf
    v_mov_b32_dpp v58, v50 quad_perm:[1,1,3,3] row_mask:0xf bank_mask:0xf
    v_mov_b32_dpp v59, v51 quad_perm:[1,1,3,3] row_mask:0xf bank_mask:0xf
    v_mov_b32_dpp v60, v52 quad_perm:[1,1,3,3] row_mask:0xf bank_mask:0xf
    v_mov_b32_dpp v61, v53 quad_perm:[1,1,3,3] row_mask:0xf bank_mask:0xf
    v_mov_b32_dpp v62, v54 quad_perm:[1,1,3,3] row_mask:0xf bank_mask:0xf
    v_mov_b32_dpp v63, v55 quad_perm:[1,1,3,3] row_mask:0xf bank_mask:0xf
    v_mov_b32_dpp v48, v48 quad_perm:[0,0,2,2] row_mask:0xf bank_mask:0xf
    v_mov_b32_dpp v49, v49 quad_perm:[0,0,2,2] row_mask:0xf bank_mask:0xf
    v_mov_b32_dpp v50, v50 quad_perm:[0,0,2,2] row_mask:0xf bank_mask:0xf
    v_mov_b32_dpp v51, v51 quad_perm:[0,0,2,2] row_mask:0xf bank_mask:0xf
    v_mov_b32_dpp v52, v52 quad_perm:[0,0,2,2] row_mask:0xf bank_mask:0xf
    v_mov_b32_dpp v53, v53 quad_perm:[0,0,2,2] row_mask:0xf bank_mask:0xf
    v_mov_b32_dpp v54, v54 quad_perm:[0,0,2,2] row_mask:0xf bank_mask:0xf
    v_mov_b32_dpp v55, v55 quad_perm:[0,0,2,2] row_mask:0xf bank_mask:0xf
    s_waitcnt lgkmcnt(0)
    v_mov_b32_e64 v64, s35
    v_pk_fma_f32 v[16:17], v[48:49], v[80:81], v[16:17] op_sel:[0,0,0] op_sel_hi:[1,0,1]
    v_pk_fma_f32 v[18:19], v[50:51], v[80:81], v[18:19] op_sel:[0,0,0] op_sel_hi:[1,0,1]
    v_pk_fma_f32 v[16:17], v[80:81], v[16:17], v[56:57] op_sel:[1,0,0] op_sel_hi:[1,1,1]
    v_pk_fma_f32 v[18:19], v[80:81], v[18:19], v[58:59] op_sel:[1,0,0] op_sel_hi:[1,1,1]
    v_pk_mul_f32 v[88:89], v[16:17], v[16:17]
    v_pk_mul_f32 v[90:91], v[18:19], v[18:19]
    v_pk_fma_f32 v[88:89], v[88:89], s[34:35], s[34:35] op_sel:[0,0,1] op_sel_hi:[1,0,1]
    v_pk_fma_f32 v[90:91], v[90:91], s[34:35], s[34:35] op_sel:[0,0,1] op_sel_hi:[1,0,1]
    v_pk_mul_f32 v[88:89], v[88:89], v[16:17]
    v_pk_mul_f32 v[90:91], v[90:91], v[18:19]
    v_exp_f32 v88, v88
    v_exp_f32 v89, v89
    v_exp_f32 v90, v90
    v_exp_f32 v91, v91
    v_pk_add_f32 v[88:89], v[88:89], s[36:37]
    v_pk_add_f32 v[90:91], v[90:91], s[36:37]
    v_rcp_f32 v88, v88
    v_rcp_f32 v89, v89
    v_rcp_f32 v90, v90
    v_rcp_f32 v91, v91
    v_pk_mul_f32 v[16:17], v[16:17], v[88:89]
    v_pk_mul_f32 v[18:19], v[18:19], v[90:91]
    v_pk_add_f32 v[112:113], v[16:17], v[18:19]
    v_pk_mul_f32 v[114:115], v[16:17], v[16:17]
    v_pk_fma_f32 v[114:115], v[18:19], v[18:19], v[114:115]
    s_add_u32 s67, s38, 4096
    buffer_load_dwordx4 v[160:163], v3, s[8:11], s67 offen offset:0 sc1
    s_add_u32 s67, s38, 4096
    buffer_load_dwordx4 v[164:167], v3, s[8:11], s67 offen offset:1024 sc1
    s_add_u32 s67, s38, 4096
    buffer_load_dwordx4 v[168:171], v3, s[8:11], s67 offen offset:2048 sc1
    v_pk_fma_f32 v[20:21], v[48:49], v[82:83], v[20:21] op_sel:[0,0,0] op_sel_hi:[1,0,1]
    v_pk_fma_f32 v[22:23], v[50:51], v[82:83], v[22:23] op_sel:[0,0,0] op_sel_hi:[1,0,1]
    v_pk_fma_f32 v[20:21], v[82:83], v[20:21], v[56:57] op_sel:[1,0,0] op_sel_hi:[1,1,1]
    v_pk_fma_f32 v[22:23], v[82:83], v[22:23], v[58:59] op_sel:[1,0,0] op_sel_hi:[1,1,1]
    v_pk_mul_f32 v[92:93], v[20:21], v[20:21]
    v_pk_mul_f32 v[94:95], v[22:23], v[22:23]
    v_pk_fma_f32 v[92:93], v[92:93], s[34:35], s[34:35] op_sel:[0,0,1] op_sel_hi:[1,0,1]
    v_pk_fma_f32 v[94:95], v[94:95], s[34:35], s[34:35] op_sel:[0,0,1] op_sel_hi:[1,0,1]
    v_pk_mul_f32 v[92:93], v[92:93], v[20:21]
    v_pk_mul_f32 v[94:95], v[94:95], v[22:23]
    v_exp_f32 v92, v92
    v_exp_f32 v93, v93
    v_exp_f32 v94, v94
    v_exp_f32 v95, v95
    v_pk_add_f32 v[92:93], v[92:93], s[36:37]
    v_pk_add_f32 v[94:95], v[94:95], s[36:37]
    v_rcp_f32 v92, v92
    v_rcp_f32 v93, v93
    v_rcp_f32 v94, v94
    v_rcp_f32 v95, v95
    v_pk_mul_f32 v[20:21], v[20:21], v[92:93]
    v_pk_mul_f32 v[22:23], v[22:23], v[94:95]
    v_pk_add_f32 v[116:117], v[20:21], v[22:23]
    v_pk_mul_f32 v[118:119], v[20:21], v[20:21]
    v_pk_fma_f32 v[118:119], v[22:23], v[22:23], v[118:119]
    s_add_u32 s67, s38, 4096
    buffer_load_dwordx4 v[172:175], v3, s[8:11], s67 offen offset:3072 sc1
    s_add_u32 s67, s38, 45056
    buffer_load_dwordx4 v[176:179], v3, s[8:11], s67 offen offset:0 sc1
    s_add_u32 s67, s38, 45056
    buffer_load_dwordx4 v[180:183], v3, s[8:11], s67 offen offset:1024 sc1
    v_pk_fma_f32 v[24:25], v[48:49], v[84:85], v[24:25] op_sel:[0,0,0] op_sel_hi:[1,0,1]
    v_pk_fma_f32 v[26:27], v[50:51], v[84:85], v[26:27] op_sel:[0,0,0] op_sel_hi:[1,0,1]
    v_pk_fma_f32 v[24:25], v[84:85], v[24:25], v[56:57] op_sel:[1,0,0] op_sel_hi:[1,1,1]
    v_pk_fma_f32 v[26:27], v[84:85], v[26:27], v[58:59] op_sel:[1,0,0] op_sel_hi:[1,1,1]
    v_pk_mul_f32 v[88:89], v[24:25], v[24:25]
    v_pk_mul_f32 v[90:91], v[26:27], v[26:27]
    v_pk_fma_f32 v[88:89], v[88:89], s[34:35], s[34:35] op_sel:[0,0,1] op_sel_hi:[1,0,1]
    v_pk_fma_f32 v[90:91], v[90:91], s[34:35], s[34:35] op_sel:[0,0,1] op_sel_hi:[1,0,1]
    v_pk_mul_f32 v[88:89], v[88:89], v[24:25]
    v_pk_mul_f32 v[90:91], v[90:91], v[26:27]
    v_exp_f32 v88, v88
    v_exp_f32 v89, v89
    v_exp_f32 v90, v90
    v_exp_f32 v91, v91
    v_pk_add_f32 v[88:89], v[88:89], s[36:37]
    v_pk_add_f32 v[90:91], v[90:91], s[36:37]
    v_rcp_f32 v88, v88
    v_rcp_f32 v89, v89
    v_rcp_f32 v90, v90
    v_rcp_f32 v91, v91
    v_pk_mul_f32 v[24:25], v[24:25], v[88:89]
    v_pk_mul_f32 v[26:27], v[26:27], v[90:91]
    v_pk_add_f32 v[120:121], v[24:25], v[26:27]
    v_pk_mul_f32 v[122:123], v[24:25], v[24:25]
    v_pk_fma_f32 v[122:123], v[26:27], v[26:27], v[122:123]
    s_add_u32 s67, s38, 45056
    buffer_load_dwordx4 v[184:187], v3, s[8:11], s67 offen offset:2048 sc1
    s_add_u32 s67, s38, 45056
    buffer_load_dwordx4 v[188:191], v3, s[8:11], s67 offen offset:3072 sc1
    s_add_u32 s67, s38, 49152
    buffer_load_dwordx4 v[192:195], v3, s[8:11], s67 offen offset:0 sc1
    v_pk_fma_f32 v[28:29], v[48:49], v[86:87], v[28:29] op_sel:[0,0,0] op_sel_hi:[1,0,1]
    v_pk_fma_f32 v[30:31], v[50:51], v[86:87], v[30:31] op_sel:[0,0,0] op_sel_hi:[1,0,1]
    v_pk_fma_f32 v[28:29], v[86:87], v[28:29], v[56:57] op_sel:[1,0,0] op_sel_hi:[1,1,1]
    v_pk_fma_f32 v[30:31], v[86:87], v[30:31], v[58:59] op_sel:[1,0,0] op_sel_hi:[1,1,1]
    v_pk_mul_f32 v[92:93], v[28:29], v[28:29]
    v_pk_mul_f32 v[94:95], v[30:31], v[30:31]
    v_pk_fma_f32 v[92:93], v[92:93], s[34:35], s[34:35] op_sel:[0,0,1] op_sel_hi:[1,0,1]
    v_pk_fma_f32 v[94:95], v[94:95], s[34:35], s[34:35] op_sel:[0,0,1] op_sel_hi:[1,0,1]
    v_pk_mul_f32 v[92:93], v[92:93], v[28:29]
    v_pk_mul_f32 v[94:95], v[94:95], v[30:31]
    v_exp_f32 v92, v92
    v_exp_f32 v93, v93
    v_exp_f32 v94, v94
    v_exp_f32 v95, v95
    v_pk_add_f32 v[92:93], v[92:93], s[36:37]
    v_pk_add_f32 v[94:95], v[94:95], s[36:37]
    v_rcp_f32 v92, v92
    v_rcp_f32 v93, v93
    v_rcp_f32 v94, v94
    v_rcp_f32 v95, v95
    v_pk_mul_f32 v[28:29], v[28:29], v[92:93]
    v_pk_mul_f32 v[30:31], v[30:31], v[94:95]
    v_pk_add_f32 v[124:125], v[28:29], v[30:31]
    v_pk_mul_f32 v[126:127], v[28:29], v[28:29]
    v_pk_fma_f32 v[126:127], v[30:31], v[30:31], v[126:127]
    s_add_u32 s67, s38, 49152
    buffer_load_dwordx4 v[196:199], v3, s[8:11], s67 offen offset:1024 sc1
    s_add_u32 s67, s38, 49152
    buffer_load_dwordx4 v[200:203], v3, s[8:11], s67 offen offset:2048 sc1
    s_add_u32 s67, s38, 49152
    buffer_load_dwordx4 v[204:207], v3, s[8:11], s67 offen offset:3072 sc1
    v_pk_fma_f32 v[32:33], v[52:53], v[80:81], v[32:33] op_sel:[0,0,0] op_sel_hi:[1,0,1]
    v_pk_fma_f32 v[34:35], v[54:55], v[80:81], v[34:35] op_sel:[0,0,0] op_sel_hi:[1,0,1]
    v_pk_fma_f32 v[32:33], v[80:81], v[32:33], v[60:61] op_sel:[1,0,0] op_sel_hi:[1,1,1]
    v_pk_fma_f32 v[34:35], v[80:81], v[34:35], v[62:63] op_sel:[1,0,0] op_sel_hi:[1,1,1]
    v_pk_mul_f32 v[88:89], v[32:33], v[32:33]
    v_pk_mul_f32 v[90:91], v[34:35], v[34:35]
    v_pk_fma_f32 v[88:89], v[88:89], s[34:35], s[34:35] op_sel:[0,0,1] op_sel_hi:[1,0,1]
    v_pk_fma_f32 v[90:91], v[90:91], s[34:35], s[34:35] op_sel:[0,0,1] op_sel_hi:[1,0,1]
    v_pk_mul_f32 v[88:89], v[88:89], v[32:33]
    v_pk_mul_f32 v[90:91], v[90:91], v[34:35]
    v_exp_f32 v88, v88
    v_exp_f32 v89, v89
    v_exp_f32 v90, v90
    v_exp_f32 v91, v91
    v_pk_add_f32 v[88:89], v[88:89], s[36:37]
    v_pk_add_f32 v[90:91], v[90:91], s[36:37]
    v_rcp_f32 v88, v88
    v_rcp_f32 v89, v89
    v_rcp_f32 v90, v90
    v_rcp_f32 v91, v91
    v_pk_mul_f32 v[32:33], v[32:33], v[88:89]
    v_pk_mul_f32 v[34:35], v[34:35], v[90:91]
    v_pk_add_f32 v[112:113], v[112:113], v[32:33]
    v_pk_fma_f32 v[114:115], v[32:33], v[32:33], v[114:115]
    v_pk_add_f32 v[112:113], v[112:113], v[34:35]
    v_pk_fma_f32 v[114:115], v[34:35], v[34:35], v[114:115]
    s_add_u32 s67, s38, 53248
    buffer_load_dwordx4 v[208:211], v3, s[8:11], s67 offen offset:0 sc1
    s_add_u32 s67, s38, 53248
    buffer_load_dwordx4 v[212:215], v3, s[8:11], s67 offen offset:1024 sc1
    s_add_u32 s67, s38, 53248
    buffer_load_dwordx4 v[216:219], v3, s[8:11], s67 offen offset:2048 sc1
    v_pk_fma_f32 v[36:37], v[52:53], v[82:83], v[36:37] op_sel:[0,0,0] op_sel_hi:[1,0,1]
    v_pk_fma_f32 v[38:39], v[54:55], v[82:83], v[38:39] op_sel:[0,0,0] op_sel_hi:[1,0,1]
    v_pk_fma_f32 v[36:37], v[82:83], v[36:37], v[60:61] op_sel:[1,0,0] op_sel_hi:[1,1,1]
    v_pk_fma_f32 v[38:39], v[82:83], v[38:39], v[62:63] op_sel:[1,0,0] op_sel_hi:[1,1,1]
    v_pk_mul_f32 v[92:93], v[36:37], v[36:37]
    v_pk_mul_f32 v[94:95], v[38:39], v[38:39]
    v_pk_fma_f32 v[92:93], v[92:93], s[34:35], s[34:35] op_sel:[0,0,1] op_sel_hi:[1,0,1]
    v_pk_fma_f32 v[94:95], v[94:95], s[34:35], s[34:35] op_sel:[0,0,1] op_sel_hi:[1,0,1]
    v_pk_mul_f32 v[92:93], v[92:93], v[36:37]
    v_pk_mul_f32 v[94:95], v[94:95], v[38:39]
    v_exp_f32 v92, v92
    v_exp_f32 v93, v93
    v_exp_f32 v94, v94
    v_exp_f32 v95, v95
    v_pk_add_f32 v[92:93], v[92:93], s[36:37]
    v_pk_add_f32 v[94:95], v[94:95], s[36:37]
    v_rcp_f32 v92, v92
    v_rcp_f32 v93, v93
    v_rcp_f32 v94, v94
    v_rcp_f32 v95, v95
    v_pk_mul_f32 v[36:37], v[36:37], v[92:93]
    v_pk_mul_f32 v[38:39], v[38:39], v[94:95]
    v_pk_add_f32 v[116:117], v[116:117], v[36:37]
    v_pk_fma_f32 v[118:119], v[36:37], v[36:37], v[118:119]
    v_pk_add_f32 v[116:117], v[116:117], v[38:39]
    v_pk_fma_f32 v[118:119], v[38:39], v[38:39], v[118:119]
    s_add_u32 s67, s38, 53248
    buffer_load_dwordx4 v[220:223], v3, s[8:11], s67 offen offset:3072 sc1
    s_add_u32 s67, s38, 57344
    buffer_load_dwordx4 v[224:227], v3, s[8:11], s67 offen offset:0 sc1
    s_add_u32 s67, s38, 57344
    buffer_load_dwordx4 v[228:231], v3, s[8:11], s67 offen offset:1024 sc1
    v_pk_fma_f32 v[40:41], v[52:53], v[84:85], v[40:41] op_sel:[0,0,0] op_sel_hi:[1,0,1]
    v_pk_fma_f32 v[42:43], v[54:55], v[84:85], v[42:43] op_sel:[0,0,0] op_sel_hi:[1,0,1]
    v_pk_fma_f32 v[40:41], v[84:85], v[40:41], v[60:61] op_sel:[1,0,0] op_sel_hi:[1,1,1]
    v_pk_fma_f32 v[42:43], v[84:85], v[42:43], v[62:63] op_sel:[1,0,0] op_sel_hi:[1,1,1]
    v_pk_mul_f32 v[88:89], v[40:41], v[40:41]
    v_pk_mul_f32 v[90:91], v[42:43], v[42:43]
    v_pk_fma_f32 v[88:89], v[88:89], s[34:35], s[34:35] op_sel:[0,0,1] op_sel_hi:[1,0,1]
    v_pk_fma_f32 v[90:91], v[90:91], s[34:35], s[34:35] op_sel:[0,0,1] op_sel_hi:[1,0,1]
    v_pk_mul_f32 v[88:89], v[88:89], v[40:41]
    v_pk_mul_f32 v[90:91], v[90:91], v[42:43]
    v_exp_f32 v88, v88
    v_exp_f32 v89, v89
    v_exp_f32 v90, v90
    v_exp_f32 v91, v91
    v_pk_add_f32 v[88:89], v[88:89], s[36:37]
    v_pk_add_f32 v[90:91], v[90:91], s[36:37]
    v_rcp_f32 v88, v88
    v_rcp_f32 v89, v89
    v_rcp_f32 v90, v90
    v_rcp_f32 v91, v91
    v_pk_mul_f32 v[40:41], v[40:41], v[88:89]
    v_pk_mul_f32 v[42:43], v[42:43], v[90:91]
    v_pk_add_f32 v[120:121], v[120:121], v[40:41]
    v_pk_fma_f32 v[122:123], v[40:41], v[40:41], v[122:123]
    v_pk_add_f32 v[120:121], v[120:121], v[42:43]
    v_pk_fma_f32 v[122:123], v[42:43], v[42:43], v[122:123]
    s_add_u32 s67, s38, 57344
    buffer_load_dwordx4 v[232:235], v3, s[8:11], s67 offen offset:2048 sc1
    s_add_u32 s67, s38, 57344
    buffer_load_dwordx4 v[236:239], v3, s[8:11], s67 offen offset:3072 sc1
    s_add_u32 s67, s38, 61440
    buffer_load_dwordx4 v[240:243], v3, s[8:11], s67 offen offset:0 sc1
    v_pk_fma_f32 v[44:45], v[52:53], v[86:87], v[44:45] op_sel:[0,0,0] op_sel_hi:[1,0,1]
    v_pk_fma_f32 v[46:47], v[54:55], v[86:87], v[46:47] op_sel:[0,0,0] op_sel_hi:[1,0,1]
    v_pk_fma_f32 v[44:45], v[86:87], v[44:45], v[60:61] op_sel:[1,0,0] op_sel_hi:[1,1,1]
    v_pk_fma_f32 v[46:47], v[86:87], v[46:47], v[62:63] op_sel:[1,0,0] op_sel_hi:[1,1,1]
    v_pk_mul_f32 v[92:93], v[44:45], v[44:45]
    v_pk_mul_f32 v[94:95], v[46:47], v[46:47]
    v_pk_fma_f32 v[92:93], v[92:93], s[34:35], s[34:35] op_sel:[0,0,1] op_sel_hi:[1,0,1]
    v_pk_fma_f32 v[94:95], v[94:95], s[34:35], s[34:35] op_sel:[0,0,1] op_sel_hi:[1,0,1]
    v_pk_mul_f32 v[92:93], v[92:93], v[44:45]
    v_pk_mul_f32 v[94:95], v[94:95], v[46:47]
    v_exp_f32 v92, v92
    v_exp_f32 v93, v93
    v_exp_f32 v94, v94
    v_exp_f32 v95, v95
    v_pk_add_f32 v[92:93], v[92:93], s[36:37]
    v_pk_add_f32 v[94:95], v[94:95], s[36:37]
    v_rcp_f32 v92, v92
    v_rcp_f32 v93, v93
    v_rcp_f32 v94, v94
    v_rcp_f32 v95, v95
    v_pk_mul_f32 v[44:45], v[44:45], v[92:93]
    v_pk_mul_f32 v[46:47], v[46:47], v[94:95]
    v_pk_add_f32 v[124:125], v[124:125], v[44:45]
    v_pk_fma_f32 v[126:127], v[44:45], v[44:45], v[126:127]
    v_pk_add_f32 v[124:125], v[124:125], v[46:47]
    v_pk_fma_f32 v[126:127], v[46:47], v[46:47], v[126:127]
    s_add_u32 s67, s38, 61440
    buffer_load_dwordx4 v[244:247], v3, s[8:11], s67 offen offset:1024 sc1
    s_add_u32 s67, s38, 61440
    buffer_load_dwordx4 v[248:251], v3, s[8:11], s67 offen offset:2048 sc1
    s_add_u32 s67, s38, 61440
    buffer_load_dwordx4 v[252:255], v3, s[8:11], s67 offen offset:3072 sc1
    v_add_f32 v112, v112, v113
    v_add_f32 v113, v114, v115
    v_add_f32 v116, v116, v117
    v_add_f32 v117, v118, v119
    v_add_f32 v120, v120, v121
    v_add_f32 v121, v122, v123
    v_add_f32 v124, v124, v125
    v_add_f32 v125, v126, v127
    v_permlane32_swap_b32 v112, v120
    v_permlane32_swap_b32 v116, v124
    v_permlane32_swap_b32 v113, v121
    v_permlane32_swap_b32 v117, v125
    v_pk_add_f32 v[112:113], v[112:113], v[120:121]
    v_pk_add_f32 v[116:117], v[116:117], v[124:125]
    s_lshl_b32 s67, s28, zlit_b-zlit_a+(9)
    s_add_u32 s67, s67, 155648
    v_add_u32 v0, s67, v9
    v_permlane16_swap_b32 v112, v116
    v_permlane16_swap_b32_e64 v113, v117
    v_pk_add_f32 v[112:113], v[112:113], v[116:117]
    ds_write_b64 v0, v[112:113]
    v_mov_b32 v88, 162820
    v_mov_b32 v89, 1
    s_mov_b64 exec, 1
    ds_add_u32 v88, v89
    s_mov_b64 exec, -1
    s_lshl_b32 s30, s28, 11
    s_add_u32 s30, s30, 147456
    v_lshrrev_b32_e64 v90, 1, v6
    v_lshl_add_u32 v90, v7, 2, v90
    v_add_u32_e64 v90, s30, v90
    v_lshl_add_u32 v91, v6, 4, v7
    v_add_u32_e64 v91, s30, v91
    s_mul_i32 s30, s17, 458752
    s_mul_i32 s31, s16, 14336
    s_add_u32 s30, s30, s31
    s_lshl_b32 s31, s28, zlit_b-zlit_a+(11)
    s_add_u32 s30, s30, s31
    s_add_u32 s30, s30, 26148864
    s_add_u32 s31, s30, 7168
    v_add_u32 v4, 162304, v7
    v_mov_b32 v88, 162824
    s_mov_b32 s70, zlit_b-zlit_a+(0)
kf_kernel_b_spzc12:
    ds_read_b32 v89, v88
    s_add_u32 s70, s70, zlit_b-zlit_a+(1)
    s_cmp_lt_u32 s70, 0x400000
    s_waitcnt lgkmcnt(0)
    v_cmp_ne_u32_e64 vcc, 1, v89
    s_cbranch_vccz kf_kernel_b_sqzc12
    s_sleep 1
    s_cbranch_scc1 kf_kernel_b_spzc12
kf_kernel_b_sqzc12:
    ds_read_b64 v[80:81], v4 offset:0
    ds_read_b64 v[82:83], v4 offset:128
    ds_read_b64 v[84:85], v4 offset:256
    ds_read_b64 v[86:87], v4 offset:384
    s_waitcnt lgkmcnt(0)
    v_fma_f32 v16, v81, v16, v80
    v_fma_f32 v17, v81, v17, v80
    v_fma_f32 v18, v81, v18, v80
    v_fma_f32 v19, v81, v19, v80
    v_cvt_pk_bf16_f32 v16, v16, v17
    v_cvt_pk_bf16_f32 v17, v18, v19
    ds_write_b64 v90, v[16:17] offset:0
    v_fma_f32 v20, v83, v20, v82
    v_fma_f32 v21, v83, v21, v82
    v_fma_f32 v22, v83, v22, v82
    v_fma_f32 v23, v83, v23, v82
    v_cvt_pk_bf16_f32 v20, v20, v21
    v_cvt_pk_bf16_f32 v21, v22, v23
    ds_write_b64 v90, v[20:21] offset:512
    v_fma_f32 v32, v81, v32, v80
    v_fma_f32 v33, v81, v33, v80
    v_fma_f32 v34, v81, v34, v80
    v_fma_f32 v35, v81, v35, v80
    v_cvt_pk_bf16_f32 v32, v32, v33
    v_cvt_pk_bf16_f32 v33, v34, v35
    ds_write_b64 v90, v[32:33] offset:1024
    v_fma_f32 v36, v83, v36, v82
    v_fma_f32 v37, v83, v37, v82
    v_fma_f32 v38, v83, v38, v82
    v_fma_f32 v39, v83, v39, v82
    v_cvt_pk_bf16_f32 v36, v36, v37
    v_cvt_pk_bf16_f32 v37, v38, v39
    ds_write_b64 v90, v[36:37] offset:1536
    ds_read_b64_tr_b16 v[64:65], v91 offset:0
    ds_read_b64_tr_b16 v[66:67], v91 offset:128
    ds_read_b64_tr_b16 v[68:69], v91 offset:1024
    ds_read_b64_tr_b16 v[70:71], v91 offset:1152
    v_fma_f32 v24, v85, v24, v84
    v_fma_f32 v25, v85, v25, v84
    v_fma_f32 v26, v85, v26, v84
    v_fma_f32 v27, v85, v27, v84
    v_cvt_pk_bf16_f32 v24, v24, v25
    v_cvt_pk_bf16_f32 v25, v26, v27
    ds_write_b64 v90, v[24:25] offset:0
    v_fma_f32 v28, v87, v28, v86
    v_fma_f32 v29, v87, v29, v86
    v_fma_f32 v30, v87, v30, v86
    v_fma_f32 v31, v87, v31, v86
    v_cvt_pk_bf16_f32 v28, v28, v29
    v_cvt_pk_bf16_f32 v29, v30, v31
    ds_write_b64 v90, v[28:29] offset:512
    v_fma_f32 v40, v85, v40, v84
    v_fma_f32 v41, v85, v41, v84
    v_fma_f32 v42, v85, v42, v84
    v_fma_f32 v43, v85, v43, v84
    v_cvt_pk_bf16_f32 v40, v40, v41
    v_cvt_pk_bf16_f32 v41, v42, v43
    ds_write_b64 v90, v[40:41] offset:1024
    v_fma_f32 v44, v87, v44, v86
    v_fma_f32 v45, v87, v45, v86
    v_fma_f32 v46, v87, v46, v86
    v_fma_f32 v47, v87, v47, v86
    v_cvt_pk_bf16_f32 v44, v44, v45
    v_cvt_pk_bf16_f32 v45, v46, v47
    ds_write_b64 v90, v[44:45] offset:1536
    ds_read_b64_tr_b16 v[72:73], v91 offset:0
    ds_read_b64_tr_b16 v[74:75], v91 offset:128
    ds_read_b64_tr_b16 v[76:77], v91 offset:1024
    ds_read_b64_tr_b16 v[78:79], v91 offset:1152
    s_waitcnt lgkmcnt(10)
    buffer_store_dwordx4 v[64:67], v3, s[8:11], s30 offen offset:0 sc1
    s_waitcnt lgkmcnt(8)
    buffer_store_dwordx4 v[68:71], v3, s[8:11], s30 offen offset:1024 sc1
    s_waitcnt lgkmcnt(2)
    buffer_store_dwordx4 v[72:75], v3, s[8:11], s31 offen offset:0 sc1
    s_waitcnt lgkmcnt(0)
    buffer_store_dwordx4 v[76:79], v3, s[8:11], s31 offen offset:1024 sc1
    s_add_u32 s67, s38, 0
    buffer_load_dwordx4 v[144:147], v3, s[8:11], s67 offen offset:0 sc1
    s_add_u32 s67, s38, zlit_b-zlit_a+(0)
    buffer_load_dwordx4 v[148:151], v3, s[8:11], s67 offen offset:1024 sc1
    s_add_u32 s67, s38, zlit_b-zlit_a+(0)
    buffer_load_dwordx4 v[152:155], v3, s[8:11], s67 offen offset:2048 sc1
    s_add_u32 s67, s38, zlit_b-zlit_a+(0)
    buffer_load_dwordx4 v[156:159], v3, s[8:11], s67 offen offset:3072 sc1
    s_waitcnt vmcnt(4)
    v_mov_b32 v88, 162828
    v_mov_b32_e64 v89, 1
    s_mov_b64 exec, 1
    ds_add_u32 v88, v89
    s_mov_b64 exec, -1
    s_barrier
kf_kernel_b_d0:
    s_setprio 3
    buffer_load_dwordx4 v[80:83], v3, s[8:11], s45 offen offset:0 sc1
    buffer_load_dwordx4 v[84:87], v3, s[8:11], s45 offen offset:1024 sc1
    buffer_load_dwordx4 v[88:91], v3, s[8:11], s45 offen offset:2048 sc1
    buffer_load_dwordx4 v[92:95], v3, s[8:11], s45 offen offset:3072 sc1
    buffer_load_dwordx4 v[96:99], v3, s[8:11], s46 offen offset:0 sc1
    buffer_load_dwordx4 v[100:103], v3, s[8:11], s46 offen offset:1024 sc1
    buffer_load_dwordx4 v[104:107], v3, s[8:11], s46 offen offset:2048 sc1
    buffer_load_dwordx4 v[108:111], v3, s[8:11], s46 offen offset:3072 sc1
    s_setprio 2
    buffer_load_dwordx4 v[112:115], v3, s[8:11], s47 offen offset:0 sc1
    buffer_load_dwordx4 v[116:119], v3, s[8:11], s47 offen offset:1024 sc1
    buffer_load_dwordx4 v[120:123], v3, s[8:11], s47 offen offset:2048 sc1
    buffer_load_dwordx4 v[124:127], v3, s[8:11], s47 offen offset:3072 sc1
    buffer_load_dwordx4 v[128:131], v3, s[8:11], s48 offen offset:0 sc1
    buffer_load_dwordx4 v[132:135], v3, s[8:11], s48 offen offset:1024 sc1
    buffer_load_dwordx4 v[136:139], v3, s[8:11], s48 offen offset:2048 sc1
    buffer_load_dwordx4 v[140:143], v3, s[8:11], s48 offen offset:3072 sc1
    s_mov_b32 s14, 4096
    v_lshrrev_b32 v0, 2, v7
    s_lshl_b32 s67, s29, 5
    buffer_load_ushort v4, v0, s[12:15], s67 offen
    v_add_u32_e64 v8, s40, v3
    v_add_u32 v0, 81920, v8
    s_mul_i32 s30, s28, 7168
    s_mul_i32 s31, s26, 143360
    s_add_u32 s31, s31, s30
    s_add_u32 s31, s31, 3502080
    s_add_u32 s30, s30, 100352
    s_waitcnt vmcnt(16)
    v_mfma_f32_16x16x32_bf16 v[16:19], v[80:83], v[144:147], 0
    v_mfma_f32_16x16x32_bf16 v[20:23], v[80:83], v[148:151], 0
    v_mfma_f32_16x16x32_bf16 v[24:27], v[80:83], v[152:155], 0
    v_mfma_f32_16x16x32_bf16 v[28:31], v[80:83], v[156:159], 0
    s_setprio 1
    buffer_load_dwordx4 v[80:83], v3, s[8:11], s49 offen offset:0 sc1
    s_waitcnt vmcnt(16)
    v_mfma_f32_16x16x32_bf16 v[32:35], v[84:87], v[144:147], 0
    v_mfma_f32_16x16x32_bf16 v[36:39], v[84:87], v[148:151], 0
    v_mfma_f32_16x16x32_bf16 v[40:43], v[84:87], v[152:155], 0
    v_mfma_f32_16x16x32_bf16 v[44:47], v[84:87], v[156:159], 0
    buffer_load_dwordx4 v[84:87], v3, s[8:11], s49 offen offset:1024 sc1
    s_waitcnt vmcnt(16)
    v_mfma_f32_16x16x32_bf16 v[48:51], v[88:91], v[144:147], 0
    v_mfma_f32_16x16x32_bf16 v[52:55], v[88:91], v[148:151], 0
    v_mfma_f32_16x16x32_bf16 v[56:59], v[88:91], v[152:155], 0
    v_mfma_f32_16x16x32_bf16 v[60:63], v[88:91], v[156:159], 0
    buffer_load_dwordx4 v[88:91], v3, s[8:11], s49 offen offset:2048 sc1
    s_waitcnt vmcnt(16)
    v_mfma_f32_16x16x32_bf16 v[64:67], v[92:95], v[144:147], 0
    v_mfma_f32_16x16x32_bf16 v[68:71], v[92:95], v[148:151], 0
    v_mfma_f32_16x16x32_bf16 v[72:75], v[92:95], v[152:155], 0
    v_mfma_f32_16x16x32_bf16 v[76:79], v[92:95], v[156:159], 0
    buffer_load_dwordx4 v[92:95], v3, s[8:11], s49 offen offset:3072 sc1
    ds_read_b128 v[144:147], v0 offset:0
    ds_read_b128 v[148:151], v0 offset:1024
    ds_read_b128 v[152:155], v0 offset:2048
    ds_read_b128 v[156:159], v0 offset:3072
    s_waitcnt vmcnt(16)
    v_mfma_f32_16x16x32_bf16 v[16:19], v[96:99], v[160:163], v[16:19]
    v_mfma_f32_16x16x32_bf16 v[20:23], v[96:99], v[164:167], v[20:23]
    v_mfma_f32_16x16x32_bf16 v[24:27], v[96:99], v[168:171], v[24:27]
    v_mfma_f32_16x16x32_bf16 v[28:31], v[96:99], v[172:175], v[28:31]
    buffer_load_dwordx4 v[96:99], v3, s[8:11], s50 offen offset:0 sc1
    s_waitcnt vmcnt(16)
    v_mfma_f32_16x16x32_bf16 v[32:35], v[100:103], v[160:163], v[32:35]
    v_mfma_f32_16x16x32_bf16 v[36:39], v[100:103], v[164:167], v[36:39]
    v_mfma_f32_16x16x32_bf16 v[40:43], v[100:103], v[168:171], v[40:43]
    v_mfma_f32_16x16x32_bf16 v[44:47], v[100:103], v[172:175], v[44:47]
    buffer_load_dwordx4 v[100:103], v3, s[8:11], s50 offen offset:1024 sc1
    s_waitcnt vmcnt(16)
    v_mfma_f32_16x16x32_bf16 v[48:51], v[104:107], v[160:163], v[48:51]
    v_mfma_f32_16x16x32_bf16 v[52:55], v[104:107], v[164:167], v[52:55]
    v_mfma_f32_16x16x32_bf16 v[56:59], v[104:107], v[168:171], v[56:59]
    v_mfma_f32_16x16x32_bf16 v[60:63], v[104:107], v[172:175], v[60:63]
    buffer_load_dwordx4 v[104:107], v3, s[8:11], s50 offen offset:2048 sc1
    s_waitcnt vmcnt(16)
    v_mfma_f32_16x16x32_bf16 v[64:67], v[108:111], v[160:163], v[64:67]
    v_mfma_f32_16x16x32_bf16 v[68:71], v[108:111], v[164:167], v[68:71]
    v_mfma_f32_16x16x32_bf16 v[72:75], v[108:111], v[168:171], v[72:75]
    v_mfma_f32_16x16x32_bf16 v[76:79], v[108:111], v[172:175], v[76:79]
    buffer_load_dwordx4 v[108:111], v3, s[8:11], s50 offen offset:3072 sc1
    ds_read_b128 v[160:163], v0 offset:16384
    ds_read_b128 v[164:167], v0 offset:17408
    ds_read_b128 v[168:171], v0 offset:18432
    ds_read_b128 v[172:175], v0 offset:19456
    s_waitcnt vmcnt(16) lgkmcnt(4)
    v_mfma_f32_16x16x32_bf16 v[16:19], v[112:115], v[144:147], v[16:19]
    v_mfma_f32_16x16x32_bf16 v[20:23], v[112:115], v[148:151], v[20:23]
    v_mfma_f32_16x16x32_bf16 v[24:27], v[112:115], v[152:155], v[24:27]
    v_mfma_f32_16x16x32_bf16 v[28:31], v[112:115], v[156:159], v[28:31]
    s_setprio 0
    buffer_load_dwordx4 v[112:115], v3, s[8:11], s51 offen offset:0 sc1
    s_waitcnt vmcnt(16)
    v_mfma_f32_16x16x32_bf16 v[32:35], v[116:119], v[144:147], v[32:35]
    v_mfma_f32_16x16x32_bf16 v[36:39], v[116:119], v[148:151], v[36:39]
    v_mfma_f32_16x16x32_bf16 v[40:43], v[116:119], v[152:155], v[40:43]
    v_mfma_f32_16x16x32_bf16 v[44:47], v[116:119], v[156:159], v[44:47]
    buffer_load_dwordx4 v[116:119], v3, s[8:11], s51 offen offset:1024 sc1
    s_waitcnt vmcnt(16)
    v_mfma_f32_16x16x32_bf16 v[48:51], v[120:123], v[144:147], v[48:51]
    v_mfma_f32_16x16x32_bf16 v[52:55], v[120:123], v[148:151], v[52:55]
    v_mfma_f32_16x16x32_bf16 v[56:59], v[120:123], v[152:155], v[56:59]
    v_mfma_f32_16x16x32_bf16 v[60:63], v[120:123], v[156:159], v[60:63]
    buffer_load_dwordx4 v[120:123], v3, s[8:11], s51 offen offset:2048 sc1
    s_waitcnt vmcnt(16)
    v_mfma_f32_16x16x32_bf16 v[64:67], v[124:127], v[144:147], v[64:67]
    v_mfma_f32_16x16x32_bf16 v[68:71], v[124:127], v[148:151], v[68:71]
    v_mfma_f32_16x16x32_bf16 v[72:75], v[124:127], v[152:155], v[72:75]
    v_mfma_f32_16x16x32_bf16 v[76:79], v[124:127], v[156:159], v[76:79]
    buffer_load_dwordx4 v[124:127], v3, s[8:11], s51 offen offset:3072 sc1
    ds_read_b128 v[144:147], v0 offset:32768
    ds_read_b128 v[148:151], v0 offset:33792
    ds_read_b128 v[152:155], v0 offset:34816
    ds_read_b128 v[156:159], v0 offset:35840
    s_waitcnt vmcnt(16) lgkmcnt(4)
    v_mfma_f32_16x16x32_bf16 v[16:19], v[128:131], v[160:163], v[16:19]
    v_mfma_f32_16x16x32_bf16 v[20:23], v[128:131], v[164:167], v[20:23]
    v_mfma_f32_16x16x32_bf16 v[24:27], v[128:131], v[168:171], v[24:27]
    v_mfma_f32_16x16x32_bf16 v[28:31], v[128:131], v[172:175], v[28:31]
    s_barrier
    buffer_load_dwordx4 v[128:131], v3, s[8:11], s52 offen offset:0 sc1
    s_waitcnt vmcnt(16)
    v_mfma_f32_16x16x32_bf16 v[32:35], v[132:135], v[160:163], v[32:35]
    v_mfma_f32_16x16x32_bf16 v[36:39], v[132:135], v[164:167], v[36:39]
    v_mfma_f32_16x16x32_bf16 v[40:43], v[132:135], v[168:171], v[40:43]
    v_mfma_f32_16x16x32_bf16 v[44:47], v[132:135], v[172:175], v[44:47]
    buffer_load_dwordx4 v[132:135], v3, s[8:11], s52 offen offset:1024 sc1
    s_waitcnt vmcnt(16)
    v_mfma_f32_16x16x32_bf16 v[48:51], v[136:139], v[160:163], v[48:51]
    v_mfma_f32_16x16x32_bf16 v[52:55], v[136:139], v[164:167], v[52:55]
    v_mfma_f32_16x16x32_bf16 v[56:59], v[136:139], v[168:171], v[56:59]
    v_mfma_f32_16x16x32_bf16 v[60:63], v[136:139], v[172:175], v[60:63]
    buffer_load_dwordx4 v[136:139], v3, s[8:11], s52 offen offset:2048 sc1
    s_waitcnt vmcnt(16)
    v_mfma_f32_16x16x32_bf16 v[64:67], v[140:143], v[160:163], v[64:67]
    v_mfma_f32_16x16x32_bf16 v[68:71], v[140:143], v[164:167], v[68:71]
    v_mfma_f32_16x16x32_bf16 v[72:75], v[140:143], v[168:171], v[72:75]
    v_mfma_f32_16x16x32_bf16 v[76:79], v[140:143], v[172:175], v[76:79]
    buffer_load_dwordx4 v[140:143], v3, s[8:11], s52 offen offset:3072 sc1
    ds_read_b128 v[160:163], v0 offset:49152
    ds_read_b128 v[164:167], v0 offset:50176
    ds_read_b128 v[168:171], v0 offset:51200
    ds_read_b128 v[172:175], v0 offset:52224
    s_waitcnt vmcnt(15) lgkmcnt(4)
    v_mfma_f32_16x16x32_bf16 v[16:19], v[80:83], v[144:147], v[16:19]
    v_mfma_f32_16x16x32_bf16 v[20:23], v[80:83], v[148:151], v[20:23]
    v_mfma_f32_16x16x32_bf16 v[24:27], v[80:83], v[152:155], v[24:27]
    v_mfma_f32_16x16x32_bf16 v[28:31], v[80:83], v[156:159], v[28:31]
    s_setprio 3
    buffer_load_dwordx4 v[80:83], v3, s[8:11], s53 offen offset:0 sc1
    s_waitcnt vmcnt(15)
    v_mfma_f32_16x16x32_bf16 v[32:35], v[84:87], v[144:147], v[32:35]
    v_mfma_f32_16x16x32_bf16 v[36:39], v[84:87], v[148:151], v[36:39]
    v_mfma_f32_16x16x32_bf16 v[40:43], v[84:87], v[152:155], v[40:43]
    v_mfma_f32_16x16x32_bf16 v[44:47], v[84:87], v[156:159], v[44:47]
    buffer_load_dwordx4 v[84:87], v3, s[8:11], s53 offen offset:1024 sc1
    s_waitcnt vmcnt(15)
    v_mfma_f32_16x16x32_bf16 v[48:51], v[88:91], v[144:147], v[48:51]
    v_mfma_f32_16x16x32_bf16 v[52:55], v[88:91], v[148:151], v[52:55]
    v_mfma_f32_16x16x32_bf16 v[56:59], v[88:91], v[152:155], v[56:59]
    v_mfma_f32_16x16x32_bf16 v[60:63], v[88:91], v[156:159], v[60:63]
    buffer_load_dwordx4 v[88:91], v3, s[8:11], s53 offen offset:2048 sc1
    s_waitcnt vmcnt(15)
    v_mfma_f32_16x16x32_bf16 v[64:67], v[92:95], v[144:147], v[64:67]
    v_mfma_f32_16x16x32_bf16 v[68:71], v[92:95], v[148:151], v[68:71]
    v_mfma_f32_16x16x32_bf16 v[72:75], v[92:95], v[152:155], v[72:75]
    v_mfma_f32_16x16x32_bf16 v[76:79], v[92:95], v[156:159], v[76:79]
    buffer_load_dwordx4 v[92:95], v3, s[8:11], s53 offen offset:3072 sc1
    ds_read_b128 v[144:147], v8 offset:0
    ds_read_b128 v[148:151], v8 offset:1024
    ds_read_b128 v[152:155], v8 offset:2048
    ds_read_b128 v[156:159], v8 offset:3072
    s_waitcnt vmcnt(15) lgkmcnt(4)
    v_mfma_f32_16x16x32_bf16 v[16:19], v[96:99], v[160:163], v[16:19]
    v_mfma_f32_16x16x32_bf16 v[20:23], v[96:99], v[164:167], v[20:23]
    v_mfma_f32_16x16x32_bf16 v[24:27], v[96:99], v[168:171], v[24:27]
    v_mfma_f32_16x16x32_bf16 v[28:31], v[96:99], v[172:175], v[28:31]
    buffer_load_dwordx4 v[96:99], v3, s[8:11], s54 offen offset:0 sc1
    s_waitcnt vmcnt(15)
    v_mfma_f32_16x16x32_bf16 v[32:35], v[100:103], v[160:163], v[32:35]
    v_mfma_f32_16x16x32_bf16 v[36:39], v[100:103], v[164:167], v[36:39]
    v_mfma_f32_16x16x32_bf16 v[40:43], v[100:103], v[168:171], v[40:43]
    v_mfma_f32_16x16x32_bf16 v[44:47], v[100:103], v[172:175], v[44:47]
    buffer_load_dwordx4 v[100:103], v3, s[8:11], s54 offen offset:1024 sc1
    s_waitcnt vmcnt(15)
    v_mfma_f32_16x16x32_bf16 v[48:51], v[104:107], v[160:163], v[48:51]
    v_mfma_f32_16x16x32_bf16 v[52:55], v[104:107], v[164:167], v[52:55]
    v_mfma_f32_16x16x32_bf16 v[56:59], v[104:107], v[168:171], v[56:59]
    v_mfma_f32_16x16x32_bf16 v[60:63], v[104:107], v[172:175], v[60:63]
    buffer_load_dwordx4 v[104:107], v3, s[8:11], s54 offen offset:2048 sc1
    s_waitcnt vmcnt(15)
    v_mfma_f32_16x16x32_bf16 v[64:67], v[108:111], v[160:163], v[64:67]
    v_mfma_f32_16x16x32_bf16 v[68:71], v[108:111], v[164:167], v[68:71]
    v_mfma_f32_16x16x32_bf16 v[72:75], v[108:111], v[168:171], v[72:75]
    v_mfma_f32_16x16x32_bf16 v[76:79], v[108:111], v[172:175], v[76:79]
    buffer_load_dwordx4 v[108:111], v3, s[8:11], s54 offen offset:3072 sc1
    ds_read_b128 v[160:163], v8 offset:16384
    ds_read_b128 v[164:167], v8 offset:17408
    ds_read_b128 v[168:171], v8 offset:18432
    ds_read_b128 v[172:175], v8 offset:19456
    s_waitcnt vmcnt(15) lgkmcnt(4)
    v_mfma_f32_16x16x32_bf16 v[16:19], v[112:115], v[144:147], v[16:19]
    v_mfma_f32_16x16x32_bf16 v[20:23], v[112:115], v[148:151], v[20:23]
    v_mfma_f32_16x16x32_bf16 v[24:27], v[112:115], v[152:155], v[24:27]
    v_mfma_f32_16x16x32_bf16 v[28:31], v[112:115], v[156:159], v[28:31]
    s_setprio 2
    buffer_load_dwordx4 v[112:115], v3, s[8:11], s55 offen offset:0 sc1
    s_waitcnt vmcnt(15)
    v_mfma_f32_16x16x32_bf16 v[32:35], v[116:119], v[144:147], v[32:35]
    v_mfma_f32_16x16x32_bf16 v[36:39], v[116:119], v[148:151], v[36:39]
    v_mfma_f32_16x16x32_bf16 v[40:43], v[116:119], v[152:155], v[40:43]
    v_mfma_f32_16x16x32_bf16 v[44:47], v[116:119], v[156:159], v[44:47]
    buffer_load_dwordx4 v[116:119], v3, s[8:11], s55 offen offset:1024 sc1
    s_waitcnt vmcnt(15)
    v_mfma_f32_16x16x32_bf16 v[48:51], v[120:123], v[144:147], v[48:51]
    v_mfma_f32_16x16x32_bf16 v[52:55], v[120:123], v[148:151], v[52:55]
    v_mfma_f32_16x16x32_bf16 v[56:59], v[120:123], v[152:155], v[56:59]
    v_mfma_f32_16x16x32_bf16 v[60:63], v[120:123], v[156:159], v[60:63]
    buffer_load_dwordx4 v[120:123], v3, s[8:11], s55 offen offset:2048 sc1
    s_waitcnt vmcnt(15)
    v_mfma_f32_16x16x32_bf16 v[64:67], v[124:127], v[144:147], v[64:67]
    v_mfma_f32_16x16x32_bf16 v[68:71], v[124:127], v[148:151], v[68:71]
    v_mfma_f32_16x16x32_bf16 v[72:75], v[124:127], v[152:155], v[72:75]
    v_mfma_f32_16x16x32_bf16 v[76:79], v[124:127], v[156:159], v[76:79]
    buffer_load_dwordx4 v[124:127], v3, s[8:11], s55 offen offset:3072 sc1
    ds_read_b128 v[144:147], v8 offset:32768
    ds_read_b128 v[148:151], v8 offset:33792
    ds_read_b128 v[152:155], v8 offset:34816
    ds_read_b128 v[156:159], v8 offset:35840
    s_waitcnt vmcnt(15) lgkmcnt(4)
    v_mfma_f32_16x16x32_bf16 v[16:19], v[128:131], v[160:163], v[16:19]
    v_mfma_f32_16x16x32_bf16 v[20:23], v[128:131], v[164:167], v[20:23]
    v_mfma_f32_16x16x32_bf16 v[24:27], v[128:131], v[168:171], v[24:27]
    v_mfma_f32_16x16x32_bf16 v[28:31], v[128:131], v[172:175], v[28:31]
    buffer_load_dwordx4 v[128:131], v3, s[8:11], s56 offen offset:0 sc1
    s_waitcnt vmcnt(15)
    v_mfma_f32_16x16x32_bf16 v[32:35], v[132:135], v[160:163], v[32:35]
    v_mfma_f32_16x16x32_bf16 v[36:39], v[132:135], v[164:167], v[36:39]
    v_mfma_f32_16x16x32_bf16 v[40:43], v[132:135], v[168:171], v[40:43]
    v_mfma_f32_16x16x32_bf16 v[44:47], v[132:135], v[172:175], v[44:47]
    s_setprio 1
    buffer_load_dwordx4 v[132:135], v3, s[8:11], s57 offen offset:0 sc1
    s_waitcnt vmcnt(15)
    v_mfma_f32_16x16x32_bf16 v[48:51], v[136:139], v[160:163], v[48:51]
    v_mfma_f32_16x16x32_bf16 v[52:55], v[136:139], v[164:167], v[52:55]
    v_mfma_f32_16x16x32_bf16 v[56:59], v[136:139], v[168:171], v[56:59]
    v_mfma_f32_16x16x32_bf16 v[60:63], v[136:139], v[172:175], v[60:63]
    buffer_load_dwordx4 v[136:139], v3, s[8:11], s58 offen offset:0 sc1
    s_waitcnt vmcnt(15)
    v_mfma_f32_16x16x32_bf16 v[64:67], v[140:143], v[160:163], v[64:67]
    v_mfma_f32_16x16x32_bf16 v[68:71], v[140:143], v[164:167], v[68:71]
    v_mfma_f32_16x16x32_bf16 v[72:75], v[140:143], v[168:171], v[72:75]
    v_mfma_f32_16x16x32_bf16 v[76:79], v[140:143], v[172:175], v[76:79]
    s_setprio 0
    buffer_load_dwordx4 v[140:143], v3, s[8:11], s59 offen offset:0 sc1
    ds_read_b128 v[160:163], v8 offset:49152
    ds_read_b128 v[164:167], v8 offset:50176
    ds_read_b128 v[168:171], v8 offset:51200
    ds_read_b128 v[172:175], v8 offset:52224
    s_waitcnt vmcnt(15) lgkmcnt(4)
    v_mfma_f32_16x16x32_bf16 v[16:19], v[80:83], v[144:147], v[16:19]
    v_mfma_f32_16x16x32_bf16 v[20:23], v[80:83], v[148:151], v[20:23]
    v_mfma_f32_16x16x32_bf16 v[24:27], v[80:83], v[152:155], v[24:27]
    v_mfma_f32_16x16x32_bf16 v[28:31], v[80:83], v[156:159], v[28:31]
    buffer_load_dwordx4 v[80:83], v3, s[8:11], s60 offen offset:0 sc1
    s_waitcnt vmcnt(15)
    v_mfma_f32_16x16x32_bf16 v[32:35], v[84:87], v[144:147], v[32:35]
    v_mfma_f32_16x16x32_bf16 v[36:39], v[84:87], v[148:151], v[36:39]
    v_mfma_f32_16x16x32_bf16 v[40:43], v[84:87], v[152:155], v[40:43]
    v_mfma_f32_16x16x32_bf16 v[44:47], v[84:87], v[156:159], v[44:47]
    buffer_load_dwordx4 v[84:87], v3, s[8:11], s56 offen offset:1024 sc1
    s_waitcnt vmcnt(15)
    v_mfma_f32_16x16x32_bf16 v[48:51], v[88:91], v[144:147], v[48:51]
    v_mfma_f32_16x16x32_bf16 v[52:55], v[88:91], v[148:151], v[52:55]
    v_mfma_f32_16x16x32_bf16 v[56:59], v[88:91], v[152:155], v[56:59]
    v_mfma_f32_16x16x32_bf16 v[60:63], v[88:91], v[156:159], v[60:63]
    buffer_load_dwordx4 v[88:91], v3, s[8:11], s57 offen offset:1024 sc1
    s_waitcnt vmcnt(15)
    v_mfma_f32_16x16x32_bf16 v[64:67], v[92:95], v[144:147], v[64:67]
    v_mfma_f32_16x16x32_bf16 v[68:71], v[92:95], v[148:151], v[68:71]
    v_mfma_f32_16x16x32_bf16 v[72:75], v[92:95], v[152:155], v[72:75]
    v_mfma_f32_16x16x32_bf16 v[76:79], v[92:95], v[156:159], v[76:79]
    buffer_load_dwordx4 v[92:95], v3, s[8:11], s58 offen offset:1024 sc1
    v_add_u32 v0, 65536, v8
    ds_read_b128 v[144:147], v0 offset:0
    ds_read_b128 v[148:151], v0 offset:1024
    ds_read_b128 v[152:155], v0 offset:2048
    ds_read_b128 v[156:159], v0 offset:3072
    s_waitcnt vmcnt(15) lgkmcnt(4)
    v_mfma_f32_16x16x32_bf16 v[16:19], v[96:99], v[160:163], v[16:19]
    v_mfma_f32_16x16x32_bf16 v[20:23], v[96:99], v[164:167], v[20:23]
    v_mfma_f32_16x16x32_bf16 v[24:27], v[96:99], v[168:171], v[24:27]
    v_mfma_f32_16x16x32_bf16 v[28:31], v[96:99], v[172:175], v[28:31]
    buffer_load_dwordx4 v[96:99], v3, s[8:11], s59 offen offset:1024 sc1
    s_waitcnt vmcnt(15)
    v_mfma_f32_16x16x32_bf16 v[32:35], v[100:103], v[160:163], v[32:35]
    v_mfma_f32_16x16x32_bf16 v[36:39], v[100:103], v[164:167], v[36:39]
    v_mfma_f32_16x16x32_bf16 v[40:43], v[100:103], v[168:171], v[40:43]
    v_mfma_f32_16x16x32_bf16 v[44:47], v[100:103], v[172:175], v[44:47]
    buffer_load_dwordx4 v[100:103], v3, s[8:11], s60 offen offset:1024 sc1
    s_waitcnt vmcnt(15)
    v_mfma_f32_16x16x32_bf16 v[48:51], v[104:107], v[160:163], v[48:51]
    v_mfma_f32_16x16x32_bf16 v[52:55], v[104:107], v[164:167], v[52:55]
    v_mfma_f32_16x16x32_bf16 v[56:59], v[104:107], v[168:171], v[56:59]
    v_mfma_f32_16x16x32_bf16 v[60:63], v[104:107], v[172:175], v[60:63]
    buffer_load_dwordx4 v[104:107], v3, s[8:11], s56 offen offset:2048 sc1
    s_waitcnt vmcnt(15)
    v_mfma_f32_16x16x32_bf16 v[64:67], v[108:111], v[160:163], v[64:67]
    v_mfma_f32_16x16x32_bf16 v[68:71], v[108:111], v[164:167], v[68:71]
    v_mfma_f32_16x16x32_bf16 v[72:75], v[108:111], v[168:171], v[72:75]
    v_mfma_f32_16x16x32_bf16 v[76:79], v[108:111], v[172:175], v[76:79]
    buffer_load_dwordx4 v[108:111], v3, s[8:11], s57 offen offset:2048 sc1
    buffer_load_dwordx4 v[160:163], v3, s[8:11], s58 offen offset:2048 sc1
    buffer_load_dwordx4 v[164:167], v3, s[8:11], s59 offen offset:2048 sc1
    buffer_load_dwordx4 v[168:171], v3, s[8:11], s60 offen offset:2048 sc1
    buffer_load_dwordx4 v[172:175], v3, s[8:11], s56 offen offset:3072 sc1
    s_waitcnt vmcnt(19) lgkmcnt(0)
    v_mfma_f32_16x16x32_bf16 v[16:19], v[112:115], v[144:147], v[16:19]
    v_mfma_f32_16x16x32_bf16 v[20:23], v[112:115], v[148:151], v[20:23]
    v_mfma_f32_16x16x32_bf16 v[24:27], v[112:115], v[152:155], v[24:27]
    v_mfma_f32_16x16x32_bf16 v[28:31], v[112:115], v[156:159], v[28:31]
    s_barrier
    s_mul_i32 s68, s28, 12288
    s_add_u32 s68, s68, 0
    v_add_u32 v8, s68, v3
    buffer_load_dwordx4 v[112:115], v3, s[8:11], s57 offen offset:3072 sc1
    s_waitcnt vmcnt(19)
    v_mfma_f32_16x16x32_bf16 v[32:35], v[116:119], v[144:147], v[32:35]
    v_mfma_f32_16x16x32_bf16 v[36:39], v[116:119], v[148:151], v[36:39]
    v_mfma_f32_16x16x32_bf16 v[40:43], v[116:119], v[152:155], v[40:43]
    v_mfma_f32_16x16x32_bf16 v[44:47], v[116:119], v[156:159], v[44:47]
    buffer_load_dwordx4 v[116:119], v3, s[8:11], s58 offen offset:3072 sc1
    s_waitcnt vmcnt(19)
    v_mfma_f32_16x16x32_bf16 v[48:51], v[120:123], v[144:147], v[48:51]
    v_mfma_f32_16x16x32_bf16 v[52:55], v[120:123], v[148:151], v[52:55]
    v_mfma_f32_16x16x32_bf16 v[56:59], v[120:123], v[152:155], v[56:59]
    v_mfma_f32_16x16x32_bf16 v[60:63], v[120:123], v[156:159], v[60:63]
    buffer_load_dwordx4 v[120:123], v3, s[8:11], s59 offen offset:3072 sc1
    s_waitcnt vmcnt(19)
    v_mfma_f32_16x16x32_bf16 v[64:67], v[124:127], v[144:147], v[64:67]
    v_mfma_f32_16x16x32_bf16 v[68:71], v[124:127], v[148:151], v[68:71]
    v_mfma_f32_16x16x32_bf16 v[72:75], v[124:127], v[152:155], v[72:75]
    v_mfma_f32_16x16x32_bf16 v[76:79], v[124:127], v[156:159], v[76:79]
    buffer_load_dwordx4 v[124:127], v3, s[8:11], s60 offen offset:3072 sc1
    s_add_u32 m0, s30, 0
    s_add_u32 s67, s31, zlit_b-zlit_a+(0)
    buffer_load_dwordx4 v3, s[8:11], s67 offen offset:0 sc1 lds
    buffer_load_dwordx4 v3, s[8:11], s67 offen offset:1024 sc1 lds
    s_waitcnt vmcnt(21)
    v_mfma_f32_16x16x32_bf16 v[16:19], v[128:131], v[176:179], v[16:19]
    v_mfma_f32_16x16x32_bf16 v[20:23], v[128:131], v[180:183], v[20:23]
    v_mfma_f32_16x16x32_bf16 v[24:27], v[128:131], v[184:187], v[24:27]
    v_mfma_f32_16x16x32_bf16 v[28:31], v[128:131], v[188:191], v[28:31]
    buffer_load_dwordx4 v3, s[8:11], s67 offen offset:2048 sc1 lds
    s_waitcnt vmcnt(21)
    v_mfma_f32_16x16x32_bf16 v[16:19], v[132:135], v[192:195], v[16:19]
    v_mfma_f32_16x16x32_bf16 v[20:23], v[132:135], v[196:199], v[20:23]
    v_mfma_f32_16x16x32_bf16 v[24:27], v[132:135], v[200:203], v[24:27]
    v_mfma_f32_16x16x32_bf16 v[28:31], v[132:135], v[204:207], v[28:31]
    buffer_load_dwordx4 v3, s[8:11], s67 offen offset:3072 sc1 lds
    s_waitcnt vmcnt(21)
    v_mfma_f32_16x16x32_bf16 v[16:19], v[136:139], v[208:211], v[16:19]
    v_mfma_f32_16x16x32_bf16 v[20:23], v[136:139], v[212:215], v[20:23]
    v_mfma_f32_16x16x32_bf16 v[24:27], v[136:139], v[216:219], v[24:27]
    v_mfma_f32_16x16x32_bf16 v[28:31], v[136:139], v[220:223], v[28:31]
    s_add_u32 m0, s30, 4096
    s_add_u32 s67, s31, 4096
    buffer_load_dwordx4 v3, s[8:11], s67 offen offset:0 sc1 lds
    s_waitcnt vmcnt(21)
    v_mfma_f32_16x16x32_bf16 v[16:19], v[140:143], v[224:227], v[16:19]
    v_mfma_f32_16x16x32_bf16 v[20:23], v[140:143], v[228:231], v[20:23]
    v_mfma_f32_16x16x32_bf16 v[24:27], v[140:143], v[232:235], v[24:27]
    v_mfma_f32_16x16x32_bf16 v[28:31], v[140:143], v[236:239], v[28:31]
    buffer_load_dwordx4 v3, s[8:11], s67 offen offset:1024 sc1 lds
    s_waitcnt vmcnt(21)
    v_mfma_f32_16x16x32_bf16 v[16:19], v[80:83], v[240:243], v[16:19]
    v_mfma_f32_16x16x32_bf16 v[20:23], v[80:83], v[244:247], v[20:23]
    v_mfma_f32_16x16x32_bf16 v[24:27], v[80:83], v[248:251], v[24:27]
    v_mfma_f32_16x16x32_bf16 v[28:31], v[80:83], v[252:255], v[28:31]
    buffer_load_dwordx4 v3, s[8:11], s67 offen offset:2048 sc1 lds
    s_waitcnt vmcnt(21)
    v_mfma_f32_16x16x32_bf16 v[32:35], v[84:87], v[176:179], v[32:35]
    v_mfma_f32_16x16x32_bf16 v[36:39], v[84:87], v[180:183], v[36:39]
    v_mfma_f32_16x16x32_bf16 v[40:43], v[84:87], v[184:187], v[40:43]
    v_mfma_f32_16x16x32_bf16 v[44:47], v[84:87], v[188:191], v[44:47]
    ds_write_b128 v8, v[20:23] offset:0
    ds_write_b128 v8, v[24:27] offset:4096
    ds_write_b128 v8, v[28:31] offset:8192
    s_waitcnt vmcnt(20)
    v_mfma_f32_16x16x32_bf16 v[32:35], v[88:91], v[192:195], v[32:35]
    v_mfma_f32_16x16x32_bf16 v[36:39], v[88:91], v[196:199], v[36:39]
    v_mfma_f32_16x16x32_bf16 v[40:43], v[88:91], v[200:203], v[40:43]
    v_mfma_f32_16x16x32_bf16 v[44:47], v[88:91], v[204:207], v[44:47]
    s_waitcnt vmcnt(19)
    v_mfma_f32_16x16x32_bf16 v[32:35], v[92:95], v[208:211], v[32:35]
    v_mfma_f32_16x16x32_bf16 v[36:39], v[92:95], v[212:215], v[36:39]
    v_mfma_f32_16x16x32_bf16 v[40:43], v[92:95], v[216:219], v[40:43]
    v_mfma_f32_16x16x32_bf16 v[44:47], v[92:95], v[220:223], v[44:47]
    s_waitcnt vmcnt(18)
    v_mfma_f32_16x16x32_bf16 v[32:35], v[96:99], v[224:227], v[32:35]
    v_mfma_f32_16x16x32_bf16 v[36:39], v[96:99], v[228:231], v[36:39]
    v_mfma_f32_16x16x32_bf16 v[40:43], v[96:99], v[232:235], v[40:43]
    v_mfma_f32_16x16x32_bf16 v[44:47], v[96:99], v[236:239], v[44:47]
    s_waitcnt vmcnt(17)
    v_mfma_f32_16x16x32_bf16 v[32:35], v[100:103], v[240:243], v[32:35]
    v_mfma_f32_16x16x32_bf16 v[36:39], v[100:103], v[244:247], v[36:39]
    v_mfma_f32_16x16x32_bf16 v[40:43], v[100:103], v[248:251], v[40:43]
    v_mfma_f32_16x16x32_bf16 v[44:47], v[100:103], v[252:255], v[44:47]
    s_waitcnt vmcnt(16)
    v_mfma_f32_16x16x32_bf16 v[48:51], v[104:107], v[176:179], v[48:51]
    v_mfma_f32_16x16x32_bf16 v[52:55], v[104:107], v[180:183], v[52:55]
    v_mfma_f32_16x16x32_bf16 v[56:59], v[104:107], v[184:187], v[56:59]
    v_mfma_f32_16x16x32_bf16 v[60:63], v[104:107], v[188:191], v[60:63]
    s_nop 0
    ds_write_b128 v8, v[36:39] offset:1024
    ds_write_b128 v8, v[40:43] offset:5120
    ds_write_b128 v8, v[44:47] offset:9216
    s_waitcnt vmcnt(15)
    v_mfma_f32_16x16x32_bf16 v[48:51], v[108:111], v[192:195], v[48:51]
    v_mfma_f32_16x16x32_bf16 v[52:55], v[108:111], v[196:199], v[52:55]
    v_mfma_f32_16x16x32_bf16 v[56:59], v[108:111], v[200:203], v[56:59]
    v_mfma_f32_16x16x32_bf16 v[60:63], v[108:111], v[204:207], v[60:63]
    s_waitcnt vmcnt(14)
    v_mfma_f32_16x16x32_bf16 v[48:51], v[160:163], v[208:211], v[48:51]
    v_mfma_f32_16x16x32_bf16 v[52:55], v[160:163], v[212:215], v[52:55]
    v_mfma_f32_16x16x32_bf16 v[56:59], v[160:163], v[216:219], v[56:59]
    v_mfma_f32_16x16x32_bf16 v[60:63], v[160:163], v[220:223], v[60:63]
    s_waitcnt vmcnt(13)
    v_mfma_f32_16x16x32_bf16 v[48:51], v[164:167], v[224:227], v[48:51]
    v_mfma_f32_16x16x32_bf16 v[52:55], v[164:167], v[228:231], v[52:55]
    v_mfma_f32_16x16x32_bf16 v[56:59], v[164:167], v[232:235], v[56:59]
    v_mfma_f32_16x16x32_bf16 v[60:63], v[164:167], v[236:239], v[60:63]
    s_waitcnt vmcnt(12)
    v_mfma_f32_16x16x32_bf16 v[48:51], v[168:171], v[240:243], v[48:51]
    v_mfma_f32_16x16x32_bf16 v[52:55], v[168:171], v[244:247], v[52:55]
    v_mfma_f32_16x16x32_bf16 v[56:59], v[168:171], v[248:251], v[56:59]
    v_mfma_f32_16x16x32_bf16 v[60:63], v[168:171], v[252:255], v[60:63]
    s_waitcnt vmcnt(11)
    v_mfma_f32_16x16x32_bf16 v[64:67], v[172:175], v[176:179], v[64:67]
    v_mfma_f32_16x16x32_bf16 v[68:71], v[172:175], v[180:183], v[68:71]
    v_mfma_f32_16x16x32_bf16 v[72:75], v[172:175], v[184:187], v[72:75]
    v_mfma_f32_16x16x32_bf16 v[76:79], v[172:175], v[188:191], v[76:79]
    s_nop 0
    ds_write_b128 v8, v[52:55] offset:2048
    ds_write_b128 v8, v[56:59] offset:6144
    ds_write_b128 v8, v[60:63] offset:10240
    s_waitcnt vmcnt(10)
    v_mfma_f32_16x16x32_bf16 v[64:67], v[112:115], v[192:195], v[64:67]
    v_mfma_f32_16x16x32_bf16 v[68:71], v[112:115], v[196:199], v[68:71]
    v_mfma_f32_16x16x32_bf16 v[72:75], v[112:115], v[200:203], v[72:75]
    v_mfma_f32_16x16x32_bf16 v[76:79], v[112:115], v[204:207], v[76:79]
    s_waitcnt vmcnt(9)
    v_mfma_f32_16x16x32_bf16 v[64:67], v[116:119], v[208:211], v[64:67]
    v_mfma_f32_16x16x32_bf16 v[68:71], v[116:119], v[212:215], v[68:71]
    v_mfma_f32_16x16x32_bf16 v[72:75], v[116:119], v[216:219], v[72:75]
    v_mfma_f32_16x16x32_bf16 v[76:79], v[116:119], v[220:223], v[76:79]
    s_waitcnt vmcnt(8)
    v_mfma_f32_16x16x32_bf16 v[64:67], v[120:123], v[224:227], v[64:67]
    v_mfma_f32_16x16x32_bf16 v[68:71], v[120:123], v[228:231], v[68:71]
    v_mfma_f32_16x16x32_bf16 v[72:75], v[120:123], v[232:235], v[72:75]
    v_mfma_f32_16x16x32_bf16 v[76:79], v[120:123], v[236:239], v[76:79]
    s_waitcnt vmcnt(7)
    v_mfma_f32_16x16x32_bf16 v[64:67], v[124:127], v[240:243], v[64:67]
    v_mfma_f32_16x16x32_bf16 v[68:71], v[124:127], v[244:247], v[68:71]
    v_mfma_f32_16x16x32_bf16 v[72:75], v[124:127], v[248:251], v[72:75]
    v_mfma_f32_16x16x32_bf16 v[76:79], v[124:127], v[252:255], v[76:79]
    s_setprio 0
    s_xor_b32 s67, s28, 1
    s_mul_i32 s67, s67, 12288
    s_add_u32 s67, s67, 0
    v_add_u32 v137, s67, v3
    s_xor_b32 s67, s28, zlit_b-zlit_a+(2)
    s_mul_i32 s67, s67, 12288
    s_add_u32 s67, s67, 0
    v_add_u32 v138, s67, v3
    s_xor_b32 s67, s28, zlit_b-zlit_a+(3)
    s_mul_i32 s67, s67, 12288
    s_add_u32 s67, s67, 0
    v_add_u32 v139, s67, v3
    ds_write_b128 v8, v[68:71] offset:3072
    ds_write_b128 v8, v[72:75] offset:7168
    ds_write_b128 v8, v[76:79] offset:11264
    s_mul_i32 s67, s28, 3584
    s_add_u32 s67, s67, 86016
    v_add_u32 v136, s67, v9
    v_lshlrev_b32 v4, 16, v4
    s_mul_i32 s39, s29, 28672
    s_add_u32 s39, s39, 29818880
    s_mul_i32 s67, s17, 3584
    s_add_u32 s67, s67, s39
    v_add_f32 v16, v16, v4
    v_add_f32 v17, v17, v4
    v_add_f32 v18, v18, v4
    v_add_f32 v19, v19, v4
    v_add_f32 v32, v32, v4
    v_add_f32 v33, v33, v4
    v_add_f32 v34, v34, v4
    v_add_f32 v35, v35, v4
    v_add_f32 v48, v48, v4
    v_add_f32 v49, v49, v4
    v_add_f32 v50, v50, v4
    v_add_f32 v51, v51, v4
    v_add_f32 v64, v64, v4
    v_add_f32 v65, v65, v4
    v_add_f32 v66, v66, v4
    v_add_f32_e64 v67, v67, v4
    s_waitcnt lgkmcnt(0)
    s_barrier
    ds_read_b64 v[128:129], v136 offset:0
    ds_read_b128 v[80:83], v137 offset:0
    ds_read_b128 v[84:87], v138 offset:4096
    ds_read_b128 v[88:91], v139 offset:8192
    ds_read_b64 v[130:131], v136 offset:512
    ds_read_b128 v[92:95], v137 offset:1024
    ds_read_b128 v[96:99], v138 offset:5120
    ds_read_b128 v[100:103], v139 offset:9216
    ds_read_b64 v[132:133], v136 offset:1024
    ds_read_b128 v[104:107], v137 offset:2048
    ds_read_b128 v[108:111], v138 offset:6144
    ds_read_b128 v[112:115], v139 offset:10240
    ds_read_b64 v[134:135], v136 offset:1536
    ds_read_b128 v[116:119], v137 offset:3072
    ds_read_b128 v[120:123], v138 offset:7168
    ds_read_b128 v[124:127], v139 offset:11264
    s_waitcnt lgkmcnt(12)
    v_pk_add_f32 v[16:17], v[16:17], v[80:81]
    v_pk_add_f32 v[84:85], v[84:85], v[88:89]
    v_pk_add_f32 v[18:19], v[18:19], v[82:83]
    v_pk_add_f32 v[86:87], v[86:87], v[90:91]
    v_lshlrev_b32 v80, 16, v128
    v_and_b32 v81, 0xffff0000, v128
    v_lshlrev_b32_e64 v82, 16, v129
    v_and_b32 v83, 0xffff0000, v129
    v_pk_add_f32 v[16:17], v[16:17], v[84:85]
    v_pk_add_f32 v[18:19], v[18:19], v[86:87]
    v_pk_mul_f32 v[16:17], v[16:17], v[80:81]
    v_pk_mul_f32 v[18:19], v[18:19], v[82:83]
    v_cvt_pk_bf16_f32 v140, v16, v17
    v_cvt_pk_bf16_f32 v141, v18, v19
    s_waitcnt lgkmcnt(8)
    v_pk_add_f32 v[32:33], v[32:33], v[92:93]
    v_pk_add_f32 v[96:97], v[96:97], v[100:101]
    v_pk_add_f32 v[34:35], v[34:35], v[94:95]
    v_pk_add_f32 v[98:99], v[98:99], v[102:103]
    v_lshlrev_b32 v92, 16, v130
    v_and_b32 v93, 0xffff0000, v130
    v_lshlrev_b32_e64 v94, 16, v131
    v_and_b32 v95, 0xffff0000, v131
    v_pk_add_f32 v[32:33], v[32:33], v[96:97]
    v_pk_add_f32 v[34:35], v[34:35], v[98:99]
    v_pk_mul_f32 v[32:33], v[32:33], v[92:93]
    v_pk_mul_f32 v[34:35], v[34:35], v[94:95]
    v_cvt_pk_bf16_f32 v142, v32, v33
    v_cvt_pk_bf16_f32 v143, v34, v35
    buffer_store_dwordx4 v[140:143], v3, s[8:11], s67 offen offset:0 sc1
    s_waitcnt lgkmcnt(4)
    v_pk_add_f32 v[48:49], v[48:49], v[104:105]
    v_pk_add_f32 v[108:109], v[108:109], v[112:113]
    v_pk_add_f32 v[50:51], v[50:51], v[106:107]
    v_pk_add_f32 v[110:111], v[110:111], v[114:115]
    v_lshlrev_b32 v104, 16, v132
    v_and_b32 v105, 0xffff0000, v132
    v_lshlrev_b32_e64 v106, 16, v133
    v_and_b32 v107, 0xffff0000, v133
    v_pk_add_f32 v[48:49], v[48:49], v[108:109]
    v_pk_add_f32 v[50:51], v[50:51], v[110:111]
    v_pk_mul_f32 v[48:49], v[48:49], v[104:105]
    v_pk_mul_f32 v[50:51], v[50:51], v[106:107]
    v_cvt_pk_bf16_f32 v144, v48, v49
    v_cvt_pk_bf16_f32 v145, v50, v51
    s_waitcnt lgkmcnt(0)
    v_pk_add_f32 v[64:65], v[64:65], v[116:117]
    v_pk_add_f32 v[120:121], v[120:121], v[124:125]
    v_pk_add_f32 v[66:67], v[66:67], v[118:119]
    v_pk_add_f32 v[122:123], v[122:123], v[126:127]
    v_lshlrev_b32 v116, 16, v134
    v_and_b32 v117, 0xffff0000, v134
    v_lshlrev_b32_e64 v118, 16, v135
    v_and_b32 v119, 0xffff0000, v135
    v_pk_add_f32 v[64:65], v[64:65], v[120:121]
    v_pk_add_f32 v[66:67], v[66:67], v[122:123]
    v_pk_mul_f32 v[64:65], v[64:65], v[116:117]
    v_pk_mul_f32 v[66:67], v[66:67], v[118:119]
    v_cvt_pk_bf16_f32 v146, v64, v65
    v_cvt_pk_bf16_f32 v147, v66, v67
    buffer_store_dwordx4 v[144:147], v3, s[8:11], s67 offen offset:1024 sc1
    s_waitcnt vmcnt(2)
    s_barrier
    s_load_dwordx2 s[80:81], s[0:1], 80
    s_add_u32 s30, s28, zlit_b-zlit_a+(0)
    s_mul_i32 s30, s30, 12288
    s_mul_i32 s31, s26, 143360
    s_add_u32 s31, s31, 3530752
    s_add_u32 s31, s31, s30
    s_cmp_eq_u32 s64, 3
    s_cbranch_scc1 kf_kernel_b_e3
    s_add_u32 m0, s30, 0
    s_add_u32 s67, s31, zlit_b-zlit_a+(0)
    buffer_load_dwordx4 v3, s[8:11], s67 offen offset:0 sc1 lds
    buffer_load_dwordx4 v3, s[8:11], s67 offen offset:1024 sc1 lds
    s_add_u32 m0, s30, 2048
    s_add_u32 s67, s31, 2048
    buffer_load_dwordx4 v3, s[8:11], s67 offen offset:0 sc1 lds
    buffer_load_dwordx4 v3, s[8:11], s67 offen offset:1024 sc1 lds
    s_waitcnt vmcnt(4)
    v_mov_b32 v72, 162832
    v_mov_b32_e64 v73, 1
    s_mov_b64 exec, 1
    ds_add_u32 v72, v73
    s_mov_b64 exec, -1
    s_add_u32 m0, s30, 4096
    s_add_u32 s67, s31, 4096
    buffer_load_dwordx4 v3, s[8:11], s67 offen offset:0 sc1 lds
    buffer_load_dwordx4 v3, s[8:11], s67 offen offset:1024 sc1 lds
    s_add_u32 m0, s30, 6144
    s_add_u32 s67, s31, 6144
    buffer_load_dwordx4 v3, s[8:11], s67 offen offset:0 sc1 lds
    buffer_load_dwordx4 v3, s[8:11], s67 offen offset:1024 sc1 lds
    s_add_u32 m0, s30, 8192
    s_add_u32 s67, s31, 8192
    buffer_load_dwordx4 v3, s[8:11], s67 offen offset:0 sc1 lds
    buffer_load_dwordx4 v3, s[8:11], s67 offen offset:1024 sc1 lds
    s_add_u32 m0, s30, 10240
    s_add_u32 s67, s31, 10240
    buffer_load_dwordx4 v3, s[8:11], s67 offen offset:0 sc1 lds
    buffer_load_dwordx4 v3, s[8:11], s67 offen offset:1024 sc1 lds
    s_branch kf_kernel_b_go5
kf_kernel_b_e3:
    s_lshl_b32 s67, s17, 2
    s_lshl_b32 s70, s16, zlit_b-zlit_a+(10)
    s_add_u32 s67, s67, s70
    s_add_u32 s67, s67, 36515840
    s_lshl_b32 s68, s26, 7
    s_lshl_b32 s70, s25, zlit_b-zlit_a+(10)
    s_add_u32 s68, s68, s70
    s_add_u32 s68, s68, 36515840
    v_lshlrev_b32 v72, 7, v2
    v_lshlrev_b32 v73, 2, v2
    v_mov_b32 v74, 1
    s_waitcnt vmcnt(0)
    v_mov_b32 v75, 162832
    s_mov_b32 s70, zlit_b-zlit_a+(0)
kf_kernel_b_spe:
    ds_read_b32 v76, v75
    s_add_u32 s70, s70, zlit_b-zlit_a+(1)
    s_cmp_lt_u32 s70, 0x400000
    s_waitcnt lgkmcnt(0)
    v_cmp_ne_u32 vcc, 7, v76
    s_cbranch_vccz kf_kernel_b_sqe
    s_sleep 1
    s_cbranch_scc1 kf_kernel_b_spe
kf_kernel_b_sqe:
    s_mov_b32 exec_hi, 0
    s_mov_b32 exec_lo, 0xff
    buffer_store_dword v74, v72, s[8:11], s67 offen sc1
    s_mov_b32 s70, zlit_b-zlit_a+(0)
    buffer_load_dword v75, v73, s[8:11], s68 offen sc1
kf_kernel_b_poll5:
    s_waitcnt vmcnt(0)
    v_cmp_ne_u32 vcc, 1, v75
    s_cbranch_vccz kf_kernel_b_go5
    s_sleep 1
    buffer_load_dword v75, v73, s[8:11], s68 offen sc1
    s_add_u32 s70, s70, zlit_b-zlit_a+(1)
    s_cmp_lt_u32 s70, 0x40000
    s_cbranch_scc1 kf_kernel_b_poll5
kf_kernel_b_go5:
    s_mov_b64 exec, -1
    v_add_u32 v8, 100352, v3
    v_add_u32_e64 v0, 0, v3
    v_add_u32 v4, 161408, v6
    s_mul_i32 s41, s33, 28672
    s_add_u32 s41, s41, 29818880
    s_add_u32 s42, s41, 3584
    s_add_u32 s43, s41, 7168
    s_add_u32 s44, s41, 10752
    s_barrier
    buffer_load_dwordx4 v[16:19], v3, s[8:11], s41 offen offset:0 sc1
    buffer_load_dwordx4 v[20:23], v3, s[8:11], s41 offen offset:1024 sc1
    buffer_load_dwordx4 v[24:27], v3, s[8:11], s41 offen offset:2048 sc1
    buffer_load_dwordx4 v[28:31], v3, s[8:11], s42 offen offset:0 sc1
    buffer_load_dwordx4 v[32:35], v3, s[8:11], s42 offen offset:1024 sc1
    buffer_load_dwordx4 v[36:39], v3, s[8:11], s42 offen offset:2048 sc1
    buffer_load_dwordx2 v[40:41], v9, s[8:11], s41 offen offset:3072 sc1
    buffer_load_dwordx2 v[42:43], v9, s[8:11], s42 offen offset:3072 sc1
    buffer_load_dwordx4 v[44:47], v3, s[8:11], s43 offen offset:0 sc1
    buffer_load_dwordx4 v[48:51], v3, s[8:11], s43 offen offset:1024 sc1
    buffer_load_dwordx4 v[52:55], v3, s[8:11], s43 offen offset:2048 sc1
    buffer_load_dwordx4 v[56:59], v3, s[8:11], s44 offen offset:0 sc1
    buffer_load_dwordx4 v[60:63], v3, s[8:11], s44 offen offset:1024 sc1
    buffer_load_dwordx4 v[64:67], v3, s[8:11], s44 offen offset:2048 sc1
    buffer_load_dwordx2 v[68:69], v9, s[8:11], s43 offen offset:3072 sc1
    buffer_load_dwordx2 v[70:71], v9, s[8:11], s44 offen offset:3072 sc1
    ds_read_b128 v[148:151], v8 offset:0
    ds_read_b128 v[152:155], v8 offset:1024
    ds_read_b128 v[156:159], v8 offset:2048
    ds_read_b128 v[160:163], v8 offset:3072
    ds_read_b128 v[164:167], v8 offset:4096
    ds_read_b128 v[168:171], v8 offset:5120
    ds_read_b128 v[172:175], v8 offset:6144
    ds_read_b128 v[176:179], v8 offset:7168
    ds_read_b128 v[180:183], v8 offset:8192
    ds_read_b128 v[184:187], v8 offset:9216
    ds_read_b128 v[188:191], v8 offset:10240
    ds_read_b128 v[192:195], v8 offset:11264
    ds_read_b128 v[196:199], v8 offset:12288
    ds_read_b128 v[200:203], v8 offset:13312
    ds_read_b128 v[204:207], v8 offset:14336
    ds_read_b128 v[208:211], v8 offset:15360
    ds_read_b128 v[212:215], v8 offset:16384
    ds_read_b128 v[216:219], v8 offset:17408
    ds_read_b128 v[220:223], v8 offset:18432
    ds_read_b128 v[224:227], v8 offset:19456
    ds_read_b128 v[228:231], v8 offset:20480
    ds_read_b128 v[232:235], v8 offset:21504
    ds_read_b128 v[236:239], v8 offset:22528
    ds_read_b128 v[240:243], v8 offset:23552
    ds_read_b128 v[244:247], v8 offset:24576
    ds_read_b128 v[96:99], v4 offset:0
    ds_read_b128 v[100:103], v4 offset:64
    ds_read_b128 v[104:107], v4 offset:128
    s_mul_i32 s67, s28, 5120
    s_add_u32 s67, s67, 100352
    v_add_u32 v4, s67, v3
    s_waitcnt lgkmcnt(0)
    s_waitcnt vmcnt(15)
    v_mfma_f32_16x16x32_bf16 v[72:75], v[148:151], v[16:19], 0
    v_mfma_f32_16x16x32_bf16 v[76:79], v[152:155], v[16:19], 0
    v_mfma_f32_16x16x32_bf16 v[80:83], v[156:159], v[16:19], 0
    v_mfma_f32_16x16x32_bf16 v[84:87], v[160:163], v[16:19], 0
    v_mfma_f32_16x16x32_bf16 v[88:91], v[164:167], v[16:19], 0
    s_barrier
    ds_read_b128 v[148:151], v8 offset:25600
    ds_read_b128 v[152:155], v8 offset:26624
    ds_read_b128 v[156:159], v8 offset:27648
    ds_read_b128 v[160:163], v0 offset:0
    ds_read_b128 v[164:167], v0 offset:1024
    s_waitcnt vmcnt(14)
    v_mfma_f32_16x16x32_bf16 v[72:75], v[168:171], v[20:23], v[72:75]
    v_mfma_f32_16x16x32_bf16 v[76:79], v[172:175], v[20:23], v[76:79]
    v_mfma_f32_16x16x32_bf16 v[80:83], v[176:179], v[20:23], v[80:83]
    v_mfma_f32_16x16x32_bf16 v[84:87], v[180:183], v[20:23], v[84:87]
    v_mfma_f32_16x16x32_bf16 v[88:91], v[184:187], v[20:23], v[88:91]
    ds_read_b128 v[168:171], v0 offset:2048
    ds_read_b128 v[172:175], v0 offset:3072
    ds_read_b128 v[176:179], v0 offset:4096
    ds_read_b128 v[180:183], v0 offset:5120
    ds_read_b128 v[184:187], v0 offset:6144
    s_waitcnt vmcnt(13)
    v_mfma_f32_16x16x32_bf16 v[72:75], v[188:191], v[24:27], v[72:75]
    v_mfma_f32_16x16x32_bf16 v[76:79], v[192:195], v[24:27], v[76:79]
    v_mfma_f32_16x16x32_bf16 v[80:83], v[196:199], v[24:27], v[80:83]
    v_mfma_f32_16x16x32_bf16 v[84:87], v[200:203], v[24:27], v[84:87]
    v_mfma_f32_16x16x32_bf16 v[88:91], v[204:207], v[24:27], v[88:91]
    ds_read_b128 v[188:191], v0 offset:7168
    ds_read_b128 v[192:195], v0 offset:8192
    ds_read_b128 v[196:199], v0 offset:9216
    ds_read_b128 v[200:203], v0 offset:10240
    ds_read_b128 v[204:207], v0 offset:11264
    s_waitcnt vmcnt(12)
    v_mfma_f32_16x16x32_bf16 v[72:75], v[208:211], v[28:31], v[72:75]
    v_mfma_f32_16x16x32_bf16 v[76:79], v[212:215], v[28:31], v[76:79]
    v_mfma_f32_16x16x32_bf16 v[80:83], v[216:219], v[28:31], v[80:83]
    v_mfma_f32_16x16x32_bf16 v[84:87], v[220:223], v[28:31], v[84:87]
    v_mfma_f32_16x16x32_bf16 v[88:91], v[224:227], v[28:31], v[88:91]
    ds_read_b128 v[208:211], v0 offset:12288
    ds_read_b128 v[212:215], v0 offset:13312
    ds_read_b128 v[216:219], v0 offset:14336
    ds_read_b128 v[220:223], v0 offset:15360
    ds_read_b128 v[224:227], v0 offset:16384
    s_waitcnt vmcnt(11)
    v_mfma_f32_16x16x32_bf16 v[72:75], v[228:231], v[32:35], v[72:75]
    v_mfma_f32_16x16x32_bf16 v[76:79], v[232:235], v[32:35], v[76:79]
    v_mfma_f32_16x16x32_bf16 v[80:83], v[236:239], v[32:35], v[80:83]
    v_mfma_f32_16x16x32_bf16 v[84:87], v[240:243], v[32:35], v[84:87]
    v_mfma_f32_16x16x32_bf16 v[88:91], v[244:247], v[32:35], v[88:91]
    ds_read_b128 v[228:231], v0 offset:17408
    ds_read_b128 v[232:235], v0 offset:18432
    ds_read_b128 v[236:239], v0 offset:19456
    ds_read_b128 v[240:243], v0 offset:20480
    ds_read_b128 v[244:247], v0 offset:21504
    s_waitcnt vmcnt(10) lgkmcnt(15)
    v_mfma_f32_16x16x32_bf16 v[72:75], v[148:151], v[36:39], v[72:75]
    v_mfma_f32_16x16x32_bf16 v[76:79], v[152:155], v[36:39], v[76:79]
    v_mfma_f32_16x16x32_bf16 v[80:83], v[156:159], v[36:39], v[80:83]
    v_mfma_f32_16x16x32_bf16 v[84:87], v[160:163], v[36:39], v[84:87]
    v_mfma_f32_16x16x32_bf16 v[88:91], v[164:167], v[36:39], v[88:91]
    ds_read_b128 v[148:151], v0 offset:22528
    ds_read_b128 v[152:155], v0 offset:23552
    ds_read_b128 v[156:159], v0 offset:24576
    ds_read_b128 v[160:163], v0 offset:25600
    ds_read_b128 v[164:167], v0 offset:26624
    s_waitcnt vmcnt(8) lgkmcnt(15)
    v_mfma_f32_16x16x32_bf16 v[72:75], v[168:171], v[40:43], v[72:75]
    v_mfma_f32_16x16x32_bf16 v[76:79], v[172:175], v[40:43], v[76:79]
    v_mfma_f32_16x16x32_bf16 v[80:83], v[176:179], v[40:43], v[80:83]
    v_mfma_f32_16x16x32_bf16 v[84:87], v[180:183], v[40:43], v[84:87]
    v_mfma_f32_16x16x32_bf16 v[88:91], v[184:187], v[40:43], v[88:91]
    ds_read_b128 v[168:171], v0 offset:27648
    ds_read_b128 v[172:175], v0 offset:28672
    ds_read_b128 v[176:179], v0 offset:29696
    ds_read_b128 v[180:183], v0 offset:30720
    ds_read_b128 v[184:187], v0 offset:31744
    s_waitcnt vmcnt(7) lgkmcnt(15)
    v_mfma_f32_16x16x32_bf16 v[72:75], v[188:191], v[44:47], v[72:75]
    v_mfma_f32_16x16x32_bf16 v[76:79], v[192:195], v[44:47], v[76:79]
    v_mfma_f32_16x16x32_bf16 v[80:83], v[196:199], v[44:47], v[80:83]
    v_mfma_f32_16x16x32_bf16 v[84:87], v[200:203], v[44:47], v[84:87]
    v_mfma_f32_16x16x32_bf16 v[88:91], v[204:207], v[44:47], v[88:91]
    ds_read_b128 v[188:191], v0 offset:32768
    ds_read_b128 v[192:195], v0 offset:33792
    ds_read_b128 v[196:199], v0 offset:34816
    ds_read_b128 v[200:203], v0 offset:35840
    ds_read_b128 v[204:207], v0 offset:36864
    s_waitcnt vmcnt(6) lgkmcnt(15)
    v_mfma_f32_16x16x32_bf16 v[72:75], v[208:211], v[48:51], v[72:75]
    v_mfma_f32_16x16x32_bf16 v[76:79], v[212:215], v[48:51], v[76:79]
    v_mfma_f32_16x16x32_bf16 v[80:83], v[216:219], v[48:51], v[80:83]
    v_mfma_f32_16x16x32_bf16 v[84:87], v[220:223], v[48:51], v[84:87]
    v_mfma_f32_16x16x32_bf16 v[88:91], v[224:227], v[48:51], v[88:91]
    ds_read_b128 v[208:211], v0 offset:37888
    ds_read_b128 v[212:215], v0 offset:38912
    ds_read_b128 v[216:219], v0 offset:39936
    ds_read_b128 v[220:223], v0 offset:40960
    ds_read_b128 v[224:227], v0 offset:41984
    s_waitcnt vmcnt(5) lgkmcnt(15)
    v_mfma_f32_16x16x32_bf16 v[72:75], v[228:231], v[52:55], v[72:75]
    v_mfma_f32_16x16x32_bf16 v[76:79], v[232:235], v[52:55], v[76:79]
    v_mfma_f32_16x16x32_bf16 v[80:83], v[236:239], v[52:55], v[80:83]
    v_mfma_f32_16x16x32_bf16 v[84:87], v[240:243], v[52:55], v[84:87]
    v_mfma_f32_16x16x32_bf16 v[88:91], v[244:247], v[52:55], v[88:91]
    s_waitcnt vmcnt(4) lgkmcnt(15)
    v_mfma_f32_16x16x32_bf16 v[72:75], v[148:151], v[56:59], v[72:75]
    v_mfma_f32_16x16x32_bf16 v[76:79], v[152:155], v[56:59], v[76:79]
    v_mfma_f32_16x16x32_bf16 v[80:83], v[156:159], v[56:59], v[80:83]
    v_mfma_f32_16x16x32_bf16 v[84:87], v[160:163], v[56:59], v[84:87]
    v_mfma_f32_16x16x32_bf16 v[88:91], v[164:167], v[56:59], v[88:91]
    s_waitcnt vmcnt(3) lgkmcnt(10)
    v_mfma_f32_16x16x32_bf16 v[72:75], v[168:171], v[60:63], v[72:75]
    v_mfma_f32_16x16x32_bf16 v[76:79], v[172:175], v[60:63], v[76:79]
    v_mfma_f32_16x16x32_bf16 v[80:83], v[176:179], v[60:63], v[80:83]
    v_mfma_f32_16x16x32_bf16 v[84:87], v[180:183], v[60:63], v[84:87]
    v_mfma_f32_16x16x32_bf16 v[88:91], v[184:187], v[60:63], v[88:91]
    s_waitcnt vmcnt(2) lgkmcnt(5)
    v_mfma_f32_16x16x32_bf16 v[72:75], v[188:191], v[64:67], v[72:75]
    v_mfma_f32_16x16x32_bf16 v[76:79], v[192:195], v[64:67], v[76:79]
    v_mfma_f32_16x16x32_bf16 v[80:83], v[196:199], v[64:67], v[80:83]
    v_mfma_f32_16x16x32_bf16 v[84:87], v[200:203], v[64:67], v[84:87]
    v_mfma_f32_16x16x32_bf16 v[88:91], v[204:207], v[64:67], v[88:91]
    s_waitcnt vmcnt(0) lgkmcnt(0)
    v_mfma_f32_16x16x32_bf16 v[72:75], v[208:211], v[68:71], v[72:75]
    v_mfma_f32_16x16x32_bf16 v[76:79], v[212:215], v[68:71], v[76:79]
    v_mfma_f32_16x16x32_bf16 v[80:83], v[216:219], v[68:71], v[80:83]
    v_mfma_f32_16x16x32_bf16 v[84:87], v[220:223], v[68:71], v[84:87]
    v_mfma_f32_16x16x32_bf16 v[88:91], v[224:227], v[68:71], v[88:91]
    s_nop 6
    ds_write_b128 v4, v[84:87] offset:3072
    ds_write_b128 v4, v[88:91] offset:4096
    v_lshlrev_b32 v16, 16, v10
    v_and_b32 v17, 0xffff0000, v10
    v_lshlrev_b32_e64 v18, 16, v11
    v_and_b32 v19, 0xffff0000, v11
    v_lshlrev_b32_e64 v20, 16, v12
    v_and_b32 v21, 0xffff0000, v12
    v_lshlrev_b32_e64 v22, 16, v13
    v_and_b32 v23, 0xffff0000, v13
    v_lshlrev_b32_e64 v24, 16, v14
    v_and_b32 v25, 0xffff0000, v14
    v_lshlrev_b32_e64 v26, 16, v15
    v_and_b32 v27, 0xffff0000, v15
    s_waitcnt lgkmcnt(0)
    s_barrier
    ds_read_b128 v[148:151], v4 offset:0
    ds_read_b128 v[152:155], v4 offset:1024
    ds_read_b128 v[156:159], v4 offset:2048
    s_waitcnt lgkmcnt(2)
    v_pk_add_f32 v[72:73], v[72:73], v[148:149]
    v_pk_add_f32 v[74:75], v[74:75], v[150:151]
    v_pk_fma_f32 v[16:17], v[72:73], v[96:97], v[16:17]
    v_pk_fma_f32 v[18:19], v[74:75], v[98:99], v[18:19]
    v_cvt_pk_bf16_f32 v10, v16, v17
    v_cvt_pk_bf16_f32 v11, v18, v19
    buffer_store_dwordx2 v[10:11], v5, s[80:83], s32 offen offset:0
    s_waitcnt lgkmcnt(1)
    v_pk_add_f32 v[76:77], v[76:77], v[152:153]
    v_pk_add_f32 v[78:79], v[78:79], v[154:155]
    v_pk_fma_f32 v[20:21], v[76:77], v[100:101], v[20:21]
    v_pk_fma_f32 v[22:23], v[78:79], v[102:103], v[22:23]
    v_cvt_pk_bf16_f32 v12, v20, v21
    v_cvt_pk_bf16_f32 v13, v22, v23
    buffer_store_dwordx2 v[12:13], v5, s[80:83], s32 offen offset:32
    s_waitcnt lgkmcnt(0)
    v_pk_add_f32 v[80:81], v[80:81], v[156:157]
    v_pk_add_f32 v[82:83], v[82:83], v[158:159]
    v_pk_fma_f32 v[24:25], v[80:81], v[104:105], v[24:25]
    v_pk_fma_f32 v[26:27], v[82:83], v[106:107], v[26:27]
    v_cvt_pk_bf16_f32 v14, v24, v25
    v_cvt_pk_bf16_f32 v15, v26, v27
    buffer_store_dwordx2 v[14:15], v5, s[80:83], s32 offen offset:64
kf_kernel_b_end:
    s_endpgm
kf_kernel_b_c1_0:
    v_and_b32_e64 v0, 1, v2
    v_lshl_add_u32 v0, v0, 6, v6
    v_add_u32 v0, 157696, v0
    v_add_u32 v8, 40960, v3
    v_add_u32 v4, 40960, v9
    s_mul_i32 s39, s16, 81920
    s_mul_i32 s30, s28, 5120
    s_add_u32 s39, s39, s30
    s_add_u32 s39, s39, 23527424
    s_setprio 3
    ds_read_b128 v[56:59], v0 offset:0
    ds_read_b128 v[60:63], v0 offset:128
    ds_read_b128 v[64:67], v0 offset:256
    ds_read_b128 v[68:71], v0 offset:384
    ds_read_b128 v[72:75], v0 offset:512
    ds_read_b128 v[76:79], v0 offset:640
    ds_read_b128 v[80:83], v0 offset:768
    ds_read_b128 v[84:87], v0 offset:896
    s_waitcnt lgkmcnt(7)
    v_mfma_f32_16x16x32_bf16 v[48:51], v[240:243], v[56:59], 0
    ds_read_b128 v[56:59], v0 offset:1024
    s_waitcnt lgkmcnt(7)
    v_mfma_f32_16x16x32_bf16 v[48:51], v[244:247], v[60:63], v[48:51]
    ds_read_b128 v[60:63], v0 offset:1152
    s_waitcnt lgkmcnt(7)
    v_mfma_f32_16x16x32_bf16 v[48:51], v[248:251], v[64:67], v[48:51]
    ds_read_b128 v[64:67], v0 offset:1280
    s_waitcnt lgkmcnt(7)
    v_mfma_f32_16x16x32_bf16 v[48:51], v[252:255], v[68:71], v[48:51]
    ds_read_b128 v[68:71], v0 offset:1408
    s_waitcnt lgkmcnt(7)
    v_mfma_f32_16x16x32_bf16 v[48:51], v[116:119], v[72:75], v[48:51]
    ds_read_b128 v[72:75], v0 offset:1536
    s_waitcnt lgkmcnt(7)
    v_mfma_f32_16x16x32_bf16 v[48:51], v[120:123], v[76:79], v[48:51]
    ds_read_b128 v[76:79], v0 offset:1664
    s_waitcnt lgkmcnt(7)
    v_mfma_f32_16x16x32_bf16 v[48:51], v[124:127], v[80:83], v[48:51]
    ds_read_b128 v[80:83], v0 offset:1792
    s_waitcnt lgkmcnt(7)
    v_mfma_f32_16x16x32_bf16 v[48:51], v[128:131], v[84:87], v[48:51]
    ds_read_b128 v[84:87], v0 offset:1920
    s_waitcnt lgkmcnt(7)
    v_mfma_f32_16x16x32_bf16 v[48:51], v[140:143], v[56:59], v[48:51]
    ds_read_b128 v[56:59], v0 offset:2048
    s_waitcnt lgkmcnt(7)
    v_mfma_f32_16x16x32_bf16 v[48:51], v[144:147], v[60:63], v[48:51]
    ds_read_b128 v[60:63], v0 offset:2176
    s_waitcnt lgkmcnt(7)
    v_mfma_f32_16x16x32_bf16 v[48:51], v[148:151], v[64:67], v[48:51]
    ds_read_b128 v[64:67], v0 offset:2304
    s_waitcnt lgkmcnt(7)
    v_mfma_f32_16x16x32_bf16 v[48:51], v[152:155], v[68:71], v[48:51]
    ds_read_b128 v[68:71], v0 offset:2432
    s_waitcnt lgkmcnt(7)
    v_mfma_f32_16x16x32_bf16 v[48:51], v[132:135], v[72:75], v[48:51]
    s_waitcnt lgkmcnt(6)
    v_mfma_f32_16x16x32_bf16 v[48:51], v[136:139], v[76:79], v[48:51]
    s_waitcnt lgkmcnt(5)
    v_mfma_f32_16x16x32_bf16 v[48:51], v[156:159], v[80:83], v[48:51]
    s_waitcnt lgkmcnt(4)
    v_mfma_f32_16x16x32_bf16 v[48:51], v[96:99], v[84:87], v[48:51]
    s_waitcnt lgkmcnt(3)
    v_mfma_f32_16x16x32_bf16 v[48:51], v[100:103], v[56:59], v[48:51]
    s_waitcnt lgkmcnt(2)
    v_mfma_f32_16x16x32_bf16 v[48:51], v[104:107], v[60:63], v[48:51]
    s_waitcnt lgkmcnt(1)
    v_mfma_f32_16x16x32_bf16 v[48:51], v[108:111], v[64:67], v[48:51]
    s_waitcnt lgkmcnt(0)
    v_mfma_f32_16x16x32_bf16 v[48:51], v[112:115], v[68:71], v[48:51]
    s_lshl_b32 s67, s26, 2
    s_lshl_b32 s70, s25, zlit_b-zlit_a+(10)
    s_add_u32 s67, s67, s70
    s_add_u32 s67, s67, 36450304
    s_lshl_b32 s68, s17, 7
    s_lshl_b32 s70, s16, zlit_b-zlit_a+(10)
    s_add_u32 s68, s68, s70
    s_add_u32 s68, s68, 36450304
    v_lshlrev_b32 v32, 7, v2
    v_lshlrev_b32 v33, 2, v2
    v_mov_b32 v34, 1
    s_waitcnt vmcnt(0)
    s_barrier
    s_mov_b32 exec_hi, 0
    s_mov_b32 exec_lo, 0xff
    buffer_store_dword v34, v32, s[8:11], s67 offen sc1
    s_mov_b32 s70, zlit_b-zlit_a+(0)
    buffer_load_dword v35, v33, s[8:11], s68 offen sc1
kf_kernel_b_poll2:
    s_waitcnt vmcnt(0)
    v_cmp_ne_u32 vcc, 1, v35
    s_cbranch_vccz kf_kernel_b_go2
    s_sleep 1
    buffer_load_dword v35, v33, s[8:11], s68 offen sc1
    s_add_u32 s70, s70, zlit_b-zlit_a+(1)
    s_cmp_lt_u32 s70, 0x40000
    s_cbranch_scc1 kf_kernel_b_poll2
kf_kernel_b_go2:
    s_mov_b64 exec, -1
    s_barrier
    s_barrier
    ds_read_b128 v[56:59], v3 offset:0
    ds_read_b128 v[60:63], v3 offset:2560
    ds_read_b128 v[64:67], v3 offset:5120
    ds_read_b128 v[68:71], v3 offset:7680
    ds_read_b128 v[72:75], v3 offset:1024
    ds_read_b128 v[76:79], v3 offset:3584
    ds_read_b128 v[80:83], v3 offset:6144
    ds_read_b128 v[84:87], v3 offset:8704
    ds_read_b128 v[88:91], v3 offset:10240
    ds_read_b128 v[92:95], v3 offset:12800
    s_waitcnt lgkmcnt(9)
    v_mfma_f32_16x16x32_bf16 v[16:19], v[240:243], v[56:59], 0
    ds_read_b128 v[56:59], v3 offset:15360
    s_waitcnt lgkmcnt(9)
    v_mfma_f32_16x16x32_bf16 v[20:23], v[240:243], v[60:63], 0
    ds_read_b128 v[60:63], v3 offset:17920
    s_waitcnt lgkmcnt(9)
    v_mfma_f32_16x16x32_bf16 v[24:27], v[240:243], v[64:67], 0
    ds_read_b128 v[64:67], v3 offset:11264
    s_waitcnt lgkmcnt(9)
    v_mfma_f32_16x16x32_bf16 v[28:31], v[240:243], v[68:71], 0
    ds_read_b128 v[68:71], v3 offset:13824
    s_waitcnt lgkmcnt(9)
    v_mfma_f32_16x16x32_bf16 v[16:19], v[244:247], v[72:75], v[16:19]
    ds_read_b128 v[72:75], v3 offset:16384
    s_waitcnt lgkmcnt(9)
    v_mfma_f32_16x16x32_bf16 v[20:23], v[244:247], v[76:79], v[20:23]
    ds_read_b128 v[76:79], v3 offset:18944
    s_waitcnt lgkmcnt(9)
    v_mfma_f32_16x16x32_bf16 v[24:27], v[244:247], v[80:83], v[24:27]
    ds_read_b64 v[80:81], v9 offset:2048
    ds_read_b64 v[82:83], v9 offset:12288
    s_waitcnt lgkmcnt(10)
    v_mfma_f32_16x16x32_bf16 v[28:31], v[244:247], v[84:87], v[28:31]
    ds_read_b64 v[84:85], v9 offset:4608
    ds_read_b64 v[86:87], v9 offset:14848
    s_waitcnt lgkmcnt(11)
    v_mfma_f32_16x16x32_bf16 v[16:19], v[248:251], v[88:91], v[16:19]
    ds_read_b64 v[88:89], v9 offset:7168
    ds_read_b64 v[90:91], v9 offset:17408
    s_waitcnt lgkmcnt(12)
    v_mfma_f32_16x16x32_bf16 v[20:23], v[248:251], v[92:95], v[20:23]
    ds_read_b64 v[92:93], v9 offset:9728
    ds_read_b64 v[94:95], v9 offset:19968
    s_waitcnt lgkmcnt(13)
    v_mfma_f32_16x16x32_bf16 v[24:27], v[248:251], v[56:59], v[24:27]
    s_barrier
    ds_read_b128 v[56:59], v3 offset:20480
    s_waitcnt lgkmcnt(13)
    v_mfma_f32_16x16x32_bf16 v[28:31], v[248:251], v[60:63], v[28:31]
    ds_read_b128 v[60:63], v3 offset:23040
    s_waitcnt lgkmcnt(13)
    v_mfma_f32_16x16x32_bf16 v[16:19], v[252:255], v[64:67], v[16:19]
    ds_read_b128 v[64:67], v3 offset:25600
    s_waitcnt lgkmcnt(13)
    v_mfma_f32_16x16x32_bf16 v[20:23], v[252:255], v[68:71], v[20:23]
    ds_read_b128 v[68:71], v3 offset:28160
    s_waitcnt lgkmcnt(13)
    v_mfma_f32_16x16x32_bf16 v[24:27], v[252:255], v[72:75], v[24:27]
    ds_read_b128 v[72:75], v3 offset:21504
    s_waitcnt lgkmcnt(13)
    v_mfma_f32_16x16x32_bf16 v[28:31], v[252:255], v[76:79], v[28:31]
    ds_read_b128 v[76:79], v3 offset:24064
    s_waitcnt lgkmcnt(12)
    v_mfma_f32_16x16x32_bf16 v[16:19], v[116:119], v[80:83], v[16:19]
    ds_read_b128 v[80:83], v3 offset:26624
    s_waitcnt lgkmcnt(11)
    v_mfma_f32_16x16x32_bf16 v[20:23], v[116:119], v[84:87], v[20:23]
    ds_read_b128 v[84:87], v3 offset:29184
    s_waitcnt lgkmcnt(10)
    v_mfma_f32_16x16x32_bf16 v[24:27], v[116:119], v[88:91], v[24:27]
    ds_read_b128 v[88:91], v3 offset:30720
    s_waitcnt lgkmcnt(9)
    v_mfma_f32_16x16x32_bf16 v[28:31], v[116:119], v[92:95], v[28:31]
    ds_read_b128 v[92:95], v3 offset:33280
    s_waitcnt lgkmcnt(9)
    v_mfma_f32_16x16x32_bf16 v[16:19], v[120:123], v[56:59], v[16:19]
    ds_read_b128 v[56:59], v3 offset:35840
    s_waitcnt lgkmcnt(9)
    v_mfma_f32_16x16x32_bf16 v[20:23], v[120:123], v[60:63], v[20:23]
    ds_read_b128 v[60:63], v3 offset:38400
    s_waitcnt lgkmcnt(9)
    v_mfma_f32_16x16x32_bf16 v[24:27], v[120:123], v[64:67], v[24:27]
    ds_read_b128 v[64:67], v3 offset:31744
    s_waitcnt lgkmcnt(9)
    v_mfma_f32_16x16x32_bf16 v[28:31], v[120:123], v[68:71], v[28:31]
    ds_read_b128 v[68:71], v3 offset:34304
    s_waitcnt lgkmcnt(9)
    v_mfma_f32_16x16x32_bf16 v[16:19], v[124:127], v[72:75], v[16:19]
    ds_read_b128 v[72:75], v3 offset:36864
    s_add_u32 s67, s38, 61440
    buffer_load_dwordx4 v[240:243], v3, s[8:11], s67 offen offset:0 sc1
    s_waitcnt lgkmcnt(9)
    v_mfma_f32_16x16x32_bf16 v[20:23], v[124:127], v[76:79], v[20:23]
    ds_read_b128 v[76:79], v3 offset:39424
    s_add_u32 s67, s38, 61440
    buffer_load_dwordx4 v[244:247], v3, s[8:11], s67 offen offset:1024 sc1
    s_waitcnt lgkmcnt(9)
    v_mfma_f32_16x16x32_bf16 v[24:27], v[124:127], v[80:83], v[24:27]
    ds_read_b64 v[80:81], v9 offset:22528
    ds_read_b64 v[82:83], v9 offset:32768
    s_add_u32 s67, s38, 61440
    buffer_load_dwordx4 v[248:251], v3, s[8:11], s67 offen offset:2048 sc1
    s_waitcnt lgkmcnt(10)
    v_mfma_f32_16x16x32_bf16 v[28:31], v[124:127], v[84:87], v[28:31]
    ds_read_b64 v[84:85], v9 offset:25088
    ds_read_b64 v[86:87], v9 offset:35328
    s_waitcnt lgkmcnt(11)
    v_mfma_f32_16x16x32_bf16 v[16:19], v[128:131], v[88:91], v[16:19]
    ds_read_b64 v[88:89], v9 offset:27648
    ds_read_b64 v[90:91], v9 offset:37888
    s_add_u32 s67, s38, 61440
    buffer_load_dwordx4 v[252:255], v3, s[8:11], s67 offen offset:3072 sc1
    s_waitcnt lgkmcnt(12)
    v_mfma_f32_16x16x32_bf16 v[20:23], v[128:131], v[92:95], v[20:23]
    ds_read_b64 v[92:93], v9 offset:30208
    ds_read_b64 v[94:95], v9 offset:40448
    s_waitcnt lgkmcnt(13)
    v_mfma_f32_16x16x32_bf16 v[24:27], v[128:131], v[56:59], v[24:27]
    s_barrier
    ds_read_b128 v[56:59], v8 offset:0
    s_waitcnt lgkmcnt(13)
    v_mfma_f32_16x16x32_bf16 v[28:31], v[128:131], v[60:63], v[28:31]
    ds_read_b128 v[60:63], v8 offset:2560
    s_waitcnt lgkmcnt(13)
    v_mfma_f32_16x16x32_bf16 v[16:19], v[140:143], v[64:67], v[16:19]
    ds_read_b128 v[64:67], v8 offset:5120
    s_waitcnt lgkmcnt(13)
    v_mfma_f32_16x16x32_bf16 v[20:23], v[140:143], v[68:71], v[20:23]
    ds_read_b128 v[68:71], v8 offset:7680
    s_waitcnt lgkmcnt(13)
    v_mfma_f32_16x16x32_bf16 v[24:27], v[140:143], v[72:75], v[24:27]
    ds_read_b128 v[72:75], v8 offset:1024
    s_waitcnt lgkmcnt(13)
    v_mfma_f32_16x16x32_bf16 v[28:31], v[140:143], v[76:79], v[28:31]
    ds_read_b128 v[76:79], v8 offset:3584
    s_waitcnt lgkmcnt(12)
    v_mfma_f32_16x16x32_bf16 v[16:19], v[144:147], v[80:83], v[16:19]
    ds_read_b128 v[80:83], v8 offset:6144
    s_waitcnt lgkmcnt(11)
    v_mfma_f32_16x16x32_bf16 v[20:23], v[144:147], v[84:87], v[20:23]
    ds_read_b128 v[84:87], v8 offset:8704
    s_waitcnt lgkmcnt(10)
    v_mfma_f32_16x16x32_bf16 v[24:27], v[144:147], v[88:91], v[24:27]
    ds_read_b128 v[88:91], v8 offset:10240
    s_waitcnt lgkmcnt(9)
    v_mfma_f32_16x16x32_bf16 v[28:31], v[144:147], v[92:95], v[28:31]
    ds_read_b128 v[92:95], v8 offset:12800
    s_waitcnt lgkmcnt(9)
    v_mfma_f32_16x16x32_bf16 v[16:19], v[148:151], v[56:59], v[16:19]
    ds_read_b128 v[56:59], v8 offset:15360
    s_add_u32 s67, s38, 0
    buffer_load_dwordx4 v[144:147], v3, s[8:11], s67 offen offset:0 sc1
    s_waitcnt lgkmcnt(9)
    v_mfma_f32_16x16x32_bf16 v[20:23], v[148:151], v[60:63], v[20:23]
    ds_read_b128 v[60:63], v8 offset:17920
    s_waitcnt lgkmcnt(9)
    v_mfma_f32_16x16x32_bf16 v[24:27], v[148:151], v[64:67], v[24:27]
    ds_read_b128 v[64:67], v8 offset:11264
    s_waitcnt lgkmcnt(9)
    v_mfma_f32_16x16x32_bf16 v[28:31], v[148:151], v[68:71], v[28:31]
    ds_read_b128 v[68:71], v8 offset:13824
    s_waitcnt lgkmcnt(9)
    v_mfma_f32_16x16x32_bf16 v[16:19], v[152:155], v[72:75], v[16:19]
    ds_read_b128 v[72:75], v8 offset:16384
    s_add_u32 s67, s38, zlit_b-zlit_a+(0)
    buffer_load_dwordx4 v[148:151], v3, s[8:11], s67 offen offset:1024 sc1
    s_waitcnt lgkmcnt(9)
    v_mfma_f32_16x16x32_bf16 v[20:23], v[152:155], v[76:79], v[20:23]
    ds_read_b128 v[76:79], v8 offset:18944
    s_waitcnt lgkmcnt(9)
    v_mfma_f32_16x16x32_bf16 v[24:27], v[152:155], v[80:83], v[24:27]
    ds_read_b64 v[80:81], v4 offset:2048
    ds_read_b64 v[82:83], v4 offset:12288
    s_waitcnt lgkmcnt(10)
    v_mfma_f32_16x16x32_bf16 v[28:31], v[152:155], v[84:87], v[28:31]
    ds_read_b64 v[84:85], v4 offset:4608
    ds_read_b64 v[86:87], v4 offset:14848
    s_waitcnt lgkmcnt(11)
    v_mfma_f32_16x16x32_bf16 v[16:19], v[132:135], v[88:91], v[16:19]
    ds_read_b64 v[88:89], v4 offset:7168
    ds_read_b64 v[90:91], v4 offset:17408
    s_add_u32 s67, s38, zlit_b-zlit_a+(0)
    buffer_load_dwordx4 v[152:155], v3, s[8:11], s67 offen offset:2048 sc1
    s_waitcnt lgkmcnt(12)
    v_mfma_f32_16x16x32_bf16 v[20:23], v[132:135], v[92:95], v[20:23]
    ds_read_b64 v[92:93], v4 offset:9728
    ds_read_b64 v[94:95], v4 offset:19968
    s_waitcnt lgkmcnt(13)
    v_mfma_f32_16x16x32_bf16 v[24:27], v[132:135], v[56:59], v[24:27]
    s_barrier
    ds_read_b128 v[56:59], v8 offset:20480
    s_waitcnt lgkmcnt(13)
    v_mfma_f32_16x16x32_bf16 v[28:31], v[132:135], v[60:63], v[28:31]
    ds_read_b128 v[60:63], v8 offset:23040
    s_waitcnt lgkmcnt(13)
    v_mfma_f32_16x16x32_bf16 v[16:19], v[136:139], v[64:67], v[16:19]
    ds_read_b128 v[64:67], v8 offset:25600
    s_waitcnt lgkmcnt(13)
    v_mfma_f32_16x16x32_bf16 v[20:23], v[136:139], v[68:71], v[20:23]
    ds_read_b128 v[68:71], v8 offset:28160
    s_waitcnt lgkmcnt(13)
    v_mfma_f32_16x16x32_bf16 v[24:27], v[136:139], v[72:75], v[24:27]
    ds_read_b128 v[72:75], v8 offset:21504
    s_waitcnt lgkmcnt(13)
    v_mfma_f32_16x16x32_bf16 v[28:31], v[136:139], v[76:79], v[28:31]
    ds_read_b128 v[76:79], v8 offset:24064
    s_waitcnt lgkmcnt(12)
    v_mfma_f32_16x16x32_bf16 v[16:19], v[156:159], v[80:83], v[16:19]
    ds_read_b128 v[80:83], v8 offset:26624
    s_waitcnt lgkmcnt(11)
    v_mfma_f32_16x16x32_bf16 v[20:23], v[156:159], v[84:87], v[20:23]
    ds_read_b128 v[84:87], v8 offset:29184
    s_waitcnt lgkmcnt(10)
    v_mfma_f32_16x16x32_bf16 v[24:27], v[156:159], v[88:91], v[24:27]
    ds_read_b128 v[88:91], v8 offset:30720
    s_waitcnt lgkmcnt(9)
    v_mfma_f32_16x16x32_bf16 v[28:31], v[156:159], v[92:95], v[28:31]
    ds_read_b128 v[92:95], v8 offset:33280
    s_waitcnt lgkmcnt(9)
    v_mfma_f32_16x16x32_bf16 v[16:19], v[96:99], v[56:59], v[16:19]
    ds_read_b128 v[56:59], v8 offset:35840
    s_add_u32 s67, s38, 0
    buffer_load_dwordx4 v[156:159], v3, s[8:11], s67 offen offset:3072 sc1
    s_waitcnt lgkmcnt(9)
    v_mfma_f32_16x16x32_bf16 v[20:23], v[96:99], v[60:63], v[20:23]
    ds_read_b128 v[60:63], v8 offset:38400
    s_waitcnt lgkmcnt(9)
    v_mfma_f32_16x16x32_bf16 v[24:27], v[96:99], v[64:67], v[24:27]
    ds_read_b128 v[64:67], v8 offset:31744
    s_waitcnt lgkmcnt(9)
    v_mfma_f32_16x16x32_bf16 v[28:31], v[96:99], v[68:71], v[28:31]
    ds_read_b128 v[68:71], v8 offset:34304
    s_waitcnt lgkmcnt(9)
    v_mfma_f32_16x16x32_bf16 v[16:19], v[100:103], v[72:75], v[16:19]
    ds_read_b128 v[72:75], v8 offset:36864
    s_waitcnt lgkmcnt(9)
    v_mfma_f32_16x16x32_bf16 v[20:23], v[100:103], v[76:79], v[20:23]
    ds_read_b128 v[76:79], v8 offset:39424
    s_waitcnt lgkmcnt(9)
    v_mfma_f32_16x16x32_bf16 v[24:27], v[100:103], v[80:83], v[24:27]
    ds_read_b64 v[80:81], v4 offset:22528
    ds_read_b64 v[82:83], v4 offset:32768
    s_waitcnt lgkmcnt(10)
    v_mfma_f32_16x16x32_bf16 v[28:31], v[100:103], v[84:87], v[28:31]
    ds_read_b64 v[84:85], v4 offset:25088
    ds_read_b64 v[86:87], v4 offset:35328
    s_waitcnt lgkmcnt(11)
    v_mfma_f32_16x16x32_bf16 v[16:19], v[104:107], v[88:91], v[16:19]
    ds_read_b64 v[88:89], v4 offset:27648
    ds_read_b64 v[90:91], v4 offset:37888
    s_waitcnt lgkmcnt(12)
    v_mfma_f32_16x16x32_bf16 v[20:23], v[104:107], v[92:95], v[20:23]
    ds_read_b64 v[92:93], v4 offset:30208
    ds_read_b64 v[94:95], v4 offset:40448
    s_waitcnt lgkmcnt(13)
    v_mfma_f32_16x16x32_bf16 v[24:27], v[104:107], v[56:59], v[24:27]
    s_waitcnt lgkmcnt(12)
    v_mfma_f32_16x16x32_bf16 v[28:31], v[104:107], v[60:63], v[28:31]
    s_waitcnt lgkmcnt(11)
    v_mfma_f32_16x16x32_bf16 v[16:19], v[108:111], v[64:67], v[16:19]
    s_waitcnt lgkmcnt(10)
    v_mfma_f32_16x16x32_bf16 v[20:23], v[108:111], v[68:71], v[20:23]
    s_waitcnt lgkmcnt(9)
    v_mfma_f32_16x16x32_bf16 v[24:27], v[108:111], v[72:75], v[24:27]
    s_waitcnt lgkmcnt(8)
    v_mfma_f32_16x16x32_bf16 v[28:31], v[108:111], v[76:79], v[28:31]
    s_waitcnt lgkmcnt(6)
    v_mfma_f32_16x16x32_bf16 v[16:19], v[112:115], v[80:83], v[16:19]
    s_waitcnt lgkmcnt(4)
    v_mfma_f32_16x16x32_bf16 v[20:23], v[112:115], v[84:87], v[20:23]
    s_waitcnt lgkmcnt(2)
    v_mfma_f32_16x16x32_bf16 v[24:27], v[112:115], v[88:91], v[24:27]
    s_waitcnt lgkmcnt(0)
    v_mfma_f32_16x16x32_bf16 v[28:31], v[112:115], v[92:95], v[28:31]
    v_mov_b32 v88, 162816
    v_mov_b32_e64 v89, 1
    s_mov_b64 exec, 1
    ds_add_u32 v88, v89
    s_mov_b64 exec, -1
    v_add_u32 v0, 161792, v7
    ds_read_b64 v[80:81], v0 offset:0
    ds_read_b64 v[82:83], v0 offset:128
    ds_read_b64 v[84:85], v0 offset:256
    ds_read_b64 v[86:87], v0 offset:384
    v_mov_b32_dpp v56, v48 quad_perm:[1,1,3,3] row_mask:0xf bank_mask:0xf
    v_mov_b32_dpp v57, v49 quad_perm:[1,1,3,3] row_mask:0xf bank_mask:0xf
    v_mov_b32_dpp v58, v50 quad_perm:[1,1,3,3] row_mask:0xf bank_mask:0xf
    v_mov_b32_dpp v59, v51 quad_perm:[1,1,3,3] row_mask:0xf bank_mask:0xf
    v_mov_b32_dpp v48, v48 quad_perm:[0,0,2,2] row_mask:0xf bank_mask:0xf
    v_mov_b32_dpp v49, v49 quad_perm:[0,0,2,2] row_mask:0xf bank_mask:0xf
    v_mov_b32_dpp v50, v50 quad_perm:[0,0,2,2] row_mask:0xf bank_mask:0xf
    v_mov_b32_dpp v51, v51 quad_perm:[0,0,2,2] row_mask:0xf bank_mask:0xf
    s_waitcnt lgkmcnt(0)
    v_mov_b32_e64 v64, s35
    v_pk_fma_f32 v[16:17], v[48:49], v[80:81], v[16:17] op_sel:[0,0,0] op_sel_hi:[1,0,1]
    v_pk_fma_f32 v[18:19], v[50:51], v[80:81], v[18:19] op_sel:[0,0,0] op_sel_hi:[1,0,1]
    v_pk_fma_f32 v[16:17], v[80:81], v[16:17], v[56:57] op_sel:[1,0,0] op_sel_hi:[1,1,1]
    v_pk_fma_f32 v[18:19], v[80:81], v[18:19], v[58:59] op_sel:[1,0,0] op_sel_hi:[1,1,1]
    v_pk_mul_f32 v[88:89], v[16:17], v[16:17]
    v_pk_mul_f32 v[90:91], v[18:19], v[18:19]
    v_pk_fma_f32 v[88:89], v[88:89], s[34:35], s[34:35] op_sel:[0,0,1] op_sel_hi:[1,0,1]
    v_pk_fma_f32 v[90:91], v[90:91], s[34:35], s[34:35] op_sel:[0,0,1] op_sel_hi:[1,0,1]
    v_pk_mul_f32 v[88:89], v[88:89], v[16:17]
    v_pk_mul_f32 v[90:91], v[90:91], v[18:19]
    v_exp_f32 v88, v88
    v_exp_f32 v89, v89
    v_exp_f32 v90, v90
    v_exp_f32 v91, v91
    v_pk_add_f32 v[88:89], v[88:89], s[36:37]
    v_pk_add_f32 v[90:91], v[90:91], s[36:37]
    v_rcp_f32 v88, v88
    v_rcp_f32 v89, v89
    v_rcp_f32 v90, v90
    v_rcp_f32 v91, v91
    v_pk_mul_f32 v[16:17], v[16:17], v[88:89]
    v_pk_mul_f32 v[18:19], v[18:19], v[90:91]
    v_pk_add_f32 v[112:113], v[16:17], v[18:19]
    v_pk_mul_f32 v[114:115], v[16:17], v[16:17]
    v_pk_fma_f32 v[114:115], v[18:19], v[18:19], v[114:115]
    v_pk_fma_f32 v[20:21], v[48:49], v[82:83], v[20:21] op_sel:[0,0,0] op_sel_hi:[1,0,1]
    v_pk_fma_f32 v[22:23], v[50:51], v[82:83], v[22:23] op_sel:[0,0,0] op_sel_hi:[1,0,1]
    v_pk_fma_f32 v[20:21], v[82:83], v[20:21], v[56:57] op_sel:[1,0,0] op_sel_hi:[1,1,1]
    v_pk_fma_f32 v[22:23], v[82:83], v[22:23], v[58:59] op_sel:[1,0,0] op_sel_hi:[1,1,1]
    v_pk_mul_f32 v[92:93], v[20:21], v[20:21]
    v_pk_mul_f32 v[94:95], v[22:23], v[22:23]
    v_pk_fma_f32 v[92:93], v[92:93], s[34:35], s[34:35] op_sel:[0,0,1] op_sel_hi:[1,0,1]
    v_pk_fma_f32 v[94:95], v[94:95], s[34:35], s[34:35] op_sel:[0,0,1] op_sel_hi:[1,0,1]
    v_pk_mul_f32 v[92:93], v[92:93], v[20:21]
    v_pk_mul_f32 v[94:95], v[94:95], v[22:23]
    v_exp_f32 v92, v92
    v_exp_f32 v93, v93
    v_exp_f32 v94, v94
    v_exp_f32 v95, v95
    v_pk_add_f32 v[92:93], v[92:93], s[36:37]
    v_pk_add_f32 v[94:95], v[94:95], s[36:37]
    v_rcp_f32 v92, v92
    v_rcp_f32 v93, v93
    v_rcp_f32 v94, v94
    v_rcp_f32 v95, v95
    v_pk_mul_f32 v[20:21], v[20:21], v[92:93]
    v_pk_mul_f32 v[22:23], v[22:23], v[94:95]
    v_pk_add_f32 v[116:117], v[20:21], v[22:23]
    v_pk_mul_f32 v[118:119], v[20:21], v[20:21]
    v_pk_fma_f32 v[118:119], v[22:23], v[22:23], v[118:119]
    v_pk_fma_f32 v[24:25], v[48:49], v[84:85], v[24:25] op_sel:[0,0,0] op_sel_hi:[1,0,1]
    v_pk_fma_f32 v[26:27], v[50:51], v[84:85], v[26:27] op_sel:[0,0,0] op_sel_hi:[1,0,1]
    v_pk_fma_f32 v[24:25], v[84:85], v[24:25], v[56:57] op_sel:[1,0,0] op_sel_hi:[1,1,1]
    v_pk_fma_f32 v[26:27], v[84:85], v[26:27], v[58:59] op_sel:[1,0,0] op_sel_hi:[1,1,1]
    v_pk_mul_f32 v[88:89], v[24:25], v[24:25]
    v_pk_mul_f32 v[90:91], v[26:27], v[26:27]
    v_pk_fma_f32 v[88:89], v[88:89], s[34:35], s[34:35] op_sel:[0,0,1] op_sel_hi:[1,0,1]
    v_pk_fma_f32 v[90:91], v[90:91], s[34:35], s[34:35] op_sel:[0,0,1] op_sel_hi:[1,0,1]
    v_pk_mul_f32 v[88:89], v[88:89], v[24:25]
    v_pk_mul_f32 v[90:91], v[90:91], v[26:27]
    v_exp_f32 v88, v88
    v_exp_f32 v89, v89
    v_exp_f32 v90, v90
    v_exp_f32 v91, v91
    v_pk_add_f32 v[88:89], v[88:89], s[36:37]
    v_pk_add_f32 v[90:91], v[90:91], s[36:37]
    v_rcp_f32 v88, v88
    v_rcp_f32 v89, v89
    v_rcp_f32 v90, v90
    v_rcp_f32 v91, v91
    v_pk_mul_f32 v[24:25], v[24:25], v[88:89]
    v_pk_mul_f32 v[26:27], v[26:27], v[90:91]
    v_pk_add_f32 v[120:121], v[24:25], v[26:27]
    v_pk_mul_f32 v[122:123], v[24:25], v[24:25]
    v_pk_fma_f32 v[122:123], v[26:27], v[26:27], v[122:123]
    v_pk_fma_f32 v[28:29], v[48:49], v[86:87], v[28:29] op_sel:[0,0,0] op_sel_hi:[1,0,1]
    v_pk_fma_f32 v[30:31], v[50:51], v[86:87], v[30:31] op_sel:[0,0,0] op_sel_hi:[1,0,1]
    v_pk_fma_f32 v[28:29], v[86:87], v[28:29], v[56:57] op_sel:[1,0,0] op_sel_hi:[1,1,1]
    v_pk_fma_f32 v[30:31], v[86:87], v[30:31], v[58:59] op_sel:[1,0,0] op_sel_hi:[1,1,1]
    v_pk_mul_f32 v[92:93], v[28:29], v[28:29]
    v_pk_mul_f32 v[94:95], v[30:31], v[30:31]
    v_pk_fma_f32 v[92:93], v[92:93], s[34:35], s[34:35] op_sel:[0,0,1] op_sel_hi:[1,0,1]
    v_pk_fma_f32 v[94:95], v[94:95], s[34:35], s[34:35] op_sel:[0,0,1] op_sel_hi:[1,0,1]
    v_pk_mul_f32 v[92:93], v[92:93], v[28:29]
    v_pk_mul_f32 v[94:95], v[94:95], v[30:31]
    v_exp_f32 v92, v92
    v_exp_f32 v93, v93
    v_exp_f32 v94, v94
    v_exp_f32 v95, v95
    v_pk_add_f32 v[92:93], v[92:93], s[36:37]
    v_pk_add_f32 v[94:95], v[94:95], s[36:37]
    v_rcp_f32 v92, v92
    v_rcp_f32 v93, v93
    v_rcp_f32 v94, v94
    v_rcp_f32 v95, v95
    v_pk_mul_f32 v[28:29], v[28:29], v[92:93]
    v_pk_mul_f32 v[30:31], v[30:31], v[94:95]
    v_pk_add_f32 v[124:125], v[28:29], v[30:31]
    v_pk_mul_f32 v[126:127], v[28:29], v[28:29]
    v_pk_fma_f32 v[126:127], v[30:31], v[30:31], v[126:127]
    v_add_f32 v112, v112, v113
    v_add_f32 v113, v114, v115
    v_add_f32 v116, v116, v117
    v_add_f32 v117, v118, v119
    v_add_f32 v120, v120, v121
    v_add_f32 v121, v122, v123
    v_add_f32 v124, v124, v125
    v_add_f32 v125, v126, v127
    v_permlane32_swap_b32 v112, v120
    v_permlane32_swap_b32 v116, v124
    v_permlane32_swap_b32 v113, v121
    v_permlane32_swap_b32 v117, v125
    v_pk_add_f32 v[112:113], v[112:113], v[120:121]
    v_pk_add_f32 v[116:117], v[116:117], v[124:125]
    s_lshl_b32 s67, s28, zlit_b-zlit_a+(9)
    s_add_u32 s67, s67, 155648
    v_add_u32 v0, s67, v9
    v_permlane16_swap_b32 v112, v116
    v_permlane16_swap_b32_e64 v113, v117
    v_pk_add_f32 v[112:113], v[112:113], v[116:117]
    v_add_u32 v0, 155648, v9
    s_lshl_b32 s68, s16, zlit_b-zlit_a+(12)
    s_add_u32 s68, s68, 36286464
    s_lshl_b32 s67, s17, 9
    s_add_u32 s67, s67, s68
    s_lshl_b32 s30, s28, zlit_b-zlit_a+(11)
    s_add_u32 s30, s30, 147456
    v_lshrrev_b32_e64 v90, 1, v6
    v_lshl_add_u32 v90, v7, 2, v90
    v_add_u32_e64 v90, s30, v90
    v_lshl_add_u32 v91, v6, 4, v7
    v_add_u32_e64 v91, s30, v91
    s_mul_i32 s30, s17, 458752
    s_mul_i32 s31, s16, 14336
    s_add_u32 s30, s30, s31
    s_lshl_b32 s31, s28, zlit_b-zlit_a+(11)
    s_add_u32 s30, s30, s31
    s_add_u32 s30, s30, 26148864
    s_add_u32 s31, s30, 7168
    v_add_u32 v4, 162304, v7
    v_mov_b32 v88, 162820
    s_mov_b32 s70, zlit_b-zlit_a+(0)
kf_kernel_b_spzc11:
    ds_read_b32 v89, v88
    s_add_u32 s70, s70, zlit_b-zlit_a+(1)
    s_cmp_lt_u32 s70, 0x400000
    s_waitcnt lgkmcnt(0)
    v_cmp_ne_u32_e64 vcc, 3, v89
    s_cbranch_vccz kf_kernel_b_sqzc11
    s_sleep 1
    s_cbranch_scc1 kf_kernel_b_spzc11
kf_kernel_b_sqzc11:
    ds_read_b64 v[114:115], v0 offset:0
    ds_read_b64 v[116:117], v0 offset:512
    ds_read_b64 v[118:119], v0 offset:1024
    s_waitcnt lgkmcnt(0)
    v_pk_add_f32 v[114:115], v[114:115], v[116:117]
    v_pk_add_f32 v[112:113], v[112:113], v[118:119]
    v_pk_add_f32 v[112:113], v[112:113], v[114:115]
    v_and_b32 v113, 0x7fffffff, v113
    buffer_store_dwordx2 v[112:113], v9, s[8:11], s67 offen sc1
    s_mov_b32 s70, 0
    v_add_u32 v0, 162304, v9
    buffer_load_dwordx2 v[114:115], v9, s[8:11], s68 offen offset:0 sc1
    buffer_load_dwordx2 v[116:117], v9, s[8:11], s68 offen offset:512 sc1
    buffer_load_dwordx2 v[118:119], v9, s[8:11], s68 offen offset:1024 sc1
    buffer_load_dwordx2 v[120:121], v9, s[8:11], s68 offen offset:1536 sc1
    buffer_load_dwordx2 v[122:123], v9, s[8:11], s68 offen offset:2048 sc1
    buffer_load_dwordx2 v[124:125], v9, s[8:11], s68 offen offset:2560 sc1
    buffer_load_dwordx2 v[126:127], v9, s[8:11], s68 offen offset:3072 sc1
    buffer_load_dwordx2 v[128:129], v9, s[8:11], s68 offen offset:3584 sc1
    s_sleep 6
    buffer_load_dwordx2 v[96:97], v9, s[8:11], s68 offen offset:0 sc1
    buffer_load_dwordx2 v[98:99], v9, s[8:11], s68 offen offset:512 sc1
    buffer_load_dwordx2 v[100:101], v9, s[8:11], s68 offen offset:1024 sc1
    buffer_load_dwordx2 v[102:103], v9, s[8:11], s68 offen offset:1536 sc1
    buffer_load_dwordx2 v[104:105], v9, s[8:11], s68 offen offset:2048 sc1
    buffer_load_dwordx2 v[106:107], v9, s[8:11], s68 offen offset:2560 sc1
    buffer_load_dwordx2 v[108:109], v9, s[8:11], s68 offen offset:3072 sc1
    buffer_load_dwordx2 v[110:111], v9, s[8:11], s68 offen offset:3584 sc1
kf_kernel_b_pollz:
    s_waitcnt vmcnt(8)
    v_or3_b32 v88, v115, v117, v119
    v_or3_b32 v89, v121, v123, v125
    v_or3_b32 v88, v88, v127, v129
    v_or_b32 v88, v88, v89
    v_cmp_gt_i32_e64 vcc, 0, v88
    s_cbranch_vccz kf_kernel_b_goz0
    buffer_load_dwordx2 v[114:115], v9, s[8:11], s68 offen offset:0 sc1
    buffer_load_dwordx2 v[116:117], v9, s[8:11], s68 offen offset:512 sc1
    buffer_load_dwordx2 v[118:119], v9, s[8:11], s68 offen offset:1024 sc1
    buffer_load_dwordx2 v[120:121], v9, s[8:11], s68 offen offset:1536 sc1
    buffer_load_dwordx2 v[122:123], v9, s[8:11], s68 offen offset:2048 sc1
    buffer_load_dwordx2 v[124:125], v9, s[8:11], s68 offen offset:2560 sc1
    buffer_load_dwordx2 v[126:127], v9, s[8:11], s68 offen offset:3072 sc1
    buffer_load_dwordx2 v[128:129], v9, s[8:11], s68 offen offset:3584 sc1
    s_waitcnt vmcnt(8)
    v_or3_b32 v88, v97, v99, v101
    v_or3_b32 v89, v103, v105, v107
    v_or3_b32 v88, v88, v109, v111
    v_or_b32 v88, v88, v89
    v_cmp_gt_i32 vcc, 0, v88
    s_cbranch_vccz kf_kernel_b_goz1
    buffer_load_dwordx2 v[96:97], v9, s[8:11], s68 offen offset:0 sc1
    buffer_load_dwordx2 v[98:99], v9, s[8:11], s68 offen offset:512 sc1
    buffer_load_dwordx2 v[100:101], v9, s[8:11], s68 offen offset:1024 sc1
    buffer_load_dwordx2 v[102:103], v9, s[8:11], s68 offen offset:1536 sc1
    buffer_load_dwordx2 v[104:105], v9, s[8:11], s68 offen offset:2048 sc1
    buffer_load_dwordx2 v[106:107], v9, s[8:11], s68 offen offset:2560 sc1
    buffer_load_dwordx2 v[108:109], v9, s[8:11], s68 offen offset:3072 sc1
    buffer_load_dwordx2 v[110:111], v9, s[8:11], s68 offen offset:3584 sc1
    s_add_u32 s70, s70, zlit_b-zlit_a+(1)
    s_cmp_lt_u32 s70, 0x40000
    s_cbranch_scc1 kf_kernel_b_pollz
kf_kernel_b_goz0:
    v_add_f32 v64, v114, v122
    v_add_f32 v65, v115, v123
    v_add_f32 v66, v116, v124
    v_add_f32 v67, v117, v125
    v_add_f32 v68, v118, v126
    v_add_f32 v69, v119, v127
    v_add_f32 v70, v120, v128
    v_add_f32 v71, v121, v129
    s_branch kf_kernel_b_goz
kf_kernel_b_goz1:
    v_add_f32 v64, v96, v104
    v_add_f32 v65, v97, v105
    v_add_f32 v66, v98, v106
    v_add_f32 v67, v99, v107
    v_add_f32 v68, v100, v108
    v_add_f32 v69, v101, v109
    v_add_f32 v70, v102, v110
    v_add_f32 v71, v103, v111
kf_kernel_b_goz:
    v_add_f32 v64, v64, v68
    v_add_f32 v65, v65, v69
    v_add_f32 v66, v66, v70
    v_add_f32 v67, v67, v71
    v_add_f32 v64, v64, v66
    v_add_f32 v65, v65, v67
    v_mul_f32 v64, 0x3a97b426, v64
    v_mul_f32 v65, 0x3a97b426, v65
    v_fma_f32 v65, -v64, v64, v65
    v_max_f32_e64 v65, 0, v65
    v_cvt_pk_bf16_f32 v65, v65, v64
    v_and_b32 v112, 0xffff0000, v65
    v_lshlrev_b32_e64 v65, 16, v65
    v_add_f32 v65, 0x3727c5ac, v65
    v_cvt_pk_bf16_f32 v65, v65, v65
    v_lshlrev_b32 v65, 16, v65
    v_sqrt_f32_e64 v65, v65
    s_nop 0
    v_cvt_pk_bf16_f32 v65, v65, v65
    v_lshlrev_b32 v65, 16, v65
    v_rcp_f32 v113, v65
    s_nop 0
    v_mul_f32 v112, v113, v112
    v_sub_f32_e64 v112, 0, v112
    ds_write_b64 v0, v[112:113]
    v_mov_b32 v88, 162824
    v_mov_b32 v89, 1
    s_mov_b64 exec, 1
    ds_add_u32 v88, v89
    s_mov_b64 exec, -1
    ds_read_b64 v[80:81], v4 offset:0
    ds_read_b64 v[82:83], v4 offset:128
    ds_read_b64 v[84:85], v4 offset:256
    ds_read_b64 v[86:87], v4 offset:384
    s_waitcnt lgkmcnt(0)
    v_fma_f32 v16, v81, v16, v80
    v_fma_f32 v17, v81, v17, v80
    v_fma_f32 v18, v81, v18, v80
    v_fma_f32 v19, v81, v19, v80
    v_cvt_pk_bf16_f32 v16, v16, v17
    v_cvt_pk_bf16_f32 v17, v18, v19
    ds_write_b64 v90, v[16:17] offset:0
    v_fma_f32 v20, v83, v20, v82
    v_fma_f32 v21, v83, v21, v82
    v_fma_f32 v22, v83, v22, v82
    v_fma_f32 v23, v83, v23, v82
    v_cvt_pk_bf16_f32 v20, v20, v21
    v_cvt_pk_bf16_f32 v21, v22, v23
    ds_write_b64 v90, v[20:21] offset:512
    ds_read_b64_tr_b16 v[64:65], v91 offset:0
    ds_read_b64_tr_b16 v[66:67], v91 offset:128
    v_fma_f32 v24, v85, v24, v84
    v_fma_f32 v25, v85, v25, v84
    v_fma_f32 v26, v85, v26, v84
    v_fma_f32 v27, v85, v27, v84
    v_cvt_pk_bf16_f32 v24, v24, v25
    v_cvt_pk_bf16_f32 v25, v26, v27
    ds_write_b64 v90, v[24:25] offset:0
    v_fma_f32 v28, v87, v28, v86
    v_fma_f32 v29, v87, v29, v86
    v_fma_f32 v30, v87, v30, v86
    v_fma_f32 v31, v87, v31, v86
    v_cvt_pk_bf16_f32 v28, v28, v29
    v_cvt_pk_bf16_f32 v29, v30, v31
    ds_write_b64 v90, v[28:29] offset:512
    ds_read_b64_tr_b16 v[72:73], v91 offset:0
    ds_read_b64_tr_b16 v[74:75], v91 offset:128
    s_waitcnt lgkmcnt(4)
    buffer_store_dwordx4 v[64:67], v3, s[8:11], s30 offen offset:0 sc1
    s_waitcnt lgkmcnt(0)
    buffer_store_dwordx4 v[72:75], v3, s[8:11], s31 offen offset:0 sc1
    s_waitcnt vmcnt(0)
    s_lshl_b32 s67, s16, 2
    s_lshl_b32 s70, s17, 12
    s_add_u32 s67, s67, s70
    s_add_u32 s67, s67, 36483072
    s_lshl_b32 s68, s16, 7
    s_lshl_b32 s70, s17, zlit_b-zlit_a+(12)
    s_add_u32 s68, s68, s70
    s_add_u32 s68, s68, 36483072
    v_lshlrev_b32 v16, 7, v2
    v_lshlrev_b32 v17, 2, v2
    v_mov_b32_e64 v18, 1
    v_mov_b32 v88, 162828
    s_mov_b32 s70, zlit_b-zlit_a+(0)
kf_kernel_b_spy:
    ds_read_b32 v89, v88
    s_add_u32 s70, s70, zlit_b-zlit_a+(1)
    s_cmp_lt_u32 s70, 0x400000
    s_waitcnt lgkmcnt(0)
    v_cmp_ne_u32 vcc, 3, v89
    s_cbranch_vccz kf_kernel_b_sqy
    s_sleep 1
    s_cbranch_scc1 kf_kernel_b_spy
kf_kernel_b_sqy:
    s_mov_b32 exec_hi, 0
    s_mov_b32 exec_lo, zlit_b-zlit_a+(-1)
    buffer_store_dword v18, v16, s[8:11], s67 offen sc1
    s_mov_b32 s70, zlit_b-zlit_a+(0)
    buffer_load_dword v19, v17, s[8:11], s68 offen sc1
kf_kernel_b_poll4:
    s_waitcnt vmcnt(0)
    v_cmp_ne_u32 vcc, 1, v19
    s_cbranch_vccz kf_kernel_b_go4
    s_sleep 1
    buffer_load_dword v19, v17, s[8:11], s68 offen sc1
    s_add_u32 s70, s70, zlit_b-zlit_a+(1)
    s_cmp_lt_u32 s70, 0x40000
    s_cbranch_scc1 kf_kernel_b_poll4
kf_kernel_b_go4:
    s_mov_b64 exec, -1
    s_barrier
    s_branch kf_kernel_b_d0
kf_kernel_b_kh1:
    ds_write_b128 v4, v[56:59] offset:0
    ds_write_b128 v4, v[60:63] offset:1024
    ds_write_b128 v4, v[64:67] offset:2048
    s_cmp_eq_u32 s28, 3
    s_cbranch_scc0 kf_kernel_b_re1
    s_add_u32 s67, s38, 4096
    buffer_load_dwordx4 v[160:163], v3, s[8:11], s67 offen offset:0 sc1
    buffer_load_dwordx4 v[164:167], v3, s[8:11], s67 offen offset:1024 sc1
    buffer_load_dwordx4 v[168:171], v3, s[8:11], s67 offen offset:2048 sc1
    buffer_load_dwordx4 v[172:175], v3, s[8:11], s67 offen offset:3072 sc1
    s_add_u32 s67, s38, 45056
    buffer_load_dwordx4 v[176:179], v3, s[8:11], s67 offen offset:0 sc1
    buffer_load_dwordx4 v[180:183], v3, s[8:11], s67 offen offset:1024 sc1
    buffer_load_dwordx4 v[184:187], v3, s[8:11], s67 offen offset:2048 sc1
    buffer_load_dwordx4 v[188:191], v3, s[8:11], s67 offen offset:3072 sc1
    s_add_u32 s67, s38, 49152
    buffer_load_dwordx4 v[192:195], v3, s[8:11], s67 offen offset:0 sc1
    buffer_load_dwordx4 v[196:199], v3, s[8:11], s67 offen offset:1024 sc1
    buffer_load_dwordx4 v[200:203], v3, s[8:11], s67 offen offset:2048 sc1
    buffer_load_dwordx4 v[204:207], v3, s[8:11], s67 offen offset:3072 sc1
    s_add_u32 s67, s38, 53248
    buffer_load_dwordx4 v[208:211], v3, s[8:11], s67 offen offset:0 sc1
    buffer_load_dwordx4 v[212:215], v3, s[8:11], s67 offen offset:1024 sc1
    buffer_load_dwordx4 v[216:219], v3, s[8:11], s67 offen offset:2048 sc1
    buffer_load_dwordx4 v[220:223], v3, s[8:11], s67 offen offset:3072 sc1
    s_add_u32 s67, s38, 57344
    buffer_load_dwordx4 v[224:227], v3, s[8:11], s67 offen offset:0 sc1
    buffer_load_dwordx4 v[228:231], v3, s[8:11], s67 offen offset:1024 sc1
    buffer_load_dwordx4 v[232:235], v3, s[8:11], s67 offen offset:2048 sc1
    buffer_load_dwordx4 v[236:239], v3, s[8:11], s67 offen offset:3072 sc1
kf_kernel_b_re1:
    v_lshlrev_b32_e64 v32, 16, v10
    v_and_b32 v33, 0xffff0000, v10
    v_lshlrev_b32_e64 v34, 16, v11
    v_and_b32 v35, 0xffff0000, v11
    v_lshlrev_b32_e64 v48, 16, v12
    v_and_b32 v49, 0xffff0000, v12
    v_lshlrev_b32_e64 v50, 16, v13
    v_and_b32 v51, 0xffff0000, v13
    s_waitcnt lgkmcnt(0)
    s_barrier
    ds_read_b128 v[76:79], v4 offset:3072
    ds_read_b128 v[88:91], v4 offset:4096
    s_waitcnt lgkmcnt(1)
    v_pk_add_f32 v[68:69], v[68:69], v[76:77]
    v_pk_add_f32 v[70:71], v[70:71], v[78:79]
    v_pk_fma_f32 v[32:33], v[68:69], v[36:37], v[32:33]
    v_pk_fma_f32 v[34:35], v[70:71], v[38:39], v[34:35]
    v_cvt_pk_bf16_f32 v10, v32, v33
    v_cvt_pk_bf16_f32 v11, v34, v35
    v_pk_mul_f32 v[32:33], v[32:33], v[80:81]
    v_pk_mul_f32 v[34:35], v[34:35], v[82:83]
    v_cvt_pk_bf16_f32 v16, v32, v33
    v_cvt_pk_bf16_f32 v17, v34, v35
    s_waitcnt lgkmcnt(0)
    v_pk_add_f32 v[72:73], v[72:73], v[88:89]
    v_pk_add_f32 v[74:75], v[74:75], v[90:91]
    v_pk_fma_f32 v[48:49], v[72:73], v[40:41], v[48:49]
    v_pk_fma_f32 v[50:51], v[74:75], v[42:43], v[50:51]
    v_cvt_pk_bf16_f32 v12, v48, v49
    v_cvt_pk_bf16_f32 v13, v50, v51
    v_pk_mul_f32 v[48:49], v[48:49], v[24:25]
    v_pk_mul_f32 v[50:51], v[50:51], v[26:27]
    v_cvt_pk_bf16_f32 v18, v48, v49
    v_cvt_pk_bf16_f32 v19, v50, v51
    buffer_store_dwordx4 v[16:19], v3, s[8:11], s30 offen offset:1024 sc1
    v_dot2_f32_bf16 v28, v10, v8, 0
    v_dot2_f32_bf16 v29, v10, v10, 0
    v_dot2_f32_bf16 v28, v11, v8, v28
    v_dot2_f32_bf16 v29, v11, v11, v29
    v_dot2_f32_bf16 v28, v12, v8, v28
    v_dot2_f32_bf16 v29, v12, v12, v29
    v_dot2_f32_bf16 v28, v13, v8, v28
    v_dot2_f32_bf16 v29, v13, v13, v29
    s_nop 2
    v_permlane32_swap_b32 v28, v29
    v_add_f32 v28, v28, v29
    v_mov_b32 v29, v28
    s_nop 1
    v_permlane16_swap_b32 v28, v29
    v_add_f32 v28, v28, v29
    v_mov_b32 v29, v28
    s_nop 1
    v_permlane32_swap_b32 v28, v29
    s_mov_b64 exec, 0xffff
    buffer_store_dwordx2 v[28:29], v9, s[8:11], s31 offen offset:128 sc1
    s_mov_b64 exec, -1
    s_cmp_eq_u32 s28, 3
    s_cbranch_scc1 kf_kernel_b_c1_1
    v_and_b32 v0, 1, v2
    v_lshl_add_u32 v0, v0, 6, v6
    v_add_u32 v0, 157696, v0
    v_add_u32 v8, 40960, v3
    v_add_u32 v4, 40960, v9
    s_mul_i32 s39, s16, 81920
    s_mul_i32 s30, s28, 5120
    s_add_u32 s39, s39, s30
    s_add_u32 s39, s39, 23527424
    s_waitcnt vmcnt(0)
    s_barrier
    ds_read_b128 v[56:59], v0 offset:0
    ds_read_b128 v[60:63], v0 offset:128
    ds_read_b128 v[64:67], v0 offset:256
    ds_read_b128 v[68:71], v0 offset:384
    ds_read_b128 v[72:75], v0 offset:512
    ds_read_b128 v[76:79], v0 offset:640
    ds_read_b128 v[80:83], v0 offset:768
    ds_read_b128 v[84:87], v0 offset:896
    s_waitcnt lgkmcnt(7)
    v_mfma_f32_16x16x32_bf16 v[48:51], v[160:163], v[56:59], 0
    v_mfma_f32_16x16x32_bf16 v[52:55], v[164:167], v[56:59], 0
    ds_read_b128 v[56:59], v0 offset:1024
    s_waitcnt lgkmcnt(7)
    v_mfma_f32_16x16x32_bf16 v[48:51], v[168:171], v[60:63], v[48:51]
    v_mfma_f32_16x16x32_bf16 v[52:55], v[172:175], v[60:63], v[52:55]
    ds_read_b128 v[60:63], v0 offset:1152
    s_waitcnt lgkmcnt(7)
    v_mfma_f32_16x16x32_bf16 v[48:51], v[176:179], v[64:67], v[48:51]
    v_mfma_f32_16x16x32_bf16 v[52:55], v[180:183], v[64:67], v[52:55]
    ds_read_b128 v[64:67], v0 offset:1280
    s_waitcnt lgkmcnt(7)
    v_mfma_f32_16x16x32_bf16 v[48:51], v[184:187], v[68:71], v[48:51]
    v_mfma_f32_16x16x32_bf16 v[52:55], v[188:191], v[68:71], v[52:55]
    ds_read_b128 v[68:71], v0 offset:1408
    s_waitcnt lgkmcnt(7)
    v_mfma_f32_16x16x32_bf16 v[48:51], v[192:195], v[72:75], v[48:51]
    v_mfma_f32_16x16x32_bf16 v[52:55], v[196:199], v[72:75], v[52:55]
    ds_read_b128 v[72:75], v0 offset:1536
    s_waitcnt lgkmcnt(7)
    v_mfma_f32_16x16x32_bf16 v[48:51], v[200:203], v[76:79], v[48:51]
    v_mfma_f32_16x16x32_bf16 v[52:55], v[204:207], v[76:79], v[52:55]
    ds_read_b128 v[76:79], v0 offset:1664
    s_waitcnt lgkmcnt(7)
    v_mfma_f32_16x16x32_bf16 v[48:51], v[208:211], v[80:83], v[48:51]
    v_mfma_f32_16x16x32_bf16 v[52:55], v[212:215], v[80:83], v[52:55]
    ds_read_b128 v[80:83], v0 offset:1792
    s_waitcnt lgkmcnt(7)
    v_mfma_f32_16x16x32_bf16 v[48:51], v[216:219], v[84:87], v[48:51]
    v_mfma_f32_16x16x32_bf16 v[52:55], v[220:223], v[84:87], v[52:55]
    ds_read_b128 v[84:87], v0 offset:1920
    s_waitcnt lgkmcnt(7)
    v_mfma_f32_16x16x32_bf16 v[48:51], v[224:227], v[56:59], v[48:51]
    v_mfma_f32_16x16x32_bf16 v[52:55], v[228:231], v[56:59], v[52:55]
    ds_read_b128 v[56:59], v0 offset:2048
    s_waitcnt lgkmcnt(7)
    v_mfma_f32_16x16x32_bf16 v[48:51], v[232:235], v[60:63], v[48:51]
    v_mfma_f32_16x16x32_bf16 v[52:55], v[236:239], v[60:63], v[52:55]
    ds_read_b128 v[60:63], v0 offset:2176
    s_waitcnt lgkmcnt(7)
    v_mfma_f32_16x16x32_bf16 v[48:51], v[240:243], v[64:67], v[48:51]
    v_mfma_f32_16x16x32_bf16 v[52:55], v[244:247], v[64:67], v[52:55]
    ds_read_b128 v[64:67], v0 offset:2304
    s_waitcnt lgkmcnt(7)
    v_mfma_f32_16x16x32_bf16 v[48:51], v[248:251], v[68:71], v[48:51]
    v_mfma_f32_16x16x32_bf16 v[52:55], v[252:255], v[68:71], v[52:55]
    ds_read_b128 v[68:71], v0 offset:2432
    s_waitcnt lgkmcnt(7)
    v_mfma_f32_16x16x32_bf16 v[48:51], v[116:119], v[72:75], v[48:51]
    v_mfma_f32_16x16x32_bf16 v[52:55], v[120:123], v[72:75], v[52:55]
    s_waitcnt lgkmcnt(6)
    v_mfma_f32_16x16x32_bf16 v[48:51], v[124:127], v[76:79], v[48:51]
    v_mfma_f32_16x16x32_bf16 v[52:55], v[128:131], v[76:79], v[52:55]
    s_waitcnt lgkmcnt(5)
    v_mfma_f32_16x16x32_bf16 v[48:51], v[140:143], v[80:83], v[48:51]
    v_mfma_f32_16x16x32_bf16 v[52:55], v[144:147], v[80:83], v[52:55]
    s_waitcnt lgkmcnt(4)
    v_mfma_f32_16x16x32_bf16 v[48:51], v[148:151], v[84:87], v[48:51]
    v_mfma_f32_16x16x32_bf16 v[52:55], v[152:155], v[84:87], v[52:55]
    s_waitcnt lgkmcnt(3)
    v_mfma_f32_16x16x32_bf16 v[48:51], v[132:135], v[56:59], v[48:51]
    v_mfma_f32_16x16x32_bf16 v[52:55], v[136:139], v[56:59], v[52:55]
    s_waitcnt lgkmcnt(2)
    v_mfma_f32_16x16x32_bf16 v[48:51], v[156:159], v[60:63], v[48:51]
    v_mfma_f32_16x16x32_bf16 v[52:55], v[96:99], v[60:63], v[52:55]
    s_waitcnt lgkmcnt(1)
    v_mfma_f32_16x16x32_bf16 v[48:51], v[100:103], v[64:67], v[48:51]
    v_mfma_f32_16x16x32_bf16 v[52:55], v[104:107], v[64:67], v[52:55]
    s_waitcnt lgkmcnt(0)
    v_mfma_f32_16x16x32_bf16 v[48:51], v[108:111], v[68:71], v[48:51]
    v_mfma_f32_16x16x32_bf16 v[52:55], v[112:115], v[68:71], v[52:55]
    s_barrier
    s_add_u32 m0, s30, 0
    s_nop 0
    buffer_load_dwordx4 v3, s[8:11], s39 offen offset:0 sc1 lds
    buffer_load_dwordx4 v3, s[8:11], s39 offen offset:1024 sc1 lds
    buffer_load_dwordx4 v3, s[8:11], s39 offen offset:2048 sc1 lds
    buffer_load_dwordx4 v3, s[8:11], s39 offen offset:3072 sc1 lds
    s_add_u32 m0, s30, 4096
    s_add_u32 s67, s39, 4096
    s_add_u32 s39, s39, 20480
    buffer_load_dwordx4 v3, s[8:11], s67 offen sc1 lds
    s_add_u32 m0, s30, 20480
    s_nop 0
    buffer_load_dwordx4 v3, s[8:11], s39 offen offset:0 sc1 lds
    buffer_load_dwordx4 v3, s[8:11], s39 offen offset:1024 sc1 lds
    buffer_load_dwordx4 v3, s[8:11], s39 offen offset:2048 sc1 lds
    buffer_load_dwordx4 v3, s[8:11], s39 offen offset:3072 sc1 lds
    s_add_u32 m0, s30, 24576
    s_add_u32 s67, s39, 4096
    s_add_u32 s39, s39, 20480
    buffer_load_dwordx4 v3, s[8:11], s67 offen sc1 lds
    s_add_u32 m0, s30, 40960
    s_nop 0
    buffer_load_dwordx4 v3, s[8:11], s39 offen offset:0 sc1 lds
    buffer_load_dwordx4 v3, s[8:11], s39 offen offset:1024 sc1 lds
    buffer_load_dwordx4 v3, s[8:11], s39 offen offset:2048 sc1 lds
    buffer_load_dwordx4 v3, s[8:11], s39 offen offset:3072 sc1 lds
    s_add_u32 m0, s30, 45056
    s_add_u32 s67, s39, 4096
    s_add_u32 s39, s39, 20480
    buffer_load_dwordx4 v3, s[8:11], s67 offen sc1 lds
    s_add_u32 m0, s30, 61440
    s_nop 0
    buffer_load_dwordx4 v3, s[8:11], s39 offen offset:0 sc1 lds
    buffer_load_dwordx4 v3, s[8:11], s39 offen offset:1024 sc1 lds
    buffer_load_dwordx4 v3, s[8:11], s39 offen offset:2048 sc1 lds
    buffer_load_dwordx4 v3, s[8:11], s39 offen offset:3072 sc1 lds
    s_add_u32 m0, s30, 65536
    s_add_u32 s67, s39, 4096
    s_add_u32 s39, s39, 20480
    buffer_load_dwordx4 v3, s[8:11], s67 offen sc1 lds
    s_waitcnt vmcnt(15)
    s_barrier
    s_waitcnt vmcnt(10)
    s_barrier
    s_waitcnt vmcnt(5)
    s_barrier
    s_waitcnt vmcnt(0)
    s_barrier
    v_mov_b32 v16, 162820
    s_mov_b32 s70, 0
kf_kernel_b_sphc02:
    ds_read_b32 v17, v16
    s_add_u32 s70, s70, zlit_b-zlit_a+(1)
    s_cmp_lt_u32 s70, 0x400000
    s_waitcnt lgkmcnt(0)
    v_cmp_ne_u32_e64 vcc, 3, v17
    s_cbranch_vccz kf_kernel_b_sqhc02
    s_sleep 1
    s_cbranch_scc1 kf_kernel_b_sphc02
kf_kernel_b_sqhc02:
    ds_read_b128 v[56:59], v3 offset:0
    ds_read_b128 v[60:63], v3 offset:2560
    ds_read_b128 v[64:67], v3 offset:5120
    ds_read_b128 v[68:71], v3 offset:7680
    ds_read_b128 v[72:75], v3 offset:1024
    ds_read_b128 v[76:79], v3 offset:3584
    ds_read_b128 v[80:83], v3 offset:6144
    ds_read_b128 v[84:87], v3 offset:8704
    ds_read_b128 v[88:91], v3 offset:10240
    ds_read_b128 v[92:95], v3 offset:12800
    s_waitcnt lgkmcnt(9)
    v_mfma_f32_16x16x32_bf16 v[16:19], v[160:163], v[56:59], 0
    v_mfma_f32_16x16x32_bf16 v[32:35], v[164:167], v[56:59], 0
    ds_read_b128 v[56:59], v3 offset:15360
    s_waitcnt lgkmcnt(9)
    v_mfma_f32_16x16x32_bf16 v[20:23], v[160:163], v[60:63], 0
    v_mfma_f32_16x16x32_bf16 v[36:39], v[164:167], v[60:63], 0
    ds_read_b128 v[60:63], v3 offset:17920
    s_waitcnt lgkmcnt(9)
    v_mfma_f32_16x16x32_bf16 v[24:27], v[160:163], v[64:67], 0
    v_mfma_f32_16x16x32_bf16 v[40:43], v[164:167], v[64:67], 0
    ds_read_b128 v[64:67], v3 offset:11264
    s_waitcnt lgkmcnt(9)
    v_mfma_f32_16x16x32_bf16 v[28:31], v[160:163], v[68:71], 0
    v_mfma_f32_16x16x32_bf16 v[44:47], v[164:167], v[68:71], 0
    ds_read_b128 v[68:71], v3 offset:13824
    s_waitcnt lgkmcnt(9)
    v_mfma_f32_16x16x32_bf16 v[16:19], v[168:171], v[72:75], v[16:19]
    v_mfma_f32_16x16x32_bf16 v[32:35], v[172:175], v[72:75], v[32:35]
    ds_read_b128 v[72:75], v3 offset:16384
    s_add_u32 s67, s38, 4096
    buffer_load_dwordx4 v[160:163], v3, s[8:11], s67 offen offset:0 sc1
    s_waitcnt lgkmcnt(9)
    v_mfma_f32_16x16x32_bf16 v[20:23], v[168:171], v[76:79], v[20:23]
    v_mfma_f32_16x16x32_bf16 v[36:39], v[172:175], v[76:79], v[36:39]
    ds_read_b128 v[76:79], v3 offset:18944
    s_add_u32 s67, s38, 4096
    buffer_load_dwordx4 v[164:167], v3, s[8:11], s67 offen offset:1024 sc1
    s_waitcnt lgkmcnt(9)
    v_mfma_f32_16x16x32_bf16 v[24:27], v[168:171], v[80:83], v[24:27]
    v_mfma_f32_16x16x32_bf16 v[40:43], v[172:175], v[80:83], v[40:43]
    ds_read_b64 v[80:81], v9 offset:2048
    ds_read_b64 v[82:83], v9 offset:12288
    s_waitcnt lgkmcnt(10)
    v_mfma_f32_16x16x32_bf16 v[28:31], v[168:171], v[84:87], v[28:31]
    v_mfma_f32_16x16x32_bf16 v[44:47], v[172:175], v[84:87], v[44:47]
    ds_read_b64 v[84:85], v9 offset:4608
    ds_read_b64 v[86:87], v9 offset:14848
    s_waitcnt lgkmcnt(11)
    v_mfma_f32_16x16x32_bf16 v[16:19], v[176:179], v[88:91], v[16:19]
    v_mfma_f32_16x16x32_bf16 v[32:35], v[180:183], v[88:91], v[32:35]
    ds_read_b64 v[88:89], v9 offset:7168
    ds_read_b64 v[90:91], v9 offset:17408
    s_add_u32 s67, s38, 4096
    buffer_load_dwordx4 v[168:171], v3, s[8:11], s67 offen offset:2048 sc1
    s_waitcnt lgkmcnt(12)
    v_mfma_f32_16x16x32_bf16 v[20:23], v[176:179], v[92:95], v[20:23]
    v_mfma_f32_16x16x32_bf16 v[36:39], v[180:183], v[92:95], v[36:39]
    ds_read_b64 v[92:93], v9 offset:9728
    ds_read_b64 v[94:95], v9 offset:19968
    s_add_u32 s67, s38, 4096
    buffer_load_dwordx4 v[172:175], v3, s[8:11], s67 offen offset:3072 sc1
    s_waitcnt lgkmcnt(13)
    v_mfma_f32_16x16x32_bf16 v[24:27], v[176:179], v[56:59], v[24:27]
    v_mfma_f32_16x16x32_bf16 v[40:43], v[180:183], v[56:59], v[40:43]
    ds_read_b128 v[56:59], v3 offset:20480
    s_waitcnt lgkmcnt(13)
    v_mfma_f32_16x16x32_bf16 v[28:31], v[176:179], v[60:63], v[28:31]
    v_mfma_f32_16x16x32_bf16 v[44:47], v[180:183], v[60:63], v[44:47]
    ds_read_b128 v[60:63], v3 offset:23040
    s_waitcnt lgkmcnt(13)
    v_mfma_f32_16x16x32_bf16 v[16:19], v[184:187], v[64:67], v[16:19]
    v_mfma_f32_16x16x32_bf16 v[32:35], v[188:191], v[64:67], v[32:35]
    ds_read_b128 v[64:67], v3 offset:25600
    s_add_u32 s67, s38, 45056
    buffer_load_dwordx4 v[176:179], v3, s[8:11], s67 offen offset:0 sc1
    s_waitcnt lgkmcnt(13)
    v_mfma_f32_16x16x32_bf16 v[20:23], v[184:187], v[68:71], v[20:23]
    v_mfma_f32_16x16x32_bf16 v[36:39], v[188:191], v[68:71], v[36:39]
    ds_read_b128 v[68:71], v3 offset:28160
    s_add_u32 s67, s38, 45056
    buffer_load_dwordx4 v[180:183], v3, s[8:11], s67 offen offset:1024 sc1
    s_waitcnt lgkmcnt(13)
    v_mfma_f32_16x16x32_bf16 v[24:27], v[184:187], v[72:75], v[24:27]
    v_mfma_f32_16x16x32_bf16 v[40:43], v[188:191], v[72:75], v[40:43]
    ds_read_b128 v[72:75], v3 offset:21504
    s_waitcnt lgkmcnt(13)
    v_mfma_f32_16x16x32_bf16 v[28:31], v[184:187], v[76:79], v[28:31]
    v_mfma_f32_16x16x32_bf16 v[44:47], v[188:191], v[76:79], v[44:47]
    ds_read_b128 v[76:79], v3 offset:24064
    s_waitcnt lgkmcnt(12)
    v_mfma_f32_16x16x32_bf16 v[16:19], v[192:195], v[80:83], v[16:19]
    v_mfma_f32_16x16x32_bf16 v[32:35], v[196:199], v[80:83], v[32:35]
    ds_read_b128 v[80:83], v3 offset:26624
    s_add_u32 s67, s38, 45056
    buffer_load_dwordx4 v[184:187], v3, s[8:11], s67 offen offset:2048 sc1
    s_waitcnt lgkmcnt(11)
    v_mfma_f32_16x16x32_bf16 v[20:23], v[192:195], v[84:87], v[20:23]
    v_mfma_f32_16x16x32_bf16 v[36:39], v[196:199], v[84:87], v[36:39]
    ds_read_b128 v[84:87], v3 offset:29184
    s_add_u32 s67, s38, 45056
    buffer_load_dwordx4 v[188:191], v3, s[8:11], s67 offen offset:3072 sc1
    s_waitcnt lgkmcnt(10)
    v_mfma_f32_16x16x32_bf16 v[24:27], v[192:195], v[88:91], v[24:27]
    v_mfma_f32_16x16x32_bf16 v[40:43], v[196:199], v[88:91], v[40:43]
    ds_read_b128 v[88:91], v3 offset:30720
    s_waitcnt lgkmcnt(9)
    v_mfma_f32_16x16x32_bf16 v[28:31], v[192:195], v[92:95], v[28:31]
    v_mfma_f32_16x16x32_bf16 v[44:47], v[196:199], v[92:95], v[44:47]
    ds_read_b128 v[92:95], v3 offset:33280
    s_waitcnt lgkmcnt(9)
    v_mfma_f32_16x16x32_bf16 v[16:19], v[200:203], v[56:59], v[16:19]
    v_mfma_f32_16x16x32_bf16 v[32:35], v[204:207], v[56:59], v[32:35]
    ds_read_b128 v[56:59], v3 offset:35840
    s_add_u32 s67, s38, 49152
    buffer_load_dwordx4 v[192:195], v3, s[8:11], s67 offen offset:0 sc1
    s_waitcnt lgkmcnt(9)
    v_mfma_f32_16x16x32_bf16 v[20:23], v[200:203], v[60:63], v[20:23]
    v_mfma_f32_16x16x32_bf16 v[36:39], v[204:207], v[60:63], v[36:39]
    ds_read_b128 v[60:63], v3 offset:38400
    s_add_u32 s67, s38, 49152
    buffer_load_dwordx4 v[196:199], v3, s[8:11], s67 offen offset:1024 sc1
    s_waitcnt lgkmcnt(9)
    v_mfma_f32_16x16x32_bf16 v[24:27], v[200:203], v[64:67], v[24:27]
    v_mfma_f32_16x16x32_bf16 v[40:43], v[204:207], v[64:67], v[40:43]
    ds_read_b128 v[64:67], v3 offset:31744
    s_waitcnt lgkmcnt(9)
    v_mfma_f32_16x16x32_bf16 v[28:31], v[200:203], v[68:71], v[28:31]
    v_mfma_f32_16x16x32_bf16 v[44:47], v[204:207], v[68:71], v[44:47]
    ds_read_b128 v[68:71], v3 offset:34304
    s_waitcnt lgkmcnt(9)
    v_mfma_f32_16x16x32_bf16 v[16:19], v[208:211], v[72:75], v[16:19]
    v_mfma_f32_16x16x32_bf16 v[32:35], v[212:215], v[72:75], v[32:35]
    ds_read_b128 v[72:75], v3 offset:36864
    s_add_u32 s67, s38, 49152
    buffer_load_dwordx4 v[200:203], v3, s[8:11], s67 offen offset:2048 sc1
    s_waitcnt lgkmcnt(9)
    v_mfma_f32_16x16x32_bf16 v[20:23], v[208:211], v[76:79], v[20:23]
    v_mfma_f32_16x16x32_bf16 v[36:39], v[212:215], v[76:79], v[36:39]
    ds_read_b128 v[76:79], v3 offset:39424
    s_add_u32 s67, s38, 49152
    buffer_load_dwordx4 v[204:207], v3, s[8:11], s67 offen offset:3072 sc1
    s_waitcnt lgkmcnt(9)
    v_mfma_f32_16x16x32_bf16 v[24:27], v[208:211], v[80:83], v[24:27]
    v_mfma_f32_16x16x32_bf16 v[40:43], v[212:215], v[80:83], v[40:43]
    ds_read_b64 v[80:81], v9 offset:22528
    ds_read_b64 v[82:83], v9 offset:32768
    s_waitcnt lgkmcnt(10)
    v_mfma_f32_16x16x32_bf16 v[28:31], v[208:211], v[84:87], v[28:31]
    v_mfma_f32_16x16x32_bf16 v[44:47], v[212:215], v[84:87], v[44:47]
    ds_read_b64 v[84:85], v9 offset:25088
    ds_read_b64 v[86:87], v9 offset:35328
    s_waitcnt lgkmcnt(11)
    v_mfma_f32_16x16x32_bf16 v[16:19], v[216:219], v[88:91], v[16:19]
    v_mfma_f32_16x16x32_bf16 v[32:35], v[220:223], v[88:91], v[32:35]
    ds_read_b64 v[88:89], v9 offset:27648
    ds_read_b64 v[90:91], v9 offset:37888
    s_add_u32 s67, s38, 53248
    buffer_load_dwordx4 v[208:211], v3, s[8:11], s67 offen offset:0 sc1
    s_waitcnt lgkmcnt(12)
    v_mfma_f32_16x16x32_bf16 v[20:23], v[216:219], v[92:95], v[20:23]
    v_mfma_f32_16x16x32_bf16 v[36:39], v[220:223], v[92:95], v[36:39]
    ds_read_b64 v[92:93], v9 offset:30208
    ds_read_b64 v[94:95], v9 offset:40448
    s_add_u32 s67, s38, 53248
    buffer_load_dwordx4 v[212:215], v3, s[8:11], s67 offen offset:1024 sc1
    s_waitcnt lgkmcnt(13)
    v_mfma_f32_16x16x32_bf16 v[24:27], v[216:219], v[56:59], v[24:27]
    v_mfma_f32_16x16x32_bf16 v[40:43], v[220:223], v[56:59], v[40:43]
    ds_read_b128 v[56:59], v8 offset:0
    s_waitcnt lgkmcnt(13)
    v_mfma_f32_16x16x32_bf16 v[28:31], v[216:219], v[60:63], v[28:31]
    v_mfma_f32_16x16x32_bf16 v[44:47], v[220:223], v[60:63], v[44:47]
    ds_read_b128 v[60:63], v8 offset:2560
    s_waitcnt lgkmcnt(13)
    v_mfma_f32_16x16x32_bf16 v[16:19], v[224:227], v[64:67], v[16:19]
    v_mfma_f32_16x16x32_bf16 v[32:35], v[228:231], v[64:67], v[32:35]
    ds_read_b128 v[64:67], v8 offset:5120
    s_add_u32 s67, s38, 53248
    buffer_load_dwordx4 v[216:219], v3, s[8:11], s67 offen offset:2048 sc1
    s_waitcnt lgkmcnt(13)
    v_mfma_f32_16x16x32_bf16 v[20:23], v[224:227], v[68:71], v[20:23]
    v_mfma_f32_16x16x32_bf16 v[36:39], v[228:231], v[68:71], v[36:39]
    ds_read_b128 v[68:71], v8 offset:7680
    s_add_u32 s67, s38, 53248
    buffer_load_dwordx4 v[220:223], v3, s[8:11], s67 offen offset:3072 sc1
    s_waitcnt lgkmcnt(13)
    v_mfma_f32_16x16x32_bf16 v[24:27], v[224:227], v[72:75], v[24:27]
    v_mfma_f32_16x16x32_bf16 v[40:43], v[228:231], v[72:75], v[40:43]
    ds_read_b128 v[72:75], v8 offset:1024
    s_waitcnt lgkmcnt(13)
    v_mfma_f32_16x16x32_bf16 v[28:31], v[224:227], v[76:79], v[28:31]
    v_mfma_f32_16x16x32_bf16 v[44:47], v[228:231], v[76:79], v[44:47]
    ds_read_b128 v[76:79], v8 offset:3584
    s_waitcnt lgkmcnt(12)
    v_mfma_f32_16x16x32_bf16 v[16:19], v[232:235], v[80:83], v[16:19]
    v_mfma_f32_16x16x32_bf16 v[32:35], v[236:239], v[80:83], v[32:35]
    ds_read_b128 v[80:83], v8 offset:6144
    s_add_u32 s67, s38, 57344
    buffer_load_dwordx4 v[224:227], v3, s[8:11], s67 offen offset:0 sc1
    s_waitcnt lgkmcnt(11)
    v_mfma_f32_16x16x32_bf16 v[20:23], v[232:235], v[84:87], v[20:23]
    v_mfma_f32_16x16x32_bf16 v[36:39], v[236:239], v[84:87], v[36:39]
    ds_read_b128 v[84:87], v8 offset:8704
    s_add_u32 s67, s38, 57344
    buffer_load_dwordx4 v[228:231], v3, s[8:11], s67 offen offset:1024 sc1
    s_waitcnt lgkmcnt(10)
    v_mfma_f32_16x16x32_bf16 v[24:27], v[232:235], v[88:91], v[24:27]
    v_mfma_f32_16x16x32_bf16 v[40:43], v[236:239], v[88:91], v[40:43]
    ds_read_b128 v[88:91], v8 offset:10240
    s_waitcnt lgkmcnt(9)
    v_mfma_f32_16x16x32_bf16 v[28:31], v[232:235], v[92:95], v[28:31]
    v_mfma_f32_16x16x32_bf16 v[44:47], v[236:239], v[92:95], v[44:47]
    ds_read_b128 v[92:95], v8 offset:12800
    s_waitcnt lgkmcnt(9)
    v_mfma_f32_16x16x32_bf16 v[16:19], v[240:243], v[56:59], v[16:19]
    v_mfma_f32_16x16x32_bf16 v[32:35], v[244:247], v[56:59], v[32:35]
    ds_read_b128 v[56:59], v8 offset:15360
    s_add_u32 s67, s38, 57344
    buffer_load_dwordx4 v[232:235], v3, s[8:11], s67 offen offset:2048 sc1
    s_waitcnt lgkmcnt(9)
    v_mfma_f32_16x16x32_bf16 v[20:23], v[240:243], v[60:63], v[20:23]
    v_mfma_f32_16x16x32_bf16 v[36:39], v[244:247], v[60:63], v[36:39]
    ds_read_b128 v[60:63], v8 offset:17920
    s_add_u32 s67, s38, 57344
    buffer_load_dwordx4 v[236:239], v3, s[8:11], s67 offen offset:3072 sc1
    s_waitcnt lgkmcnt(9)
    v_mfma_f32_16x16x32_bf16 v[24:27], v[240:243], v[64:67], v[24:27]
    v_mfma_f32_16x16x32_bf16 v[40:43], v[244:247], v[64:67], v[40:43]
    ds_read_b128 v[64:67], v8 offset:11264
    s_waitcnt lgkmcnt(9)
    v_mfma_f32_16x16x32_bf16 v[28:31], v[240:243], v[68:71], v[28:31]
    v_mfma_f32_16x16x32_bf16 v[44:47], v[244:247], v[68:71], v[44:47]
    ds_read_b128 v[68:71], v8 offset:13824
    s_waitcnt lgkmcnt(9)
    v_mfma_f32_16x16x32_bf16 v[16:19], v[248:251], v[72:75], v[16:19]
    v_mfma_f32_16x16x32_bf16 v[32:35], v[252:255], v[72:75], v[32:35]
    ds_read_b128 v[72:75], v8 offset:16384
    s_add_u32 s67, s38, 61440
    buffer_load_dwordx4 v[240:243], v3, s[8:11], s67 offen offset:0 sc1
    s_waitcnt lgkmcnt(9)
    v_mfma_f32_16x16x32_bf16 v[20:23], v[248:251], v[76:79], v[20:23]
    v_mfma_f32_16x16x32_bf16 v[36:39], v[252:255], v[76:79], v[36:39]
    ds_read_b128 v[76:79], v8 offset:18944
    s_add_u32 s67, s38, 61440
    buffer_load_dwordx4 v[244:247], v3, s[8:11], s67 offen offset:1024 sc1
    s_waitcnt lgkmcnt(9)
    v_mfma_f32_16x16x32_bf16 v[24:27], v[248:251], v[80:83], v[24:27]
    v_mfma_f32_16x16x32_bf16 v[40:43], v[252:255], v[80:83], v[40:43]
    ds_read_b64 v[80:81], v4 offset:2048
    ds_read_b64 v[82:83], v4 offset:12288
    s_waitcnt lgkmcnt(10)
    v_mfma_f32_16x16x32_bf16 v[28:31], v[248:251], v[84:87], v[28:31]
    v_mfma_f32_16x16x32_bf16 v[44:47], v[252:255], v[84:87], v[44:47]
    ds_read_b64 v[84:85], v4 offset:4608
    ds_read_b64 v[86:87], v4 offset:14848
    s_waitcnt lgkmcnt(11)
    v_mfma_f32_16x16x32_bf16 v[16:19], v[116:119], v[88:91], v[16:19]
    v_mfma_f32_16x16x32_bf16 v[32:35], v[120:123], v[88:91], v[32:35]
    ds_read_b64 v[88:89], v4 offset:7168
    ds_read_b64 v[90:91], v4 offset:17408
    s_add_u32 s67, s38, 61440
    buffer_load_dwordx4 v[248:251], v3, s[8:11], s67 offen offset:2048 sc1
    s_waitcnt lgkmcnt(12)
    v_mfma_f32_16x16x32_bf16 v[20:23], v[116:119], v[92:95], v[20:23]
    v_mfma_f32_16x16x32_bf16 v[36:39], v[120:123], v[92:95], v[36:39]
    ds_read_b64 v[92:93], v4 offset:9728
    ds_read_b64 v[94:95], v4 offset:19968
    s_add_u32 s67, s38, 61440
    buffer_load_dwordx4 v[252:255], v3, s[8:11], s67 offen offset:3072 sc1
    s_waitcnt lgkmcnt(13)
    v_mfma_f32_16x16x32_bf16 v[24:27], v[116:119], v[56:59], v[24:27]
    v_mfma_f32_16x16x32_bf16 v[40:43], v[120:123], v[56:59], v[40:43]
    ds_read_b128 v[56:59], v8 offset:20480
    s_waitcnt lgkmcnt(13)
    v_mfma_f32_16x16x32_bf16 v[28:31], v[116:119], v[60:63], v[28:31]
    v_mfma_f32_16x16x32_bf16 v[44:47], v[120:123], v[60:63], v[44:47]
    ds_read_b128 v[60:63], v8 offset:23040
    s_waitcnt lgkmcnt(13)
    v_mfma_f32_16x16x32_bf16 v[16:19], v[124:127], v[64:67], v[16:19]
    v_mfma_f32_16x16x32_bf16 v[32:35], v[128:131], v[64:67], v[32:35]
    ds_read_b128 v[64:67], v8 offset:25600
    s_waitcnt lgkmcnt(13)
    v_mfma_f32_16x16x32_bf16 v[20:23], v[124:127], v[68:71], v[20:23]
    v_mfma_f32_16x16x32_bf16 v[36:39], v[128:131], v[68:71], v[36:39]
    ds_read_b128 v[68:71], v8 offset:28160
    s_waitcnt lgkmcnt(13)
    v_mfma_f32_16x16x32_bf16 v[24:27], v[124:127], v[72:75], v[24:27]
    v_mfma_f32_16x16x32_bf16 v[40:43], v[128:131], v[72:75], v[40:43]
    ds_read_b128 v[72:75], v8 offset:21504
    s_waitcnt lgkmcnt(13)
    v_mfma_f32_16x16x32_bf16 v[28:31], v[124:127], v[76:79], v[28:31]
    v_mfma_f32_16x16x32_bf16 v[44:47], v[128:131], v[76:79], v[44:47]
    ds_read_b128 v[76:79], v8 offset:24064
    s_waitcnt lgkmcnt(12)
    v_mfma_f32_16x16x32_bf16 v[16:19], v[140:143], v[80:83], v[16:19]
    v_mfma_f32_16x16x32_bf16 v[32:35], v[144:147], v[80:83], v[32:35]
    ds_read_b128 v[80:83], v8 offset:26624
    s_waitcnt lgkmcnt(11)
    v_mfma_f32_16x16x32_bf16 v[20:23], v[140:143], v[84:87], v[20:23]
    v_mfma_f32_16x16x32_bf16 v[36:39], v[144:147], v[84:87], v[36:39]
    ds_read_b128 v[84:87], v8 offset:29184
    s_waitcnt lgkmcnt(10)
    v_mfma_f32_16x16x32_bf16 v[24:27], v[140:143], v[88:91], v[24:27]
    v_mfma_f32_16x16x32_bf16 v[40:43], v[144:147], v[88:91], v[40:43]
    ds_read_b128 v[88:91], v8 offset:30720
    s_waitcnt lgkmcnt(9)
    v_mfma_f32_16x16x32_bf16 v[28:31], v[140:143], v[92:95], v[28:31]
    v_mfma_f32_16x16x32_bf16 v[44:47], v[144:147], v[92:95], v[44:47]
    ds_read_b128 v[92:95], v8 offset:33280
    s_waitcnt lgkmcnt(9)
    v_mfma_f32_16x16x32_bf16 v[16:19], v[148:151], v[56:59], v[16:19]
    v_mfma_f32_16x16x32_bf16 v[32:35], v[152:155], v[56:59], v[32:35]
    ds_read_b128 v[56:59], v8 offset:35840
    s_add_u32 s67, s38, 0
    buffer_load_dwordx4 v[144:147], v3, s[8:11], s67 offen offset:0 sc1
    s_waitcnt lgkmcnt(9)
    v_mfma_f32_16x16x32_bf16 v[20:23], v[148:151], v[60:63], v[20:23]
    v_mfma_f32_16x16x32_bf16 v[36:39], v[152:155], v[60:63], v[36:39]
    ds_read_b128 v[60:63], v8 offset:38400
    s_waitcnt lgkmcnt(9)
    v_mfma_f32_16x16x32_bf16 v[24:27], v[148:151], v[64:67], v[24:27]
    v_mfma_f32_16x16x32_bf16 v[40:43], v[152:155], v[64:67], v[40:43]
    ds_read_b128 v[64:67], v8 offset:31744
    s_waitcnt lgkmcnt(9)
    v_mfma_f32_16x16x32_bf16 v[28:31], v[148:151], v[68:71], v[28:31]
    v_mfma_f32_16x16x32_bf16 v[44:47], v[152:155], v[68:71], v[44:47]
    ds_read_b128 v[68:71], v8 offset:34304
    s_waitcnt lgkmcnt(9)
    v_mfma_f32_16x16x32_bf16 v[16:19], v[132:135], v[72:75], v[16:19]
    v_mfma_f32_16x16x32_bf16 v[32:35], v[136:139], v[72:75], v[32:35]
    ds_read_b128 v[72:75], v8 offset:36864
    s_add_u32 s67, s38, zlit_b-zlit_a+(0)
    buffer_load_dwordx4 v[148:151], v3, s[8:11], s67 offen offset:1024 sc1
    s_waitcnt lgkmcnt(9)
    v_mfma_f32_16x16x32_bf16 v[20:23], v[132:135], v[76:79], v[20:23]
    v_mfma_f32_16x16x32_bf16 v[36:39], v[136:139], v[76:79], v[36:39]
    ds_read_b128 v[76:79], v8 offset:39424
    s_add_u32 s67, s38, 0
    buffer_load_dwordx4 v[152:155], v3, s[8:11], s67 offen offset:2048 sc1
    s_waitcnt lgkmcnt(9)
    v_mfma_f32_16x16x32_bf16 v[24:27], v[132:135], v[80:83], v[24:27]
    v_mfma_f32_16x16x32_bf16 v[40:43], v[136:139], v[80:83], v[40:43]
    ds_read_b64 v[80:81], v4 offset:22528
    ds_read_b64 v[82:83], v4 offset:32768
    s_waitcnt lgkmcnt(10)
    v_mfma_f32_16x16x32_bf16 v[28:31], v[132:135], v[84:87], v[28:31]
    v_mfma_f32_16x16x32_bf16 v[44:47], v[136:139], v[84:87], v[44:47]
    ds_read_b64 v[84:85], v4 offset:25088
    ds_read_b64 v[86:87], v4 offset:35328
    s_waitcnt lgkmcnt(11)
    v_mfma_f32_16x16x32_bf16 v[16:19], v[156:159], v[88:91], v[16:19]
    v_mfma_f32_16x16x32_bf16 v[32:35], v[96:99], v[88:91], v[32:35]
    ds_read_b64 v[88:89], v4 offset:27648
    ds_read_b64 v[90:91], v4 offset:37888
    s_waitcnt lgkmcnt(12)
    v_mfma_f32_16x16x32_bf16 v[20:23], v[156:159], v[92:95], v[20:23]
    v_mfma_f32_16x16x32_bf16 v[36:39], v[96:99], v[92:95], v[36:39]
    ds_read_b64 v[92:93], v4 offset:30208
    ds_read_b64 v[94:95], v4 offset:40448
    s_waitcnt lgkmcnt(13)
    v_mfma_f32_16x16x32_bf16 v[24:27], v[156:159], v[56:59], v[24:27]
    v_mfma_f32_16x16x32_bf16 v[40:43], v[96:99], v[56:59], v[40:43]
    s_waitcnt lgkmcnt(12)
    v_mfma_f32_16x16x32_bf16 v[28:31], v[156:159], v[60:63], v[28:31]
    v_mfma_f32_16x16x32_bf16 v[44:47], v[96:99], v[60:63], v[44:47]
    s_waitcnt lgkmcnt(11)
    v_mfma_f32_16x16x32_bf16 v[16:19], v[100:103], v[64:67], v[16:19]
    v_mfma_f32_16x16x32_bf16 v[32:35], v[104:107], v[64:67], v[32:35]
    s_add_u32 s67, s38, 0
    buffer_load_dwordx4 v[156:159], v3, s[8:11], s67 offen offset:3072 sc1
    s_waitcnt lgkmcnt(10)
    v_mfma_f32_16x16x32_bf16 v[20:23], v[100:103], v[68:71], v[20:23]
    v_mfma_f32_16x16x32_bf16 v[36:39], v[104:107], v[68:71], v[36:39]
    s_waitcnt lgkmcnt(9)
    v_mfma_f32_16x16x32_bf16 v[24:27], v[100:103], v[72:75], v[24:27]
    v_mfma_f32_16x16x32_bf16 v[40:43], v[104:107], v[72:75], v[40:43]
    s_waitcnt lgkmcnt(8)
    v_mfma_f32_16x16x32_bf16 v[28:31], v[100:103], v[76:79], v[28:31]
    v_mfma_f32_16x16x32_bf16 v[44:47], v[104:107], v[76:79], v[44:47]
    s_waitcnt lgkmcnt(6)
    v_mfma_f32_16x16x32_bf16 v[16:19], v[108:111], v[80:83], v[16:19]
    v_mfma_f32_16x16x32_bf16 v[32:35], v[112:115], v[80:83], v[32:35]
    s_waitcnt lgkmcnt(4)
    v_mfma_f32_16x16x32_bf16 v[20:23], v[108:111], v[84:87], v[20:23]
    v_mfma_f32_16x16x32_bf16 v[36:39], v[112:115], v[84:87], v[36:39]
    s_waitcnt lgkmcnt(2)
    v_mfma_f32_16x16x32_bf16 v[24:27], v[108:111], v[88:91], v[24:27]
    v_mfma_f32_16x16x32_bf16 v[40:43], v[112:115], v[88:91], v[40:43]
    s_waitcnt lgkmcnt(0)
    v_mfma_f32_16x16x32_bf16 v[28:31], v[108:111], v[92:95], v[28:31]
    v_mfma_f32_16x16x32_bf16 v[44:47], v[112:115], v[92:95], v[44:47]
    v_mov_b32 v88, 162816
    v_mov_b32_e64 v89, 1
    s_mov_b64 exec, 1
    ds_add_u32 v88, v89
    s_mov_b64 exec, -1
    v_add_u32 v0, 161792, v7
    ds_read_b64 v[80:81], v0 offset:0
    ds_read_b64 v[82:83], v0 offset:128
    ds_read_b64 v[84:85], v0 offset:256
    ds_read_b64 v[86:87], v0 offset:384
    v_mov_b32_dpp v56, v48 quad_perm:[1,1,3,3] row_mask:0xf bank_mask:0xf
    v_mov_b32_dpp v57, v49 quad_perm:[1,1,3,3] row_mask:0xf bank_mask:0xf
    v_mov_b32_dpp v58, v50 quad_perm:[1,1,3,3] row_mask:0xf bank_mask:0xf
    v_mov_b32_dpp v59, v51 quad_perm:[1,1,3,3] row_mask:0xf bank_mask:0xf
    v_mov_b32_dpp v60, v52 quad_perm:[1,1,3,3] row_mask:0xf bank_mask:0xf
    v_mov_b32_dpp v61, v53 quad_perm:[1,1,3,3] row_mask:0xf bank_mask:0xf
    v_mov_b32_dpp v62, v54 quad_perm:[1,1,3,3] row_mask:0xf bank_mask:0xf
    v_mov_b32_dpp v63, v55 quad_perm:[1,1,3,3] row_mask:0xf bank_mask:0xf
    v_mov_b32_dpp v48, v48 quad_perm:[0,0,2,2] row_mask:0xf bank_mask:0xf
    v_mov_b32_dpp v49, v49 quad_perm:[0,0,2,2] row_mask:0xf bank_mask:0xf
    v_mov_b32_dpp v50, v50 quad_perm:[0,0,2,2] row_mask:0xf bank_mask:0xf
    v_mov_b32_dpp v51, v51 quad_perm:[0,0,2,2] row_mask:0xf bank_mask:0xf
    v_mov_b32_dpp v52, v52 quad_perm:[0,0,2,2] row_mask:0xf bank_mask:0xf
    v_mov_b32_dpp v53, v53 quad_perm:[0,0,2,2] row_mask:0xf bank_mask:0xf
    v_mov_b32_dpp v54, v54 quad_perm:[0,0,2,2] row_mask:0xf bank_mask:0xf
    v_mov_b32_dpp v55, v55 quad_perm:[0,0,2,2] row_mask:0xf bank_mask:0xf
    v_mov_b32 v88, 162816
    s_mov_b32 s70, 0
kf_kernel_b_spxc02:
    ds_read_b32 v89, v88
    s_add_u32 s70, s70, zlit_b-zlit_a+(1)
    s_cmp_lt_u32 s70, 0x400000
    s_waitcnt lgkmcnt(0)
    v_cmp_ne_u32_e64 vcc, 8, v89
    s_cbranch_vccz kf_kernel_b_sqxc02
    s_sleep 1
    s_cbranch_scc1 kf_kernel_b_spxc02
kf_kernel_b_sqxc02:
    v_pk_fma_f32 v[16:17], v[48:49], v[80:81], v[16:17] op_sel:[0,0,0] op_sel_hi:[1,0,1]
    v_pk_fma_f32 v[18:19], v[50:51], v[80:81], v[18:19] op_sel:[0,0,0] op_sel_hi:[1,0,1]
    v_pk_fma_f32 v[16:17], v[80:81], v[16:17], v[56:57] op_sel:[1,0,0] op_sel_hi:[1,1,1]
    v_pk_fma_f32 v[18:19], v[80:81], v[18:19], v[58:59] op_sel:[1,0,0] op_sel_hi:[1,1,1]
    v_pk_mul_f32 v[88:89], v[16:17], v[16:17]
    v_pk_mul_f32 v[90:91], v[18:19], v[18:19]
    v_pk_fma_f32 v[88:89], v[88:89], s[34:35], s[34:35] op_sel:[0,0,1] op_sel_hi:[1,0,1]
    v_pk_fma_f32 v[90:91], v[90:91], s[34:35], s[34:35] op_sel:[0,0,1] op_sel_hi:[1,0,1]
    v_pk_mul_f32 v[88:89], v[88:89], v[16:17]
    v_pk_mul_f32 v[90:91], v[90:91], v[18:19]
    v_exp_f32 v88, v88
    v_exp_f32 v89, v89
    v_exp_f32 v90, v90
    v_exp_f32 v91, v91
    v_pk_add_f32 v[88:89], v[88:89], s[36:37]
    v_pk_add_f32 v[90:91], v[90:91], s[36:37]
    v_rcp_f32 v88, v88
    v_rcp_f32 v89, v89
    v_rcp_f32 v90, v90
    v_rcp_f32 v91, v91
    v_pk_mul_f32 v[16:17], v[16:17], v[88:89]
    v_pk_mul_f32 v[18:19], v[18:19], v[90:91]
    v_cvt_pk_bf16_f32 v64, v16, v17
    v_cvt_pk_bf16_f32 v65, v18, v19
    s_add_u32 m0, s40, zlit_b-zlit_a+(0)
    s_add_u32 s67, s38, 24576
    buffer_load_dwordx4 v3, s[8:11], s67 offen offset:0 sc1 lds
    buffer_load_dwordx4 v3, s[8:11], s67 offen offset:1024 sc1 lds
    buffer_load_dwordx4 v3, s[8:11], s67 offen offset:2048 sc1 lds
    buffer_load_dwordx4 v3, s[8:11], s67 offen offset:3072 sc1 lds
    v_pk_fma_f32 v[20:21], v[48:49], v[82:83], v[20:21] op_sel:[0,0,0] op_sel_hi:[1,0,1]
    v_pk_fma_f32 v[22:23], v[50:51], v[82:83], v[22:23] op_sel:[0,0,0] op_sel_hi:[1,0,1]
    v_pk_fma_f32 v[20:21], v[82:83], v[20:21], v[56:57] op_sel:[1,0,0] op_sel_hi:[1,1,1]
    v_pk_fma_f32 v[22:23], v[82:83], v[22:23], v[58:59] op_sel:[1,0,0] op_sel_hi:[1,1,1]
    v_pk_mul_f32 v[92:93], v[20:21], v[20:21]
    v_pk_mul_f32 v[94:95], v[22:23], v[22:23]
    v_pk_fma_f32 v[92:93], v[92:93], s[34:35], s[34:35] op_sel:[0,0,1] op_sel_hi:[1,0,1]
    v_pk_fma_f32 v[94:95], v[94:95], s[34:35], s[34:35] op_sel:[0,0,1] op_sel_hi:[1,0,1]
    v_pk_mul_f32 v[92:93], v[92:93], v[20:21]
    v_pk_mul_f32 v[94:95], v[94:95], v[22:23]
    v_exp_f32 v92, v92
    v_exp_f32 v93, v93
    v_exp_f32 v94, v94
    v_exp_f32 v95, v95
    v_pk_add_f32 v[92:93], v[92:93], s[36:37]
    v_pk_add_f32 v[94:95], v[94:95], s[36:37]
    v_rcp_f32 v92, v92
    v_rcp_f32 v93, v93
    v_rcp_f32 v94, v94
    v_rcp_f32 v95, v95
    v_pk_mul_f32 v[20:21], v[20:21], v[92:93]
    v_pk_mul_f32 v[22:23], v[22:23], v[94:95]
    v_cvt_pk_bf16_f32 v66, v20, v21
    v_cvt_pk_bf16_f32 v67, v22, v23
    s_add_u32 m0, s40, 16384
    s_add_u32 s67, s38, 28672
    buffer_load_dwordx4 v3, s[8:11], s67 offen offset:0 sc1 lds
    buffer_load_dwordx4 v3, s[8:11], s67 offen offset:1024 sc1 lds
    buffer_load_dwordx4 v3, s[8:11], s67 offen offset:2048 sc1 lds
    buffer_load_dwordx4 v3, s[8:11], s67 offen offset:3072 sc1 lds
    v_pk_fma_f32 v[24:25], v[48:49], v[84:85], v[24:25] op_sel:[0,0,0] op_sel_hi:[1,0,1]
    v_pk_fma_f32 v[26:27], v[50:51], v[84:85], v[26:27] op_sel:[0,0,0] op_sel_hi:[1,0,1]
    v_pk_fma_f32 v[24:25], v[84:85], v[24:25], v[56:57] op_sel:[1,0,0] op_sel_hi:[1,1,1]
    v_pk_fma_f32 v[26:27], v[84:85], v[26:27], v[58:59] op_sel:[1,0,0] op_sel_hi:[1,1,1]
    v_pk_mul_f32 v[88:89], v[24:25], v[24:25]
    v_pk_mul_f32 v[90:91], v[26:27], v[26:27]
    v_pk_fma_f32 v[88:89], v[88:89], s[34:35], s[34:35] op_sel:[0,0,1] op_sel_hi:[1,0,1]
    v_pk_fma_f32 v[90:91], v[90:91], s[34:35], s[34:35] op_sel:[0,0,1] op_sel_hi:[1,0,1]
    v_pk_mul_f32 v[88:89], v[88:89], v[24:25]
    v_pk_mul_f32 v[90:91], v[90:91], v[26:27]
    v_exp_f32 v88, v88
    v_exp_f32 v89, v89
    v_exp_f32 v90, v90
    v_exp_f32 v91, v91
    v_pk_add_f32 v[88:89], v[88:89], s[36:37]
    v_pk_add_f32 v[90:91], v[90:91], s[36:37]
    v_rcp_f32 v88, v88
    v_rcp_f32 v89, v89
    v_rcp_f32 v90, v90
    v_rcp_f32 v91, v91
    v_pk_mul_f32 v[24:25], v[24:25], v[88:89]
    v_pk_mul_f32 v[26:27], v[26:27], v[90:91]
    v_cvt_pk_bf16_f32 v68, v24, v25
    v_cvt_pk_bf16_f32 v69, v26, v27
    s_add_u32 m0, s40, 32768
    s_add_u32 s67, s38, 32768
    buffer_load_dwordx4 v3, s[8:11], s67 offen offset:0 sc1 lds
    buffer_load_dwordx4 v3, s[8:11], s67 offen offset:1024 sc1 lds
    buffer_load_dwordx4 v3, s[8:11], s67 offen offset:2048 sc1 lds
    buffer_load_dwordx4 v3, s[8:11], s67 offen offset:3072 sc1 lds
    v_pk_fma_f32 v[28:29], v[48:49], v[86:87], v[28:29] op_sel:[0,0,0] op_sel_hi:[1,0,1]
    v_pk_fma_f32 v[30:31], v[50:51], v[86:87], v[30:31] op_sel:[0,0,0] op_sel_hi:[1,0,1]
    v_pk_fma_f32 v[28:29], v[86:87], v[28:29], v[56:57] op_sel:[1,0,0] op_sel_hi:[1,1,1]
    v_pk_fma_f32 v[30:31], v[86:87], v[30:31], v[58:59] op_sel:[1,0,0] op_sel_hi:[1,1,1]
    v_pk_mul_f32 v[92:93], v[28:29], v[28:29]
    v_pk_mul_f32 v[94:95], v[30:31], v[30:31]
    v_pk_fma_f32 v[92:93], v[92:93], s[34:35], s[34:35] op_sel:[0,0,1] op_sel_hi:[1,0,1]
    v_pk_fma_f32 v[94:95], v[94:95], s[34:35], s[34:35] op_sel:[0,0,1] op_sel_hi:[1,0,1]
    v_pk_mul_f32 v[92:93], v[92:93], v[28:29]
    v_pk_mul_f32 v[94:95], v[94:95], v[30:31]
    v_exp_f32 v92, v92
    v_exp_f32 v93, v93
    v_exp_f32 v94, v94
    v_exp_f32 v95, v95
    v_pk_add_f32 v[92:93], v[92:93], s[36:37]
    v_pk_add_f32 v[94:95], v[94:95], s[36:37]
    v_rcp_f32 v92, v92
    v_rcp_f32 v93, v93
    v_rcp_f32 v94, v94
    v_rcp_f32 v95, v95
    v_pk_mul_f32 v[28:29], v[28:29], v[92:93]
    v_pk_mul_f32 v[30:31], v[30:31], v[94:95]
    v_cvt_pk_bf16_f32 v70, v28, v29
    v_cvt_pk_bf16_f32 v71, v30, v31
    s_add_u32 m0, s40, 49152
    s_add_u32 s67, s38, 36864
    buffer_load_dwordx4 v3, s[8:11], s67 offen offset:0 sc1 lds
    buffer_load_dwordx4 v3, s[8:11], s67 offen offset:1024 sc1 lds
    buffer_load_dwordx4 v3, s[8:11], s67 offen offset:2048 sc1 lds
    buffer_load_dwordx4 v3, s[8:11], s67 offen offset:3072 sc1 lds
    v_pk_fma_f32 v[32:33], v[52:53], v[80:81], v[32:33] op_sel:[0,0,0] op_sel_hi:[1,0,1]
    v_pk_fma_f32 v[34:35], v[54:55], v[80:81], v[34:35] op_sel:[0,0,0] op_sel_hi:[1,0,1]
    v_pk_fma_f32 v[32:33], v[80:81], v[32:33], v[60:61] op_sel:[1,0,0] op_sel_hi:[1,1,1]
    v_pk_fma_f32 v[34:35], v[80:81], v[34:35], v[62:63] op_sel:[1,0,0] op_sel_hi:[1,1,1]
    v_pk_mul_f32 v[88:89], v[32:33], v[32:33]
    v_pk_mul_f32 v[90:91], v[34:35], v[34:35]
    v_pk_fma_f32 v[88:89], v[88:89], s[34:35], s[34:35] op_sel:[0,0,1] op_sel_hi:[1,0,1]
    v_pk_fma_f32 v[90:91], v[90:91], s[34:35], s[34:35] op_sel:[0,0,1] op_sel_hi:[1,0,1]
    v_pk_mul_f32 v[88:89], v[88:89], v[32:33]
    v_pk_mul_f32 v[90:91], v[90:91], v[34:35]
    v_exp_f32 v88, v88
    v_exp_f32 v89, v89
    v_exp_f32 v90, v90
    v_exp_f32 v91, v91
    v_pk_add_f32 v[88:89], v[88:89], s[36:37]
    v_pk_add_f32 v[90:91], v[90:91], s[36:37]
    v_rcp_f32 v88, v88
    v_rcp_f32 v89, v89
    v_rcp_f32 v90, v90
    v_rcp_f32 v91, v91
    v_pk_mul_f32 v[32:33], v[32:33], v[88:89]
    v_pk_mul_f32 v[34:35], v[34:35], v[90:91]
    v_cvt_pk_bf16_f32 v72, v32, v33
    v_cvt_pk_bf16_f32 v73, v34, v35
    s_add_u32 m0, s40, 65536
    s_add_u32 s67, s38, 40960
    buffer_load_dwordx4 v3, s[8:11], s67 offen offset:0 sc1 lds
    buffer_load_dwordx4 v3, s[8:11], s67 offen offset:1024 sc1 lds
    buffer_load_dwordx4 v3, s[8:11], s67 offen offset:2048 sc1 lds
    buffer_load_dwordx4 v3, s[8:11], s67 offen offset:3072 sc1 lds
    v_pk_fma_f32 v[36:37], v[52:53], v[82:83], v[36:37] op_sel:[0,0,0] op_sel_hi:[1,0,1]
    v_pk_fma_f32 v[38:39], v[54:55], v[82:83], v[38:39] op_sel:[0,0,0] op_sel_hi:[1,0,1]
    v_pk_fma_f32 v[36:37], v[82:83], v[36:37], v[60:61] op_sel:[1,0,0] op_sel_hi:[1,1,1]
    v_pk_fma_f32 v[38:39], v[82:83], v[38:39], v[62:63] op_sel:[1,0,0] op_sel_hi:[1,1,1]
    v_pk_mul_f32 v[92:93], v[36:37], v[36:37]
    v_pk_mul_f32 v[94:95], v[38:39], v[38:39]
    v_pk_fma_f32 v[92:93], v[92:93], s[34:35], s[34:35] op_sel:[0,0,1] op_sel_hi:[1,0,1]
    v_pk_fma_f32 v[94:95], v[94:95], s[34:35], s[34:35] op_sel:[0,0,1] op_sel_hi:[1,0,1]
    v_pk_mul_f32 v[92:93], v[92:93], v[36:37]
    v_pk_mul_f32 v[94:95], v[94:95], v[38:39]
    v_exp_f32 v92, v92
    v_exp_f32 v93, v93
    v_exp_f32 v94, v94
    v_exp_f32 v95, v95
    v_pk_add_f32 v[92:93], v[92:93], s[36:37]
    v_pk_add_f32 v[94:95], v[94:95], s[36:37]
    v_rcp_f32 v92, v92
    v_rcp_f32 v93, v93
    v_rcp_f32 v94, v94
    v_rcp_f32 v95, v95
    v_pk_mul_f32 v[36:37], v[36:37], v[92:93]
    v_pk_mul_f32 v[38:39], v[38:39], v[94:95]
    v_cvt_pk_bf16_f32 v74, v36, v37
    v_cvt_pk_bf16_f32 v75, v38, v39
    v_pk_fma_f32 v[40:41], v[52:53], v[84:85], v[40:41] op_sel:[0,0,0] op_sel_hi:[1,0,1]
    v_pk_fma_f32 v[42:43], v[54:55], v[84:85], v[42:43] op_sel:[0,0,0] op_sel_hi:[1,0,1]
    v_pk_fma_f32 v[40:41], v[84:85], v[40:41], v[60:61] op_sel:[1,0,0] op_sel_hi:[1,1,1]
    v_pk_fma_f32 v[42:43], v[84:85], v[42:43], v[62:63] op_sel:[1,0,0] op_sel_hi:[1,1,1]
    v_pk_mul_f32 v[88:89], v[40:41], v[40:41]
    v_pk_mul_f32 v[90:91], v[42:43], v[42:43]
    v_pk_fma_f32 v[88:89], v[88:89], s[34:35], s[34:35] op_sel:[0,0,1] op_sel_hi:[1,0,1]
    v_pk_fma_f32 v[90:91], v[90:91], s[34:35], s[34:35] op_sel:[0,0,1] op_sel_hi:[1,0,1]
    v_pk_mul_f32 v[88:89], v[88:89], v[40:41]
    v_pk_mul_f32 v[90:91], v[90:91], v[42:43]
    v_exp_f32 v88, v88
    v_exp_f32 v89, v89
    v_exp_f32 v90, v90
    v_exp_f32 v91, v91
    v_pk_add_f32 v[88:89], v[88:89], s[36:37]
    v_pk_add_f32 v[90:91], v[90:91], s[36:37]
    v_rcp_f32 v88, v88
    v_rcp_f32 v89, v89
    v_rcp_f32 v90, v90
    v_rcp_f32 v91, v91
    v_pk_mul_f32 v[40:41], v[40:41], v[88:89]
    v_pk_mul_f32 v[42:43], v[42:43], v[90:91]
    v_cvt_pk_bf16_f32 v76, v40, v41
    v_cvt_pk_bf16_f32 v77, v42, v43
    v_pk_fma_f32 v[44:45], v[52:53], v[86:87], v[44:45] op_sel:[0,0,0] op_sel_hi:[1,0,1]
    v_pk_fma_f32 v[46:47], v[54:55], v[86:87], v[46:47] op_sel:[0,0,0] op_sel_hi:[1,0,1]
    v_pk_fma_f32 v[44:45], v[86:87], v[44:45], v[60:61] op_sel:[1,0,0] op_sel_hi:[1,1,1]
    v_pk_fma_f32 v[46:47], v[86:87], v[46:47], v[62:63] op_sel:[1,0,0] op_sel_hi:[1,1,1]
    v_pk_mul_f32 v[92:93], v[44:45], v[44:45]
    v_pk_mul_f32 v[94:95], v[46:47], v[46:47]
    v_pk_fma_f32 v[92:93], v[92:93], s[34:35], s[34:35] op_sel:[0,0,1] op_sel_hi:[1,0,1]
    v_pk_fma_f32 v[94:95], v[94:95], s[34:35], s[34:35] op_sel:[0,0,1] op_sel_hi:[1,0,1]
    v_pk_mul_f32 v[92:93], v[92:93], v[44:45]
    v_pk_mul_f32 v[94:95], v[94:95], v[46:47]
    v_exp_f32 v92, v92
    v_exp_f32 v93, v93
    v_exp_f32 v94, v94
    v_exp_f32 v95, v95
    v_pk_add_f32 v[92:93], v[92:93], s[36:37]
    v_pk_add_f32 v[94:95], v[94:95], s[36:37]
    v_rcp_f32 v92, v92
    v_rcp_f32 v93, v93
    v_rcp_f32 v94, v94
    v_rcp_f32 v95, v95
    v_pk_mul_f32 v[44:45], v[44:45], v[92:93]
    v_pk_mul_f32 v[46:47], v[46:47], v[94:95]
    v_cvt_pk_bf16_f32 v78, v44, v45
    v_cvt_pk_bf16_f32 v79, v46, v47
    s_waitcnt vmcnt(63)
    s_barrier
kf_kernel_b_d1:
    s_setprio 3
    buffer_load_dwordx4 v[80:83], v3, s[8:11], s45 offen offset:0 sc1
    buffer_load_dwordx4 v[84:87], v3, s[8:11], s45 offen offset:1024 sc1
    buffer_load_dwordx4 v[88:91], v3, s[8:11], s45 offen offset:2048 sc1
    buffer_load_dwordx4 v[92:95], v3, s[8:11], s46 offen offset:0 sc1
    buffer_load_dwordx4 v[96:99], v3, s[8:11], s46 offen offset:1024 sc1
    buffer_load_dwordx4 v[100:103], v3, s[8:11], s46 offen offset:2048 sc1
    s_setprio 2
    buffer_load_dwordx4 v[104:107], v3, s[8:11], s47 offen offset:0 sc1
    buffer_load_dwordx4 v[108:111], v3, s[8:11], s47 offen offset:1024 sc1
    buffer_load_dwordx4 v[112:115], v3, s[8:11], s47 offen offset:2048 sc1
    buffer_load_dwordx4 v[116:119], v3, s[8:11], s48 offen offset:0 sc1
    buffer_load_dwordx4 v[120:123], v3, s[8:11], s48 offen offset:1024 sc1
    buffer_load_dwordx4 v[124:127], v3, s[8:11], s48 offen offset:2048 sc1
    s_setprio 1
    buffer_load_dwordx4 v[128:131], v3, s[8:11], s49 offen offset:0 sc1
    buffer_load_dwordx4 v[132:135], v3, s[8:11], s49 offen offset:1024 sc1
    buffer_load_dwordx4 v[136:139], v3, s[8:11], s49 offen offset:2048 sc1
    buffer_load_dwordx4 v[140:143], v3, s[8:11], s50 offen offset:0 sc1
    s_mov_b32 s14, 4096
    v_lshrrev_b32 v0, 2, v7
    s_lshl_b32 s67, s29, zlit_b-zlit_a+(5)
    buffer_load_ushort v4, v0, s[12:15], s67 offen
    v_add_u32_e64 v8, s40, v3
    v_add_u32 v0, 81920, v8
    s_mul_i32 s30, s28, 7168
    s_mul_i32 s31, s26, 143360
    s_add_u32 s31, s31, s30
    s_add_u32 s31, s31, 3573760
    s_add_u32 s30, s30, 129024
    s_waitcnt vmcnt(16)
    v_mfma_f32_16x16x32_bf16 v[16:19], v[80:83], v[144:147], 0
    v_mfma_f32_16x16x32_bf16 v[20:23], v[80:83], v[148:151], 0
    v_mfma_f32_16x16x32_bf16 v[24:27], v[80:83], v[152:155], 0
    v_mfma_f32_16x16x32_bf16 v[28:31], v[80:83], v[156:159], 0
    buffer_load_dwordx4 v[80:83], v3, s[8:11], s50 offen offset:1024 sc1
    s_waitcnt vmcnt(16)
    v_mfma_f32_16x16x32_bf16 v[32:35], v[84:87], v[144:147], 0
    v_mfma_f32_16x16x32_bf16 v[36:39], v[84:87], v[148:151], 0
    v_mfma_f32_16x16x32_bf16 v[40:43], v[84:87], v[152:155], 0
    v_mfma_f32_16x16x32_bf16 v[44:47], v[84:87], v[156:159], 0
    buffer_load_dwordx4 v[84:87], v3, s[8:11], s50 offen offset:2048 sc1
    s_waitcnt vmcnt(16)
    v_mfma_f32_16x16x32_bf16 v[48:51], v[88:91], v[144:147], 0
    v_mfma_f32_16x16x32_bf16 v[52:55], v[88:91], v[148:151], 0
    v_mfma_f32_16x16x32_bf16 v[56:59], v[88:91], v[152:155], 0
    v_mfma_f32_16x16x32_bf16 v[60:63], v[88:91], v[156:159], 0
    s_setprio 0
    buffer_load_dwordx4 v[88:91], v3, s[8:11], s51 offen offset:0 sc1
    ds_read_b128 v[144:147], v0 offset:0
    ds_read_b128 v[148:151], v0 offset:1024
    ds_read_b128 v[152:155], v0 offset:2048
    ds_read_b128 v[156:159], v0 offset:3072
    s_waitcnt vmcnt(16)
    v_mfma_f32_16x16x32_bf16 v[16:19], v[92:95], v[160:163], v[16:19]
    v_mfma_f32_16x16x32_bf16 v[20:23], v[92:95], v[164:167], v[20:23]
    v_mfma_f32_16x16x32_bf16 v[24:27], v[92:95], v[168:171], v[24:27]
    v_mfma_f32_16x16x32_bf16 v[28:31], v[92:95], v[172:175], v[28:31]
    buffer_load_dwordx4 v[92:95], v3, s[8:11], s51 offen offset:1024 sc1
    s_waitcnt vmcnt(16)
    v_mfma_f32_16x16x32_bf16 v[32:35], v[96:99], v[160:163], v[32:35]
    v_mfma_f32_16x16x32_bf16 v[36:39], v[96:99], v[164:167], v[36:39]
    v_mfma_f32_16x16x32_bf16 v[40:43], v[96:99], v[168:171], v[40:43]
    v_mfma_f32_16x16x32_bf16 v[44:47], v[96:99], v[172:175], v[44:47]
    buffer_load_dwordx4 v[96:99], v3, s[8:11], s51 offen offset:2048 sc1
    s_waitcnt vmcnt(16)
    v_mfma_f32_16x16x32_bf16 v[48:51], v[100:103], v[160:163], v[48:51]
    v_mfma_f32_16x16x32_bf16 v[52:55], v[100:103], v[164:167], v[52:55]
    v_mfma_f32_16x16x32_bf16 v[56:59], v[100:103], v[168:171], v[56:59]
    v_mfma_f32_16x16x32_bf16 v[60:63], v[100:103], v[172:175], v[60:63]
    buffer_load_dwordx4 v[100:103], v3, s[8:11], s52 offen offset:0 sc1
    ds_read_b128 v[160:163], v0 offset:16384
    ds_read_b128 v[164:167], v0 offset:17408
    ds_read_b128 v[168:171], v0 offset:18432
    ds_read_b128 v[172:175], v0 offset:19456
    s_waitcnt vmcnt(16) lgkmcnt(4)
    v_mfma_f32_16x16x32_bf16 v[16:19], v[104:107], v[144:147], v[16:19]
    v_mfma_f32_16x16x32_bf16 v[20:23], v[104:107], v[148:151], v[20:23]
    v_mfma_f32_16x16x32_bf16 v[24:27], v[104:107], v[152:155], v[24:27]
    v_mfma_f32_16x16x32_bf16 v[28:31], v[104:107], v[156:159], v[28:31]
    buffer_load_dwordx4 v[104:107], v3, s[8:11], s52 offen offset:1024 sc1
    s_waitcnt vmcnt(16)
    v_mfma_f32_16x16x32_bf16 v[32:35], v[108:111], v[144:147], v[32:35]
    v_mfma_f32_16x16x32_bf16 v[36:39], v[108:111], v[148:151], v[36:39]
    v_mfma_f32_16x16x32_bf16 v[40:43], v[108:111], v[152:155], v[40:43]
    v_mfma_f32_16x16x32_bf16 v[44:47], v[108:111], v[156:159], v[44:47]
    buffer_load_dwordx4 v[108:111], v3, s[8:11], s52 offen offset:2048 sc1
    s_waitcnt vmcnt(16)
    v_mfma_f32_16x16x32_bf16 v[48:51], v[112:115], v[144:147], v[48:51]
    v_mfma_f32_16x16x32_bf16 v[52:55], v[112:115], v[148:151], v[52:55]
    v_mfma_f32_16x16x32_bf16 v[56:59], v[112:115], v[152:155], v[56:59]
    v_mfma_f32_16x16x32_bf16 v[60:63], v[112:115], v[156:159], v[60:63]
    s_setprio 3
    buffer_load_dwordx4 v[112:115], v3, s[8:11], s53 offen offset:0 sc1
    ds_read_b128 v[144:147], v0 offset:32768
    ds_read_b128 v[148:151], v0 offset:33792
    ds_read_b128 v[152:155], v0 offset:34816
    ds_read_b128 v[156:159], v0 offset:35840
    s_waitcnt vmcnt(16) lgkmcnt(4)
    v_mfma_f32_16x16x32_bf16 v[16:19], v[116:119], v[160:163], v[16:19]
    v_mfma_f32_16x16x32_bf16 v[20:23], v[116:119], v[164:167], v[20:23]
    v_mfma_f32_16x16x32_bf16 v[24:27], v[116:119], v[168:171], v[24:27]
    v_mfma_f32_16x16x32_bf16 v[28:31], v[116:119], v[172:175], v[28:31]
    s_barrier
    buffer_load_dwordx4 v[116:119], v3, s[8:11], s53 offen offset:1024 sc1
    s_waitcnt vmcnt(16)
    v_mfma_f32_16x16x32_bf16 v[32:35], v[120:123], v[160:163], v[32:35]
    v_mfma_f32_16x16x32_bf16 v[36:39], v[120:123], v[164:167], v[36:39]
    v_mfma_f32_16x16x32_bf16 v[40:43], v[120:123], v[168:171], v[40:43]
    v_mfma_f32_16x16x32_bf16 v[44:47], v[120:123], v[172:175], v[44:47]
    buffer_load_dwordx4 v[120:123], v3, s[8:11], s53 offen offset:2048 sc1
    s_waitcnt vmcnt(16)
    v_mfma_f32_16x16x32_bf16 v[48:51], v[124:127], v[160:163], v[48:51]
    v_mfma_f32_16x16x32_bf16 v[52:55], v[124:127], v[164:167], v[52:55]
    v_mfma_f32_16x16x32_bf16 v[56:59], v[124:127], v[168:171], v[56:59]
    v_mfma_f32_16x16x32_bf16 v[60:63], v[124:127], v[172:175], v[60:63]
    buffer_load_dwordx4 v[124:127], v3, s[8:11], s54 offen offset:0 sc1
    ds_read_b128 v[160:163], v0 offset:49152
    ds_read_b128 v[164:167], v0 offset:50176
    ds_read_b128 v[168:171], v0 offset:51200
    ds_read_b128 v[172:175], v0 offset:52224
    s_waitcnt vmcnt(16) lgkmcnt(4)
    v_mfma_f32_16x16x32_bf16 v[16:19], v[128:131], v[144:147], v[16:19]
    v_mfma_f32_16x16x32_bf16 v[20:23], v[128:131], v[148:151], v[20:23]
    v_mfma_f32_16x16x32_bf16 v[24:27], v[128:131], v[152:155], v[24:27]
    v_mfma_f32_16x16x32_bf16 v[28:31], v[128:131], v[156:159], v[28:31]
    buffer_load_dwordx4 v[128:131], v3, s[8:11], s54 offen offset:1024 sc1
    s_waitcnt vmcnt(16)
    v_mfma_f32_16x16x32_bf16 v[32:35], v[132:135], v[144:147], v[32:35]
    v_mfma_f32_16x16x32_bf16 v[36:39], v[132:135], v[148:151], v[36:39]
    v_mfma_f32_16x16x32_bf16 v[40:43], v[132:135], v[152:155], v[40:43]
    v_mfma_f32_16x16x32_bf16 v[44:47], v[132:135], v[156:159], v[44:47]
    buffer_load_dwordx4 v[132:135], v3, s[8:11], s54 offen offset:2048 sc1
    s_waitcnt vmcnt(16)
    v_mfma_f32_16x16x32_bf16 v[48:51], v[136:139], v[144:147], v[48:51]
    v_mfma_f32_16x16x32_bf16 v[52:55], v[136:139], v[148:151], v[52:55]
    v_mfma_f32_16x16x32_bf16 v[56:59], v[136:139], v[152:155], v[56:59]
    v_mfma_f32_16x16x32_bf16 v[60:63], v[136:139], v[156:159], v[60:63]
    s_setprio 2
    buffer_load_dwordx4 v[136:139], v3, s[8:11], s55 offen offset:0 sc1
    ds_read_b128 v[144:147], v8 offset:0
    ds_read_b128 v[148:151], v8 offset:1024
    ds_read_b128 v[152:155], v8 offset:2048
    ds_read_b128 v[156:159], v8 offset:3072
    s_waitcnt vmcnt(16) lgkmcnt(4)
    v_mfma_f32_16x16x32_bf16 v[16:19], v[140:143], v[160:163], v[16:19]
    v_mfma_f32_16x16x32_bf16 v[20:23], v[140:143], v[164:167], v[20:23]
    v_mfma_f32_16x16x32_bf16 v[24:27], v[140:143], v[168:171], v[24:27]
    v_mfma_f32_16x16x32_bf16 v[28:31], v[140:143], v[172:175], v[28:31]
    buffer_load_dwordx4 v[140:143], v3, s[8:11], s55 offen offset:1024 sc1
    s_waitcnt vmcnt(15)
    v_mfma_f32_16x16x32_bf16 v[32:35], v[80:83], v[160:163], v[32:35]
    v_mfma_f32_16x16x32_bf16 v[36:39], v[80:83], v[164:167], v[36:39]
    v_mfma_f32_16x16x32_bf16 v[40:43], v[80:83], v[168:171], v[40:43]
    v_mfma_f32_16x16x32_bf16 v[44:47], v[80:83], v[172:175], v[44:47]
    buffer_load_dwordx4 v[80:83], v3, s[8:11], s55 offen offset:2048 sc1
    s_waitcnt vmcnt(15)
    v_mfma_f32_16x16x32_bf16 v[48:51], v[84:87], v[160:163], v[48:51]
    v_mfma_f32_16x16x32_bf16 v[52:55], v[84:87], v[164:167], v[52:55]
    v_mfma_f32_16x16x32_bf16 v[56:59], v[84:87], v[168:171], v[56:59]
    v_mfma_f32_16x16x32_bf16 v[60:63], v[84:87], v[172:175], v[60:63]
    buffer_load_dwordx4 v[84:87], v3, s[8:11], s56 offen offset:0 sc1
    ds_read_b128 v[160:163], v8 offset:16384
    ds_read_b128 v[164:167], v8 offset:17408
    ds_read_b128 v[168:171], v8 offset:18432
    ds_read_b128 v[172:175], v8 offset:19456
    s_waitcnt vmcnt(15) lgkmcnt(4)
    v_mfma_f32_16x16x32_bf16 v[16:19], v[88:91], v[144:147], v[16:19]
    v_mfma_f32_16x16x32_bf16 v[20:23], v[88:91], v[148:151], v[20:23]
    v_mfma_f32_16x16x32_bf16 v[24:27], v[88:91], v[152:155], v[24:27]
    v_mfma_f32_16x16x32_bf16 v[28:31], v[88:91], v[156:159], v[28:31]
    s_setprio 1
    buffer_load_dwordx4 v[88:91], v3, s[8:11], s57 offen offset:0 sc1
    s_waitcnt vmcnt(15)
    v_mfma_f32_16x16x32_bf16 v[32:35], v[92:95], v[144:147], v[32:35]
    v_mfma_f32_16x16x32_bf16 v[36:39], v[92:95], v[148:151], v[36:39]
    v_mfma_f32_16x16x32_bf16 v[40:43], v[92:95], v[152:155], v[40:43]
    v_mfma_f32_16x16x32_bf16 v[44:47], v[92:95], v[156:159], v[44:47]
    buffer_load_dwordx4 v[92:95], v3, s[8:11], s58 offen offset:0 sc1
    s_waitcnt vmcnt(15)
    v_mfma_f32_16x16x32_bf16 v[48:51], v[96:99], v[144:147], v[48:51]
    v_mfma_f32_16x16x32_bf16 v[52:55], v[96:99], v[148:151], v[52:55]
    v_mfma_f32_16x16x32_bf16 v[56:59], v[96:99], v[152:155], v[56:59]
    v_mfma_f32_16x16x32_bf16 v[60:63], v[96:99], v[156:159], v[60:63]
    s_setprio 0
    buffer_load_dwordx4 v[96:99], v3, s[8:11], s59 offen offset:0 sc1
    ds_read_b128 v[144:147], v8 offset:32768
    ds_read_b128 v[148:151], v8 offset:33792
    ds_read_b128 v[152:155], v8 offset:34816
    ds_read_b128 v[156:159], v8 offset:35840
    s_waitcnt vmcnt(15) lgkmcnt(4)
    v_mfma_f32_16x16x32_bf16 v[16:19], v[100:103], v[160:163], v[16:19]
    v_mfma_f32_16x16x32_bf16 v[20:23], v[100:103], v[164:167], v[20:23]
    v_mfma_f32_16x16x32_bf16 v[24:27], v[100:103], v[168:171], v[24:27]
    v_mfma_f32_16x16x32_bf16 v[28:31], v[100:103], v[172:175], v[28:31]
    buffer_load_dwordx4 v[100:103], v3, s[8:11], s60 offen offset:0 sc1
    s_waitcnt vmcnt(15)
    v_mfma_f32_16x16x32_bf16 v[32:35], v[104:107], v[160:163], v[32:35]
    v_mfma_f32_16x16x32_bf16 v[36:39], v[104:107], v[164:167], v[36:39]
    v_mfma_f32_16x16x32_bf16 v[40:43], v[104:107], v[168:171], v[40:43]
    v_mfma_f32_16x16x32_bf16 v[44:47], v[104:107], v[172:175], v[44:47]
    buffer_load_dwordx4 v[104:107], v3, s[8:11], s56 offen offset:1024 sc1
    s_waitcnt vmcnt(15)
    v_mfma_f32_16x16x32_bf16 v[48:51], v[108:111], v[160:163], v[48:51]
    v_mfma_f32_16x16x32_bf16 v[52:55], v[108:111], v[164:167], v[52:55]
    v_mfma_f32_16x16x32_bf16 v[56:59], v[108:111], v[168:171], v[56:59]
    v_mfma_f32_16x16x32_bf16 v[60:63], v[108:111], v[172:175], v[60:63]
    buffer_load_dwordx4 v[108:111], v3, s[8:11], s57 offen offset:1024 sc1
    ds_read_b128 v[160:163], v8 offset:49152
    ds_read_b128 v[164:167], v8 offset:50176
    ds_read_b128 v[168:171], v8 offset:51200
    ds_read_b128 v[172:175], v8 offset:52224
    s_waitcnt vmcnt(15) lgkmcnt(4)
    v_mfma_f32_16x16x32_bf16 v[16:19], v[112:115], v[144:147], v[16:19]
    v_mfma_f32_16x16x32_bf16 v[20:23], v[112:115], v[148:151], v[20:23]
    v_mfma_f32_16x16x32_bf16 v[24:27], v[112:115], v[152:155], v[24:27]
    v_mfma_f32_16x16x32_bf16 v[28:31], v[112:115], v[156:159], v[28:31]
    buffer_load_dwordx4 v[112:115], v3, s[8:11], s58 offen offset:1024 sc1
    s_waitcnt vmcnt(15)
    v_mfma_f32_16x16x32_bf16 v[32:35], v[116:119], v[144:147], v[32:35]
    v_mfma_f32_16x16x32_bf16 v[36:39], v[116:119], v[148:151], v[36:39]
    v_mfma_f32_16x16x32_bf16 v[40:43], v[116:119], v[152:155], v[40:43]
    v_mfma_f32_16x16x32_bf16 v[44:47], v[116:119], v[156:159], v[44:47]
    buffer_load_dwordx4 v[116:119], v3, s[8:11], s59 offen offset:1024 sc1
    s_waitcnt vmcnt(15)
    v_mfma_f32_16x16x32_bf16 v[48:51], v[120:123], v[144:147], v[48:51]
    v_mfma_f32_16x16x32_bf16 v[52:55], v[120:123], v[148:151], v[52:55]
    v_mfma_f32_16x16x32_bf16 v[56:59], v[120:123], v[152:155], v[56:59]
    v_mfma_f32_16x16x32_bf16 v[60:63], v[120:123], v[156:159], v[60:63]
    buffer_load_dwordx4 v[120:123], v3, s[8:11], s60 offen offset:1024 sc1
    v_add_u32 v0, 65536, v8
    ds_read_b128 v[144:147], v0 offset:0
    ds_read_b128 v[148:151], v0 offset:1024
    ds_read_b128 v[152:155], v0 offset:2048
    ds_read_b128 v[156:159], v0 offset:3072
    s_waitcnt vmcnt(15) lgkmcnt(4)
    v_mfma_f32_16x16x32_bf16 v[16:19], v[124:127], v[160:163], v[16:19]
    v_mfma_f32_16x16x32_bf16 v[20:23], v[124:127], v[164:167], v[20:23]
    v_mfma_f32_16x16x32_bf16 v[24:27], v[124:127], v[168:171], v[24:27]
    v_mfma_f32_16x16x32_bf16 v[28:31], v[124:127], v[172:175], v[28:31]
    buffer_load_dwordx4 v[124:127], v3, s[8:11], s56 offen offset:2048 sc1
    s_waitcnt vmcnt(15)
    v_mfma_f32_16x16x32_bf16 v[32:35], v[128:131], v[160:163], v[32:35]
    v_mfma_f32_16x16x32_bf16 v[36:39], v[128:131], v[164:167], v[36:39]
    v_mfma_f32_16x16x32_bf16 v[40:43], v[128:131], v[168:171], v[40:43]
    v_mfma_f32_16x16x32_bf16 v[44:47], v[128:131], v[172:175], v[44:47]
    buffer_load_dwordx4 v[128:131], v3, s[8:11], s57 offen offset:2048 sc1
    s_waitcnt vmcnt(15)
    v_mfma_f32_16x16x32_bf16 v[48:51], v[132:135], v[160:163], v[48:51]
    v_mfma_f32_16x16x32_bf16 v[52:55], v[132:135], v[164:167], v[52:55]
    v_mfma_f32_16x16x32_bf16 v[56:59], v[132:135], v[168:171], v[56:59]
    v_mfma_f32_16x16x32_bf16 v[60:63], v[132:135], v[172:175], v[60:63]
    buffer_load_dwordx4 v[132:135], v3, s[8:11], s58 offen offset:2048 sc1
    buffer_load_dwordx4 v[160:163], v3, s[8:11], s59 offen offset:2048 sc1
    buffer_load_dwordx4 v[164:167], v3, s[8:11], s60 offen offset:2048 sc1
    s_waitcnt vmcnt(17) lgkmcnt(0)
    v_mfma_f32_16x16x32_bf16 v[16:19], v[136:139], v[144:147], v[16:19]
    v_mfma_f32_16x16x32_bf16 v[20:23], v[136:139], v[148:151], v[20:23]
    v_mfma_f32_16x16x32_bf16 v[24:27], v[136:139], v[152:155], v[24:27]
    v_mfma_f32_16x16x32_bf16 v[28:31], v[136:139], v[156:159], v[28:31]
    s_barrier
    s_mul_i32 s68, s28, 9216
    s_add_u32 s68, s68, 49152
    v_add_u32 v8, s68, v3
    s_lshl_b32 s68, s28, zlit_b-zlit_a+(10)
    s_add_u32 s68, s68, 86016
    v_add_u32_e64 v0, s68, v9
    ds_write_b64 v0, v[64:65] offset:0
    ds_write_b64 v0, v[66:67] offset:3584
    ds_write_b64 v0, v[68:69] offset:7168
    ds_write_b64 v0, v[70:71] offset:10752
    s_cmp_eq_u32 s28, 3
    s_cbranch_scc1 kf_kernel_b_z1s
    ds_write_b64 v0, v[72:73] offset:512
    ds_write_b64 v0, v[74:75] offset:4096
    ds_write_b64 v0, v[76:77] offset:7680
    ds_write_b64 v0, v[78:79] offset:11264
kf_kernel_b_z1s:
    s_add_u32 m0, s30, 0
    s_add_u32 s67, s31, 0
    buffer_load_dwordx4 v3, s[8:11], s67 offen offset:0 sc1 lds
    s_waitcnt vmcnt(17)
    v_mfma_f32_16x16x32_bf16 v[32:35], v[140:143], v[144:147], v[32:35]
    v_mfma_f32_16x16x32_bf16 v[36:39], v[140:143], v[148:151], v[36:39]
    v_mfma_f32_16x16x32_bf16 v[40:43], v[140:143], v[152:155], v[40:43]
    v_mfma_f32_16x16x32_bf16 v[44:47], v[140:143], v[156:159], v[44:47]
    buffer_load_dwordx4 v3, s[8:11], s67 offen offset:1024 sc1 lds
    s_waitcnt vmcnt(17)
    v_mfma_f32_16x16x32_bf16 v[48:51], v[80:83], v[144:147], v[48:51]
    v_mfma_f32_16x16x32_bf16 v[52:55], v[80:83], v[148:151], v[52:55]
    v_mfma_f32_16x16x32_bf16 v[56:59], v[80:83], v[152:155], v[56:59]
    v_mfma_f32_16x16x32_bf16 v[60:63], v[80:83], v[156:159], v[60:63]
    buffer_load_dwordx4 v3, s[8:11], s67 offen offset:2048 sc1 lds
    buffer_load_dwordx4 v3, s[8:11], s67 offen offset:3072 sc1 lds
    s_waitcnt vmcnt(18)
    v_mfma_f32_16x16x32_bf16 v[16:19], v[84:87], v[176:179], v[16:19]
    v_mfma_f32_16x16x32_bf16 v[20:23], v[84:87], v[180:183], v[20:23]
    v_mfma_f32_16x16x32_bf16 v[24:27], v[84:87], v[184:187], v[24:27]
    v_mfma_f32_16x16x32_bf16 v[28:31], v[84:87], v[188:191], v[28:31]
    s_add_u32 m0, s30, 4096
    s_add_u32 s67, s31, 4096
    buffer_load_dwordx4 v3, s[8:11], s67 offen offset:0 sc1 lds
    s_waitcnt vmcnt(18)
    v_mfma_f32_16x16x32_bf16 v[16:19], v[88:91], v[192:195], v[16:19]
    v_mfma_f32_16x16x32_bf16 v[20:23], v[88:91], v[196:199], v[20:23]
    v_mfma_f32_16x16x32_bf16 v[24:27], v[88:91], v[200:203], v[24:27]
    v_mfma_f32_16x16x32_bf16 v[28:31], v[88:91], v[204:207], v[28:31]
    buffer_load_dwordx4 v3, s[8:11], s67 offen offset:1024 sc1 lds
    s_waitcnt vmcnt(18)
    v_mfma_f32_16x16x32_bf16 v[16:19], v[92:95], v[208:211], v[16:19]
    v_mfma_f32_16x16x32_bf16 v[20:23], v[92:95], v[212:215], v[20:23]
    v_mfma_f32_16x16x32_bf16 v[24:27], v[92:95], v[216:219], v[24:27]
    v_mfma_f32_16x16x32_bf16 v[28:31], v[92:95], v[220:223], v[28:31]
    buffer_load_dwordx4 v3, s[8:11], s67 offen offset:2048 sc1 lds
    s_waitcnt vmcnt(18)
    v_mfma_f32_16x16x32_bf16 v[16:19], v[96:99], v[224:227], v[16:19]
    v_mfma_f32_16x16x32_bf16 v[20:23], v[96:99], v[228:231], v[20:23]
    v_mfma_f32_16x16x32_bf16 v[24:27], v[96:99], v[232:235], v[24:27]
    v_mfma_f32_16x16x32_bf16 v[28:31], v[96:99], v[236:239], v[28:31]
    s_waitcnt vmcnt(17)
    v_mfma_f32_16x16x32_bf16 v[16:19], v[100:103], v[240:243], v[16:19]
    v_mfma_f32_16x16x32_bf16 v[20:23], v[100:103], v[244:247], v[20:23]
    v_mfma_f32_16x16x32_bf16 v[24:27], v[100:103], v[248:251], v[24:27]
    v_mfma_f32_16x16x32_bf16 v[28:31], v[100:103], v[252:255], v[28:31]
    s_waitcnt vmcnt(16)
    v_mfma_f32_16x16x32_bf16 v[32:35], v[104:107], v[176:179], v[32:35]
    v_mfma_f32_16x16x32_bf16 v[36:39], v[104:107], v[180:183], v[36:39]
    v_mfma_f32_16x16x32_bf16 v[40:43], v[104:107], v[184:187], v[40:43]
    v_mfma_f32_16x16x32_bf16 v[44:47], v[104:107], v[188:191], v[44:47]
    s_nop 0
    ds_write_b128 v8, v[20:23] offset:0
    ds_write_b128 v8, v[24:27] offset:3072
    ds_write_b128 v8, v[28:31] offset:6144
    s_waitcnt vmcnt(15)
    v_mfma_f32_16x16x32_bf16 v[32:35], v[108:111], v[192:195], v[32:35]
    v_mfma_f32_16x16x32_bf16 v[36:39], v[108:111], v[196:199], v[36:39]
    v_mfma_f32_16x16x32_bf16 v[40:43], v[108:111], v[200:203], v[40:43]
    v_mfma_f32_16x16x32_bf16 v[44:47], v[108:111], v[204:207], v[44:47]
    s_waitcnt vmcnt(14)
    v_mfma_f32_16x16x32_bf16 v[32:35], v[112:115], v[208:211], v[32:35]
    v_mfma_f32_16x16x32_bf16 v[36:39], v[112:115], v[212:215], v[36:39]
    v_mfma_f32_16x16x32_bf16 v[40:43], v[112:115], v[216:219], v[40:43]
    v_mfma_f32_16x16x32_bf16 v[44:47], v[112:115], v[220:223], v[44:47]
    s_waitcnt vmcnt(13)
    v_mfma_f32_16x16x32_bf16 v[32:35], v[116:119], v[224:227], v[32:35]
    v_mfma_f32_16x16x32_bf16 v[36:39], v[116:119], v[228:231], v[36:39]
    v_mfma_f32_16x16x32_bf16 v[40:43], v[116:119], v[232:235], v[40:43]
    v_mfma_f32_16x16x32_bf16 v[44:47], v[116:119], v[236:239], v[44:47]
    s_waitcnt vmcnt(12)
    v_mfma_f32_16x16x32_bf16 v[32:35], v[120:123], v[240:243], v[32:35]
    v_mfma_f32_16x16x32_bf16 v[36:39], v[120:123], v[244:247], v[36:39]
    v_mfma_f32_16x16x32_bf16 v[40:43], v[120:123], v[248:251], v[40:43]
    v_mfma_f32_16x16x32_bf16 v[44:47], v[120:123], v[252:255], v[44:47]
    s_waitcnt vmcnt(11)
    v_mfma_f32_16x16x32_bf16 v[48:51], v[124:127], v[176:179], v[48:51]
    v_mfma_f32_16x16x32_bf16 v[52:55], v[124:127], v[180:183], v[52:55]
    v_mfma_f32_16x16x32_bf16 v[56:59], v[124:127], v[184:187], v[56:59]
    v_mfma_f32_16x16x32_bf16 v[60:63], v[124:127], v[188:191], v[60:63]
    s_nop 0
    ds_write_b128 v8, v[36:39] offset:1024
    ds_write_b128 v8, v[40:43] offset:4096
    ds_write_b128 v8, v[44:47] offset:7168
    s_waitcnt vmcnt(10)
    v_mfma_f32_16x16x32_bf16 v[48:51], v[128:131], v[192:195], v[48:51]
    v_mfma_f32_16x16x32_bf16 v[52:55], v[128:131], v[196:199], v[52:55]
    v_mfma_f32_16x16x32_bf16 v[56:59], v[128:131], v[200:203], v[56:59]
    v_mfma_f32_16x16x32_bf16 v[60:63], v[128:131], v[204:207], v[60:63]
    s_waitcnt vmcnt(9)
    v_mfma_f32_16x16x32_bf16 v[48:51], v[132:135], v[208:211], v[48:51]
    v_mfma_f32_16x16x32_bf16 v[52:55], v[132:135], v[212:215], v[52:55]
    v_mfma_f32_16x16x32_bf16 v[56:59], v[132:135], v[216:219], v[56:59]
    v_mfma_f32_16x16x32_bf16 v[60:63], v[132:135], v[220:223], v[60:63]
    s_waitcnt vmcnt(8)
    v_mfma_f32_16x16x32_bf16 v[48:51], v[160:163], v[224:227], v[48:51]
    v_mfma_f32_16x16x32_bf16 v[52:55], v[160:163], v[228:231], v[52:55]
    v_mfma_f32_16x16x32_bf16 v[56:59], v[160:163], v[232:235], v[56:59]
    v_mfma_f32_16x16x32_bf16 v[60:63], v[160:163], v[236:239], v[60:63]
    s_waitcnt vmcnt(7)
    v_mfma_f32_16x16x32_bf16 v[48:51], v[164:167], v[240:243], v[48:51]
    v_mfma_f32_16x16x32_bf16 v[52:55], v[164:167], v[244:247], v[52:55]
    v_mfma_f32_16x16x32_bf16 v[56:59], v[164:167], v[248:251], v[56:59]
    v_mfma_f32_16x16x32_bf16 v[60:63], v[164:167], v[252:255], v[60:63]
    s_setprio 0
    s_xor_b32 s67, s28, zlit_b-zlit_a+(1)
    s_mul_i32 s67, s67, 9216
    s_add_u32 s67, s67, 49152
    v_add_u32 v137, s67, v3
    s_xor_b32 s67, s28, 2
    s_mul_i32 s67, s67, 9216
    s_add_u32 s67, s67, 49152
    v_add_u32 v138, s67, v3
    s_xor_b32 s67, s28, 3
    s_mul_i32 s67, s67, 9216
    s_add_u32 s67, s67, 49152
    v_add_u32_e64 v139, s67, v3
    ds_write_b128 v8, v[52:55] offset:2048
    ds_write_b128 v8, v[56:59] offset:5120
    ds_write_b128 v8, v[60:63] offset:8192
    s_mul_i32 s67, s28, 3584
    s_add_u32 s67, s67, 88064
    v_add_u32 v136, s67, v9
    v_lshlrev_b32 v4, 16, v4
    s_mul_i32 s39, s29, 28672
    s_add_u32 s39, s39, 29818880
    s_mul_i32 s67, s17, 3584
    s_add_u32 s67, s67, s39
    v_add_f32 v16, v16, v4
    v_add_f32 v17, v17, v4
    v_add_f32 v18, v18, v4
    v_add_f32 v19, v19, v4
    v_add_f32 v32, v32, v4
    v_add_f32 v33, v33, v4
    v_add_f32 v34, v34, v4
    v_add_f32 v35, v35, v4
    v_add_f32 v48, v48, v4
    v_add_f32 v49, v49, v4
    v_add_f32 v50, v50, v4
    v_add_f32_e64 v51, v51, v4
    s_waitcnt lgkmcnt(0)
    s_barrier
    ds_read_b64 v[128:129], v136 offset:0
    ds_read_b128 v[80:83], v137 offset:0
    ds_read_b128 v[84:87], v138 offset:3072
    ds_read_b128 v[88:91], v139 offset:6144
    ds_read_b64 v[130:131], v136 offset:512
    ds_read_b128 v[92:95], v137 offset:1024
    ds_read_b128 v[96:99], v138 offset:4096
    ds_read_b128 v[100:103], v139 offset:7168
    ds_read_b64 v[132:133], v136 offset:1024
    ds_read_b128 v[104:107], v137 offset:2048
    ds_read_b128 v[108:111], v138 offset:5120
    ds_read_b128 v[112:115], v139 offset:8192
    s_waitcnt lgkmcnt(8)
    v_pk_add_f32 v[16:17], v[16:17], v[80:81]
    v_pk_add_f32 v[84:85], v[84:85], v[88:89]
    v_pk_add_f32 v[18:19], v[18:19], v[82:83]
    v_pk_add_f32 v[86:87], v[86:87], v[90:91]
    v_lshlrev_b32 v80, 16, v128
    v_and_b32 v81, 0xffff0000, v128
    v_lshlrev_b32_e64 v82, 16, v129
    v_and_b32 v83, 0xffff0000, v129
    v_pk_add_f32 v[16:17], v[16:17], v[84:85]
    v_pk_add_f32 v[18:19], v[18:19], v[86:87]
    v_pk_mul_f32 v[16:17], v[16:17], v[80:81]
    v_pk_mul_f32 v[18:19], v[18:19], v[82:83]
    v_cvt_pk_bf16_f32 v140, v16, v17
    v_cvt_pk_bf16_f32 v141, v18, v19
    s_waitcnt lgkmcnt(4)
    v_pk_add_f32 v[32:33], v[32:33], v[92:93]
    v_pk_add_f32 v[96:97], v[96:97], v[100:101]
    v_pk_add_f32 v[34:35], v[34:35], v[94:95]
    v_pk_add_f32 v[98:99], v[98:99], v[102:103]
    v_lshlrev_b32 v92, 16, v130
    v_and_b32 v93, 0xffff0000, v130
    v_lshlrev_b32_e64 v94, 16, v131
    v_and_b32 v95, 0xffff0000, v131
    v_pk_add_f32 v[32:33], v[32:33], v[96:97]
    v_pk_add_f32 v[34:35], v[34:35], v[98:99]
    v_pk_mul_f32 v[32:33], v[32:33], v[92:93]
    v_pk_mul_f32 v[34:35], v[34:35], v[94:95]
    v_cvt_pk_bf16_f32 v142, v32, v33
    v_cvt_pk_bf16_f32 v143, v34, v35
    buffer_store_dwordx4 v[140:143], v3, s[8:11], s67 offen offset:2048 sc1
    s_waitcnt lgkmcnt(0)
    v_pk_add_f32 v[48:49], v[48:49], v[104:105]
    v_pk_add_f32 v[108:109], v[108:109], v[112:113]
    v_pk_add_f32 v[50:51], v[50:51], v[106:107]
    v_pk_add_f32 v[110:111], v[110:111], v[114:115]
    v_lshlrev_b32 v104, 16, v132
    v_and_b32 v105, 0xffff0000, v132
    v_lshlrev_b32_e64 v106, 16, v133
    v_and_b32 v107, 0xffff0000, v133
    v_pk_add_f32 v[48:49], v[48:49], v[108:109]
    v_pk_add_f32 v[50:51], v[50:51], v[110:111]
    v_pk_mul_f32 v[48:49], v[48:49], v[104:105]
    v_pk_mul_f32 v[50:51], v[50:51], v[106:107]
    v_cvt_pk_bf16_f32 v144, v48, v49
    v_cvt_pk_bf16_f32 v145, v50, v51
    buffer_store_dwordx2 v[144:145], v9, s[8:11], s67 offen offset:3072 sc1
    s_waitcnt vmcnt(2)
    s_barrier
    s_load_dwordx2 s[80:81], s[0:1], 80
    s_add_u32 s30, s28, zlit_b-zlit_a+(3)
    s_mul_i32 s30, s30, 12288
    s_mul_i32 s31, s26, 143360
    s_add_u32 s31, s31, 3530752
    s_add_u32 s31, s31, s30
    s_add_u32 m0, s30, 0
    s_add_u32 s67, s31, zlit_b-zlit_a+(0)
    s_cmp_ge_u32 m0, 43008
    s_cselect_b32 s68, 28672, 0
    s_add_u32 s67, s67, s68
    buffer_load_dwordx4 v3, s[8:11], s67 offen offset:0 sc1 lds
    buffer_load_dwordx4 v3, s[8:11], s67 offen offset:1024 sc1 lds
    s_add_u32 m0, s30, 2048
    s_add_u32 s67, s31, 2048
    s_cmp_ge_u32 m0, 43008
    s_cselect_b32 s68, 28672, 0
    s_add_u32 s67, s67, s68
    buffer_load_dwordx4 v3, s[8:11], s67 offen offset:0 sc1 lds
    buffer_load_dwordx4 v3, s[8:11], s67 offen offset:1024 sc1 lds
    s_waitcnt vmcnt(4)
    v_mov_b32 v72, 162832
    v_mov_b32_e64 v73, 1
    s_mov_b64 exec, 1
    ds_add_u32 v72, v73
    s_mov_b64 exec, -1
    s_add_u32 m0, s30, 4096
    s_add_u32 s67, s31, 4096
    s_cmp_ge_u32 m0, 43008
    s_cselect_b32 s68, 28672, 0
    s_add_u32 s67, s67, s68
    buffer_load_dwordx4 v3, s[8:11], s67 offen offset:0 sc1 lds
    buffer_load_dwordx4 v3, s[8:11], s67 offen offset:1024 sc1 lds
    s_add_u32 m0, s30, 6144
    s_add_u32 s67, s31, 6144
    s_cmp_ge_u32 m0, 43008
    s_cselect_b32 s68, 28672, 0
    s_add_u32 s67, s67, s68
    buffer_load_dwordx4 v3, s[8:11], s67 offen offset:0 sc1 lds
    buffer_load_dwordx4 v3, s[8:11], s67 offen offset:1024 sc1 lds
    s_add_u32 m0, s30, 8192
    s_add_u32 s67, s31, 8192
    s_cmp_ge_u32 m0, 43008
    s_cselect_b32 s68, 28672, 0
    s_add_u32 s67, s67, s68
    buffer_load_dwordx4 v3, s[8:11], s67 offen offset:0 sc1 lds
    buffer_load_dwordx4 v3, s[8:11], s67 offen offset:1024 sc1 lds
    s_add_u32 m0, s30, 10240
    s_add_u32 s67, s31, 10240
    s_cmp_ge_u32 m0, 43008
    s_cselect_b32 s68, 28672, 0
    s_add_u32 s67, s67, s68
    buffer_load_dwordx4 v3, s[8:11], s67 offen offset:0 sc1 lds
    buffer_load_dwordx4 v3, s[8:11], s67 offen offset:1024 sc1 lds
    v_add_u32 v8, 129024, v3
    v_add_u32 v0, 43008, v3
    v_add_u32 v4, 161600, v6
    s_mul_i32 s41, s33, 28672
    s_add_u32 s41, s41, 29833216
    s_add_u32 s42, s41, 3584
    s_add_u32 s43, s41, 7168
    s_add_u32 s44, s41, 10752
    s_barrier
    buffer_load_dwordx4 v[16:19], v3, s[8:11], s41 offen offset:0 sc1
    buffer_load_dwordx4 v[20:23], v3, s[8:11], s41 offen offset:1024 sc1
    buffer_load_dwordx4 v[24:27], v3, s[8:11], s41 offen offset:2048 sc1
    buffer_load_dwordx4 v[28:31], v3, s[8:11], s42 offen offset:0 sc1
    buffer_load_dwordx4 v[32:35], v3, s[8:11], s42 offen offset:1024 sc1
    buffer_load_dwordx4 v[36:39], v3, s[8:11], s42 offen offset:2048 sc1
    buffer_load_dwordx2 v[40:41], v9, s[8:11], s41 offen offset:3072 sc1
    buffer_load_dwordx2 v[42:43], v9, s[8:11], s42 offen offset:3072 sc1
    buffer_load_dwordx4 v[44:47], v3, s[8:11], s43 offen offset:0 sc1
    buffer_load_dwordx4 v[48:51], v3, s[8:11], s43 offen offset:1024 sc1
    buffer_load_dwordx4 v[52:55], v3, s[8:11], s43 offen offset:2048 sc1
    buffer_load_dwordx4 v[56:59], v3, s[8:11], s44 offen offset:0 sc1
    buffer_load_dwordx4 v[60:63], v3, s[8:11], s44 offen offset:1024 sc1
    buffer_load_dwordx4 v[64:67], v3, s[8:11], s44 offen offset:2048 sc1
    buffer_load_dwordx2 v[68:69], v9, s[8:11], s43 offen offset:3072 sc1
    buffer_load_dwordx2 v[70:71], v9, s[8:11], s44 offen offset:3072 sc1
    ds_read_b128 v[148:151], v8 offset:0
    ds_read_b128 v[152:155], v8 offset:1024
    ds_read_b128 v[156:159], v8 offset:2048
    ds_read_b128 v[160:163], v8 offset:3072
    ds_read_b128 v[164:167], v8 offset:4096
    ds_read_b128 v[168:171], v8 offset:5120
    ds_read_b128 v[172:175], v8 offset:6144
    ds_read_b128 v[176:179], v8 offset:7168
    ds_read_b128 v[180:183], v8 offset:8192
    ds_read_b128 v[184:187], v8 offset:9216
    ds_read_b128 v[188:191], v8 offset:10240
    ds_read_b128 v[192:195], v8 offset:11264
    ds_read_b128 v[196:199], v8 offset:12288
    ds_read_b128 v[200:203], v8 offset:13312
    ds_read_b128 v[204:207], v8 offset:14336
    ds_read_b128 v[208:211], v8 offset:15360
    ds_read_b128 v[212:215], v8 offset:16384
    ds_read_b128 v[216:219], v8 offset:17408
    ds_read_b128 v[220:223], v8 offset:18432
    ds_read_b128 v[224:227], v8 offset:19456
    ds_read_b128 v[228:231], v8 offset:20480
    ds_read_b128 v[232:235], v8 offset:21504
    ds_read_b128 v[236:239], v8 offset:22528
    ds_read_b128 v[240:243], v8 offset:23552
    ds_read_b128 v[244:247], v8 offset:24576
    ds_read_b128 v[96:99], v4 offset:0
    ds_read_b128 v[100:103], v4 offset:64
    ds_read_b128 v[104:107], v4 offset:128
    s_mul_i32 s67, s28, 5120
    s_add_u32 s67, s67, 100352
    v_add_u32_e64 v4, s67, v3
    s_waitcnt lgkmcnt(0)
    s_waitcnt vmcnt(15)
    v_mfma_f32_16x16x32_bf16 v[72:75], v[148:151], v[16:19], 0
    v_mfma_f32_16x16x32_bf16 v[76:79], v[152:155], v[16:19], 0
    v_mfma_f32_16x16x32_bf16 v[80:83], v[156:159], v[16:19], 0
    v_mfma_f32_16x16x32_bf16 v[84:87], v[160:163], v[16:19], 0
    v_mfma_f32_16x16x32_bf16 v[88:91], v[164:167], v[16:19], 0
    s_barrier
    ds_read_b128 v[148:151], v8 offset:25600
    ds_read_b128 v[152:155], v8 offset:26624
    ds_read_b128 v[156:159], v8 offset:27648
    ds_read_b128 v[160:163], v0 offset:0
    ds_read_b128 v[164:167], v0 offset:1024
    s_waitcnt vmcnt(14)
    v_mfma_f32_16x16x32_bf16 v[72:75], v[168:171], v[20:23], v[72:75]
    v_mfma_f32_16x16x32_bf16 v[76:79], v[172:175], v[20:23], v[76:79]
    v_mfma_f32_16x16x32_bf16 v[80:83], v[176:179], v[20:23], v[80:83]
    v_mfma_f32_16x16x32_bf16 v[84:87], v[180:183], v[20:23], v[84:87]
    v_mfma_f32_16x16x32_bf16 v[88:91], v[184:187], v[20:23], v[88:91]
    ds_read_b128 v[168:171], v0 offset:2048
    ds_read_b128 v[172:175], v0 offset:3072
    ds_read_b128 v[176:179], v0 offset:4096
    ds_read_b128 v[180:183], v0 offset:5120
    ds_read_b128 v[184:187], v0 offset:6144
    s_waitcnt vmcnt(13)
    v_mfma_f32_16x16x32_bf16 v[72:75], v[188:191], v[24:27], v[72:75]
    v_mfma_f32_16x16x32_bf16 v[76:79], v[192:195], v[24:27], v[76:79]
    v_mfma_f32_16x16x32_bf16 v[80:83], v[196:199], v[24:27], v[80:83]
    v_mfma_f32_16x16x32_bf16 v[84:87], v[200:203], v[24:27], v[84:87]
    v_mfma_f32_16x16x32_bf16 v[88:91], v[204:207], v[24:27], v[88:91]
    ds_read_b128 v[188:191], v0 offset:7168
    ds_read_b128 v[192:195], v0 offset:8192
    ds_read_b128 v[196:199], v0 offset:9216
    ds_read_b128 v[200:203], v0 offset:10240
    ds_read_b128 v[204:207], v0 offset:11264
    s_waitcnt vmcnt(12)
    v_mfma_f32_16x16x32_bf16 v[72:75], v[208:211], v[28:31], v[72:75]
    v_mfma_f32_16x16x32_bf16 v[76:79], v[212:215], v[28:31], v[76:79]
    v_mfma_f32_16x16x32_bf16 v[80:83], v[216:219], v[28:31], v[80:83]
    v_mfma_f32_16x16x32_bf16 v[84:87], v[220:223], v[28:31], v[84:87]
    v_mfma_f32_16x16x32_bf16 v[88:91], v[224:227], v[28:31], v[88:91]
    ds_read_b128 v[208:211], v0 offset:12288
    ds_read_b128 v[212:215], v0 offset:13312
    ds_read_b128 v[216:219], v0 offset:14336
    ds_read_b128 v[220:223], v0 offset:15360
    ds_read_b128 v[224:227], v0 offset:16384
    s_waitcnt vmcnt(11)
    v_mfma_f32_16x16x32_bf16 v[72:75], v[228:231], v[32:35], v[72:75]
    v_mfma_f32_16x16x32_bf16 v[76:79], v[232:235], v[32:35], v[76:79]
    v_mfma_f32_16x16x32_bf16 v[80:83], v[236:239], v[32:35], v[80:83]
    v_mfma_f32_16x16x32_bf16 v[84:87], v[240:243], v[32:35], v[84:87]
    v_mfma_f32_16x16x32_bf16 v[88:91], v[244:247], v[32:35], v[88:91]
    ds_read_b128 v[228:231], v0 offset:17408
    ds_read_b128 v[232:235], v0 offset:18432
    ds_read_b128 v[236:239], v0 offset:19456
    ds_read_b128 v[240:243], v0 offset:20480
    ds_read_b128 v[244:247], v0 offset:21504
    s_waitcnt vmcnt(10) lgkmcnt(15)
    v_mfma_f32_16x16x32_bf16 v[72:75], v[148:151], v[36:39], v[72:75]
    v_mfma_f32_16x16x32_bf16 v[76:79], v[152:155], v[36:39], v[76:79]
    v_mfma_f32_16x16x32_bf16 v[80:83], v[156:159], v[36:39], v[80:83]
    v_mfma_f32_16x16x32_bf16 v[84:87], v[160:163], v[36:39], v[84:87]
    v_mfma_f32_16x16x32_bf16 v[88:91], v[164:167], v[36:39], v[88:91]
    ds_read_b128 v[148:151], v0 offset:22528
    ds_read_b128 v[152:155], v0 offset:23552
    ds_read_b128 v[156:159], v0 offset:24576
    ds_read_b128 v[160:163], v0 offset:25600
    ds_read_b128 v[164:167], v0 offset:26624
    s_waitcnt vmcnt(8) lgkmcnt(15)
    v_mfma_f32_16x16x32_bf16 v[72:75], v[168:171], v[40:43], v[72:75]
    v_mfma_f32_16x16x32_bf16 v[76:79], v[172:175], v[40:43], v[76:79]
    v_mfma_f32_16x16x32_bf16 v[80:83], v[176:179], v[40:43], v[80:83]
    v_mfma_f32_16x16x32_bf16 v[84:87], v[180:183], v[40:43], v[84:87]
    v_mfma_f32_16x16x32_bf16 v[88:91], v[184:187], v[40:43], v[88:91]
    ds_read_b128 v[168:171], v0 offset:27648
    ds_read_b128 v[172:175], v0 offset:28672
    ds_read_b128 v[176:179], v0 offset:29696
    ds_read_b128 v[180:183], v0 offset:30720
    ds_read_b128 v[184:187], v0 offset:31744
    s_waitcnt vmcnt(7) lgkmcnt(15)
    v_mfma_f32_16x16x32_bf16 v[72:75], v[188:191], v[44:47], v[72:75]
    v_mfma_f32_16x16x32_bf16 v[76:79], v[192:195], v[44:47], v[76:79]
    v_mfma_f32_16x16x32_bf16 v[80:83], v[196:199], v[44:47], v[80:83]
    v_mfma_f32_16x16x32_bf16 v[84:87], v[200:203], v[44:47], v[84:87]
    v_mfma_f32_16x16x32_bf16 v[88:91], v[204:207], v[44:47], v[88:91]
    ds_read_b128 v[188:191], v0 offset:32768
    ds_read_b128 v[192:195], v0 offset:33792
    ds_read_b128 v[196:199], v0 offset:34816
    ds_read_b128 v[200:203], v0 offset:35840
    ds_read_b128 v[204:207], v0 offset:36864
    s_waitcnt vmcnt(6) lgkmcnt(15)
    v_mfma_f32_16x16x32_bf16 v[72:75], v[208:211], v[48:51], v[72:75]
    v_mfma_f32_16x16x32_bf16 v[76:79], v[212:215], v[48:51], v[76:79]
    v_mfma_f32_16x16x32_bf16 v[80:83], v[216:219], v[48:51], v[80:83]
    v_mfma_f32_16x16x32_bf16 v[84:87], v[220:223], v[48:51], v[84:87]
    v_mfma_f32_16x16x32_bf16 v[88:91], v[224:227], v[48:51], v[88:91]
    ds_read_b128 v[208:211], v0 offset:37888
    ds_read_b128 v[212:215], v0 offset:38912
    ds_read_b128 v[216:219], v0 offset:39936
    ds_read_b128 v[220:223], v0 offset:40960
    ds_read_b128 v[224:227], v0 offset:41984
    s_waitcnt vmcnt(5) lgkmcnt(15)
    v_mfma_f32_16x16x32_bf16 v[72:75], v[228:231], v[52:55], v[72:75]
    v_mfma_f32_16x16x32_bf16 v[76:79], v[232:235], v[52:55], v[76:79]
    v_mfma_f32_16x16x32_bf16 v[80:83], v[236:239], v[52:55], v[80:83]
    v_mfma_f32_16x16x32_bf16 v[84:87], v[240:243], v[52:55], v[84:87]
    v_mfma_f32_16x16x32_bf16 v[88:91], v[244:247], v[52:55], v[88:91]
    s_waitcnt vmcnt(4) lgkmcnt(15)
    v_mfma_f32_16x16x32_bf16 v[72:75], v[148:151], v[56:59], v[72:75]
    v_mfma_f32_16x16x32_bf16 v[76:79], v[152:155], v[56:59], v[76:79]
    v_mfma_f32_16x16x32_bf16 v[80:83], v[156:159], v[56:59], v[80:83]
    v_mfma_f32_16x16x32_bf16 v[84:87], v[160:163], v[56:59], v[84:87]
    v_mfma_f32_16x16x32_bf16 v[88:91], v[164:167], v[56:59], v[88:91]
    s_waitcnt vmcnt(3) lgkmcnt(10)
    v_mfma_f32_16x16x32_bf16 v[72:75], v[168:171], v[60:63], v[72:75]
    v_mfma_f32_16x16x32_bf16 v[76:79], v[172:175], v[60:63], v[76:79]
    v_mfma_f32_16x16x32_bf16 v[80:83], v[176:179], v[60:63], v[80:83]
    v_mfma_f32_16x16x32_bf16 v[84:87], v[180:183], v[60:63], v[84:87]
    v_mfma_f32_16x16x32_bf16 v[88:91], v[184:187], v[60:63], v[88:91]
    s_waitcnt vmcnt(2) lgkmcnt(5)
    v_mfma_f32_16x16x32_bf16 v[72:75], v[188:191], v[64:67], v[72:75]
    v_mfma_f32_16x16x32_bf16 v[76:79], v[192:195], v[64:67], v[76:79]
    v_mfma_f32_16x16x32_bf16 v[80:83], v[196:199], v[64:67], v[80:83]
    v_mfma_f32_16x16x32_bf16 v[84:87], v[200:203], v[64:67], v[84:87]
    v_mfma_f32_16x16x32_bf16 v[88:91], v[204:207], v[64:67], v[88:91]
    s_waitcnt vmcnt(0) lgkmcnt(0)
    v_mfma_f32_16x16x32_bf16 v[72:75], v[208:211], v[68:71], v[72:75]
    v_mfma_f32_16x16x32_bf16 v[76:79], v[212:215], v[68:71], v[76:79]
    v_mfma_f32_16x16x32_bf16 v[80:83], v[216:219], v[68:71], v[80:83]
    v_mfma_f32_16x16x32_bf16 v[84:87], v[220:223], v[68:71], v[84:87]
    v_mfma_f32_16x16x32_bf16 v[88:91], v[224:227], v[68:71], v[88:91]
    s_nop 3
    ds_write_b128 v4, v[72:75] offset:0
    ds_write_b128 v4, v[76:79] offset:1024
    ds_write_b128 v4, v[80:83] offset:2048
    v_lshlrev_b32 v16, 16, v10
    v_and_b32 v17, 0xffff0000, v10
    v_lshlrev_b32_e64 v18, 16, v11
    v_and_b32 v19, 0xffff0000, v11
    v_lshlrev_b32_e64 v20, 16, v12
    v_and_b32 v21, 0xffff0000, v12
    v_lshlrev_b32_e64 v22, 16, v13
    v_and_b32 v23, 0xffff0000, v13
    s_waitcnt lgkmcnt(0)
    s_barrier
    ds_read_b128 v[148:151], v4 offset:3072
    ds_read_b128 v[152:155], v4 offset:4096
    s_waitcnt lgkmcnt(1)
    v_pk_add_f32 v[84:85], v[84:85], v[148:149]
    v_pk_add_f32 v[86:87], v[86:87], v[150:151]
    v_pk_fma_f32 v[16:17], v[84:85], v[96:97], v[16:17]
    v_pk_fma_f32 v[18:19], v[86:87], v[98:99], v[18:19]
    v_cvt_pk_bf16_f32 v10, v16, v17
    v_cvt_pk_bf16_f32 v11, v18, v19
    buffer_store_dwordx2 v[10:11], v5, s[80:83], s32 offen offset:0
    s_waitcnt lgkmcnt(0)
    v_pk_add_f32 v[88:89], v[88:89], v[152:153]
    v_pk_add_f32 v[90:91], v[90:91], v[154:155]
    v_pk_fma_f32 v[20:21], v[88:89], v[100:101], v[20:21]
    v_pk_fma_f32 v[22:23], v[90:91], v[102:103], v[22:23]
    v_cvt_pk_bf16_f32 v12, v20, v21
    v_cvt_pk_bf16_f32 v13, v22, v23
    buffer_store_dwordx2 v[12:13], v5, s[80:83], s32 offen offset:32
    s_branch kf_kernel_b_end
kf_kernel_b_c1_1:
    v_and_b32 v0, 1, v2
    v_lshl_add_u32 v0, v0, 6, v6
    v_add_u32 v0, 157696, v0
    v_add_u32 v8, 40960, v3
    v_add_u32 v4, 40960, v9
    s_mul_i32 s39, s16, 81920
    s_mul_i32 s30, s28, 5120
    s_add_u32 s39, s39, s30
    s_add_u32 s39, s39, 23527424
    s_waitcnt vmcnt(0)
    s_barrier
    ds_read_b128 v[56:59], v0 offset:0
    ds_read_b128 v[60:63], v0 offset:128
    ds_read_b128 v[64:67], v0 offset:256
    ds_read_b128 v[68:71], v0 offset:384
    ds_read_b128 v[72:75], v0 offset:512
    ds_read_b128 v[76:79], v0 offset:640
    ds_read_b128 v[80:83], v0 offset:768
    ds_read_b128 v[84:87], v0 offset:896
    s_waitcnt lgkmcnt(7)
    v_mfma_f32_16x16x32_bf16 v[48:51], v[240:243], v[56:59], 0
    ds_read_b128 v[56:59], v0 offset:1024
    s_waitcnt lgkmcnt(7)
    v_mfma_f32_16x16x32_bf16 v[48:51], v[244:247], v[60:63], v[48:51]
    ds_read_b128 v[60:63], v0 offset:1152
    s_waitcnt lgkmcnt(7)
    v_mfma_f32_16x16x32_bf16 v[48:51], v[248:251], v[64:67], v[48:51]
    ds_read_b128 v[64:67], v0 offset:1280
    s_waitcnt lgkmcnt(7)
    v_mfma_f32_16x16x32_bf16 v[48:51], v[252:255], v[68:71], v[48:51]
    ds_read_b128 v[68:71], v0 offset:1408
    s_waitcnt lgkmcnt(7)
    v_mfma_f32_16x16x32_bf16 v[48:51], v[116:119], v[72:75], v[48:51]
    ds_read_b128 v[72:75], v0 offset:1536
    s_waitcnt lgkmcnt(7)
    v_mfma_f32_16x16x32_bf16 v[48:51], v[120:123], v[76:79], v[48:51]
    ds_read_b128 v[76:79], v0 offset:1664
    s_waitcnt lgkmcnt(7)
    v_mfma_f32_16x16x32_bf16 v[48:51], v[124:127], v[80:83], v[48:51]
    ds_read_b128 v[80:83], v0 offset:1792
    s_waitcnt lgkmcnt(7)
    v_mfma_f32_16x16x32_bf16 v[48:51], v[128:131], v[84:87], v[48:51]
    ds_read_b128 v[84:87], v0 offset:1920
    s_waitcnt lgkmcnt(7)
    v_mfma_f32_16x16x32_bf16 v[48:51], v[140:143], v[56:59], v[48:51]
    ds_read_b128 v[56:59], v0 offset:2048
    s_waitcnt lgkmcnt(7)
    v_mfma_f32_16x16x32_bf16 v[48:51], v[144:147], v[60:63], v[48:51]
    ds_read_b128 v[60:63], v0 offset:2176
    s_waitcnt lgkmcnt(7)
    v_mfma_f32_16x16x32_bf16 v[48:51], v[148:151], v[64:67], v[48:51]
    ds_read_b128 v[64:67], v0 offset:2304
    s_waitcnt lgkmcnt(7)
    v_mfma_f32_16x16x32_bf16 v[48:51], v[152:155], v[68:71], v[48:51]
    ds_read_b128 v[68:71], v0 offset:2432
    s_waitcnt lgkmcnt(7)
    v_mfma_f32_16x16x32_bf16 v[48:51], v[132:135], v[72:75], v[48:51]
    s_waitcnt lgkmcnt(6)
    v_mfma_f32_16x16x32_bf16 v[48:51], v[136:139], v[76:79], v[48:51]
    s_waitcnt lgkmcnt(5)
    v_mfma_f32_16x16x32_bf16 v[48:51], v[156:159], v[80:83], v[48:51]
    s_waitcnt lgkmcnt(4)
    v_mfma_f32_16x16x32_bf16 v[48:51], v[96:99], v[84:87], v[48:51]
    s_waitcnt lgkmcnt(3)
    v_mfma_f32_16x16x32_bf16 v[48:51], v[100:103], v[56:59], v[48:51]
    s_waitcnt lgkmcnt(2)
    v_mfma_f32_16x16x32_bf16 v[48:51], v[104:107], v[60:63], v[48:51]
    s_waitcnt lgkmcnt(1)
    v_mfma_f32_16x16x32_bf16 v[48:51], v[108:111], v[64:67], v[48:51]
    s_waitcnt lgkmcnt(0)
    v_mfma_f32_16x16x32_bf16 v[48:51], v[112:115], v[68:71], v[48:51]
    s_add_u32 m0, s40, 81920
    s_add_u32 s67, s38, 8192
    buffer_load_dwordx4 v3, s[8:11], s67 offen offset:0 sc1 lds
    buffer_load_dwordx4 v3, s[8:11], s67 offen offset:1024 sc1 lds
    buffer_load_dwordx4 v3, s[8:11], s67 offen offset:2048 sc1 lds
    buffer_load_dwordx4 v3, s[8:11], s67 offen offset:3072 sc1 lds
    s_add_u32 m0, s40, 98304
    s_add_u32 s67, s38, 12288
    buffer_load_dwordx4 v3, s[8:11], s67 offen offset:0 sc1 lds
    buffer_load_dwordx4 v3, s[8:11], s67 offen offset:1024 sc1 lds
    buffer_load_dwordx4 v3, s[8:11], s67 offen offset:2048 sc1 lds
    buffer_load_dwordx4 v3, s[8:11], s67 offen offset:3072 sc1 lds
    s_add_u32 m0, s40, 114688
    s_add_u32 s67, s38, 16384
    buffer_load_dwordx4 v3, s[8:11], s67 offen offset:0 sc1 lds
    buffer_load_dwordx4 v3, s[8:11], s67 offen offset:1024 sc1 lds
    buffer_load_dwordx4 v3, s[8:11], s67 offen offset:2048 sc1 lds
    buffer_load_dwordx4 v3, s[8:11], s67 offen offset:3072 sc1 lds
    s_add_u32 m0, s40, 131072
    s_add_u32 s67, s38, 20480
    buffer_load_dwordx4 v3, s[8:11], s67 offen offset:0 sc1 lds
    buffer_load_dwordx4 v3, s[8:11], s67 offen offset:1024 sc1 lds
    buffer_load_dwordx4 v3, s[8:11], s67 offen offset:2048 sc1 lds
    buffer_load_dwordx4 v3, s[8:11], s67 offen offset:3072 sc1 lds
    s_lshl_b32 s31, s16, 13
    s_add_u32 s31, s31, 53248
    s_add_u32 s68, s31, 4096
    s_barrier
    s_add_u32 m0, s30, zlit_b-zlit_a+(0)
    s_nop 0
    buffer_load_dwordx4 v3, s[8:11], s39 offen offset:0 sc1 lds
    buffer_load_dwordx4 v3, s[8:11], s39 offen offset:1024 sc1 lds
    buffer_load_dwordx4 v3, s[8:11], s39 offen offset:2048 sc1 lds
    buffer_load_dwordx4 v3, s[8:11], s39 offen offset:3072 sc1 lds
    s_add_u32 m0, s30, 4096
    s_add_u32 s67, s39, 4096
    s_add_u32 s39, s39, 20480
    buffer_load_dwordx4 v3, s[8:11], s67 offen sc1 lds
    buffer_load_dwordx4 v[56:59], v3, s[8:11], s31 offen offset:0 sc1
    buffer_load_dwordx4 v[60:63], v3, s[8:11], s31 offen offset:1024 sc1
    buffer_load_dwordx4 v[64:67], v3, s[8:11], s31 offen offset:2048 sc1
    buffer_load_dwordx4 v[68:71], v3, s[8:11], s31 offen offset:3072 sc1
    buffer_load_dwordx4 v[72:75], v3, s[8:11], s68 offen offset:0 sc1
    buffer_load_dwordx4 v[76:79], v3, s[8:11], s68 offen offset:1024 sc1
    buffer_load_dwordx4 v[80:83], v3, s[8:11], s68 offen offset:2048 sc1
    buffer_load_dwordx4 v[84:87], v3, s[8:11], s68 offen offset:3072 sc1
    s_add_u32 m0, s30, 20480
    s_nop 0
    buffer_load_dwordx4 v3, s[8:11], s39 offen offset:0 sc1 lds
    buffer_load_dwordx4 v3, s[8:11], s39 offen offset:1024 sc1 lds
    buffer_load_dwordx4 v3, s[8:11], s39 offen offset:2048 sc1 lds
    buffer_load_dwordx4 v3, s[8:11], s39 offen offset:3072 sc1 lds
    s_add_u32 m0, s30, 24576
    s_add_u32 s67, s39, 4096
    s_add_u32 s39, s39, 20480
    buffer_load_dwordx4 v3, s[8:11], s67 offen sc1 lds
    s_add_u32 m0, s30, 40960
    s_nop 0
    buffer_load_dwordx4 v3, s[8:11], s39 offen offset:0 sc1 lds
    buffer_load_dwordx4 v3, s[8:11], s39 offen offset:1024 sc1 lds
    buffer_load_dwordx4 v3, s[8:11], s39 offen offset:2048 sc1 lds
    buffer_load_dwordx4 v3, s[8:11], s39 offen offset:3072 sc1 lds
    s_add_u32 m0, s30, 45056
    s_add_u32 s67, s39, 4096
    s_add_u32 s39, s39, 20480
    buffer_load_dwordx4 v3, s[8:11], s67 offen sc1 lds
    s_add_u32 m0, s30, 61440
    s_nop 0
    buffer_load_dwordx4 v3, s[8:11], s39 offen offset:0 sc1 lds
    buffer_load_dwordx4 v3, s[8:11], s39 offen offset:1024 sc1 lds
    buffer_load_dwordx4 v3, s[8:11], s39 offen offset:2048 sc1 lds
    buffer_load_dwordx4 v3, s[8:11], s39 offen offset:3072 sc1 lds
    s_add_u32 m0, s30, 65536
    s_add_u32 s67, s39, 4096
    s_add_u32 s39, s39, 20480
    buffer_load_dwordx4 v3, s[8:11], s67 offen sc1 lds
    s_waitcnt vmcnt(23)
    s_barrier
    s_waitcnt vmcnt(10)
    s_barrier
    v_add_f32 v56, v56, v72
    v_add_f32 v57, v57, v73
    v_add_f32 v58, v58, v74
    v_add_f32 v59, v59, v75
    v_add_f32 v60, v60, v76
    v_add_f32 v61, v61, v77
    v_add_f32 v62, v62, v78
    v_add_f32 v63, v63, v79
    v_add_f32 v64, v64, v80
    v_add_f32 v65, v65, v81
    v_add_f32 v66, v66, v82
    v_add_f32 v67, v67, v83
    v_add_f32 v68, v68, v84
    v_add_f32 v69, v69, v85
    v_add_f32 v70, v70, v86
    v_add_f32 v71, v71, v87
    v_add_f32 v56, v56, v64
    v_add_f32 v57, v57, v65
    v_add_f32 v58, v58, v66
    v_add_f32 v59, v59, v67
    v_add_f32 v60, v60, v68
    v_add_f32 v61, v61, v69
    v_add_f32 v62, v62, v70
    v_add_f32 v63, v63, v71
    v_add_f32 v56, v56, v60
    v_add_f32 v57, v57, v61
    v_add_f32 v58, v58, v62
    v_add_f32 v59, v59, v63
    v_and_b32 v60, 7, v2
    v_and_b32 v61, 8, v2
    v_cmp_ne_u32 vcc, 0, v61
    v_add_f32_dpp v56, v56, v56 row_ror:8 row_mask:0xf bank_mask:0xf
    v_add_f32_dpp v57, v57, v57 row_ror:8 row_mask:0xf bank_mask:0xf
    v_add_f32_dpp v58, v58, v58 row_ror:8 row_mask:0xf bank_mask:0xf
    v_add_f32_dpp v59, v59, v59 row_ror:8 row_mask:0xf bank_mask:0xf
    v_lshl_add_u32 v60, v60, 4, v61
    v_lshl_add_u32 v60, v6, 3, v60
    v_cndmask_b32 v56, v56, v58, vcc
    v_cndmask_b32 v57, v57, v59, vcc
    v_mul_f32 v56, 0x3acccccd, v56
    v_mul_f32 v57, 0x3acccccd, v57
    v_fma_f32 v57, -v56, v56, v57
    v_max_f32_e64 v57, 0, v57
    v_cvt_pk_bf16_f32 v57, v57, v56
    v_and_b32 v58, 0xffff0000, v57
    v_lshlrev_b32_e64 v57, 16, v57
    v_add_f32 v57, 0x3727c5ac, v57
    v_cvt_pk_bf16_f32 v57, v57, v57
    v_lshlrev_b32 v57, 16, v57
    v_sqrt_f32_e64 v57, v57
    s_nop 0
    v_cvt_pk_bf16_f32 v57, v57, v57
    v_lshlrev_b32 v57, 16, v57
    v_rcp_f32 v59, v57
    v_sub_f32_e64 v58, 0, v58
    v_add_u32 v60, 161792, v60
    ds_write_b64 v60, v[58:59]
    s_waitcnt lgkmcnt(0)
    s_waitcnt vmcnt(5)
    s_barrier
    s_waitcnt vmcnt(0)
    s_barrier
    v_mov_b32 v16, 162820
    s_mov_b32 s70, 0
kf_kernel_b_sphc01:
    ds_read_b32 v17, v16
    s_add_u32 s70, s70, zlit_b-zlit_a+(1)
    s_cmp_lt_u32 s70, 0x400000
    s_waitcnt lgkmcnt(0)
    v_cmp_ne_u32_e64 vcc, 3, v17
    s_cbranch_vccz kf_kernel_b_sqhc01
    s_sleep 1
    s_cbranch_scc1 kf_kernel_b_sphc01
kf_kernel_b_sqhc01:
    ds_read_b128 v[56:59], v3 offset:0
    ds_read_b128 v[60:63], v3 offset:2560
    ds_read_b128 v[64:67], v3 offset:5120
    ds_read_b128 v[68:71], v3 offset:7680
    ds_read_b128 v[72:75], v3 offset:1024
    ds_read_b128 v[76:79], v3 offset:3584
    ds_read_b128 v[80:83], v3 offset:6144
    ds_read_b128 v[84:87], v3 offset:8704
    ds_read_b128 v[88:91], v3 offset:10240
    ds_read_b128 v[92:95], v3 offset:12800
    s_waitcnt lgkmcnt(9)
    v_mfma_f32_16x16x32_bf16 v[16:19], v[240:243], v[56:59], 0
    ds_read_b128 v[56:59], v3 offset:15360
    s_waitcnt lgkmcnt(9)
    v_mfma_f32_16x16x32_bf16 v[20:23], v[240:243], v[60:63], 0
    ds_read_b128 v[60:63], v3 offset:17920
    s_waitcnt lgkmcnt(9)
    v_mfma_f32_16x16x32_bf16 v[24:27], v[240:243], v[64:67], 0
    ds_read_b128 v[64:67], v3 offset:11264
    s_waitcnt lgkmcnt(9)
    v_mfma_f32_16x16x32_bf16 v[28:31], v[240:243], v[68:71], 0
    ds_read_b128 v[68:71], v3 offset:13824
    s_waitcnt lgkmcnt(9)
    v_mfma_f32_16x16x32_bf16 v[16:19], v[244:247], v[72:75], v[16:19]
    ds_read_b128 v[72:75], v3 offset:16384
    s_add_u32 s67, s38, 61440
    buffer_load_dwordx4 v[240:243], v3, s[8:11], s67 offen offset:0 sc1
    s_waitcnt lgkmcnt(9)
    v_mfma_f32_16x16x32_bf16 v[20:23], v[244:247], v[76:79], v[20:23]
    ds_read_b128 v[76:79], v3 offset:18944
    s_waitcnt lgkmcnt(9)
    v_mfma_f32_16x16x32_bf16 v[24:27], v[244:247], v[80:83], v[24:27]
    ds_read_b64 v[80:81], v9 offset:2048
    ds_read_b64 v[82:83], v9 offset:12288
    s_waitcnt lgkmcnt(10)
    v_mfma_f32_16x16x32_bf16 v[28:31], v[244:247], v[84:87], v[28:31]
    ds_read_b64 v[84:85], v9 offset:4608
    ds_read_b64 v[86:87], v9 offset:14848
    s_waitcnt lgkmcnt(11)
    v_mfma_f32_16x16x32_bf16 v[16:19], v[248:251], v[88:91], v[16:19]
    ds_read_b64 v[88:89], v9 offset:7168
    ds_read_b64 v[90:91], v9 offset:17408
    s_add_u32 s67, s38, 61440
    buffer_load_dwordx4 v[244:247], v3, s[8:11], s67 offen offset:1024 sc1
    s_waitcnt lgkmcnt(12)
    v_mfma_f32_16x16x32_bf16 v[20:23], v[248:251], v[92:95], v[20:23]
    ds_read_b64 v[92:93], v9 offset:9728
    ds_read_b64 v[94:95], v9 offset:19968
    s_waitcnt lgkmcnt(13)
    v_mfma_f32_16x16x32_bf16 v[24:27], v[248:251], v[56:59], v[24:27]
    ds_read_b128 v[56:59], v3 offset:20480
    s_waitcnt lgkmcnt(13)
    v_mfma_f32_16x16x32_bf16 v[28:31], v[248:251], v[60:63], v[28:31]
    ds_read_b128 v[60:63], v3 offset:23040
    s_waitcnt lgkmcnt(13)
    v_mfma_f32_16x16x32_bf16 v[16:19], v[252:255], v[64:67], v[16:19]
    ds_read_b128 v[64:67], v3 offset:25600
    s_add_u32 s67, s38, 61440
    buffer_load_dwordx4 v[248:251], v3, s[8:11], s67 offen offset:2048 sc1
    s_waitcnt lgkmcnt(13)
    v_mfma_f32_16x16x32_bf16 v[20:23], v[252:255], v[68:71], v[20:23]
    ds_read_b128 v[68:71], v3 offset:28160
    s_waitcnt lgkmcnt(13)
    v_mfma_f32_16x16x32_bf16 v[24:27], v[252:255], v[72:75], v[24:27]
    ds_read_b128 v[72:75], v3 offset:21504
    s_waitcnt lgkmcnt(13)
    v_mfma_f32_16x16x32_bf16 v[28:31], v[252:255], v[76:79], v[28:31]
    ds_read_b128 v[76:79], v3 offset:24064
    s_waitcnt lgkmcnt(12)
    v_mfma_f32_16x16x32_bf16 v[16:19], v[116:119], v[80:83], v[16:19]
    ds_read_b128 v[80:83], v3 offset:26624
    s_add_u32 s67, s38, 61440
    buffer_load_dwordx4 v[252:255], v3, s[8:11], s67 offen offset:3072 sc1
    s_waitcnt lgkmcnt(11)
    v_mfma_f32_16x16x32_bf16 v[20:23], v[116:119], v[84:87], v[20:23]
    ds_read_b128 v[84:87], v3 offset:29184
    s_waitcnt lgkmcnt(10)
    v_mfma_f32_16x16x32_bf16 v[24:27], v[116:119], v[88:91], v[24:27]
    ds_read_b128 v[88:91], v3 offset:30720
    s_waitcnt lgkmcnt(9)
    v_mfma_f32_16x16x32_bf16 v[28:31], v[116:119], v[92:95], v[28:31]
    ds_read_b128 v[92:95], v3 offset:33280
    s_waitcnt lgkmcnt(9)
    v_mfma_f32_16x16x32_bf16 v[16:19], v[120:123], v[56:59], v[16:19]
    ds_read_b128 v[56:59], v3 offset:35840
    s_waitcnt lgkmcnt(9)
    v_mfma_f32_16x16x32_bf16 v[20:23], v[120:123], v[60:63], v[20:23]
    ds_read_b128 v[60:63], v3 offset:38400
    s_waitcnt lgkmcnt(9)
    v_mfma_f32_16x16x32_bf16 v[24:27], v[120:123], v[64:67], v[24:27]
    ds_read_b128 v[64:67], v3 offset:31744
    s_waitcnt lgkmcnt(9)
    v_mfma_f32_16x16x32_bf16 v[28:31], v[120:123], v[68:71], v[28:31]
    ds_read_b128 v[68:71], v3 offset:34304
    s_waitcnt lgkmcnt(9)
    v_mfma_f32_16x16x32_bf16 v[16:19], v[124:127], v[72:75], v[16:19]
    ds_read_b128 v[72:75], v3 offset:36864
    s_waitcnt lgkmcnt(9)
    v_mfma_f32_16x16x32_bf16 v[20:23], v[124:127], v[76:79], v[20:23]
    ds_read_b128 v[76:79], v3 offset:39424
    s_waitcnt lgkmcnt(9)
    v_mfma_f32_16x16x32_bf16 v[24:27], v[124:127], v[80:83], v[24:27]
    ds_read_b64 v[80:81], v9 offset:22528
    ds_read_b64 v[82:83], v9 offset:32768
    s_waitcnt lgkmcnt(10)
    v_mfma_f32_16x16x32_bf16 v[28:31], v[124:127], v[84:87], v[28:31]
    ds_read_b64 v[84:85], v9 offset:25088
    ds_read_b64 v[86:87], v9 offset:35328
    s_waitcnt lgkmcnt(11)
    v_mfma_f32_16x16x32_bf16 v[16:19], v[128:131], v[88:91], v[16:19]
    ds_read_b64 v[88:89], v9 offset:27648
    ds_read_b64 v[90:91], v9 offset:37888
    s_waitcnt lgkmcnt(12)
    v_mfma_f32_16x16x32_bf16 v[20:23], v[128:131], v[92:95], v[20:23]
    ds_read_b64 v[92:93], v9 offset:30208
    ds_read_b64 v[94:95], v9 offset:40448
    s_waitcnt lgkmcnt(13)
    v_mfma_f32_16x16x32_bf16 v[24:27], v[128:131], v[56:59], v[24:27]
    ds_read_b128 v[56:59], v8 offset:0
    s_waitcnt lgkmcnt(13)
    v_mfma_f32_16x16x32_bf16 v[28:31], v[128:131], v[60:63], v[28:31]
    ds_read_b128 v[60:63], v8 offset:2560
    s_waitcnt lgkmcnt(13)
    v_mfma_f32_16x16x32_bf16 v[16:19], v[140:143], v[64:67], v[16:19]
    ds_read_b128 v[64:67], v8 offset:5120
    s_waitcnt lgkmcnt(13)
    v_mfma_f32_16x16x32_bf16 v[20:23], v[140:143], v[68:71], v[20:23]
    ds_read_b128 v[68:71], v8 offset:7680
    s_waitcnt lgkmcnt(13)
    v_mfma_f32_16x16x32_bf16 v[24:27], v[140:143], v[72:75], v[24:27]
    ds_read_b128 v[72:75], v8 offset:1024
    s_waitcnt lgkmcnt(13)
    v_mfma_f32_16x16x32_bf16 v[28:31], v[140:143], v[76:79], v[28:31]
    ds_read_b128 v[76:79], v8 offset:3584
    s_waitcnt lgkmcnt(12)
    v_mfma_f32_16x16x32_bf16 v[16:19], v[144:147], v[80:83], v[16:19]
    ds_read_b128 v[80:83], v8 offset:6144
    s_waitcnt lgkmcnt(11)
    v_mfma_f32_16x16x32_bf16 v[20:23], v[144:147], v[84:87], v[20:23]
    ds_read_b128 v[84:87], v8 offset:8704
    s_waitcnt lgkmcnt(10)
    v_mfma_f32_16x16x32_bf16 v[24:27], v[144:147], v[88:91], v[24:27]
    ds_read_b128 v[88:91], v8 offset:10240
    s_waitcnt lgkmcnt(9)
    v_mfma_f32_16x16x32_bf16 v[28:31], v[144:147], v[92:95], v[28:31]
    ds_read_b128 v[92:95], v8 offset:12800
    s_waitcnt lgkmcnt(9)
    v_mfma_f32_16x16x32_bf16 v[16:19], v[148:151], v[56:59], v[16:19]
    ds_read_b128 v[56:59], v8 offset:15360
    s_add_u32 s67, s38, 0
    buffer_load_dwordx4 v[144:147], v3, s[8:11], s67 offen offset:0 sc1
    s_waitcnt lgkmcnt(9)
    v_mfma_f32_16x16x32_bf16 v[20:23], v[148:151], v[60:63], v[20:23]
    ds_read_b128 v[60:63], v8 offset:17920
    s_waitcnt lgkmcnt(9)
    v_mfma_f32_16x16x32_bf16 v[24:27], v[148:151], v[64:67], v[24:27]
    ds_read_b128 v[64:67], v8 offset:11264
    s_waitcnt lgkmcnt(9)
    v_mfma_f32_16x16x32_bf16 v[28:31], v[148:151], v[68:71], v[28:31]
    ds_read_b128 v[68:71], v8 offset:13824
    s_waitcnt lgkmcnt(9)
    v_mfma_f32_16x16x32_bf16 v[16:19], v[152:155], v[72:75], v[16:19]
    ds_read_b128 v[72:75], v8 offset:16384
    s_add_u32 s67, s38, zlit_b-zlit_a+(0)
    buffer_load_dwordx4 v[148:151], v3, s[8:11], s67 offen offset:1024 sc1
    s_waitcnt lgkmcnt(9)
    v_mfma_f32_16x16x32_bf16 v[20:23], v[152:155], v[76:79], v[20:23]
    ds_read_b128 v[76:79], v8 offset:18944
    s_waitcnt lgkmcnt(9)
    v_mfma_f32_16x16x32_bf16 v[24:27], v[152:155], v[80:83], v[24:27]
    ds_read_b64 v[80:81], v4 offset:2048
    ds_read_b64 v[82:83], v4 offset:12288
    s_waitcnt lgkmcnt(10)
    v_mfma_f32_16x16x32_bf16 v[28:31], v[152:155], v[84:87], v[28:31]
    ds_read_b64 v[84:85], v4 offset:4608
    ds_read_b64 v[86:87], v4 offset:14848
    s_waitcnt lgkmcnt(11)
    v_mfma_f32_16x16x32_bf16 v[16:19], v[132:135], v[88:91], v[16:19]
    ds_read_b64 v[88:89], v4 offset:7168
    ds_read_b64 v[90:91], v4 offset:17408
    s_add_u32 s67, s38, zlit_b-zlit_a+(0)
    buffer_load_dwordx4 v[152:155], v3, s[8:11], s67 offen offset:2048 sc1
    s_waitcnt lgkmcnt(12)
    v_mfma_f32_16x16x32_bf16 v[20:23], v[132:135], v[92:95], v[20:23]
    ds_read_b64 v[92:93], v4 offset:9728
    ds_read_b64 v[94:95], v4 offset:19968
    s_waitcnt lgkmcnt(13)
    v_mfma_f32_16x16x32_bf16 v[24:27], v[132:135], v[56:59], v[24:27]
    ds_read_b128 v[56:59], v8 offset:20480
    s_waitcnt lgkmcnt(13)
    v_mfma_f32_16x16x32_bf16 v[28:31], v[132:135], v[60:63], v[28:31]
    ds_read_b128 v[60:63], v8 offset:23040
    s_waitcnt lgkmcnt(13)
    v_mfma_f32_16x16x32_bf16 v[16:19], v[136:139], v[64:67], v[16:19]
    ds_read_b128 v[64:67], v8 offset:25600
    s_waitcnt lgkmcnt(13)
    v_mfma_f32_16x16x32_bf16 v[20:23], v[136:139], v[68:71], v[20:23]
    ds_read_b128 v[68:71], v8 offset:28160
    s_waitcnt lgkmcnt(13)
    v_mfma_f32_16x16x32_bf16 v[24:27], v[136:139], v[72:75], v[24:27]
    ds_read_b128 v[72:75], v8 offset:21504
    s_waitcnt lgkmcnt(13)
    v_mfma_f32_16x16x32_bf16 v[28:31], v[136:139], v[76:79], v[28:31]
    ds_read_b128 v[76:79], v8 offset:24064
    s_waitcnt lgkmcnt(12)
    v_mfma_f32_16x16x32_bf16 v[16:19], v[156:159], v[80:83], v[16:19]
    ds_read_b128 v[80:83], v8 offset:26624
    s_waitcnt lgkmcnt(11)
    v_mfma_f32_16x16x32_bf16 v[20:23], v[156:159], v[84:87], v[20:23]
    ds_read_b128 v[84:87], v8 offset:29184
    s_waitcnt lgkmcnt(10)
    v_mfma_f32_16x16x32_bf16 v[24:27], v[156:159], v[88:91], v[24:27]
    ds_read_b128 v[88:91], v8 offset:30720
    s_waitcnt lgkmcnt(9)
    v_mfma_f32_16x16x32_bf16 v[28:31], v[156:159], v[92:95], v[28:31]
    ds_read_b128 v[92:95], v8 offset:33280
    s_waitcnt lgkmcnt(9)
    v_mfma_f32_16x16x32_bf16 v[16:19], v[96:99], v[56:59], v[16:19]
    ds_read_b128 v[56:59], v8 offset:35840
    s_add_u32 s67, s38, zlit_b-zlit_a+(0)
    buffer_load_dwordx4 v[156:159], v3, s[8:11], s67 offen offset:3072 sc1
    s_waitcnt lgkmcnt(9)
    v_mfma_f32_16x16x32_bf16 v[20:23], v[96:99], v[60:63], v[20:23]
    ds_read_b128 v[60:63], v8 offset:38400
    s_waitcnt lgkmcnt(9)
    v_mfma_f32_16x16x32_bf16 v[24:27], v[96:99], v[64:67], v[24:27]
    ds_read_b128 v[64:67], v8 offset:31744
    s_waitcnt lgkmcnt(9)
    v_mfma_f32_16x16x32_bf16 v[28:31], v[96:99], v[68:71], v[28:31]
    ds_read_b128 v[68:71], v8 offset:34304
    s_waitcnt lgkmcnt(9)
    v_mfma_f32_16x16x32_bf16 v[16:19], v[100:103], v[72:75], v[16:19]
    ds_read_b128 v[72:75], v8 offset:36864
    s_waitcnt lgkmcnt(9)
    v_mfma_f32_16x16x32_bf16 v[20:23], v[100:103], v[76:79], v[20:23]
    ds_read_b128 v[76:79], v8 offset:39424
    s_waitcnt lgkmcnt(9)
    v_mfma_f32_16x16x32_bf16 v[24:27], v[100:103], v[80:83], v[24:27]
    ds_read_b64 v[80:81], v4 offset:22528
    ds_read_b64 v[82:83], v4 offset:32768
    s_waitcnt lgkmcnt(10)
    v_mfma_f32_16x16x32_bf16 v[28:31], v[100:103], v[84:87], v[28:31]
    ds_read_b64 v[84:85], v4 offset:25088
    ds_read_b64 v[86:87], v4 offset:35328
    s_waitcnt lgkmcnt(11)
    v_mfma_f32_16x16x32_bf16 v[16:19], v[104:107], v[88:91], v[16:19]
    ds_read_b64 v[88:89], v4 offset:27648
    ds_read_b64 v[90:91], v4 offset:37888
    s_waitcnt lgkmcnt(12)
    v_mfma_f32_16x16x32_bf16 v[20:23], v[104:107], v[92:95], v[20:23]
    ds_read_b64 v[92:93], v4 offset:30208
    ds_read_b64 v[94:95], v4 offset:40448
    s_waitcnt lgkmcnt(13)
    v_mfma_f32_16x16x32_bf16 v[24:27], v[104:107], v[56:59], v[24:27]
    s_waitcnt lgkmcnt(12)
    v_mfma_f32_16x16x32_bf16 v[28:31], v[104:107], v[60:63], v[28:31]
    s_waitcnt lgkmcnt(11)
    v_mfma_f32_16x16x32_bf16 v[16:19], v[108:111], v[64:67], v[16:19]
    s_waitcnt lgkmcnt(10)
    v_mfma_f32_16x16x32_bf16 v[20:23], v[108:111], v[68:71], v[20:23]
    s_waitcnt lgkmcnt(9)
    v_mfma_f32_16x16x32_bf16 v[24:27], v[108:111], v[72:75], v[24:27]
    s_waitcnt lgkmcnt(8)
    v_mfma_f32_16x16x32_bf16 v[28:31], v[108:111], v[76:79], v[28:31]
    s_waitcnt lgkmcnt(6)
    v_mfma_f32_16x16x32_bf16 v[16:19], v[112:115], v[80:83], v[16:19]
    s_waitcnt lgkmcnt(4)
    v_mfma_f32_16x16x32_bf16 v[20:23], v[112:115], v[84:87], v[20:23]
    s_waitcnt lgkmcnt(2)
    v_mfma_f32_16x16x32_bf16 v[24:27], v[112:115], v[88:91], v[24:27]
    s_waitcnt lgkmcnt(0)
    v_mfma_f32_16x16x32_bf16 v[28:31], v[112:115], v[92:95], v[28:31]
    v_mov_b32 v88, 162816
    v_mov_b32_e64 v89, 1
    s_mov_b64 exec, 1
    ds_add_u32 v88, v89
    s_mov_b64 exec, -1
    v_add_u32 v0, 161792, v7
    ds_read_b64 v[80:81], v0 offset:0
    ds_read_b64 v[82:83], v0 offset:128
    ds_read_b64 v[84:85], v0 offset:256
    ds_read_b64 v[86:87], v0 offset:384
    v_mov_b32_dpp v56, v48 quad_perm:[1,1,3,3] row_mask:0xf bank_mask:0xf
    v_mov_b32_dpp v57, v49 quad_perm:[1,1,3,3] row_mask:0xf bank_mask:0xf
    v_mov_b32_dpp v58, v50 quad_perm:[1,1,3,3] row_mask:0xf bank_mask:0xf
    v_mov_b32_dpp v59, v51 quad_perm:[1,1,3,3] row_mask:0xf bank_mask:0xf
    v_mov_b32_dpp v48, v48 quad_perm:[0,0,2,2] row_mask:0xf bank_mask:0xf
    v_mov_b32_dpp v49, v49 quad_perm:[0,0,2,2] row_mask:0xf bank_mask:0xf
    v_mov_b32_dpp v50, v50 quad_perm:[0,0,2,2] row_mask:0xf bank_mask:0xf
    v_mov_b32_dpp v51, v51 quad_perm:[0,0,2,2] row_mask:0xf bank_mask:0xf
    s_waitcnt lgkmcnt(0)
    v_pk_fma_f32 v[16:17], v[48:49], v[80:81], v[16:17] op_sel:[0,0,0] op_sel_hi:[1,0,1]
    v_pk_fma_f32 v[18:19], v[50:51], v[80:81], v[18:19] op_sel:[0,0,0] op_sel_hi:[1,0,1]
    v_pk_fma_f32 v[16:17], v[80:81], v[16:17], v[56:57] op_sel:[1,0,0] op_sel_hi:[1,1,1]
    v_pk_fma_f32 v[18:19], v[80:81], v[18:19], v[58:59] op_sel:[1,0,0] op_sel_hi:[1,1,1]
    v_pk_mul_f32 v[88:89], v[16:17], v[16:17]
    v_pk_mul_f32 v[90:91], v[18:19], v[18:19]
    v_pk_fma_f32 v[88:89], v[88:89], s[34:35], s[34:35] op_sel:[0,0,1] op_sel_hi:[1,0,1]
    v_pk_fma_f32 v[90:91], v[90:91], s[34:35], s[34:35] op_sel:[0,0,1] op_sel_hi:[1,0,1]
    v_pk_mul_f32 v[88:89], v[88:89], v[16:17]
    v_pk_mul_f32 v[90:91], v[90:91], v[18:19]
    v_exp_f32 v88, v88
    v_exp_f32 v89, v89
    v_exp_f32 v90, v90
    v_exp_f32 v91, v91
    v_pk_add_f32 v[88:89], v[88:89], s[36:37]
    v_pk_add_f32 v[90:91], v[90:91], s[36:37]
    v_rcp_f32 v88, v88
    v_rcp_f32 v89, v89
    v_rcp_f32 v90, v90
    v_rcp_f32 v91, v91
    v_pk_mul_f32 v[16:17], v[16:17], v[88:89]
    v_pk_mul_f32 v[18:19], v[18:19], v[90:91]
    v_cvt_pk_bf16_f32 v64, v16, v17
    v_cvt_pk_bf16_f32 v65, v18, v19
    v_pk_fma_f32 v[20:21], v[48:49], v[82:83], v[20:21] op_sel:[0,0,0] op_sel_hi:[1,0,1]
    v_pk_fma_f32 v[22:23], v[50:51], v[82:83], v[22:23] op_sel:[0,0,0] op_sel_hi:[1,0,1]
    v_pk_fma_f32 v[20:21], v[82:83], v[20:21], v[56:57] op_sel:[1,0,0] op_sel_hi:[1,1,1]
    v_pk_fma_f32 v[22:23], v[82:83], v[22:23], v[58:59] op_sel:[1,0,0] op_sel_hi:[1,1,1]
    v_pk_mul_f32 v[92:93], v[20:21], v[20:21]
    v_pk_mul_f32 v[94:95], v[22:23], v[22:23]
    v_pk_fma_f32 v[92:93], v[92:93], s[34:35], s[34:35] op_sel:[0,0,1] op_sel_hi:[1,0,1]
    v_pk_fma_f32 v[94:95], v[94:95], s[34:35], s[34:35] op_sel:[0,0,1] op_sel_hi:[1,0,1]
    v_pk_mul_f32 v[92:93], v[92:93], v[20:21]
    v_pk_mul_f32 v[94:95], v[94:95], v[22:23]
    v_exp_f32 v92, v92
    v_exp_f32 v93, v93
    v_exp_f32 v94, v94
    v_exp_f32 v95, v95
    v_pk_add_f32 v[92:93], v[92:93], s[36:37]
    v_pk_add_f32 v[94:95], v[94:95], s[36:37]
    v_rcp_f32 v92, v92
    v_rcp_f32 v93, v93
    v_rcp_f32 v94, v94
    v_rcp_f32 v95, v95
    v_pk_mul_f32 v[20:21], v[20:21], v[92:93]
    v_pk_mul_f32 v[22:23], v[22:23], v[94:95]
    v_cvt_pk_bf16_f32 v66, v20, v21
    v_cvt_pk_bf16_f32 v67, v22, v23
    v_pk_fma_f32 v[24:25], v[48:49], v[84:85], v[24:25] op_sel:[0,0,0] op_sel_hi:[1,0,1]
    v_pk_fma_f32 v[26:27], v[50:51], v[84:85], v[26:27] op_sel:[0,0,0] op_sel_hi:[1,0,1]
    v_pk_fma_f32 v[24:25], v[84:85], v[24:25], v[56:57] op_sel:[1,0,0] op_sel_hi:[1,1,1]
    v_pk_fma_f32 v[26:27], v[84:85], v[26:27], v[58:59] op_sel:[1,0,0] op_sel_hi:[1,1,1]
    v_pk_mul_f32 v[88:89], v[24:25], v[24:25]
    v_pk_mul_f32 v[90:91], v[26:27], v[26:27]
    v_pk_fma_f32 v[88:89], v[88:89], s[34:35], s[34:35] op_sel:[0,0,1] op_sel_hi:[1,0,1]
    v_pk_fma_f32 v[90:91], v[90:91], s[34:35], s[34:35] op_sel:[0,0,1] op_sel_hi:[1,0,1]
    v_pk_mul_f32 v[88:89], v[88:89], v[24:25]
    v_pk_mul_f32 v[90:91], v[90:91], v[26:27]
    v_exp_f32 v88, v88
    v_exp_f32 v89, v89
    v_exp_f32 v90, v90
    v_exp_f32 v91, v91
    v_pk_add_f32 v[88:89], v[88:89], s[36:37]
    v_pk_add_f32 v[90:91], v[90:91], s[36:37]
    v_rcp_f32 v88, v88
    v_rcp_f32 v89, v89
    v_rcp_f32 v90, v90
    v_rcp_f32 v91, v91
    v_pk_mul_f32 v[24:25], v[24:25], v[88:89]
    v_pk_mul_f32 v[26:27], v[26:27], v[90:91]
    v_cvt_pk_bf16_f32 v68, v24, v25
    v_cvt_pk_bf16_f32 v69, v26, v27
    v_pk_fma_f32 v[28:29], v[48:49], v[86:87], v[28:29] op_sel:[0,0,0] op_sel_hi:[1,0,1]
    v_pk_fma_f32 v[30:31], v[50:51], v[86:87], v[30:31] op_sel:[0,0,0] op_sel_hi:[1,0,1]
    v_pk_fma_f32 v[28:29], v[86:87], v[28:29], v[56:57] op_sel:[1,0,0] op_sel_hi:[1,1,1]
    v_pk_fma_f32 v[30:31], v[86:87], v[30:31], v[58:59] op_sel:[1,0,0] op_sel_hi:[1,1,1]
    v_pk_mul_f32 v[92:93], v[28:29], v[28:29]
    v_pk_mul_f32 v[94:95], v[30:31], v[30:31]
    v_pk_fma_f32 v[92:93], v[92:93], s[34:35], s[34:35] op_sel:[0,0,1] op_sel_hi:[1,0,1]
    v_pk_fma_f32 v[94:95], v[94:95], s[34:35], s[34:35] op_sel:[0,0,1] op_sel_hi:[1,0,1]
    v_pk_mul_f32 v[92:93], v[92:93], v[28:29]
    v_pk_mul_f32 v[94:95], v[94:95], v[30:31]
    v_exp_f32 v92, v92
    v_exp_f32 v93, v93
    v_exp_f32 v94, v94
    v_exp_f32 v95, v95
    v_pk_add_f32 v[92:93], v[92:93], s[36:37]
    v_pk_add_f32 v[94:95], v[94:95], s[36:37]
    v_rcp_f32 v92, v92
    v_rcp_f32 v93, v93
    v_rcp_f32 v94, v94
    v_rcp_f32 v95, v95
    v_pk_mul_f32 v[28:29], v[28:29], v[92:93]
    v_pk_mul_f32 v[30:31], v[30:31], v[94:95]
    v_cvt_pk_bf16_f32 v70, v28, v29
    v_cvt_pk_bf16_f32 v71, v30, v31
    v_mov_b32 v88, 162816
    s_mov_b32 s70, zlit_b-zlit_a+(0)
kf_kernel_b_spxc01:
    ds_read_b32 v89, v88
    s_add_u32 s70, s70, zlit_b-zlit_a+(1)
    s_cmp_lt_u32 s70, 0x400000
    s_waitcnt lgkmcnt(0)
    v_cmp_ne_u32 vcc, 8, v89
    s_cbranch_vccz kf_kernel_b_sqxc01
    s_sleep 1
    s_cbranch_scc1 kf_kernel_b_spxc01
kf_kernel_b_sqxc01:
    s_add_u32 m0, s40, 0
    s_add_u32 s67, s38, 24576
    buffer_load_dwordx4 v3, s[8:11], s67 offen offset:0 sc1 lds
    buffer_load_dwordx4 v3, s[8:11], s67 offen offset:1024 sc1 lds
    buffer_load_dwordx4 v3, s[8:11], s67 offen offset:2048 sc1 lds
    buffer_load_dwordx4 v3, s[8:11], s67 offen offset:3072 sc1 lds
    s_add_u32 m0, s40, 16384
    s_add_u32 s67, s38, 28672
    buffer_load_dwordx4 v3, s[8:11], s67 offen offset:0 sc1 lds
    buffer_load_dwordx4 v3, s[8:11], s67 offen offset:1024 sc1 lds
    buffer_load_dwordx4 v3, s[8:11], s67 offen offset:2048 sc1 lds
    buffer_load_dwordx4 v3, s[8:11], s67 offen offset:3072 sc1 lds
    s_add_u32 m0, s40, 32768
    s_add_u32 s67, s38, 32768
    buffer_load_dwordx4 v3, s[8:11], s67 offen offset:0 sc1 lds
    buffer_load_dwordx4 v3, s[8:11], s67 offen offset:1024 sc1 lds
    buffer_load_dwordx4 v3, s[8:11], s67 offen offset:2048 sc1 lds
    buffer_load_dwordx4 v3, s[8:11], s67 offen offset:3072 sc1 lds
    s_add_u32 m0, s40, 49152
    s_add_u32 s67, s38, 36864
    buffer_load_dwordx4 v3, s[8:11], s67 offen offset:0 sc1 lds
    buffer_load_dwordx4 v3, s[8:11], s67 offen offset:1024 sc1 lds
    buffer_load_dwordx4 v3, s[8:11], s67 offen offset:2048 sc1 lds
    buffer_load_dwordx4 v3, s[8:11], s67 offen offset:3072 sc1 lds
    s_add_u32 m0, s40, 65536
    s_add_u32 s67, s38, 40960
    buffer_load_dwordx4 v3, s[8:11], s67 offen offset:0 sc1 lds
    buffer_load_dwordx4 v3, s[8:11], s67 offen offset:1024 sc1 lds
    buffer_load_dwordx4 v3, s[8:11], s67 offen offset:2048 sc1 lds
    buffer_load_dwordx4 v3, s[8:11], s67 offen offset:3072 sc1 lds
    s_waitcnt vmcnt(56)
    s_barrier
    s_branch kf_kernel_b_d1
kf_kernel_b_ac1:
    s_mov_b32 s101, 0
kf_kernel_b_ac3:
    buffer_load_dwordx4 v[160:163], v3, s[8:11], s63 offen sc1
    s_add_u32 s101, s101, zlit_b-zlit_a+(1)
    s_cmp_lt_u32 s101, 0x40000
    s_waitcnt vmcnt(0)
    v_xor_b32 v160, s100, v160
    v_bitop3_b32 v160, v160, v161, s100 bitop3:0xf6
    v_bitop3_b32 v160, v160, v162, s100 bitop3:0xf6
    v_bitop3_b32 v160, v160, v163, s100 bitop3:0xf6
    v_cmp_ne_u32_e64 vcc, 0, v160
    s_cbranch_vccz kf_kernel_b_ac2
    s_sleep 4
    s_cbranch_scc1 kf_kernel_b_ac3
    s_branch kf_kernel_b_ac2
kf_kernel_b_slow:
    v_mov_b32 v87, 0xff800000
    s_mov_b32 s69, zlit_b-zlit_a+(0)
    s_mov_b32 s72, s87
    s_mov_b32 s73, s88
kf_kernel_b_slow1:
    buffer_load_dwordx4 v[88:91], v3, s[8:11], s72 offen sc1
    buffer_load_dwordx2 v[96:97], v4, s[8:11], s73 offen sc1
    s_add_u32 s72, s72, 1024
    s_add_u32 s73, s73, 512
    s_waitcnt vmcnt(0)
    v_mfma_f32_32x32x16_bf16 v[32:47], v[88:91], v[12:15], 0
    v_mfma_f32_32x32x8bf16_1k v[32:47], v[96:97], v[10:11], v[32:47]
    s_nop 11
    v_max3_f32 v84, v32, v33, v34
    v_max3_f32 v85, v35, v36, v37
    v_max3_f32 v84, v84, v38, v39
    v_max3_f32 v85, v85, v40, v41
    v_max3_f32 v84, v84, v42, v43
    v_max3_f32 v85, v85, v44, v45
    v_max3_f32 v84, v84, v46, v47
    v_max3_f32 v87, v84, v85, v87
    s_add_u32 s69, s69, 1
    s_cmp_lt_u32 s69, 64
    s_cbranch_scc1 kf_kernel_b_slow1
    v_mov_b32 v85, v87
    v_mov_b32 v86, v87
    s_nop 1
    v_permlane32_swap_b32 v85, v86
    v_max_f32 v85, v85, v86
    v_sub_f32 v16, 0, v85
    v_mov_b32 v17, v16
    v_mov_b32 v18, v16
    v_mov_b32 v19, v16
    v_mov_b32 v20, v16
    v_mov_b32 v21, v16
    v_mov_b32 v22, v16
    v_mov_b32 v23, v16
    v_mov_b32 v24, v16
    v_mov_b32 v25, v16
    v_mov_b32 v26, v16
    v_mov_b32 v27, v16
    v_mov_b32 v28, v16
    v_mov_b32 v29, v16
    v_mov_b32 v30, v16
    v_mov_b32 v31, v16
    v_mov_b32 v64, 0
    v_mov_b32 v65, 0
    v_mov_b32 v66, 0
    v_mov_b32 v67, 0
    v_mov_b32 v68, 0
    v_mov_b32 v69, 0
    v_mov_b32 v70, 0
    v_mov_b32 v71, 0
    v_mov_b32 v72, 0
    v_mov_b32 v73, 0
    v_mov_b32 v74, 0
    v_mov_b32 v75, 0
    v_mov_b32 v76, 0
    v_mov_b32 v77, 0
    v_mov_b32 v78, 0
    v_mov_b32 v79, 0
    s_mov_b32 s69, 0
    s_mov_b32 s72, s87
    s_mov_b32 s73, s88
    s_mov_b32 s74, s89
kf_kernel_b_slow2:
    buffer_load_dwordx4 v[88:91], v3, s[8:11], s72 offen sc1
    buffer_load_dwordx2 v[96:97], v4, s[8:11], s73 offen sc1
    s_mov_b64 exec, s[78:79]
    buffer_load_dwordx4 v[100:103], v5, s[8:11], s74 offen sc1
    buffer_load_dwordx4 v[104:107], v5, s[8:11], s74 offen offset:640 sc1
    s_mov_b64 exec, -1
    s_add_u32 s72, s72, 1024
    s_add_u32 s73, s73, 512
    s_add_u32 s74, s74, 1280
    s_waitcnt vmcnt(0)
    v_mfma_f32_32x32x16_bf16 v[32:47], v[88:91], v[12:15], v[16:31]
    v_mfma_f32_32x32x8bf16_1k v[32:47], v[96:97], v[10:11], v[32:47]
    s_nop 11
    v_exp_f32 v32, v32
    v_exp_f32 v33, v33
    v_exp_f32 v34, v34
    v_exp_f32 v35, v35
    v_exp_f32 v36, v36
    v_exp_f32 v37, v37
    v_exp_f32 v38, v38
    v_exp_f32 v39, v39
    v_exp_f32 v40, v40
    v_exp_f32 v41, v41
    v_exp_f32 v42, v42
    v_exp_f32 v43, v43
    v_exp_f32 v44, v44
    v_exp_f32 v45, v45
    v_exp_f32 v46, v46
    v_exp_f32 v47, v47
    v_cvt_pk_bf16_f32 v80, v32, v33
    v_cvt_pk_bf16_f32 v81, v34, v35
    v_cvt_pk_bf16_f32 v82, v36, v37
    v_cvt_pk_bf16_f32 v83, v38, v39
    v_cvt_pk_bf16_f32 v84, v40, v41
    v_cvt_pk_bf16_f32 v85, v42, v43
    v_cvt_pk_bf16_f32 v86, v44, v45
    v_cvt_pk_bf16_f32 v87, v46, v47
    v_mfma_f32_32x32x16_bf16 v[64:79], v[100:103], v[80:83], v[64:79]
    s_nop 0
    v_mfma_f32_32x32x16_bf16 v[64:79], v[104:107], v[84:87], v[64:79]
    s_add_u32 s69, s69, 1
    s_cmp_lt_u32 s69, 64
    s_cbranch_scc1 kf_kernel_b_slow2
    s_nop 7
    s_branch kf_kernel_b_fin
kf_kernel_codeend:
zlit_a:
zlit_b:
.section .rodata,"a"
.p2align 6
.amdhsa_kernel kf_kernel
  .amdhsa_next_free_vgpr 256
  .amdhsa_next_free_sgpr 102
  .amdhsa_accum_offset 256
  .amdhsa_group_segment_fixed_size 0
  .amdhsa_kernarg_size 104
  .amdhsa_user_sgpr_count 2
  .amdhsa_user_sgpr_kernarg_segment_ptr 1
  .amdhsa_system_sgpr_workgroup_id_x 1
.end_amdhsa_kernel
```
